```python
import torch

def _softmax(x, axis=-1):
    return torch.softmax(x, dim=axis)

def _gelu(x):
    return torch.nn.functional.gelu(x, approximate='tanh')

def _silu(x):
    return torch.nn.functional.silu(x)

def _sigmoid(x):
    return torch.sigmoid(x)

def _layernorm(x, axis=-1, eps=1e-05):
    m = x.mean(dim=axis, keepdim=True)
    v = x.var(dim=axis, keepdim=True, unbiased=False)
    return (x - m) / torch.sqrt(v + eps)

def _scatter_add(tgt, idx, src, axis=0):
    return tgt.clone().index_add_(axis, idx, src)

def _segment_sum(src, seg, n):
    out = torch.zeros((n,) + src.shape[1:], dtype=src.dtype)
    return out.index_add_(0, seg, src)

def _pad(x, pw):
    flat = tuple((v for pair in reversed(pw) for v in pair))
    return torch.nn.functional.pad(x, flat)
kernel_name = 'adaLN_cond__mha_block_cached__moe_arch_mod__prompt'

def setup_inputs():

    _w = lambda a: (lambda t: t.to(torch.bfloat16) if t.is_floating_point() else t)(torch.as_tensor(a))

    def _A_setup():
        B, Sq, D = (1, 2048, 448)
        H, Sk, Dh = (16, 2048, 256)
        return {'x': _w((lambda *s: torch.randn(*s, dtype=torch.bfloat16) * 0.05)(B, Sq, D)), 'k_cache': _w((lambda *s: torch.randn(*s, dtype=torch.bfloat16) * 3.2)(B, H, Sk, Dh)), 'v_cache': _w((lambda *s: torch.randn(*s, dtype=torch.bfloat16) * 0.4)(B, H, Sk, Dh)), 'wq': _w((lambda *s: torch.randn(*s, dtype=torch.bfloat16) * 3.2)(D, H * Dh) * D ** (-0.5)), 'wo': _w((lambda *s: torch.randn(*s, dtype=torch.bfloat16) * 0.4)(H * Dh, D) * (H * Dh) ** (-0.5))}
    _A_in = _A_setup()

    def _B_setup():
        B, S, D, F, C = (1, 2048, 448, 1792, 1)
        return {'x': _w((lambda *s: torch.randn(*s, dtype=torch.bfloat16) * 0.05)(B, S, D)), 'w_r': _w((lambda *s: torch.randn(*s, dtype=torch.bfloat16) * 3.2)(D)), 'w_gate': _w((lambda *s: torch.randn(*s, dtype=torch.bfloat16) * 0.1)(D, F)), 'w_up': _w((lambda *s: torch.randn(*s, dtype=torch.bfloat16) * 0.1)(D, F)), 'w_down': _w((lambda *s: torch.randn(*s, dtype=torch.bfloat16) * 0.1)(F, D))}
    _B_in = _B_setup()
    return {'A_x': _A_in['x'], 'A_k_cache': _A_in['k_cache'], 'A_v_cache': _A_in['v_cache'], 'A_wq': _A_in['wq'], 'A_wo': _A_in['wo'], 'B_x': _B_in['x'], 'B_w_r': _B_in['w_r'], 'B_w_gate': _B_in['w_gate'], 'B_w_up': _B_in['w_up'], 'B_w_down': _B_in['w_down'], 'c': _w((lambda *s: torch.randn(*s, dtype=torch.bfloat16) * 0.1)(1, 448) * 8.0), 'w_mod': _w((lambda *s: torch.randn(*s, dtype=torch.bfloat16) * 0.1)(448, 6 * 448) * 448 ** (-0.5) * 8.0)}

def reference(A_x, A_k_cache, A_v_cache, A_wq, A_wo, B_x, B_w_r, B_w_gate, B_w_up, B_w_down, c, w_mod):

    def _A_ref(x, k_cache, v_cache, wq, wo):
        B, Sq, D = x.shape
        H, Dh = (16, 256)
        q = (lambda x, *d: x.permute(*d))((x @ wq).reshape(B, Sq, H, Dh), 0, 2, 1, 3)
        scores = torch.einsum('bhqd,bhkd->bhqk', q, k_cache) * Dh ** (-0.5)
        p = _softmax(scores, axis=-1)
        o = torch.einsum('bhqk,bhkd->bhqd', p, v_cache)
        return (lambda x, *d: x.permute(*d))(o, 0, 2, 1, 3).reshape(B, Sq, H * Dh) @ wo

    def _B_ref(x, w_r, w_gate, w_up, w_down):
        B, S, D = x.shape
        C = 1
        r = x @ w_r
        idx = torch.argsort(-r, axis=-1)[:, :C]
        idx_e = (lambda x, n, axis: torch.repeat_interleave(x, n, dim=axis))(idx.reshape(B, C, 1), D, axis=2)
        x_sel = (lambda x, i, axis: torch.take_along_dim(x, i, dim=axis))(x, idx_e, axis=1)
        g = _silu(x_sel @ w_gate)
        u = x_sel @ w_up
        y = g * u @ w_down
        r_sel = _sigmoid((lambda x, i, axis: torch.take_along_dim(x, i, dim=axis))(r, idx, axis=1))
        y = y * r_sel.reshape(B, C, 1)
        b_off = (torch.arange(B) * S).reshape(B, 1)
        flat_idx = (idx + b_off).reshape(B * C)
        zero = (x * 0.0).reshape(B * S, D)
        upd = _scatter_add(zero, flat_idx, y.reshape(B * C, D), axis=0)
        return x + upd.reshape(B, S, D)
    x = A_x
    mod = (_silu(c) @ w_mod).reshape(c.shape[0], 6, 1, -1)
    sa, ca, ga, sb, cb, gb = (mod[:, 0].clone(), mod[:, 1].clone(), mod[:, 2].clone(), mod[:, 3].clone(), mod[:, 4].clone(), mod[:, 5].clone())
    h = _layernorm(x, axis=-1) * (1 + ca) + sa
    x = x + ga * _A_ref(h, A_k_cache, A_v_cache, A_wq, A_wo)
    h = _layernorm(x, axis=-1) * (1 + cb) + sb
    x = x + gb * _B_ref(h, B_w_r, B_w_gate, B_w_up, B_w_down)
    return x
```

```asm
; @launch grid=(256,1,1) block=(256,1,1) lds=163840
.amdgcn_target "amdgcn-amd-amdhsa--gfx950"
.text
.globl adaLN_cond__mha_block_cached__moe_arch_mod__prompt_kernel
.p2align 8
.type adaLN_cond__mha_block_cached__moe_arch_mod__prompt_kernel,@function
adaLN_cond__mha_block_cached__moe_arch_mod__prompt_kernel:
    s_cmp_ge_u32 s2, 256
    s_cbranch_scc1 K2_end
    s_load_dwordx8 s[48:55], s[0:1], 8
    s_load_dwordx2 s[56:57], s[0:1], 112
    v_lshrrev_b32 v1, 6, v0
    v_and_b32 v2, 63, v0
    s_and_b32 s28, s2, 7
    v_readfirstlane_b32 s27, v1
    s_lshr_b32 s29, s2, 3
    s_lshr_b32 s32, s29, 4
    s_lshl_b32 s28, s28, 1
    s_add_u32 s28, s28, s32
    s_and_b32 s29, s29, 15
    s_lshr_b32 s30, s27, 1
    s_and_b32 s31, s27, 1
    v_lshrrev_b32 v3, 5, v2
    v_and_b32 v4, 31, v2
    v_lshlrev_b32 v5, 1, v3
    v_xor_b32 v4, v4, v5
    v_lshlrev_b32 v4, 4, v4
    v_lshl_add_u32 v57, v3, 9, v4
    v_lshl_add_u32 v56, v3, 13, v4
    v_lshlrev_b32 v55, 4, v2
    s_load_dwordx2 s[36:37], s[0:1], 0
    s_load_dwordx4 s[40:43], s[0:1], 80
    s_load_dwordx2 s[38:39], s[0:1], 104
    s_getpc_b64 s[58:59]
P0_pc:
    s_lshr_b32 s32, s2, 3
    s_mul_i32 s32, s32, 28
    v_min_u32 v42, 27, v0
    v_add_u32 v42, s32, v42
    v_lshlrev_b32 v42, 6, v42
    v_min_u32 v42, K2_end-P0_pc, v42
    v_mov_b32 v47, s59
    v_add_co_u32 v46, vcc, s58, v42
    s_nop 1
    v_addc_co_u32 v47, vcc, 0, v47, vcc
    global_load_dword v45, v[46:47], off
    s_lshl_b32 s22, s29, 4
    s_add_u32 s22, s22, s28
    v_lshrrev_b32 v1, 6, v0
    s_sub_u32 s21, s2, 168
    s_cmp_lt_u32 s21, 84
    s_cselect_b32 s20, 1, 0
    s_cbranch_scc1 P0_mod
    s_cmp_ge_u32 s2, 128
    s_cbranch_scc1 P0_idle
    s_and_b32 s33, s2, 7
    s_lshl_b32 s23, s29, 3
    s_add_u32 s23, s23, s33
    s_mul_i32 s23, s23, 14336
    v_mul_u32_u24 v3, 3584, v1
    v_lshl_add_u32 v3, v2, 4, v3
    v_cmp_gt_u32 vcc, 56, v2
    v_mov_b32 v4, 0x7fffffff
    v_lshlrev_b32 v5, 8, v2
    v_lshl_add_u32 v5, v1, 6, v5
    v_cndmask_b32 v3, v4, v3, vcc
    s_mul_i32 s32, s29, 229376
    s_lshl_b32 s33, s33, 10
    s_add_u32 s32, s32, s33
    v_lshrrev_b32 v42, 3, v0
    v_and_b32 v44, 7, v0
    v_lshlrev_b32 v44, 7, v44
    v_lshl_add_u32 v42, v42, 13, v44
    s_waitcnt lgkmcnt(0)
    s_add_u32 s8, s36, s23
    s_addc_u32 s9, s37, 0
    s_mov_b32 s10, 14336
    s_mov_b32 s11, 0x20000
    buffer_load_dwordx4 v[64:67], v3, s[8:11], 0 offen offset:0 nt
    buffer_load_dwordx4 v[68:71], v3, s[8:11], 0 offen offset:896 nt
    buffer_load_dwordx4 v[72:75], v3, s[8:11], 0 offen offset:1792 nt
    buffer_load_dwordx4 v[76:79], v3, s[8:11], 0 offen offset:2688 nt
    s_add_u32 s60, s52, s32
    s_addc_u32 s61, s53, 0
    s_mov_b32 s62, 222208
    s_mov_b32 s63, 0x20000
    buffer_load_dword v44, v42, s[60:63], 0 offen
    s_add_u32 s23, s23, 0
    s_add_u32 s76, s56, s23
    s_addc_u32 s77, s57, 0
    s_mov_b32 s78, 14336
    s_mov_b32 s79, 0x20000
    s_mov_b32 s44, s38
    s_mov_b32 s45, s39
    s_mov_b32 s46, 4
    s_mov_b32 s47, 0x20000
    s_waitcnt vmcnt(4)
    v_lshlrev_b32 v80, 16, v64
    v_and_b32 v81, 0xffff0000, v64
    v_lshlrev_b32 v82, 16, v65
    v_and_b32 v83, 0xffff0000, v65
    v_lshlrev_b32 v84, 16, v66
    v_and_b32 v85, 0xffff0000, v66
    v_lshlrev_b32 v86, 16, v67
    v_and_b32 v87, 0xffff0000, v67
    v_pk_add_f32 v[16:17], v[80:81], v[82:83]
    v_pk_mul_f32 v[18:19], v[80:81], v[80:81]
    v_pk_fma_f32 v[18:19], v[82:83], v[82:83], v[18:19]
    v_pk_add_f32 v[16:17], v[16:17], v[84:85]
    v_pk_fma_f32 v[18:19], v[84:85], v[84:85], v[18:19]
    v_pk_add_f32 v[16:17], v[16:17], v[86:87]
    v_pk_fma_f32 v[18:19], v[86:87], v[86:87], v[18:19]
    v_add_f32 v32, v16, v17
    v_add_f32 v36, v18, v19
    s_waitcnt vmcnt(3)
    v_lshlrev_b32 v88, 16, v68
    v_and_b32 v89, 0xffff0000, v68
    v_lshlrev_b32 v90, 16, v69
    v_and_b32 v91, 0xffff0000, v69
    v_lshlrev_b32 v92, 16, v70
    v_and_b32 v93, 0xffff0000, v70
    v_lshlrev_b32 v94, 16, v71
    v_and_b32 v95, 0xffff0000, v71
    v_pk_add_f32 v[16:17], v[88:89], v[90:91]
    v_pk_mul_f32 v[18:19], v[88:89], v[88:89]
    v_pk_fma_f32 v[18:19], v[90:91], v[90:91], v[18:19]
    v_pk_add_f32 v[16:17], v[16:17], v[92:93]
    v_pk_fma_f32 v[18:19], v[92:93], v[92:93], v[18:19]
    v_pk_add_f32 v[16:17], v[16:17], v[94:95]
    v_pk_fma_f32 v[18:19], v[94:95], v[94:95], v[18:19]
    v_add_f32 v33, v16, v17
    v_add_f32 v37, v18, v19
    s_waitcnt vmcnt(2)
    v_lshlrev_b32 v96, 16, v72
    v_and_b32 v97, 0xffff0000, v72
    v_lshlrev_b32 v98, 16, v73
    v_and_b32 v99, 0xffff0000, v73
    v_lshlrev_b32 v100, 16, v74
    v_and_b32 v101, 0xffff0000, v74
    v_lshlrev_b32 v102, 16, v75
    v_and_b32 v103, 0xffff0000, v75
    v_pk_add_f32 v[16:17], v[96:97], v[98:99]
    v_pk_mul_f32 v[18:19], v[96:97], v[96:97]
    v_pk_fma_f32 v[18:19], v[98:99], v[98:99], v[18:19]
    v_pk_add_f32 v[16:17], v[16:17], v[100:101]
    v_pk_fma_f32 v[18:19], v[100:101], v[100:101], v[18:19]
    v_pk_add_f32 v[16:17], v[16:17], v[102:103]
    v_pk_fma_f32 v[18:19], v[102:103], v[102:103], v[18:19]
    v_add_f32 v34, v16, v17
    v_add_f32 v38, v18, v19
    s_waitcnt vmcnt(1)
    v_lshlrev_b32 v104, 16, v76
    v_and_b32 v105, 0xffff0000, v76
    v_lshlrev_b32 v106, 16, v77
    v_and_b32 v107, 0xffff0000, v77
    v_lshlrev_b32 v108, 16, v78
    v_and_b32 v109, 0xffff0000, v78
    v_lshlrev_b32 v110, 16, v79
    v_and_b32 v111, 0xffff0000, v79
    v_pk_add_f32 v[16:17], v[104:105], v[106:107]
    v_pk_mul_f32 v[18:19], v[104:105], v[104:105]
    v_pk_fma_f32 v[18:19], v[106:107], v[106:107], v[18:19]
    v_pk_add_f32 v[16:17], v[16:17], v[108:109]
    v_pk_fma_f32 v[18:19], v[108:109], v[108:109], v[18:19]
    v_pk_add_f32 v[16:17], v[16:17], v[110:111]
    v_pk_fma_f32 v[18:19], v[110:111], v[110:111], v[18:19]
    v_add_f32 v35, v16, v17
    v_add_f32 v39, v18, v19
    s_nop 0
    v_permlane32_swap_b32 v32, v36
    v_permlane32_swap_b32 v33, v37
    v_permlane32_swap_b32 v34, v38
    v_permlane32_swap_b32 v35, v39
    s_nop 0
    v_add_f32 v32, v32, v36
    v_add_f32 v33, v33, v37
    v_add_f32 v34, v34, v38
    v_add_f32 v35, v35, v39
    s_nop 1
    v_add_f32_dpp v32, v32, v32 quad_perm:[1,0,3,2] row_mask:0xf bank_mask:0xf
    v_add_f32_dpp v33, v33, v33 quad_perm:[1,0,3,2] row_mask:0xf bank_mask:0xf
    v_add_f32_dpp v34, v34, v34 quad_perm:[1,0,3,2] row_mask:0xf bank_mask:0xf
    v_add_f32_dpp v35, v35, v35 quad_perm:[1,0,3,2] row_mask:0xf bank_mask:0xf
    s_nop 1
    v_add_f32_dpp v32, v32, v32 quad_perm:[2,3,0,1] row_mask:0xf bank_mask:0xf
    v_add_f32_dpp v33, v33, v33 quad_perm:[2,3,0,1] row_mask:0xf bank_mask:0xf
    v_add_f32_dpp v34, v34, v34 quad_perm:[2,3,0,1] row_mask:0xf bank_mask:0xf
    v_add_f32_dpp v35, v35, v35 quad_perm:[2,3,0,1] row_mask:0xf bank_mask:0xf
    s_nop 1
    v_add_f32_dpp v32, v32, v32 row_half_mirror row_mask:0xf bank_mask:0xf
    v_add_f32_dpp v33, v33, v33 row_half_mirror row_mask:0xf bank_mask:0xf
    v_add_f32_dpp v34, v34, v34 row_half_mirror row_mask:0xf bank_mask:0xf
    v_add_f32_dpp v35, v35, v35 row_half_mirror row_mask:0xf bank_mask:0xf
    s_nop 1
    v_add_f32_dpp v32, v32, v32 row_mirror row_mask:0xf bank_mask:0xf
    v_add_f32_dpp v33, v33, v33 row_mirror row_mask:0xf bank_mask:0xf
    v_add_f32_dpp v34, v34, v34 row_mirror row_mask:0xf bank_mask:0xf
    v_add_f32_dpp v35, v35, v35 row_mirror row_mask:0xf bank_mask:0xf
    v_mov_b32 v36, v32
    v_mov_b32 v37, v33
    v_mov_b32 v38, v34
    v_mov_b32 v39, v35
    s_nop 1
    v_permlane16_swap_b32 v32, v36
    v_permlane16_swap_b32 v33, v37
    v_permlane16_swap_b32 v34, v38
    v_permlane16_swap_b32 v35, v39
    s_nop 1
    v_add_f32 v32, v32, v36
    v_add_f32 v33, v33, v37
    v_add_f32 v34, v34, v38
    v_add_f32 v35, v35, v39
    v_mov_b32 v25, v32
    v_mov_b32 v24, v32
    v_mov_b32 v27, v33
    v_mov_b32 v26, v33
    v_mov_b32 v29, v34
    v_mov_b32 v28, v34
    v_mov_b32 v31, v35
    v_mov_b32 v30, v35
    s_nop 0
    v_permlane32_swap_b32 v24, v25
    v_permlane32_swap_b32 v26, v27
    v_permlane32_swap_b32 v28, v29
    v_permlane32_swap_b32 v30, v31
    s_nop 0
    v_mul_f32 v24, 0x3b124925, v24
    v_mul_f32 v26, 0x3b124925, v26
    v_mul_f32 v28, 0x3b124925, v28
    v_mul_f32 v30, 0x3b124925, v30
    v_mul_f32 v25, 0x3b124925, v25
    v_mul_f32 v27, 0x3b124925, v27
    v_mul_f32 v29, 0x3b124925, v29
    v_mul_f32 v31, 0x3b124925, v31
    v_fma_f32 v25, -v24, v24, v25
    v_fma_f32 v27, -v26, v26, v27
    v_fma_f32 v29, -v28, v28, v29
    v_fma_f32 v31, -v30, v30, v31
    v_max_f32 v25, 0, v25
    v_max_f32 v27, 0, v27
    v_max_f32 v29, 0, v29
    v_max_f32 v31, 0, v31
    v_cvt_pk_bf16_f32 v24, v24, v24
    v_cvt_pk_bf16_f32 v26, v26, v26
    v_cvt_pk_bf16_f32 v28, v28, v28
    v_cvt_pk_bf16_f32 v30, v30, v30
    v_and_b32 v24, 0xffff0000, v24
    v_and_b32 v26, 0xffff0000, v26
    v_and_b32 v28, 0xffff0000, v28
    v_and_b32 v30, 0xffff0000, v30
    v_cvt_pk_bf16_f32 v25, v25, v25
    v_cvt_pk_bf16_f32 v27, v27, v27
    v_cvt_pk_bf16_f32 v29, v29, v29
    v_cvt_pk_bf16_f32 v31, v31, v31
    v_and_b32 v25, 0xffff0000, v25
    v_and_b32 v27, 0xffff0000, v27
    v_and_b32 v29, 0xffff0000, v29
    v_and_b32 v31, 0xffff0000, v31
    v_add_f32 v25, 0x3727c5ac, v25
    v_add_f32 v27, 0x3727c5ac, v27
    v_add_f32 v29, 0x3727c5ac, v29
    v_add_f32 v31, 0x3727c5ac, v31
    v_cvt_pk_bf16_f32 v25, v25, v25
    v_cvt_pk_bf16_f32 v27, v27, v27
    v_cvt_pk_bf16_f32 v29, v29, v29
    v_cvt_pk_bf16_f32 v31, v31, v31
    v_and_b32 v25, 0xffff0000, v25
    v_and_b32 v27, 0xffff0000, v27
    v_and_b32 v29, 0xffff0000, v29
    v_and_b32 v31, 0xffff0000, v31
    v_sqrt_f32 v25, v25
    v_sqrt_f32 v27, v27
    v_sqrt_f32 v29, v29
    v_sqrt_f32 v31, v31
    v_cvt_pk_bf16_f32 v25, v25, v25
    v_cvt_pk_bf16_f32 v27, v27, v27
    v_cvt_pk_bf16_f32 v29, v29, v29
    v_cvt_pk_bf16_f32 v31, v31, v31
    v_and_b32 v25, 0xffff0000, v25
    v_and_b32 v27, 0xffff0000, v27
    v_and_b32 v29, 0xffff0000, v29
    v_and_b32 v31, 0xffff0000, v31
    v_rcp_f32 v25, v25
    v_rcp_f32 v27, v27
    v_rcp_f32 v29, v29
    v_rcp_f32 v31, v31
    v_pk_add_f32 v[38:39], v[80:81], v[24:25] op_sel_hi:[1,0] neg_lo:[0,1] neg_hi:[0,1]
    v_cvt_pk_bf16_f32 v39, v38, v39
    v_lshlrev_b32 v38, 16, v39
    v_and_b32 v39, 0xffff0000, v39
    v_pk_mul_f32 v[38:39], v[38:39], v[24:25] op_sel:[0,1] op_sel_hi:[1,1]
    v_cvt_pk_bf16_f32 v39, v38, v39
    v_lshlrev_b32 v38, 16, v39
    v_and_b32 v39, 0xffff0000, v39
    v_cvt_pkrtz_f16_f32 v64, v38, v39
    v_pk_add_f32 v[38:39], v[82:83], v[24:25] op_sel_hi:[1,0] neg_lo:[0,1] neg_hi:[0,1]
    v_cvt_pk_bf16_f32 v39, v38, v39
    v_lshlrev_b32 v38, 16, v39
    v_and_b32 v39, 0xffff0000, v39
    v_pk_mul_f32 v[38:39], v[38:39], v[24:25] op_sel:[0,1] op_sel_hi:[1,1]
    v_cvt_pk_bf16_f32 v39, v38, v39
    v_lshlrev_b32 v38, 16, v39
    v_and_b32 v39, 0xffff0000, v39
    v_cvt_pkrtz_f16_f32 v65, v38, v39
    v_pk_add_f32 v[38:39], v[84:85], v[24:25] op_sel_hi:[1,0] neg_lo:[0,1] neg_hi:[0,1]
    v_cvt_pk_bf16_f32 v39, v38, v39
    v_lshlrev_b32 v38, 16, v39
    v_and_b32 v39, 0xffff0000, v39
    v_pk_mul_f32 v[38:39], v[38:39], v[24:25] op_sel:[0,1] op_sel_hi:[1,1]
    v_cvt_pk_bf16_f32 v39, v38, v39
    v_lshlrev_b32 v38, 16, v39
    v_and_b32 v39, 0xffff0000, v39
    v_cvt_pkrtz_f16_f32 v66, v38, v39
    v_pk_add_f32 v[38:39], v[86:87], v[24:25] op_sel_hi:[1,0] neg_lo:[0,1] neg_hi:[0,1]
    v_cvt_pk_bf16_f32 v39, v38, v39
    v_lshlrev_b32 v38, 16, v39
    v_and_b32 v39, 0xffff0000, v39
    v_pk_mul_f32 v[38:39], v[38:39], v[24:25] op_sel:[0,1] op_sel_hi:[1,1]
    v_cvt_pk_bf16_f32 v39, v38, v39
    v_lshlrev_b32 v38, 16, v39
    v_and_b32 v39, 0xffff0000, v39
    v_cvt_pkrtz_f16_f32 v67, v38, v39
    ds_write_b128 v5, v[64:67] offset:0
    v_pk_add_f32 v[38:39], v[88:89], v[26:27] op_sel_hi:[1,0] neg_lo:[0,1] neg_hi:[0,1]
    v_cvt_pk_bf16_f32 v39, v38, v39
    v_lshlrev_b32 v38, 16, v39
    v_and_b32 v39, 0xffff0000, v39
    v_pk_mul_f32 v[38:39], v[38:39], v[26:27] op_sel:[0,1] op_sel_hi:[1,1]
    v_cvt_pk_bf16_f32 v39, v38, v39
    v_lshlrev_b32 v38, 16, v39
    v_and_b32 v39, 0xffff0000, v39
    v_cvt_pkrtz_f16_f32 v68, v38, v39
    v_pk_add_f32 v[38:39], v[90:91], v[26:27] op_sel_hi:[1,0] neg_lo:[0,1] neg_hi:[0,1]
    v_cvt_pk_bf16_f32 v39, v38, v39
    v_lshlrev_b32 v38, 16, v39
    v_and_b32 v39, 0xffff0000, v39
    v_pk_mul_f32 v[38:39], v[38:39], v[26:27] op_sel:[0,1] op_sel_hi:[1,1]
    v_cvt_pk_bf16_f32 v39, v38, v39
    v_lshlrev_b32 v38, 16, v39
    v_and_b32 v39, 0xffff0000, v39
    v_cvt_pkrtz_f16_f32 v69, v38, v39
    v_pk_add_f32 v[38:39], v[92:93], v[26:27] op_sel_hi:[1,0] neg_lo:[0,1] neg_hi:[0,1]
    v_cvt_pk_bf16_f32 v39, v38, v39
    v_lshlrev_b32 v38, 16, v39
    v_and_b32 v39, 0xffff0000, v39
    v_pk_mul_f32 v[38:39], v[38:39], v[26:27] op_sel:[0,1] op_sel_hi:[1,1]
    v_cvt_pk_bf16_f32 v39, v38, v39
    v_lshlrev_b32 v38, 16, v39
    v_and_b32 v39, 0xffff0000, v39
    v_cvt_pkrtz_f16_f32 v70, v38, v39
    v_pk_add_f32 v[38:39], v[94:95], v[26:27] op_sel_hi:[1,0] neg_lo:[0,1] neg_hi:[0,1]
    v_cvt_pk_bf16_f32 v39, v38, v39
    v_lshlrev_b32 v38, 16, v39
    v_and_b32 v39, 0xffff0000, v39
    v_pk_mul_f32 v[38:39], v[38:39], v[26:27] op_sel:[0,1] op_sel_hi:[1,1]
    v_cvt_pk_bf16_f32 v39, v38, v39
    v_lshlrev_b32 v38, 16, v39
    v_and_b32 v39, 0xffff0000, v39
    v_cvt_pkrtz_f16_f32 v71, v38, v39
    ds_write_b128 v5, v[68:71] offset:16
    v_pk_add_f32 v[38:39], v[96:97], v[28:29] op_sel_hi:[1,0] neg_lo:[0,1] neg_hi:[0,1]
    v_cvt_pk_bf16_f32 v39, v38, v39
    v_lshlrev_b32 v38, 16, v39
    v_and_b32 v39, 0xffff0000, v39
    v_pk_mul_f32 v[38:39], v[38:39], v[28:29] op_sel:[0,1] op_sel_hi:[1,1]
    v_cvt_pk_bf16_f32 v39, v38, v39
    v_lshlrev_b32 v38, 16, v39
    v_and_b32 v39, 0xffff0000, v39
    v_cvt_pkrtz_f16_f32 v72, v38, v39
    v_pk_add_f32 v[38:39], v[98:99], v[28:29] op_sel_hi:[1,0] neg_lo:[0,1] neg_hi:[0,1]
    v_cvt_pk_bf16_f32 v39, v38, v39
    v_lshlrev_b32 v38, 16, v39
    v_and_b32 v39, 0xffff0000, v39
    v_pk_mul_f32 v[38:39], v[38:39], v[28:29] op_sel:[0,1] op_sel_hi:[1,1]
    v_cvt_pk_bf16_f32 v39, v38, v39
    v_lshlrev_b32 v38, 16, v39
    v_and_b32 v39, 0xffff0000, v39
    v_cvt_pkrtz_f16_f32 v73, v38, v39
    v_pk_add_f32 v[38:39], v[100:101], v[28:29] op_sel_hi:[1,0] neg_lo:[0,1] neg_hi:[0,1]
    v_cvt_pk_bf16_f32 v39, v38, v39
    v_lshlrev_b32 v38, 16, v39
    v_and_b32 v39, 0xffff0000, v39
    v_pk_mul_f32 v[38:39], v[38:39], v[28:29] op_sel:[0,1] op_sel_hi:[1,1]
    v_cvt_pk_bf16_f32 v39, v38, v39
    v_lshlrev_b32 v38, 16, v39
    v_and_b32 v39, 0xffff0000, v39
    v_cvt_pkrtz_f16_f32 v74, v38, v39
    v_pk_add_f32 v[38:39], v[102:103], v[28:29] op_sel_hi:[1,0] neg_lo:[0,1] neg_hi:[0,1]
    v_cvt_pk_bf16_f32 v39, v38, v39
    v_lshlrev_b32 v38, 16, v39
    v_and_b32 v39, 0xffff0000, v39
    v_pk_mul_f32 v[38:39], v[38:39], v[28:29] op_sel:[0,1] op_sel_hi:[1,1]
    v_cvt_pk_bf16_f32 v39, v38, v39
    v_lshlrev_b32 v38, 16, v39
    v_and_b32 v39, 0xffff0000, v39
    v_cvt_pkrtz_f16_f32 v75, v38, v39
    ds_write_b128 v5, v[72:75] offset:32
    v_pk_add_f32 v[38:39], v[104:105], v[30:31] op_sel_hi:[1,0] neg_lo:[0,1] neg_hi:[0,1]
    v_cvt_pk_bf16_f32 v39, v38, v39
    v_lshlrev_b32 v38, 16, v39
    v_and_b32 v39, 0xffff0000, v39
    v_pk_mul_f32 v[38:39], v[38:39], v[30:31] op_sel:[0,1] op_sel_hi:[1,1]
    v_cvt_pk_bf16_f32 v39, v38, v39
    v_lshlrev_b32 v38, 16, v39
    v_and_b32 v39, 0xffff0000, v39
    v_cvt_pkrtz_f16_f32 v76, v38, v39
    v_pk_add_f32 v[38:39], v[106:107], v[30:31] op_sel_hi:[1,0] neg_lo:[0,1] neg_hi:[0,1]
    v_cvt_pk_bf16_f32 v39, v38, v39
    v_lshlrev_b32 v38, 16, v39
    v_and_b32 v39, 0xffff0000, v39
    v_pk_mul_f32 v[38:39], v[38:39], v[30:31] op_sel:[0,1] op_sel_hi:[1,1]
    v_cvt_pk_bf16_f32 v39, v38, v39
    v_lshlrev_b32 v38, 16, v39
    v_and_b32 v39, 0xffff0000, v39
    v_cvt_pkrtz_f16_f32 v77, v38, v39
    v_pk_add_f32 v[38:39], v[108:109], v[30:31] op_sel_hi:[1,0] neg_lo:[0,1] neg_hi:[0,1]
    v_cvt_pk_bf16_f32 v39, v38, v39
    v_lshlrev_b32 v38, 16, v39
    v_and_b32 v39, 0xffff0000, v39
    v_pk_mul_f32 v[38:39], v[38:39], v[30:31] op_sel:[0,1] op_sel_hi:[1,1]
    v_cvt_pk_bf16_f32 v39, v38, v39
    v_lshlrev_b32 v38, 16, v39
    v_and_b32 v39, 0xffff0000, v39
    v_cvt_pkrtz_f16_f32 v78, v38, v39
    v_pk_add_f32 v[38:39], v[110:111], v[30:31] op_sel_hi:[1,0] neg_lo:[0,1] neg_hi:[0,1]
    v_cvt_pk_bf16_f32 v39, v38, v39
    v_lshlrev_b32 v38, 16, v39
    v_and_b32 v39, 0xffff0000, v39
    v_pk_mul_f32 v[38:39], v[38:39], v[30:31] op_sel:[0,1] op_sel_hi:[1,1]
    v_cvt_pk_bf16_f32 v39, v38, v39
    v_lshlrev_b32 v38, 16, v39
    v_and_b32 v39, 0xffff0000, v39
    v_cvt_pkrtz_f16_f32 v79, v38, v39
    ds_write_b128 v5, v[76:79] offset:48
    v_lshlrev_b32 v5, 4, v0
    buffer_load_dword v52, off, s[44:47], 0 sc1
    s_waitcnt lgkmcnt(0)
    s_barrier
    ds_read_b128 v[64:67], v5 offset:0
    ds_read_b128 v[68:71], v5 offset:4096
    ds_read_b128 v[72:75], v5 offset:8192
    ds_read_b128 v[76:79], v5 offset:12288
    s_mov_b32 s33, 0
    s_waitcnt lgkmcnt(3)
    buffer_store_dwordx4 v[64:67], v5, s[76:79], s33 offen sc1
    s_mov_b32 s33, 4096
    s_waitcnt lgkmcnt(2)
    buffer_store_dwordx4 v[68:71], v5, s[76:79], s33 offen sc1
    s_mov_b32 s33, 8192
    s_waitcnt lgkmcnt(1)
    buffer_store_dwordx4 v[72:75], v5, s[76:79], s33 offen sc1
    s_mov_b32 s33, 12288
    s_waitcnt lgkmcnt(0)
    buffer_store_dwordx4 v[76:79], v5, s[76:79], s33 offen sc1
    s_branch P0_done
P0_idle:
    s_waitcnt lgkmcnt(0)
    s_mov_b32 s44, s38
    s_mov_b32 s45, s39
    s_mov_b32 s46, 4
    s_mov_b32 s47, 0x20000
    s_add_u32 s72, s56, 43974656
    s_addc_u32 s73, s57, 0
    s_mov_b32 s74, 4
    s_mov_b32 s75, 0x20000
    s_sub_u32 s35, s2, 128
    s_or_b32 s35, s35, s27
    s_cbranch_scc1 P0_notag
    s_mov_b64 exec, 1
    buffer_load_dword v43, off, s[72:75], 0 sc1
    s_waitcnt vmcnt(0)
    v_add_u32 v43, 1, v43
    v_max_u32 v43, 1, v43
    buffer_store_dword v43, off, s[44:47], 0 sc1
    buffer_store_dword v43, off, s[72:75], 0 sc1
    s_mov_b64 exec, -1
P0_notag:
    v_mov_b32 v52, 0
    s_sleep 40
    s_branch P0_done
P0_mod:
    v_and_b32 v6, 3, v0
    v_lshrrev_b32 v7, 2, v0
    v_mul_u32_u24 v40, 5376, v7
    v_lshl_add_u32 v40, v6, 4, v40
    v_lshlrev_b32 v41, 1, v7
    s_lshl_b32 s3, s21, 6
    s_sub_u32 s32, 2408448, s3
    s_mov_b32 s34, 0
    s_waitcnt lgkmcnt(0)
    s_mov_b32 s12, s40
    s_mov_b32 s13, s41
    s_mov_b32 s14, 896
    s_mov_b32 s15, 0x20000
    s_add_u32 s16, s42, s3
    s_addc_u32 s17, s43, 0
    s_mov_b32 s18, s32
    s_mov_b32 s19, 0x20000
    buffer_load_ushort v64, v41, s[12:15], 0 offen offset:0
    buffer_load_ushort v65, v41, s[12:15], 0 offen offset:128
    buffer_load_ushort v66, v41, s[12:15], 0 offen offset:256
    buffer_load_ushort v67, v41, s[12:15], 0 offen offset:384
    buffer_load_ushort v68, v41, s[12:15], 0 offen offset:512
    buffer_load_ushort v69, v41, s[12:15], 0 offen offset:640
    buffer_load_ushort v70, v41, s[12:15], 0 offen offset:768
    buffer_load_dwordx4 v[72:75], v40, s[16:19], s34 offen
    s_add_u32 s34, s34, 344064
    buffer_load_dwordx4 v[76:79], v40, s[16:19], s34 offen
    s_add_u32 s34, s34, 344064
    buffer_load_dwordx4 v[80:83], v40, s[16:19], s34 offen
    s_add_u32 s34, s34, 344064
    buffer_load_dwordx4 v[84:87], v40, s[16:19], s34 offen
    s_add_u32 s34, s34, 344064
    buffer_load_dwordx4 v[88:91], v40, s[16:19], s34 offen
    s_add_u32 s34, s34, 344064
    buffer_load_dwordx4 v[92:95], v40, s[16:19], s34 offen
    s_add_u32 s34, s34, 344064
    buffer_load_dwordx4 v[96:99], v40, s[16:19], s34 offen
    s_mov_b32 s44, s38
    s_mov_b32 s45, s39
    s_mov_b32 s46, 4
    s_mov_b32 s47, 0x20000
    s_add_u32 s12, s56, 2097152
    s_addc_u32 s13, s57, 0
    s_mov_b32 s14, 32768
    s_mov_b32 s15, 0x20000
    s_mul_i32 s33, s21, 147
    s_lshr_b32 s33, s33, 11
    s_mul_i32 s35, s33, 14
    s_sub_u32 s35, s21, s35
    s_lshl_b32 s35, s35, 5
    v_lshlrev_b32 v6, 3, v6
    v_lshrrev_b32 v7, 5, v2
    v_lshl_add_u32 v6, v7, 2, v6
    v_bfe_u32 v7, v2, 4, 1
    v_lshl_add_u32 v6, v7, 1, v6
    v_lshlrev_b32 v6, 2, v6
    v_lshl_add_u32 v6, v1, 7, v6
    s_waitcnt vmcnt(7)
    v_lshlrev_b32 v64, 16, v64
    v_mul_f32 v16, 0xbfb8aa3b, v64
    v_lshlrev_b32 v65, 16, v65
    v_mul_f32 v17, 0xbfb8aa3b, v65
    v_lshlrev_b32 v66, 16, v66
    v_mul_f32 v18, 0xbfb8aa3b, v66
    v_lshlrev_b32 v67, 16, v67
    v_mul_f32 v19, 0xbfb8aa3b, v67
    v_lshlrev_b32 v68, 16, v68
    v_mul_f32 v20, 0xbfb8aa3b, v68
    v_lshlrev_b32 v69, 16, v69
    v_mul_f32 v21, 0xbfb8aa3b, v69
    v_lshlrev_b32 v70, 16, v70
    v_mul_f32 v22, 0xbfb8aa3b, v70
    v_exp_f32 v16, v16
    v_exp_f32 v17, v17
    v_exp_f32 v18, v18
    v_exp_f32 v19, v19
    v_exp_f32 v20, v20
    v_exp_f32 v21, v21
    v_exp_f32 v22, v22
    v_add_f32 v16, 1.0, v16
    v_add_f32 v17, 1.0, v17
    v_add_f32 v18, 1.0, v18
    v_add_f32 v19, 1.0, v19
    v_add_f32 v20, 1.0, v20
    v_add_f32 v21, 1.0, v21
    v_add_f32 v22, 1.0, v22
    v_rcp_f32 v16, v16
    v_rcp_f32 v17, v17
    v_rcp_f32 v18, v18
    v_rcp_f32 v19, v19
    v_rcp_f32 v20, v20
    v_rcp_f32 v21, v21
    v_rcp_f32 v22, v22
    v_mul_f32 v64, v64, v16
    v_mul_f32 v65, v65, v17
    v_mul_f32 v66, v66, v18
    v_mul_f32 v67, v67, v19
    v_mul_f32 v68, v68, v20
    v_mul_f32 v69, v69, v21
    v_mul_f32 v70, v70, v22
    v_cvt_pk_bf16_f32 v64, v64, v64
    v_and_b32 v64, 0xffff0000, v64
    v_cvt_pk_bf16_f32 v65, v65, v65
    v_and_b32 v65, 0xffff0000, v65
    v_cvt_pk_bf16_f32 v66, v66, v66
    v_and_b32 v66, 0xffff0000, v66
    v_cvt_pk_bf16_f32 v67, v67, v67
    v_and_b32 v67, 0xffff0000, v67
    v_cvt_pk_bf16_f32 v68, v68, v68
    v_and_b32 v68, 0xffff0000, v68
    v_cvt_pk_bf16_f32 v69, v69, v69
    v_and_b32 v69, 0xffff0000, v69
    v_cvt_pk_bf16_f32 v70, v70, v70
    v_and_b32 v70, 0xffff0000, v70
    s_waitcnt vmcnt(6)
    buffer_load_dword v52, off, s[44:47], 0 sc1
    v_lshlrev_b32 v16, 16, v72
    v_and_b32 v17, 0xffff0000, v72
    v_pk_mul_f32 v[32:33], v[16:17], v[64:65] op_sel:[0,0] op_sel_hi:[1,0]
    v_lshlrev_b32 v18, 16, v73
    v_and_b32 v19, 0xffff0000, v73
    v_pk_mul_f32 v[34:35], v[18:19], v[64:65] op_sel:[0,0] op_sel_hi:[1,0]
    v_lshlrev_b32 v16, 16, v74
    v_and_b32 v17, 0xffff0000, v74
    v_pk_mul_f32 v[36:37], v[16:17], v[64:65] op_sel:[0,0] op_sel_hi:[1,0]
    v_lshlrev_b32 v18, 16, v75
    v_and_b32 v19, 0xffff0000, v75
    v_pk_mul_f32 v[38:39], v[18:19], v[64:65] op_sel:[0,0] op_sel_hi:[1,0]
    s_waitcnt vmcnt(6)
    v_lshlrev_b32 v16, 16, v76
    v_and_b32 v17, 0xffff0000, v76
    v_pk_fma_f32 v[32:33], v[16:17], v[64:65], v[32:33] op_sel:[0,1,0] op_sel_hi:[1,1,1]
    v_lshlrev_b32 v18, 16, v77
    v_and_b32 v19, 0xffff0000, v77
    v_pk_fma_f32 v[34:35], v[18:19], v[64:65], v[34:35] op_sel:[0,1,0] op_sel_hi:[1,1,1]
    v_lshlrev_b32 v16, 16, v78
    v_and_b32 v17, 0xffff0000, v78
    v_pk_fma_f32 v[36:37], v[16:17], v[64:65], v[36:37] op_sel:[0,1,0] op_sel_hi:[1,1,1]
    v_lshlrev_b32 v18, 16, v79
    v_and_b32 v19, 0xffff0000, v79
    v_pk_fma_f32 v[38:39], v[18:19], v[64:65], v[38:39] op_sel:[0,1,0] op_sel_hi:[1,1,1]
    s_waitcnt vmcnt(5)
    v_lshlrev_b32 v16, 16, v80
    v_and_b32 v17, 0xffff0000, v80
    v_pk_fma_f32 v[32:33], v[16:17], v[66:67], v[32:33] op_sel:[0,0,0] op_sel_hi:[1,0,1]
    v_lshlrev_b32 v18, 16, v81
    v_and_b32 v19, 0xffff0000, v81
    v_pk_fma_f32 v[34:35], v[18:19], v[66:67], v[34:35] op_sel:[0,0,0] op_sel_hi:[1,0,1]
    v_lshlrev_b32 v16, 16, v82
    v_and_b32 v17, 0xffff0000, v82
    v_pk_fma_f32 v[36:37], v[16:17], v[66:67], v[36:37] op_sel:[0,0,0] op_sel_hi:[1,0,1]
    v_lshlrev_b32 v18, 16, v83
    v_and_b32 v19, 0xffff0000, v83
    v_pk_fma_f32 v[38:39], v[18:19], v[66:67], v[38:39] op_sel:[0,0,0] op_sel_hi:[1,0,1]
    s_waitcnt vmcnt(4)
    v_lshlrev_b32 v16, 16, v84
    v_and_b32 v17, 0xffff0000, v84
    v_pk_fma_f32 v[32:33], v[16:17], v[66:67], v[32:33] op_sel:[0,1,0] op_sel_hi:[1,1,1]
    v_lshlrev_b32 v18, 16, v85
    v_and_b32 v19, 0xffff0000, v85
    v_pk_fma_f32 v[34:35], v[18:19], v[66:67], v[34:35] op_sel:[0,1,0] op_sel_hi:[1,1,1]
    v_lshlrev_b32 v16, 16, v86
    v_and_b32 v17, 0xffff0000, v86
    v_pk_fma_f32 v[36:37], v[16:17], v[66:67], v[36:37] op_sel:[0,1,0] op_sel_hi:[1,1,1]
    v_lshlrev_b32 v18, 16, v87
    v_and_b32 v19, 0xffff0000, v87
    v_pk_fma_f32 v[38:39], v[18:19], v[66:67], v[38:39] op_sel:[0,1,0] op_sel_hi:[1,1,1]
    s_waitcnt vmcnt(3)
    v_lshlrev_b32 v16, 16, v88
    v_and_b32 v17, 0xffff0000, v88
    v_pk_fma_f32 v[32:33], v[16:17], v[68:69], v[32:33] op_sel:[0,0,0] op_sel_hi:[1,0,1]
    v_lshlrev_b32 v18, 16, v89
    v_and_b32 v19, 0xffff0000, v89
    v_pk_fma_f32 v[34:35], v[18:19], v[68:69], v[34:35] op_sel:[0,0,0] op_sel_hi:[1,0,1]
    v_lshlrev_b32 v16, 16, v90
    v_and_b32 v17, 0xffff0000, v90
    v_pk_fma_f32 v[36:37], v[16:17], v[68:69], v[36:37] op_sel:[0,0,0] op_sel_hi:[1,0,1]
    v_lshlrev_b32 v18, 16, v91
    v_and_b32 v19, 0xffff0000, v91
    v_pk_fma_f32 v[38:39], v[18:19], v[68:69], v[38:39] op_sel:[0,0,0] op_sel_hi:[1,0,1]
    s_waitcnt vmcnt(2)
    v_lshlrev_b32 v16, 16, v92
    v_and_b32 v17, 0xffff0000, v92
    v_pk_fma_f32 v[32:33], v[16:17], v[68:69], v[32:33] op_sel:[0,1,0] op_sel_hi:[1,1,1]
    v_lshlrev_b32 v18, 16, v93
    v_and_b32 v19, 0xffff0000, v93
    v_pk_fma_f32 v[34:35], v[18:19], v[68:69], v[34:35] op_sel:[0,1,0] op_sel_hi:[1,1,1]
    v_lshlrev_b32 v16, 16, v94
    v_and_b32 v17, 0xffff0000, v94
    v_pk_fma_f32 v[36:37], v[16:17], v[68:69], v[36:37] op_sel:[0,1,0] op_sel_hi:[1,1,1]
    v_lshlrev_b32 v18, 16, v95
    v_and_b32 v19, 0xffff0000, v95
    v_pk_fma_f32 v[38:39], v[18:19], v[68:69], v[38:39] op_sel:[0,1,0] op_sel_hi:[1,1,1]
    s_waitcnt vmcnt(1)
    v_lshlrev_b32 v16, 16, v96
    v_and_b32 v17, 0xffff0000, v96
    v_pk_fma_f32 v[32:33], v[16:17], v[70:71], v[32:33] op_sel:[0,0,0] op_sel_hi:[1,0,1]
    v_lshlrev_b32 v18, 16, v97
    v_and_b32 v19, 0xffff0000, v97
    v_pk_fma_f32 v[34:35], v[18:19], v[70:71], v[34:35] op_sel:[0,0,0] op_sel_hi:[1,0,1]
    v_lshlrev_b32 v16, 16, v98
    v_and_b32 v17, 0xffff0000, v98
    v_pk_fma_f32 v[36:37], v[16:17], v[70:71], v[36:37] op_sel:[0,0,0] op_sel_hi:[1,0,1]
    v_lshlrev_b32 v18, 16, v99
    v_and_b32 v19, 0xffff0000, v99
    v_pk_fma_f32 v[38:39], v[18:19], v[70:71], v[38:39] op_sel:[0,0,0] op_sel_hi:[1,0,1]
    s_nop 1
    v_permlane32_swap_b32 v32, v36
    v_permlane32_swap_b32 v33, v37
    v_permlane32_swap_b32 v34, v38
    v_permlane32_swap_b32 v35, v39
    s_nop 0
    v_add_f32 v32, v32, v36
    v_add_f32 v33, v33, v37
    v_add_f32 v34, v34, v38
    v_add_f32 v35, v35, v39
    s_nop 0
    v_permlane16_swap_b32 v32, v34
    v_permlane16_swap_b32 v33, v35
    s_nop 1
    v_add_f32 v32, v32, v34
    v_add_f32 v33, v33, v35
    s_nop 1
    v_add_f32_dpp v32, v32, v32 row_ror:8 row_mask:0xf bank_mask:0xf
    v_add_f32_dpp v33, v33, v33 row_ror:8 row_mask:0xf bank_mask:0xf
    s_nop 1
    v_add_f32_dpp v32, v32, v32 row_ror:4 row_mask:0xf bank_mask:0xf
    v_add_f32_dpp v33, v33, v33 row_ror:4 row_mask:0xf bank_mask:0xf
    ds_write_b64 v6, v[32:33]
    v_and_b32 v7, 31, v2
    v_lshlrev_b32 v6, 2, v7
    s_mov_b32 s34, 200000
    s_waitcnt vmcnt(0)
P0_tagm:
    v_readfirstlane_b32 s99, v52
    s_sub_u32 s34, s34, 1
    s_cbranch_scc1 P0_tagmok
    s_cmp_lg_u32 s99, 0
    s_cbranch_scc1 P0_tagmok
    s_sleep 2
    buffer_load_dword v52, off, s[44:47], 0 sc1
    s_waitcnt vmcnt(0)
    s_branch P0_tagm
P0_tagmok:
    s_waitcnt lgkmcnt(0)
    s_barrier
    ds_read_b32 v16, v6 offset:0
    ds_read_b32 v17, v6 offset:128
    ds_read_b32 v18, v6 offset:256
    ds_read_b32 v19, v6 offset:384
    v_add_u32 v20, s35, v7
    s_waitcnt lgkmcnt(0)
    v_add_f32 v16, v16, v17
    v_add_f32 v18, v18, v19
    v_add_f32 v16, v16, v18
    v_cvt_pk_bf16_f32 v16, v16, v16
    v_and_b32 v16, 0xffff0000, v16
    v_add_f32 v17, 1.0, v16
    v_cvt_pk_bf16_f32 v17, v17, v17
    v_and_b32 v17, 0xffff0000, v17
    s_cmp_eq_u32 s33, 1
    s_cselect_b64 vcc, -1, 0
    s_cmp_eq_u32 s33, 4
    s_cselect_b64 vcc, -1, vcc
    v_cndmask_b32 v16, v16, v17, vcc
    s_cmp_lg_u32 s27, 0
    s_cbranch_scc1 P0_pub
    s_cmp_lt_u32 s33, 2
    s_cbranch_scc0 P0_plain
    v_mul_f32 v16, 0x3db8aa3b, v16
    v_mov_b32 v17, s99
    v_lshrrev_b32 v18, 3, v20
    v_and_b32 v19, 7, v20
    v_lshlrev_b32 v19, 3, v19
    v_lshl_add_u32 v18, v18, 7, v19
    s_xor_b32 s32, s33, 1
    s_lshl_b32 s32, s32, 6
    s_add_u32 s32, s32, 16384
    buffer_store_dwordx2 v[16:17], v18, s[12:15], s32 offen sc1
    s_branch P0_pub
P0_plain:
    v_lshlrev_b32 v19, 2, v20
    s_mul_i32 s32, s33, 1792
    s_add_u32 s32, s32, 512
    buffer_store_dword v16, v19, s[12:15], s32 offen sc1
    s_waitcnt vmcnt(0)
    s_branch P0_pub
P0_done:
    s_mov_b32 s34, 200000
    s_waitcnt vmcnt(0)
P0_tag:
    v_readfirstlane_b32 s99, v52
    s_sub_u32 s34, s34, 1
    s_cbranch_scc1 P0_tagok
    s_cmp_lg_u32 s99, 0
    s_cbranch_scc1 P0_tagok
    s_sleep 2
    buffer_load_dword v52, off, s[44:47], 0 sc1
    s_waitcnt vmcnt(0)
    s_branch P0_tag
P0_tagok:
    s_barrier
P0_pub:
    s_add_u32 s12, s56, 43515904
    s_addc_u32 s13, s57, 0
    s_mov_b32 s14, 163840
    s_mov_b32 s15, 0x20000
    s_mul_i32 s32, s2, 640
    v_lshlrev_b32 v18, 7, v2
    v_mov_b32 v19, s99
    s_cmp_lg_u32 s27, 0
    s_cbranch_scc1 P0_nopub
    s_mov_b64 exec, 3
    buffer_store_dword v19, v18, s[12:15], s32 offen offset:384 sc1
    s_mov_b64 exec, -1
P0_nopub:
    s_lshl_b32 s32, s28, 9
    s_lshl_b32 s33, s30, 17
    s_add_u32 s32, s32, s33
    s_lshl_b32 s33, s31, 15
    s_add_u32 s32, s32, s33
    s_sub_u32 s33, 3670016, s32
    s_mul_i32 s70, s27, 4352
    s_add_u32 s4, s52, s32
    s_addc_u32 s5, s53, 0
    s_mov_b32 s6, s33
    s_mov_b32 s7, 0x20000
    s_add_u32 m0, s70, 34816
    s_mov_b32 s71, 0
    buffer_load_dwordx4 v56, s[4:7], s71 offen lds
    s_add_u32 m0, s70, 35904
    s_mov_b32 s71, 16384
    buffer_load_dwordx4 v56, s[4:7], s71 offen lds
    s_add_u32 m0, s70, 36992
    s_mov_b32 s71, 65536
    buffer_load_dwordx4 v56, s[4:7], s71 offen lds
    s_add_u32 m0, s70, 38080
    s_mov_b32 s71, 81920
    buffer_load_dwordx4 v56, s[4:7], s71 offen lds
    s_add_u32 m0, s70, 104448
    s_mov_b32 s71, 262144
    buffer_load_dwordx4 v56, s[4:7], s71 offen lds
    s_add_u32 m0, s70, 105536
    s_mov_b32 s71, 278528
    buffer_load_dwordx4 v56, s[4:7], s71 offen lds
    s_add_u32 m0, s70, 106624
    s_mov_b32 s71, 327680
    buffer_load_dwordx4 v56, s[4:7], s71 offen lds
    s_add_u32 m0, s70, 107712
    s_mov_b32 s71, 344064
    buffer_load_dwordx4 v56, s[4:7], s71 offen lds
    s_mul_i32 s32, s22, 1792
    s_add_u32 s32, s32, 42008576
    s_and_b32 s33, s2, 7
    s_mul_i32 s33, s33, 7
    s_lshr_b32 s34, s2, 3
    s_add_u32 s33, s33, s34
    s_mul_i32 s33, s33, 1792
    s_cmp_lt_u32 s2, 56
    s_cselect_b32 s33, s33, 0
    s_cselect_b32 s34, 1792, 0
    s_add_u32 s33, s33, 43057152
    v_lshlrev_b32 v42, 4, v0
    v_mov_b32 v48, -1
    v_mov_b32 v49, -1
    v_mov_b32 v50, -1
    v_mov_b32 v51, -1
    s_add_u32 s60, s56, s32
    s_addc_u32 s61, s57, 0
    s_mov_b32 s62, 1792
    s_mov_b32 s63, 0x20000
    s_add_u32 s64, s56, s33
    s_addc_u32 s65, s57, 0
    s_mov_b32 s66, s34
    s_mov_b32 s67, 0x20000
    s_add_u32 s76, s56, 2113536
    s_addc_u32 s77, s57, 0
    s_mov_b32 s78, 7168
    s_mov_b32 s79, 0x20000
    s_lshl_b32 s33, s29, 3
    v_add_u32 v16, s33, v2
    v_mul_u32_u24 v16, 640, v16
    v_lshlrev_b32 v20, 3, v0
    v_lshlrev_b32 v21, 2, v0
    v_add_u32 v21, 156928, v21
    v_min_u32 v22, 127, v0
    v_lshlrev_b32 v23, 3, v22
    v_add_u32 v23, 6144, v23
    v_lshlrev_b32 v22, 2, v22
    v_add_u32 v22, 160000, v22
    s_mul_i32 s33, s2, 37
    s_and_b32 s33, s33, 0x7f
    s_mul_i32 s33, s33, 56
    s_cmp_lg_u32 s27, 3
    s_cbranch_scc1 P0_go
    s_mov_b64 exec, 0xff
    s_mov_b32 s34, 200000
P0_pn:
    buffer_load_dword v17, v16, s[12:15], 0 offen offset:384 sc1
    s_waitcnt vmcnt(0)
    v_cmp_ne_u32 vcc, s99, v17
    s_sub_u32 s34, s34, 1
    s_cbranch_scc1 P0_pn_out
    s_cbranch_vccz P0_pn_out
    s_mov_b64 exec, vcc
    s_sleep 4
    s_branch P0_pn
P0_pn_out:
    s_mov_b64 exec, -1
    s_mov_b64 exec, 1
    s_mov_b32 s34, 200000
P0_ph:
    buffer_load_dword v17, off, s[76:79], s33 offset:4 sc1
    s_waitcnt vmcnt(0)
    v_cmp_ne_u32 vcc, s99, v17
    s_sub_u32 s34, s34, 1
    s_cbranch_scc1 P0_ph_out
    s_cbranch_vccz P0_ph_out
    s_mov_b64 exec, vcc
    s_sleep 2
    s_branch P0_ph
P0_ph_out:
    s_mov_b64 exec, -1
P0_go:
    s_barrier
    s_mov_b32 s35, 4096
    buffer_load_dwordx2 v[24:25], v20, s[76:79], 0 offen offset:0 sc1
    buffer_load_dwordx2 v[26:27], v20, s[76:79], 0 offen offset:2048 sc1
    buffer_load_dwordx2 v[28:29], v20, s[76:79], s35 offen sc1
    buffer_load_dwordx2 v[30:31], v23, s[76:79], 0 offen sc1
    s_lshl_b32 s3, s29, 7
    s_lshl_b32 s33, s31, 6
    s_add_u32 s3, s3, s33
    s_lshl_b32 s33, s30, 5
    s_add_u32 s3, s3, s33
    s_mul_i32 s33, s3, 896
    s_add_u32 s33, s33, 0
    s_mov_b32 s44, 0
    s_mov_b32 s72, 14336
    s_add_u32 s36, s56, s33
    s_addc_u32 s37, s57, 0
    s_mov_b32 s38, 28672
    s_mov_b32 s39, 0x20000
    buffer_load_dwordx4 v[64:67], v55, s[36:39], s44 offen offset:0 sc1
    buffer_load_dwordx4 v[68:71], v55, s[36:39], s72 offen offset:0 sc1
    buffer_load_dwordx4 v[72:75], v55, s[36:39], s44 offen offset:1024 sc1
    buffer_load_dwordx4 v[76:79], v55, s[36:39], s72 offen offset:1024 sc1
    s_waitcnt vmcnt(4)
    v_xor_b32 v17, s99, v25
    v_xor_b32 v18, s99, v27
    v_xor_b32 v19, s99, v29
    v_or3_b32 v17, v17, v18, v19
    v_xor_b32 v18, s99, v31
    v_or_b32 v17, v17, v18
    v_cmp_ne_u32 vcc, 0, v17
    s_nop 0
    s_cbranch_vccnz P0_again
P0_have:
    ds_write_b32 v21, v24
    ds_write_b32 v21, v26 offset:1024
    ds_write_b32 v21, v28 offset:2048
    ds_write_b32 v22, v30
    buffer_store_dwordx4 v[48:51], v42, s[60:63], 0 offen sc1
    buffer_store_dwordx4 v[48:51], v42, s[64:67], 0 offen sc1
    v_and_b32 v3, 15, v2
    v_lshrrev_b32 v4, 4, v2
    s_lshr_b32 s34, s3, 3
    s_mul_i32 s34, s34, 114688
    s_mul_i32 s35, s28, 7168
    s_add_u32 s34, s34, s35
    s_add_u32 s34, s34, 4194304
    s_add_u32 s40, s56, s34
    s_addc_u32 s41, s57, 0
    s_mov_b32 s42, 351232
    s_mov_b32 s43, 0x20000
    s_lshl_b32 s32, s28, 20
    s_lshl_b32 s33, s30, 19
    s_add_u32 s32, s32, s33
    s_lshl_b32 s33, s31, 13
    s_add_u32 s33, s32, s33
    s_sub_u32 s34, 0x1000000, s33
    s_add_u32 s8, s48, s33
    s_addc_u32 s9, s49, 0
    s_mov_b32 s10, s34
    s_mov_b32 s11, 0x20000
    s_add_u32 s12, s50, s33
    s_addc_u32 s13, s51, 0
    s_mov_b32 s14, s34
    s_mov_b32 s15, 0x20000
    s_lshl_b32 s33, s29, 10
    s_add_u32 s33, s32, s33
    s_cmp_eq_u32 s31, 0
    s_cselect_b32 s58, s48, s50
    s_cselect_b32 s59, s49, s51
    s_add_u32 s64, s58, s33
    s_addc_u32 s65, s59, 0
    s_mov_b32 s66, 508928
    s_mov_b32 s67, 0x20000
    s_mov_b32 s68, 4294950912
    s_lshl_b32 s33, s2, 2
    s_add_u32 s33, s33, s27
    s_mul_i32 s33, s33, 28672
    s_add_u32 s33, s33, 4194304
    s_add_u32 s60, s56, s33
    s_addc_u32 s61, s57, 0
    s_mov_b32 s62, 28672
    s_mov_b32 s63, 0x20000
    s_mov_b32 s69, 0
    s_mov_b32 s45, 6
    s_mul_i32 s73, s30, 69632
    s_mul_i32 s34, s31, 8704
    s_add_u32 s34, s34, s73
    s_add_u32 s16, s34, 0
    s_add_u32 s17, s34, 17408
    s_add_u32 s18, s34, 34816
    s_add_u32 s19, s34, 52224
    s_mov_b32 s20, 0
    s_mov_b32 s21, 4096
    s_mov_b32 s22, 0
    s_mov_b32 s23, 4096
    s_mov_b32 s25, 0x39800000
    s_mov_b32 s26, 0x42cc0000
    v_lshrrev_b32 v5, 1, v4
    v_and_b32 v6, 1, v4
    v_lshlrev_b32 v6, 2, v6
    v_lshl_add_u32 v5, v5, 4, v6
    v_bfe_u32 v6, v2, 2, 2
    v_add_u32 v5, v5, v6
    v_and_b32 v6, 1, v5
    v_lshrrev_b32 v5, 1, v5
    v_mul_u32_u24 v5, 1088, v5
    v_lshl_add_u32 v5, v6, 9, v5
    v_and_b32 v7, 3, v2
    v_lshl_add_u32 v5, v7, 3, v5
    v_add_u32 v5, 34816, v5
    v_lshl_add_u32 v52, v6, 5, v5
    v_xor_b32 v6, 1, v6
    v_lshl_add_u32 v53, v6, 5, v5
    v_lshlrev_b32 v5, 6, v4
    v_add_u32 v54, 156928, v5
    s_waitcnt lgkmcnt(0)
    s_barrier
    ds_read_b128 v[0:3], v54 offset:0
    ds_read_b128 v[8:11], v54 offset:32
    ds_read_b128 v[4:7], v54 offset:16
    ds_read_b128 v[12:15], v54 offset:48
    s_waitcnt vmcnt(5)
    s_waitcnt lgkmcnt(2)
    v_fma_mix_f32 v48, v64, v0, v8 op_sel_hi:[1,0,0]
    v_fma_mix_f32 v49, v64, v1, v9 op_sel:[1,0,0] op_sel_hi:[1,0,0]
    v_cvt_pk_bf16_f32 v64, v48, v49
    s_waitcnt vmcnt(4)
    v_fma_mix_f32 v50, v68, v0, v8 op_sel_hi:[1,0,0]
    v_fma_mix_f32 v51, v68, v1, v9 op_sel:[1,0,0] op_sel_hi:[1,0,0]
    v_cvt_pk_bf16_f32 v68, v50, v51
    v_fma_mix_f32 v48, v65, v2, v10 op_sel_hi:[1,0,0]
    v_fma_mix_f32 v49, v65, v3, v11 op_sel:[1,0,0] op_sel_hi:[1,0,0]
    v_cvt_pk_bf16_f32 v65, v48, v49
    v_fma_mix_f32 v50, v69, v2, v10 op_sel_hi:[1,0,0]
    v_fma_mix_f32 v51, v69, v3, v11 op_sel:[1,0,0] op_sel_hi:[1,0,0]
    v_cvt_pk_bf16_f32 v69, v50, v51
    ds_read_b128 v[0:3], v54 offset:256
    ds_read_b128 v[8:11], v54 offset:288
    s_waitcnt lgkmcnt(2)
    v_fma_mix_f32 v48, v66, v4, v12 op_sel_hi:[1,0,0]
    v_fma_mix_f32 v49, v66, v5, v13 op_sel:[1,0,0] op_sel_hi:[1,0,0]
    v_cvt_pk_bf16_f32 v66, v48, v49
    v_fma_mix_f32 v50, v70, v4, v12 op_sel_hi:[1,0,0]
    v_fma_mix_f32 v51, v70, v5, v13 op_sel:[1,0,0] op_sel_hi:[1,0,0]
    v_cvt_pk_bf16_f32 v70, v50, v51
    v_fma_mix_f32 v48, v67, v6, v14 op_sel_hi:[1,0,0]
    v_fma_mix_f32 v49, v67, v7, v15 op_sel:[1,0,0] op_sel_hi:[1,0,0]
    v_cvt_pk_bf16_f32 v67, v48, v49
    v_fma_mix_f32 v50, v71, v6, v14 op_sel_hi:[1,0,0]
    v_fma_mix_f32 v51, v71, v7, v15 op_sel:[1,0,0] op_sel_hi:[1,0,0]
    v_cvt_pk_bf16_f32 v71, v50, v51
    ds_read_b128 v[4:7], v54 offset:272
    ds_read_b128 v[12:15], v54 offset:304
    ds_read_b64_tr_b16 v[16:17], v52 offset:0
    ds_read_b64_tr_b16 v[18:19], v52 offset:4352
    ds_read_b64_tr_b16 v[20:21], v53 offset:0
    ds_read_b64_tr_b16 v[22:23], v53 offset:4352
    ds_read_b64_tr_b16 v[24:25], v52 offset:64
    ds_read_b64_tr_b16 v[26:27], v52 offset:4416
    ds_read_b64_tr_b16 v[28:29], v53 offset:64
    ds_read_b64_tr_b16 v[30:31], v53 offset:4416
    ds_read_b64_tr_b16 v[32:33], v52 offset:128
    ds_read_b64_tr_b16 v[34:35], v52 offset:4480
    ds_read_b64_tr_b16 v[36:37], v53 offset:128
    ds_read_b64_tr_b16 v[38:39], v53 offset:4480
    s_waitcnt lgkmcnt(10)
    v_mfma_f32_16x16x32_bf16 v[128:131], v[16:19], v[64:67], 0
    s_waitcnt vmcnt(3)
    ds_read_b64_tr_b16 v[40:41], v52 offset:192
    v_fma_mix_f32 v48, v72, v0, v8 op_sel_hi:[1,0,0]
    v_fma_mix_f32 v49, v72, v1, v9 op_sel:[1,0,0] op_sel_hi:[1,0,0]
    v_mfma_f32_16x16x32_bf16 v[132:135], v[16:19], v[68:71], 0
    s_waitcnt lgkmcnt(9)
    ds_read_b64_tr_b16 v[42:43], v52 offset:4544
    buffer_load_dwordx4 v[80:83], v55, s[36:39], s44 offen offset:2048 sc1
    v_mfma_f32_16x16x32_bf16 v[140:143], v[20:23], v[68:71], 0
    ds_read_b64_tr_b16 v[44:45], v53 offset:192
    v_cvt_pk_bf16_f32 v72, v48, v49
    v_mfma_f32_16x16x32_bf16 v[136:139], v[20:23], v[64:67], 0
    s_waitcnt vmcnt(3) lgkmcnt(9)
    ds_read_b64_tr_b16 v[46:47], v53 offset:4544
    v_fma_mix_f32 v50, v76, v0, v8 op_sel_hi:[1,0,0]
    v_fma_mix_f32 v51, v76, v1, v9 op_sel:[1,0,0] op_sel_hi:[1,0,0]
    v_mfma_f32_16x16x32_bf16 v[144:147], v[24:27], v[64:67], 0
    s_waitcnt lgkmcnt(8)
    ds_read_b64_tr_b16 v[16:17], v52 offset:256
    buffer_load_dwordx4 v[84:87], v55, s[36:39], s72 offen offset:2048 sc1
    v_mfma_f32_16x16x32_bf16 v[148:151], v[24:27], v[68:71], 0
    s_mov_b32 s71, 524288
    ds_read_b64_tr_b16 v[18:19], v52 offset:4608
    v_cvt_pk_bf16_f32 v76, v50, v51
    v_mfma_f32_16x16x32_bf16 v[156:159], v[28:31], v[68:71], 0
    s_add_u32 m0, s70, 52224
    ds_read_b64_tr_b16 v[20:21], v53 offset:256
    v_fma_mix_f32 v48, v73, v2, v10 op_sel_hi:[1,0,0]
    v_fma_mix_f32 v49, v73, v3, v11 op_sel:[1,0,0] op_sel_hi:[1,0,0]
    v_mfma_f32_16x16x32_bf16 v[152:155], v[28:31], v[64:67], 0
    s_waitcnt lgkmcnt(6)
    ds_read_b64_tr_b16 v[22:23], v53 offset:4608
    buffer_load_dwordx4 v56, s[4:7], s71 offen lds
    v_mfma_f32_16x16x32_bf16 v[160:163], v[32:35], v[64:67], 0
    ds_read_b64_tr_b16 v[24:25], v52 offset:320
    v_cvt_pk_bf16_f32 v73, v48, v49
    v_mfma_f32_16x16x32_bf16 v[164:167], v[32:35], v[68:71], 0
    s_mov_b32 s71, 540672
    ds_read_b64_tr_b16 v[26:27], v52 offset:4672
    v_fma_mix_f32 v50, v77, v2, v10 op_sel_hi:[1,0,0]
    v_fma_mix_f32 v51, v77, v3, v11 op_sel:[1,0,0] op_sel_hi:[1,0,0]
    v_mfma_f32_16x16x32_bf16 v[172:175], v[36:39], v[68:71], 0
    s_add_u32 m0, s70, 53312
    ds_read_b64_tr_b16 v[28:29], v53 offset:320
    v_cvt_pk_bf16_f32 v77, v50, v51
    v_mfma_f32_16x16x32_bf16 v[168:171], v[36:39], v[64:67], 0
    s_waitcnt lgkmcnt(6)
    ds_read_b64_tr_b16 v[30:31], v53 offset:4672
    buffer_load_dwordx4 v56, s[4:7], s71 offen lds
    v_mfma_f32_16x16x32_bf16 v[176:179], v[40:43], v[64:67], 0
    s_mov_b32 s71, 589824
    ds_read_b64_tr_b16 v[32:33], v52 offset:384
    ds_read_b128 v[0:3], v54 offset:512
    ds_read_b128 v[8:11], v54 offset:544
    v_mfma_f32_16x16x32_bf16 v[180:183], v[40:43], v[68:71], 0
    s_add_u32 m0, s70, 54400
    ds_read_b64_tr_b16 v[34:35], v52 offset:4736
    v_fma_mix_f32 v48, v74, v4, v12 op_sel_hi:[1,0,0]
    v_mfma_f32_16x16x32_bf16 v[188:191], v[44:47], v[68:71], 0
    s_waitcnt lgkmcnt(8)
    ds_read_b64_tr_b16 v[36:37], v53 offset:384
    buffer_load_dwordx4 v56, s[4:7], s71 offen lds
    v_mfma_f32_16x16x32_bf16 v[184:187], v[44:47], v[64:67], 0
    s_mov_b32 s71, 606208
    ds_read_b64_tr_b16 v[38:39], v53 offset:4736
    v_fma_mix_f32 v49, v74, v5, v13 op_sel:[1,0,0] op_sel_hi:[1,0,0]
    v_cvt_pk_bf16_f32 v74, v48, v49
    v_mfma_f32_16x16x32_bf16 v[192:195], v[16:19], v[64:67], 0
    s_add_u32 m0, s70, 55488
    ds_read_b64_tr_b16 v[40:41], v52 offset:448
    v_fma_mix_f32 v50, v78, v4, v12 op_sel_hi:[1,0,0]
    v_mfma_f32_16x16x32_bf16 v[196:199], v[16:19], v[68:71], 0
    s_waitcnt lgkmcnt(8)
    ds_read_b64_tr_b16 v[42:43], v52 offset:4800
    buffer_load_dwordx4 v56, s[4:7], s71 offen lds
    v_mfma_f32_16x16x32_bf16 v[204:207], v[20:23], v[68:71], 0
    s_mov_b32 s71, 786432
    ds_read_b64_tr_b16 v[44:45], v53 offset:448
    v_add_u32 v52, 69632, v52
    v_mfma_f32_16x16x32_bf16 v[200:203], v[20:23], v[64:67], 0
    s_add_u32 m0, s70, 121856
    ds_read_b64_tr_b16 v[46:47], v53 offset:4800
    v_add_u32 v53, 69632, v53
    v_mfma_f32_16x16x32_bf16 v[208:211], v[24:27], v[64:67], 0
    s_barrier
    ds_read_b64_tr_b16 v[16:17], v52 offset:0
    v_mfma_f32_16x16x32_bf16 v[212:215], v[24:27], v[68:71], 0
    s_waitcnt lgkmcnt(6)
    ds_read_b64_tr_b16 v[18:19], v52 offset:4352
    buffer_load_dwordx4 v56, s[4:7], s71 offen lds
    v_mfma_f32_16x16x32_bf16 v[220:223], v[28:31], v[68:71], 0
    ds_read_b64_tr_b16 v[20:21], v53 offset:0
    v_fma_mix_f32 v51, v78, v5, v13 op_sel:[1,0,0] op_sel_hi:[1,0,0]
    v_cvt_pk_bf16_f32 v78, v50, v51
    v_mfma_f32_16x16x32_bf16 v[216:219], v[28:31], v[64:67], 0
    ds_read_b64_tr_b16 v[22:23], v53 offset:4352
    v_fma_mix_f32 v48, v75, v6, v14 op_sel_hi:[1,0,0]
    v_mfma_f32_16x16x32_bf16 v[224:227], v[32:35], v[64:67], 0
    ds_read_b64_tr_b16 v[24:25], v52 offset:64
    buffer_load_dwordx4 v[88:91], v55, s[36:39], s44 offen offset:3072 sc1
    v_mfma_f32_16x16x32_bf16 v[228:231], v[32:35], v[68:71], 0
    s_waitcnt lgkmcnt(6)
    ds_read_b64_tr_b16 v[26:27], v52 offset:4416
    v_fma_mix_f32 v49, v75, v7, v15 op_sel:[1,0,0] op_sel_hi:[1,0,0]
    v_cvt_pk_bf16_f32 v75, v48, v49
    v_mfma_f32_16x16x32_bf16 v[236:239], v[36:39], v[68:71], 0
    ds_read_b64_tr_b16 v[28:29], v53 offset:64
    v_fma_mix_f32 v50, v79, v6, v14 op_sel_hi:[1,0,0]
    v_mfma_f32_16x16x32_bf16 v[232:235], v[36:39], v[64:67], 0
    s_add_u32 s44, s44, 4096
    ds_read_b64_tr_b16 v[30:31], v53 offset:4416
    buffer_load_dwordx4 v[92:95], v55, s[36:39], s72 offen offset:3072 sc1
    s_add_u32 s72, s72, 4096
    v_mfma_f32_16x16x32_bf16 v[240:243], v[40:43], v[64:67], 0
    ds_read_b64_tr_b16 v[32:33], v52 offset:128
    v_fma_mix_f32 v51, v79, v7, v15 op_sel:[1,0,0] op_sel_hi:[1,0,0]
    v_cvt_pk_bf16_f32 v79, v50, v51
    v_mfma_f32_16x16x32_bf16 v[244:247], v[40:43], v[68:71], 0
    s_waitcnt lgkmcnt(6)
    ds_read_b64_tr_b16 v[34:35], v52 offset:4480
    ds_read_b128 v[4:7], v54 offset:528
    v_mfma_f32_16x16x32_bf16 v[252:255], v[44:47], v[68:71], 0
    s_waitcnt vmcnt(8)
    ds_read_b64_tr_b16 v[36:37], v53 offset:128
    ds_read_b128 v[12:15], v54 offset:560
    v_mfma_f32_16x16x32_bf16 v[248:251], v[44:47], v[64:67], 0
    s_mov_b32 s71, 802816
    ds_read_b64_tr_b16 v[38:39], v53 offset:4480
    v_mfma_f32_16x16x32_bf16 v[128:131], v[16:19], v[72:75], v[128:131]
    s_add_u32 m0, s70, 122944
    ds_read_b64_tr_b16 v[40:41], v52 offset:192
    v_fma_mix_f32 v48, v80, v0, v8 op_sel_hi:[1,0,0]
    v_fma_mix_f32 v49, v80, v1, v9 op_sel:[1,0,0] op_sel_hi:[1,0,0]
    v_mfma_f32_16x16x32_bf16 v[132:135], v[16:19], v[76:79], v[132:135]
    s_waitcnt lgkmcnt(8)
    ds_read_b64_tr_b16 v[42:43], v52 offset:4544
    buffer_load_dwordx4 v56, s[4:7], s71 offen lds
    v_mfma_f32_16x16x32_bf16 v[140:143], v[20:23], v[76:79], v[140:143]
    s_waitcnt vmcnt(8)
    ds_read_b64_tr_b16 v[44:45], v53 offset:192
    v_cvt_pk_bf16_f32 v80, v48, v49
    v_mfma_f32_16x16x32_bf16 v[136:139], v[20:23], v[72:75], v[136:139]
    s_mov_b32 s71, 851968
    ds_read_b64_tr_b16 v[46:47], v53 offset:4544
    v_fma_mix_f32 v50, v84, v0, v8 op_sel_hi:[1,0,0]
    v_mfma_f32_16x16x32_bf16 v[144:147], v[24:27], v[72:75], v[144:147]
    s_add_u32 m0, s70, 124032
    ds_read_b64_tr_b16 v[16:17], v52 offset:256
    v_fma_mix_f32 v51, v84, v1, v9 op_sel:[1,0,0] op_sel_hi:[1,0,0]
    v_cvt_pk_bf16_f32 v84, v50, v51
    v_mfma_f32_16x16x32_bf16 v[148:151], v[24:27], v[76:79], v[148:151]
    s_waitcnt lgkmcnt(6)
    ds_read_b64_tr_b16 v[18:19], v52 offset:4608
    buffer_load_dwordx4 v56, s[4:7], s71 offen lds
    v_mfma_f32_16x16x32_bf16 v[156:159], v[28:31], v[76:79], v[156:159]
    ds_read_b64_tr_b16 v[20:21], v53 offset:256
    v_fma_mix_f32 v48, v81, v2, v10 op_sel_hi:[1,0,0]
    v_mfma_f32_16x16x32_bf16 v[152:155], v[28:31], v[72:75], v[152:155]
    s_mov_b32 s71, 868352
    ds_read_b64_tr_b16 v[22:23], v53 offset:4608
    v_fma_mix_f32 v49, v81, v3, v11 op_sel:[1,0,0] op_sel_hi:[1,0,0]
    v_mfma_f32_16x16x32_bf16 v[160:163], v[32:35], v[72:75], v[160:163]
    s_add_u32 m0, s70, 125120
    ds_read_b64_tr_b16 v[24:25], v52 offset:320
    v_cvt_pk_bf16_f32 v81, v48, v49
    v_fma_mix_f32 v50, v85, v2, v10 op_sel_hi:[1,0,0]
    v_mfma_f32_16x16x32_bf16 v[164:167], v[32:35], v[76:79], v[164:167]
    s_waitcnt lgkmcnt(6)
    ds_read_b64_tr_b16 v[26:27], v52 offset:4672
    buffer_load_dwordx4 v56, s[4:7], s71 offen lds
    v_mfma_f32_16x16x32_bf16 v[172:175], v[36:39], v[76:79], v[172:175]
    ds_read_b64_tr_b16 v[28:29], v53 offset:320
    v_fma_mix_f32 v51, v85, v3, v11 op_sel:[1,0,0] op_sel_hi:[1,0,0]
    v_mfma_f32_16x16x32_bf16 v[168:171], v[36:39], v[72:75], v[168:171]
    s_mov_b32 s71, 1048576
    ds_read_b64_tr_b16 v[30:31], v53 offset:4672
    v_cvt_pk_bf16_f32 v85, v50, v51
    v_mfma_f32_16x16x32_bf16 v[176:179], v[40:43], v[72:75], v[176:179]
    s_add_u32 m0, s70, 139520
    ds_read_b64_tr_b16 v[32:33], v52 offset:384
    ds_read_b128 v[0:3], v54 offset:768
    ds_read_b128 v[8:11], v54 offset:800
    v_mfma_f32_16x16x32_bf16 v[180:183], v[40:43], v[76:79], v[180:183]
    s_waitcnt lgkmcnt(8)
    ds_read_b64_tr_b16 v[34:35], v52 offset:4736
    buffer_load_dwordx4 v56, s[4:7], s71 offen lds
    v_mfma_f32_16x16x32_bf16 v[188:191], v[44:47], v[76:79], v[188:191]
    ds_read_b64_tr_b16 v[36:37], v53 offset:384
    v_fma_mix_f32 v48, v82, v4, v12 op_sel_hi:[1,0,0]
    v_mfma_f32_16x16x32_bf16 v[184:187], v[44:47], v[72:75], v[184:187]
    ds_read_b64_tr_b16 v[38:39], v53 offset:4736
    v_fma_mix_f32 v49, v82, v5, v13 op_sel:[1,0,0] op_sel_hi:[1,0,0]
    v_mfma_f32_16x16x32_bf16 v[192:195], v[16:19], v[72:75], v[192:195]
    ds_read_b64_tr_b16 v[40:41], v52 offset:448
    v_cvt_pk_bf16_f32 v82, v48, v49
    v_fma_mix_f32 v50, v86, v4, v12 op_sel_hi:[1,0,0]
    v_mfma_f32_16x16x32_bf16 v[196:199], v[16:19], v[76:79], v[196:199]
    s_waitcnt lgkmcnt(8)
    ds_read_b64_tr_b16 v[42:43], v52 offset:4800
    v_fma_mix_f32 v51, v86, v5, v13 op_sel:[1,0,0] op_sel_hi:[1,0,0]
    v_mfma_f32_16x16x32_bf16 v[204:207], v[20:23], v[76:79], v[204:207]
    s_mov_b32 s71, 1064960
    ds_read_b64_tr_b16 v[44:45], v53 offset:448
    v_add_u32 v52, 4294915072, v52
    v_mfma_f32_16x16x32_bf16 v[200:203], v[20:23], v[72:75], v[200:203]
    s_add_u32 m0, s70, 140608
    ds_read_b64_tr_b16 v[46:47], v53 offset:4800
    v_add_u32 v53, 4294915072, v53
    v_mfma_f32_16x16x32_bf16 v[208:211], v[24:27], v[72:75], v[208:211]
    s_waitcnt vmcnt(7)
    s_barrier
    ds_read_b64_tr_b16 v[16:17], v52 offset:0
    v_mfma_f32_16x16x32_bf16 v[212:215], v[24:27], v[76:79], v[212:215]
    s_waitcnt lgkmcnt(6)
    ds_read_b64_tr_b16 v[18:19], v52 offset:4352
    buffer_load_dwordx4 v56, s[4:7], s71 offen lds
    v_mfma_f32_16x16x32_bf16 v[220:223], v[28:31], v[76:79], v[220:223]
    ds_read_b64_tr_b16 v[20:21], v53 offset:0
    buffer_load_dwordx4 v[96:99], v55, s[36:39], s44 offen offset:0 sc1
    v_mfma_f32_16x16x32_bf16 v[216:219], v[28:31], v[72:75], v[216:219]
    ds_read_b64_tr_b16 v[22:23], v53 offset:4352
    v_cvt_pk_bf16_f32 v86, v50, v51
    v_mfma_f32_16x16x32_bf16 v[224:227], v[32:35], v[72:75], v[224:227]
    ds_read_b64_tr_b16 v[24:25], v52 offset:64
    v_fma_mix_f32 v48, v83, v6, v14 op_sel_hi:[1,0,0]
    v_fma_mix_f32 v49, v83, v7, v15 op_sel:[1,0,0] op_sel_hi:[1,0,0]
    v_mfma_f32_16x16x32_bf16 v[228:231], v[32:35], v[76:79], v[228:231]
    s_waitcnt lgkmcnt(6)
    ds_read_b64_tr_b16 v[26:27], v52 offset:4416
    v_cvt_pk_bf16_f32 v83, v48, v49
    v_mfma_f32_16x16x32_bf16 v[236:239], v[36:39], v[76:79], v[236:239]
    ds_read_b64_tr_b16 v[28:29], v53 offset:64
    buffer_load_dwordx4 v[100:103], v55, s[36:39], s72 offen offset:0 sc1
    v_mfma_f32_16x16x32_bf16 v[232:235], v[36:39], v[72:75], v[232:235]
    ds_read_b64_tr_b16 v[30:31], v53 offset:4416
    v_fma_mix_f32 v50, v87, v6, v14 op_sel_hi:[1,0,0]
    v_mfma_f32_16x16x32_bf16 v[240:243], v[40:43], v[72:75], v[240:243]
    ds_read_b64_tr_b16 v[32:33], v52 offset:128
    v_fma_mix_f32 v51, v87, v7, v15 op_sel:[1,0,0] op_sel_hi:[1,0,0]
    v_cvt_pk_bf16_f32 v87, v50, v51
    v_mfma_f32_16x16x32_bf16 v[244:247], v[40:43], v[76:79], v[244:247]
    s_waitcnt lgkmcnt(6)
    ds_read_b64_tr_b16 v[34:35], v52 offset:4480
    ds_read_b128 v[4:7], v54 offset:784
    v_mfma_f32_16x16x32_bf16 v[252:255], v[44:47], v[76:79], v[252:255]
    s_waitcnt vmcnt(8)
    ds_read_b64_tr_b16 v[36:37], v53 offset:128
    ds_read_b128 v[12:15], v54 offset:816
    v_mfma_f32_16x16x32_bf16 v[248:251], v[44:47], v[72:75], v[248:251]
    s_mov_b32 s71, 1114112
    ds_read_b64_tr_b16 v[38:39], v53 offset:4480
    v_mfma_f32_16x16x32_bf16 v[128:131], v[16:19], v[80:83], v[128:131]
    s_add_u32 m0, s70, 141696
    ds_read_b64_tr_b16 v[40:41], v52 offset:192
    v_fma_mix_f32 v48, v88, v0, v8 op_sel_hi:[1,0,0]
    v_fma_mix_f32 v49, v88, v1, v9 op_sel:[1,0,0] op_sel_hi:[1,0,0]
    v_mfma_f32_16x16x32_bf16 v[132:135], v[16:19], v[84:87], v[132:135]
    s_waitcnt lgkmcnt(8)
    ds_read_b64_tr_b16 v[42:43], v52 offset:4544
    buffer_load_dwordx4 v56, s[4:7], s71 offen lds
    v_mfma_f32_16x16x32_bf16 v[140:143], v[20:23], v[84:87], v[140:143]
    s_waitcnt vmcnt(8)
    ds_read_b64_tr_b16 v[44:45], v53 offset:192
    v_cvt_pk_bf16_f32 v88, v48, v49
    v_mfma_f32_16x16x32_bf16 v[136:139], v[20:23], v[80:83], v[136:139]
    s_mov_b32 s71, 1130496
    ds_read_b64_tr_b16 v[46:47], v53 offset:4544
    v_fma_mix_f32 v50, v92, v0, v8 op_sel_hi:[1,0,0]
    v_mfma_f32_16x16x32_bf16 v[144:147], v[24:27], v[80:83], v[144:147]
    s_add_u32 m0, s70, 142784
    ds_read_b64_tr_b16 v[16:17], v52 offset:256
    v_fma_mix_f32 v51, v92, v1, v9 op_sel:[1,0,0] op_sel_hi:[1,0,0]
    v_cvt_pk_bf16_f32 v92, v50, v51
    v_mfma_f32_16x16x32_bf16 v[148:151], v[24:27], v[84:87], v[148:151]
    s_waitcnt lgkmcnt(6)
    ds_read_b64_tr_b16 v[18:19], v52 offset:4608
    buffer_load_dwordx4 v56, s[4:7], s71 offen lds
    v_mfma_f32_16x16x32_bf16 v[156:159], v[28:31], v[84:87], v[156:159]
    ds_read_b64_tr_b16 v[20:21], v53 offset:256
    v_fma_mix_f32 v48, v89, v2, v10 op_sel_hi:[1,0,0]
    v_mfma_f32_16x16x32_bf16 v[152:155], v[28:31], v[80:83], v[152:155]
    s_mov_b32 s71, 1310720
    ds_read_b64_tr_b16 v[22:23], v53 offset:4608
    v_fma_mix_f32 v49, v89, v3, v11 op_sel:[1,0,0] op_sel_hi:[1,0,0]
    v_mfma_f32_16x16x32_bf16 v[160:163], v[32:35], v[80:83], v[160:163]
    s_add_u32 m0, s70, 0
    ds_read_b64_tr_b16 v[24:25], v52 offset:320
    v_cvt_pk_bf16_f32 v89, v48, v49
    v_fma_mix_f32 v50, v93, v2, v10 op_sel_hi:[1,0,0]
    v_mfma_f32_16x16x32_bf16 v[164:167], v[32:35], v[84:87], v[164:167]
    s_waitcnt lgkmcnt(6)
    ds_read_b64_tr_b16 v[26:27], v52 offset:4672
    buffer_load_dwordx4 v56, s[4:7], s71 offen lds
    v_mfma_f32_16x16x32_bf16 v[172:175], v[36:39], v[84:87], v[172:175]
    ds_read_b64_tr_b16 v[28:29], v53 offset:320
    v_fma_mix_f32 v51, v93, v3, v11 op_sel:[1,0,0] op_sel_hi:[1,0,0]
    v_mfma_f32_16x16x32_bf16 v[168:171], v[36:39], v[80:83], v[168:171]
    s_mov_b32 s71, 1327104
    ds_read_b64_tr_b16 v[30:31], v53 offset:4672
    v_cvt_pk_bf16_f32 v93, v50, v51
    v_mfma_f32_16x16x32_bf16 v[176:179], v[40:43], v[80:83], v[176:179]
    s_add_u32 m0, s70, 1088
    ds_read_b64_tr_b16 v[32:33], v52 offset:384
    ds_read_b128 v[0:3], v54 offset:1024
    ds_read_b128 v[8:11], v54 offset:1056
    v_mfma_f32_16x16x32_bf16 v[180:183], v[40:43], v[84:87], v[180:183]
    s_waitcnt lgkmcnt(8)
    ds_read_b64_tr_b16 v[34:35], v52 offset:4736
    buffer_load_dwordx4 v56, s[4:7], s71 offen lds
    v_mfma_f32_16x16x32_bf16 v[188:191], v[44:47], v[84:87], v[188:191]
    ds_read_b64_tr_b16 v[36:37], v53 offset:384
    v_fma_mix_f32 v48, v90, v4, v12 op_sel_hi:[1,0,0]
    v_mfma_f32_16x16x32_bf16 v[184:187], v[44:47], v[80:83], v[184:187]
    ds_read_b64_tr_b16 v[38:39], v53 offset:4736
    v_fma_mix_f32 v49, v90, v5, v13 op_sel:[1,0,0] op_sel_hi:[1,0,0]
    v_mfma_f32_16x16x32_bf16 v[192:195], v[16:19], v[80:83], v[192:195]
    ds_read_b64_tr_b16 v[40:41], v52 offset:448
    v_cvt_pk_bf16_f32 v90, v48, v49
    v_fma_mix_f32 v50, v94, v4, v12 op_sel_hi:[1,0,0]
    v_mfma_f32_16x16x32_bf16 v[196:199], v[16:19], v[84:87], v[196:199]
    s_waitcnt lgkmcnt(8)
    ds_read_b64_tr_b16 v[42:43], v52 offset:4800
    v_fma_mix_f32 v51, v94, v5, v13 op_sel:[1,0,0] op_sel_hi:[1,0,0]
    v_mfma_f32_16x16x32_bf16 v[204:207], v[20:23], v[84:87], v[204:207]
    s_mov_b32 s71, 1376256
    ds_read_b64_tr_b16 v[44:45], v53 offset:448
    v_add_u32 v52, 69632, v52
    v_mfma_f32_16x16x32_bf16 v[200:203], v[20:23], v[80:83], v[200:203]
    s_add_u32 m0, s70, 2176
    ds_read_b64_tr_b16 v[46:47], v53 offset:4800
    v_add_u32 v53, 69632, v53
    v_mfma_f32_16x16x32_bf16 v[208:211], v[24:27], v[80:83], v[208:211]
    s_waitcnt vmcnt(8)
    s_barrier
    ds_read_b64_tr_b16 v[16:17], v52 offset:0
    v_mfma_f32_16x16x32_bf16 v[212:215], v[24:27], v[84:87], v[212:215]
    s_waitcnt lgkmcnt(6)
    ds_read_b64_tr_b16 v[18:19], v52 offset:4352
    buffer_load_dwordx4 v56, s[4:7], s71 offen lds
    v_mfma_f32_16x16x32_bf16 v[220:223], v[28:31], v[84:87], v[220:223]
    ds_read_b64_tr_b16 v[20:21], v53 offset:0
    buffer_load_dwordx4 v[104:107], v55, s[36:39], s44 offen offset:1024 sc1
    v_mfma_f32_16x16x32_bf16 v[216:219], v[28:31], v[80:83], v[216:219]
    ds_read_b64_tr_b16 v[22:23], v53 offset:4352
    v_cvt_pk_bf16_f32 v94, v50, v51
    v_mfma_f32_16x16x32_bf16 v[224:227], v[32:35], v[80:83], v[224:227]
    ds_read_b64_tr_b16 v[24:25], v52 offset:64
    v_fma_mix_f32 v48, v91, v6, v14 op_sel_hi:[1,0,0]
    v_fma_mix_f32 v49, v91, v7, v15 op_sel:[1,0,0] op_sel_hi:[1,0,0]
    v_mfma_f32_16x16x32_bf16 v[228:231], v[32:35], v[84:87], v[228:231]
    s_waitcnt lgkmcnt(6)
    ds_read_b64_tr_b16 v[26:27], v52 offset:4416
    v_cvt_pk_bf16_f32 v91, v48, v49
    v_mfma_f32_16x16x32_bf16 v[236:239], v[36:39], v[84:87], v[236:239]
    ds_read_b64_tr_b16 v[28:29], v53 offset:64
    buffer_load_dwordx4 v[108:111], v55, s[36:39], s72 offen offset:1024 sc1
    v_mfma_f32_16x16x32_bf16 v[232:235], v[36:39], v[80:83], v[232:235]
    ds_read_b64_tr_b16 v[30:31], v53 offset:4416
    v_fma_mix_f32 v50, v95, v6, v14 op_sel_hi:[1,0,0]
    v_mfma_f32_16x16x32_bf16 v[240:243], v[40:43], v[80:83], v[240:243]
    ds_read_b64_tr_b16 v[32:33], v52 offset:128
    v_fma_mix_f32 v51, v95, v7, v15 op_sel:[1,0,0] op_sel_hi:[1,0,0]
    v_cvt_pk_bf16_f32 v95, v50, v51
    v_mfma_f32_16x16x32_bf16 v[244:247], v[40:43], v[84:87], v[244:247]
    s_waitcnt lgkmcnt(6)
    ds_read_b64_tr_b16 v[34:35], v52 offset:4480
    ds_read_b128 v[4:7], v54 offset:1040
    v_mfma_f32_16x16x32_bf16 v[252:255], v[44:47], v[84:87], v[252:255]
    s_waitcnt vmcnt(8)
    ds_read_b64_tr_b16 v[36:37], v53 offset:128
    ds_read_b128 v[12:15], v54 offset:1072
    v_mfma_f32_16x16x32_bf16 v[248:251], v[44:47], v[80:83], v[248:251]
    s_mov_b32 s71, 1392640
    ds_read_b64_tr_b16 v[38:39], v53 offset:4480
    v_mfma_f32_16x16x32_bf16 v[128:131], v[16:19], v[88:91], v[128:131]
    s_add_u32 m0, s70, 3264
    ds_read_b64_tr_b16 v[40:41], v52 offset:192
    v_fma_mix_f32 v48, v96, v0, v8 op_sel_hi:[1,0,0]
    v_fma_mix_f32 v49, v96, v1, v9 op_sel:[1,0,0] op_sel_hi:[1,0,0]
    v_mfma_f32_16x16x32_bf16 v[132:135], v[16:19], v[92:95], v[132:135]
    s_waitcnt lgkmcnt(8)
    ds_read_b64_tr_b16 v[42:43], v52 offset:4544
    buffer_load_dwordx4 v56, s[4:7], s71 offen lds
    v_mfma_f32_16x16x32_bf16 v[140:143], v[20:23], v[92:95], v[140:143]
    s_waitcnt vmcnt(8)
    ds_read_b64_tr_b16 v[44:45], v53 offset:192
    v_cvt_pk_bf16_f32 v96, v48, v49
    v_mfma_f32_16x16x32_bf16 v[136:139], v[20:23], v[88:91], v[136:139]
    s_mov_b32 s71, 1572864
    ds_read_b64_tr_b16 v[46:47], v53 offset:4544
    v_fma_mix_f32 v50, v100, v0, v8 op_sel_hi:[1,0,0]
    v_mfma_f32_16x16x32_bf16 v[144:147], v[24:27], v[88:91], v[144:147]
    s_add_u32 m0, s70, 69632
    ds_read_b64_tr_b16 v[16:17], v52 offset:256
    v_fma_mix_f32 v51, v100, v1, v9 op_sel:[1,0,0] op_sel_hi:[1,0,0]
    v_cvt_pk_bf16_f32 v100, v50, v51
    v_mfma_f32_16x16x32_bf16 v[148:151], v[24:27], v[92:95], v[148:151]
    s_waitcnt lgkmcnt(6)
    ds_read_b64_tr_b16 v[18:19], v52 offset:4608
    buffer_load_dwordx4 v56, s[4:7], s71 offen lds
    v_mfma_f32_16x16x32_bf16 v[156:159], v[28:31], v[92:95], v[156:159]
    ds_read_b64_tr_b16 v[20:21], v53 offset:256
    v_fma_mix_f32 v48, v97, v2, v10 op_sel_hi:[1,0,0]
    v_mfma_f32_16x16x32_bf16 v[152:155], v[28:31], v[88:91], v[152:155]
    s_mov_b32 s71, 1589248
    ds_read_b64_tr_b16 v[22:23], v53 offset:4608
    v_fma_mix_f32 v49, v97, v3, v11 op_sel:[1,0,0] op_sel_hi:[1,0,0]
    v_mfma_f32_16x16x32_bf16 v[160:163], v[32:35], v[88:91], v[160:163]
    s_add_u32 m0, s70, 70720
    ds_read_b64_tr_b16 v[24:25], v52 offset:320
    v_cvt_pk_bf16_f32 v97, v48, v49
    v_fma_mix_f32 v50, v101, v2, v10 op_sel_hi:[1,0,0]
    v_mfma_f32_16x16x32_bf16 v[164:167], v[32:35], v[92:95], v[164:167]
    s_waitcnt lgkmcnt(6)
    ds_read_b64_tr_b16 v[26:27], v52 offset:4672
    buffer_load_dwordx4 v56, s[4:7], s71 offen lds
    v_mfma_f32_16x16x32_bf16 v[172:175], v[36:39], v[92:95], v[172:175]
    ds_read_b64_tr_b16 v[28:29], v53 offset:320
    v_fma_mix_f32 v51, v101, v3, v11 op_sel:[1,0,0] op_sel_hi:[1,0,0]
    v_mfma_f32_16x16x32_bf16 v[168:171], v[36:39], v[88:91], v[168:171]
    s_mov_b32 s71, 1638400
    ds_read_b64_tr_b16 v[30:31], v53 offset:4672
    v_cvt_pk_bf16_f32 v101, v50, v51
    v_mfma_f32_16x16x32_bf16 v[176:179], v[40:43], v[88:91], v[176:179]
    s_add_u32 m0, s70, 71808
    ds_read_b64_tr_b16 v[32:33], v52 offset:384
    ds_read_b128 v[0:3], v54 offset:1280
    ds_read_b128 v[8:11], v54 offset:1312
    v_mfma_f32_16x16x32_bf16 v[180:183], v[40:43], v[92:95], v[180:183]
    s_waitcnt lgkmcnt(8)
    ds_read_b64_tr_b16 v[34:35], v52 offset:4736
    buffer_load_dwordx4 v56, s[4:7], s71 offen lds
    v_mfma_f32_16x16x32_bf16 v[188:191], v[44:47], v[92:95], v[188:191]
    ds_read_b64_tr_b16 v[36:37], v53 offset:384
    v_fma_mix_f32 v48, v98, v4, v12 op_sel_hi:[1,0,0]
    v_mfma_f32_16x16x32_bf16 v[184:187], v[44:47], v[88:91], v[184:187]
    ds_read_b64_tr_b16 v[38:39], v53 offset:4736
    v_fma_mix_f32 v49, v98, v5, v13 op_sel:[1,0,0] op_sel_hi:[1,0,0]
    v_mfma_f32_16x16x32_bf16 v[192:195], v[16:19], v[88:91], v[192:195]
    ds_read_b64_tr_b16 v[40:41], v52 offset:448
    v_cvt_pk_bf16_f32 v98, v48, v49
    v_fma_mix_f32 v50, v102, v4, v12 op_sel_hi:[1,0,0]
    v_mfma_f32_16x16x32_bf16 v[196:199], v[16:19], v[92:95], v[196:199]
    s_waitcnt lgkmcnt(8)
    ds_read_b64_tr_b16 v[42:43], v52 offset:4800
    v_fma_mix_f32 v51, v102, v5, v13 op_sel:[1,0,0] op_sel_hi:[1,0,0]
    v_mfma_f32_16x16x32_bf16 v[204:207], v[20:23], v[92:95], v[204:207]
    s_mov_b32 s71, 1654784
    ds_read_b64_tr_b16 v[44:45], v53 offset:448
    v_add_u32 v52, 17664, v52
    v_mfma_f32_16x16x32_bf16 v[200:203], v[20:23], v[88:91], v[200:203]
    s_add_u32 m0, s70, 72896
    ds_read_b64_tr_b16 v[46:47], v53 offset:4800
    v_add_u32 v53, 17664, v53
    v_mfma_f32_16x16x32_bf16 v[208:211], v[24:27], v[88:91], v[208:211]
    s_waitcnt vmcnt(9)
    s_barrier
    ds_read_b64_tr_b16 v[16:17], v52 offset:0
    v_mfma_f32_16x16x32_bf16 v[212:215], v[24:27], v[92:95], v[212:215]
    s_waitcnt lgkmcnt(6)
    ds_read_b64_tr_b16 v[18:19], v52 offset:4352
    buffer_load_dwordx4 v56, s[4:7], s71 offen lds
    v_mfma_f32_16x16x32_bf16 v[220:223], v[28:31], v[92:95], v[220:223]
    ds_read_b64_tr_b16 v[20:21], v53 offset:0
    buffer_load_dwordx4 v[112:115], v55, s[36:39], s44 offen offset:2048 sc1
    v_mfma_f32_16x16x32_bf16 v[216:219], v[28:31], v[88:91], v[216:219]
    ds_read_b64_tr_b16 v[22:23], v53 offset:4352
    v_cvt_pk_bf16_f32 v102, v50, v51
    v_mfma_f32_16x16x32_bf16 v[224:227], v[32:35], v[88:91], v[224:227]
    ds_read_b64_tr_b16 v[24:25], v52 offset:64
    v_fma_mix_f32 v48, v99, v6, v14 op_sel_hi:[1,0,0]
    v_fma_mix_f32 v49, v99, v7, v15 op_sel:[1,0,0] op_sel_hi:[1,0,0]
    v_mfma_f32_16x16x32_bf16 v[228:231], v[32:35], v[92:95], v[228:231]
    s_waitcnt lgkmcnt(6)
    ds_read_b64_tr_b16 v[26:27], v52 offset:4416
    v_cvt_pk_bf16_f32 v99, v48, v49
    v_mfma_f32_16x16x32_bf16 v[236:239], v[36:39], v[92:95], v[236:239]
    ds_read_b64_tr_b16 v[28:29], v53 offset:64
    buffer_load_dwordx4 v[116:119], v55, s[36:39], s72 offen offset:2048 sc1
    v_mfma_f32_16x16x32_bf16 v[232:235], v[36:39], v[88:91], v[232:235]
    ds_read_b64_tr_b16 v[30:31], v53 offset:4416
    v_fma_mix_f32 v50, v103, v6, v14 op_sel_hi:[1,0,0]
    v_mfma_f32_16x16x32_bf16 v[240:243], v[40:43], v[88:91], v[240:243]
    ds_read_b64_tr_b16 v[32:33], v52 offset:128
    v_fma_mix_f32 v51, v103, v7, v15 op_sel:[1,0,0] op_sel_hi:[1,0,0]
    v_cvt_pk_bf16_f32 v103, v50, v51
    v_mfma_f32_16x16x32_bf16 v[244:247], v[40:43], v[92:95], v[244:247]
    s_waitcnt lgkmcnt(6)
    ds_read_b64_tr_b16 v[34:35], v52 offset:4480
    ds_read_b128 v[4:7], v54 offset:1296
    v_mfma_f32_16x16x32_bf16 v[252:255], v[44:47], v[92:95], v[252:255]
    s_waitcnt vmcnt(8)
    ds_read_b64_tr_b16 v[36:37], v53 offset:128
    ds_read_b128 v[12:15], v54 offset:1328
    v_mfma_f32_16x16x32_bf16 v[248:251], v[44:47], v[88:91], v[248:251]
    s_mov_b32 s71, 1835008
    ds_read_b64_tr_b16 v[38:39], v53 offset:4480
    v_mfma_f32_16x16x32_bf16 v[128:131], v[16:19], v[96:99], v[128:131]
    s_add_u32 m0, s70, 17408
    ds_read_b64_tr_b16 v[40:41], v52 offset:192
    v_fma_mix_f32 v48, v104, v0, v8 op_sel_hi:[1,0,0]
    v_fma_mix_f32 v49, v104, v1, v9 op_sel:[1,0,0] op_sel_hi:[1,0,0]
    v_mfma_f32_16x16x32_bf16 v[132:135], v[16:19], v[100:103], v[132:135]
    s_waitcnt lgkmcnt(8)
    ds_read_b64_tr_b16 v[42:43], v52 offset:4544
    buffer_load_dwordx4 v56, s[4:7], s71 offen lds
    v_mfma_f32_16x16x32_bf16 v[140:143], v[20:23], v[100:103], v[140:143]
    ds_read_b64_tr_b16 v[44:45], v53 offset:192
    v_cvt_pk_bf16_f32 v104, v48, v49
    v_mfma_f32_16x16x32_bf16 v[136:139], v[20:23], v[96:99], v[136:139]
    s_waitcnt vmcnt(8) lgkmcnt(8)
    ds_read_b64_tr_b16 v[46:47], v53 offset:4544
    v_fma_mix_f32 v50, v108, v0, v8 op_sel_hi:[1,0,0]
    v_mfma_f32_16x16x32_bf16 v[144:147], v[24:27], v[96:99], v[144:147]
    s_mov_b32 s71, 1851392
    ds_read_b64_tr_b16 v[16:17], v52 offset:256
    v_fma_mix_f32 v51, v108, v1, v9 op_sel:[1,0,0] op_sel_hi:[1,0,0]
    v_cvt_pk_bf16_f32 v108, v50, v51
    v_mfma_f32_16x16x32_bf16 v[148:151], v[24:27], v[100:103], v[148:151]
    s_add_u32 m0, s70, 18496
    ds_read_b64_tr_b16 v[18:19], v52 offset:4608
    v_fma_mix_f32 v48, v105, v2, v10 op_sel_hi:[1,0,0]
    v_mfma_f32_16x16x32_bf16 v[156:159], v[28:31], v[100:103], v[156:159]
    ds_read_b64_tr_b16 v[20:21], v53 offset:256
    buffer_load_dwordx4 v56, s[4:7], s71 offen lds
    v_mfma_f32_16x16x32_bf16 v[152:155], v[28:31], v[96:99], v[152:155]
    s_waitcnt lgkmcnt(6)
    ds_read_b64_tr_b16 v[22:23], v53 offset:4608
    v_fma_mix_f32 v49, v105, v3, v11 op_sel:[1,0,0] op_sel_hi:[1,0,0]
    v_mfma_f32_16x16x32_bf16 v[160:163], v[32:35], v[96:99], v[160:163]
    ds_read_b64_tr_b16 v[24:25], v52 offset:320
    v_cvt_pk_bf16_f32 v105, v48, v49
    v_mfma_f32_16x16x32_bf16 v[164:167], v[32:35], v[100:103], v[164:167]
    s_mov_b32 s71, 1900544
    ds_read_b64_tr_b16 v[26:27], v52 offset:4672
    v_fma_mix_f32 v50, v109, v2, v10 op_sel_hi:[1,0,0]
    v_fma_mix_f32 v51, v109, v3, v11 op_sel:[1,0,0] op_sel_hi:[1,0,0]
    v_mfma_f32_16x16x32_bf16 v[172:175], v[36:39], v[100:103], v[172:175]
    s_add_u32 m0, s70, 19584
    ds_read_b64_tr_b16 v[28:29], v53 offset:320
    v_cvt_pk_bf16_f32 v109, v50, v51
    v_mfma_f32_16x16x32_bf16 v[168:171], v[36:39], v[96:99], v[168:171]
    s_waitcnt lgkmcnt(6)
    ds_read_b64_tr_b16 v[30:31], v53 offset:4672
    buffer_load_dwordx4 v56, s[4:7], s71 offen lds
    v_mfma_f32_16x16x32_bf16 v[176:179], v[40:43], v[96:99], v[176:179]
    ds_read_b64_tr_b16 v[32:33], v52 offset:384
    ds_read_b128 v[0:3], v54 offset:1536
    v_mfma_f32_16x16x32_bf16 v[180:183], v[40:43], v[100:103], v[180:183]
    s_waitcnt lgkmcnt(7)
    ds_read_b64_tr_b16 v[34:35], v52 offset:4736
    ds_read_b128 v[8:11], v54 offset:1568
    v_mfma_f32_16x16x32_bf16 v[188:191], v[44:47], v[100:103], v[188:191]
    s_mov_b32 s71, 1916928
    ds_read_b64_tr_b16 v[36:37], v53 offset:384
    v_fma_mix_f32 v48, v106, v4, v12 op_sel_hi:[1,0,0]
    v_fma_mix_f32 v49, v106, v5, v13 op_sel:[1,0,0] op_sel_hi:[1,0,0]
    v_mfma_f32_16x16x32_bf16 v[184:187], v[44:47], v[96:99], v[184:187]
    s_add_u32 m0, s70, 20672
    ds_read_b64_tr_b16 v[38:39], v53 offset:4736
    v_cvt_pk_bf16_f32 v106, v48, v49
    v_mfma_f32_16x16x32_bf16 v[192:195], v[16:19], v[96:99], v[192:195]
    ds_read_b64_tr_b16 v[40:41], v52 offset:448
    buffer_load_dwordx4 v56, s[4:7], s71 offen lds
    v_mfma_f32_16x16x32_bf16 v[196:199], v[16:19], v[100:103], v[196:199]
    s_waitcnt lgkmcnt(8)
    ds_read_b64_tr_b16 v[42:43], v52 offset:4800
    v_fma_mix_f32 v50, v110, v4, v12 op_sel_hi:[1,0,0]
    v_mfma_f32_16x16x32_bf16 v[204:207], v[20:23], v[100:103], v[204:207]
    ds_read_b64_tr_b16 v[44:45], v53 offset:448
    v_add_u32 v52, 4294827776, v52
    v_mfma_f32_16x16x32_bf16 v[200:203], v[20:23], v[96:99], v[200:203]
    ds_read_b64_tr_b16 v[46:47], v53 offset:4800
    v_add_u32 v53, 4294827776, v53
    v_mfma_f32_16x16x32_bf16 v[208:211], v[24:27], v[96:99], v[208:211]
    s_waitcnt vmcnt(10)
    s_barrier
    ds_read_b64_tr_b16 v[16:17], v52 offset:0
    v_mfma_f32_16x16x32_bf16 v[212:215], v[24:27], v[100:103], v[212:215]
    s_waitcnt lgkmcnt(6)
    ds_read_b64_tr_b16 v[18:19], v52 offset:4352
    buffer_load_dwordx4 v[120:123], v55, s[36:39], s44 offen offset:3072 sc1
    v_mfma_f32_16x16x32_bf16 v[220:223], v[28:31], v[100:103], v[220:223]
    ds_read_b64_tr_b16 v[20:21], v53 offset:0
    v_fma_mix_f32 v51, v110, v5, v13 op_sel:[1,0,0] op_sel_hi:[1,0,0]
    v_cvt_pk_bf16_f32 v110, v50, v51
    v_mfma_f32_16x16x32_bf16 v[216:219], v[28:31], v[96:99], v[216:219]
    ds_read_b64_tr_b16 v[22:23], v53 offset:4352
    v_fma_mix_f32 v48, v107, v6, v14 op_sel_hi:[1,0,0]
    v_mfma_f32_16x16x32_bf16 v[224:227], v[32:35], v[96:99], v[224:227]
    ds_read_b64_tr_b16 v[24:25], v52 offset:64
    v_fma_mix_f32 v49, v107, v7, v15 op_sel:[1,0,0] op_sel_hi:[1,0,0]
    v_mfma_f32_16x16x32_bf16 v[228:231], v[32:35], v[100:103], v[228:231]
    s_waitcnt lgkmcnt(6)
    ds_read_b64_tr_b16 v[26:27], v52 offset:4416
    v_cvt_pk_bf16_f32 v107, v48, v49
    v_mfma_f32_16x16x32_bf16 v[236:239], v[36:39], v[100:103], v[236:239]
    s_add_u32 s44, s44, 4096
    ds_read_b64_tr_b16 v[28:29], v53 offset:64
    buffer_load_dwordx4 v[124:127], v55, s[36:39], s72 offen offset:3072 sc1
    s_add_u32 s72, s72, 4096
    v_mfma_f32_16x16x32_bf16 v[232:235], v[36:39], v[96:99], v[232:235]
    ds_read_b64_tr_b16 v[30:31], v53 offset:4416
    v_fma_mix_f32 v50, v111, v6, v14 op_sel_hi:[1,0,0]
    v_fma_mix_f32 v51, v111, v7, v15 op_sel:[1,0,0] op_sel_hi:[1,0,0]
    v_mfma_f32_16x16x32_bf16 v[240:243], v[40:43], v[96:99], v[240:243]
    ds_read_b64_tr_b16 v[32:33], v52 offset:128
    v_cvt_pk_bf16_f32 v111, v50, v51
    v_mfma_f32_16x16x32_bf16 v[244:247], v[40:43], v[100:103], v[244:247]
    s_waitcnt lgkmcnt(6)
    ds_read_b64_tr_b16 v[34:35], v52 offset:4480
    ds_read_b128 v[4:7], v54 offset:1552
    v_mfma_f32_16x16x32_bf16 v[252:255], v[44:47], v[100:103], v[252:255]
    s_waitcnt vmcnt(7)
    ds_read_b64_tr_b16 v[36:37], v53 offset:128
    ds_read_b128 v[12:15], v54 offset:1584
    v_mfma_f32_16x16x32_bf16 v[248:251], v[44:47], v[96:99], v[248:251]
    s_mov_b32 s71, 2097152
    ds_read_b64_tr_b16 v[38:39], v53 offset:4480
    v_mfma_f32_16x16x32_bf16 v[128:131], v[16:19], v[104:107], v[128:131]
    s_add_u32 m0, s70, 87040
    ds_read_b64_tr_b16 v[40:41], v52 offset:192
    v_fma_mix_f32 v48, v112, v0, v8 op_sel_hi:[1,0,0]
    v_fma_mix_f32 v49, v112, v1, v9 op_sel:[1,0,0] op_sel_hi:[1,0,0]
    v_mfma_f32_16x16x32_bf16 v[132:135], v[16:19], v[108:111], v[132:135]
    s_waitcnt vmcnt(6) lgkmcnt(8)
    ds_read_b64_tr_b16 v[42:43], v52 offset:4544
    buffer_load_dwordx4 v56, s[4:7], s71 offen lds
    v_mfma_f32_16x16x32_bf16 v[140:143], v[20:23], v[108:111], v[140:143]
    s_mov_b32 s71, 2113536
    ds_read_b64_tr_b16 v[44:45], v53 offset:192
    v_cvt_pk_bf16_f32 v112, v48, v49
    v_mfma_f32_16x16x32_bf16 v[136:139], v[20:23], v[104:107], v[136:139]
    s_add_u32 m0, s70, 88128
    ds_read_b64_tr_b16 v[46:47], v53 offset:4544
    v_fma_mix_f32 v50, v116, v0, v8 op_sel_hi:[1,0,0]
    v_fma_mix_f32 v51, v116, v1, v9 op_sel:[1,0,0] op_sel_hi:[1,0,0]
    v_mfma_f32_16x16x32_bf16 v[144:147], v[24:27], v[104:107], v[144:147]
    s_waitcnt lgkmcnt(7)
    ds_read_b64_tr_b16 v[16:17], v52 offset:256
    buffer_load_dwordx4 v56, s[4:7], s71 offen lds
    v_mfma_f32_16x16x32_bf16 v[148:151], v[24:27], v[108:111], v[148:151]
    s_mov_b32 s71, 2162688
    ds_read_b64_tr_b16 v[18:19], v52 offset:4608
    v_cvt_pk_bf16_f32 v116, v50, v51
    v_mfma_f32_16x16x32_bf16 v[156:159], v[28:31], v[108:111], v[156:159]
    s_add_u32 m0, s70, 89216
    ds_read_b64_tr_b16 v[20:21], v53 offset:256
    v_fma_mix_f32 v48, v113, v2, v10 op_sel_hi:[1,0,0]
    v_fma_mix_f32 v49, v113, v3, v11 op_sel:[1,0,0] op_sel_hi:[1,0,0]
    v_mfma_f32_16x16x32_bf16 v[152:155], v[28:31], v[104:107], v[152:155]
    ds_read_b64_tr_b16 v[22:23], v53 offset:4608
    buffer_load_dwordx4 v56, s[4:7], s71 offen lds
    v_mfma_f32_16x16x32_bf16 v[160:163], v[32:35], v[104:107], v[160:163]
    s_waitcnt lgkmcnt(6)
    ds_read_b64_tr_b16 v[24:25], v52 offset:320
    v_cvt_pk_bf16_f32 v113, v48, v49
    v_mfma_f32_16x16x32_bf16 v[164:167], v[32:35], v[108:111], v[164:167]
    s_mov_b32 s71, 2179072
    ds_read_b64_tr_b16 v[26:27], v52 offset:4672
    v_fma_mix_f32 v50, v117, v2, v10 op_sel_hi:[1,0,0]
    v_fma_mix_f32 v51, v117, v3, v11 op_sel:[1,0,0] op_sel_hi:[1,0,0]
    v_mfma_f32_16x16x32_bf16 v[172:175], v[36:39], v[108:111], v[172:175]
    s_add_u32 m0, s70, 90304
    ds_read_b64_tr_b16 v[28:29], v53 offset:320
    v_cvt_pk_bf16_f32 v117, v50, v51
    v_mfma_f32_16x16x32_bf16 v[168:171], v[36:39], v[104:107], v[168:171]
    s_waitcnt lgkmcnt(6)
    ds_read_b64_tr_b16 v[30:31], v53 offset:4672
    buffer_load_dwordx4 v56, s[4:7], s71 offen lds
    v_mfma_f32_16x16x32_bf16 v[176:179], v[40:43], v[104:107], v[176:179]
    s_mov_b32 s71, 2359296
    ds_read_b64_tr_b16 v[32:33], v52 offset:384
    ds_read_b128 v[0:3], v54 offset:1792
    ds_read_b128 v[8:11], v54 offset:1824
    v_mfma_f32_16x16x32_bf16 v[180:183], v[40:43], v[108:111], v[180:183]
    s_add_u32 m0, s70, 34816
    ds_read_b64_tr_b16 v[34:35], v52 offset:4736
    v_fma_mix_f32 v48, v114, v4, v12 op_sel_hi:[1,0,0]
    v_mfma_f32_16x16x32_bf16 v[188:191], v[44:47], v[108:111], v[188:191]
    ds_read_b64_tr_b16 v[36:37], v53 offset:384
    buffer_load_dwordx4 v56, s[4:7], s71 offen lds
    v_mfma_f32_16x16x32_bf16 v[184:187], v[44:47], v[104:107], v[184:187]
    s_waitcnt lgkmcnt(8)
    ds_read_b64_tr_b16 v[38:39], v53 offset:4736
    v_fma_mix_f32 v49, v114, v5, v13 op_sel:[1,0,0] op_sel_hi:[1,0,0]
    v_cvt_pk_bf16_f32 v114, v48, v49
    v_mfma_f32_16x16x32_bf16 v[192:195], v[16:19], v[104:107], v[192:195]
    ds_read_b64_tr_b16 v[40:41], v52 offset:448
    v_fma_mix_f32 v50, v118, v4, v12 op_sel_hi:[1,0,0]
    v_mfma_f32_16x16x32_bf16 v[196:199], v[16:19], v[108:111], v[196:199]
    ds_read_b64_tr_b16 v[42:43], v52 offset:4800
    buffer_load_dwordx4 v[64:67], v55, s[36:39], s44 offen offset:0 sc1
    v_mfma_f32_16x16x32_bf16 v[204:207], v[20:23], v[108:111], v[204:207]
    ds_read_b64_tr_b16 v[44:45], v53 offset:448
    v_add_u32 v52, 69632, v52
    v_mfma_f32_16x16x32_bf16 v[200:203], v[20:23], v[104:107], v[200:203]
    s_waitcnt lgkmcnt(6)
    ds_read_b64_tr_b16 v[46:47], v53 offset:4800
    v_add_u32 v53, 69632, v53
    v_mfma_f32_16x16x32_bf16 v[208:211], v[24:27], v[104:107], v[208:211]
    s_barrier
    ds_read_b64_tr_b16 v[16:17], v52 offset:0
    v_mfma_f32_16x16x32_bf16 v[212:215], v[24:27], v[108:111], v[212:215]
    ds_read_b64_tr_b16 v[18:19], v52 offset:4352
    buffer_load_dwordx4 v[68:71], v55, s[36:39], s72 offen offset:0 sc1
    v_mfma_f32_16x16x32_bf16 v[220:223], v[28:31], v[108:111], v[220:223]
    ds_read_b64_tr_b16 v[20:21], v53 offset:0
    v_fma_mix_f32 v51, v118, v5, v13 op_sel:[1,0,0] op_sel_hi:[1,0,0]
    v_cvt_pk_bf16_f32 v118, v50, v51
    v_mfma_f32_16x16x32_bf16 v[216:219], v[28:31], v[104:107], v[216:219]
    s_waitcnt lgkmcnt(6)
    ds_read_b64_tr_b16 v[22:23], v53 offset:4352
    v_fma_mix_f32 v48, v115, v6, v14 op_sel_hi:[1,0,0]
    v_mfma_f32_16x16x32_bf16 v[224:227], v[32:35], v[104:107], v[224:227]
    ds_read_b64_tr_b16 v[24:25], v52 offset:64
    buffer_load_dwordx4 v[72:75], v55, s[36:39], s44 offen offset:1024 sc1
    v_mfma_f32_16x16x32_bf16 v[228:231], v[32:35], v[108:111], v[228:231]
    ds_read_b64_tr_b16 v[26:27], v52 offset:4416
    v_fma_mix_f32 v49, v115, v7, v15 op_sel:[1,0,0] op_sel_hi:[1,0,0]
    v_cvt_pk_bf16_f32 v115, v48, v49
    v_mfma_f32_16x16x32_bf16 v[236:239], v[36:39], v[108:111], v[236:239]
    ds_read_b64_tr_b16 v[28:29], v53 offset:64
    v_fma_mix_f32 v50, v119, v6, v14 op_sel_hi:[1,0,0]
    v_mfma_f32_16x16x32_bf16 v[232:235], v[36:39], v[104:107], v[232:235]
    s_waitcnt lgkmcnt(6)
    ds_read_b64_tr_b16 v[30:31], v53 offset:4416
    buffer_load_dwordx4 v[76:79], v55, s[36:39], s72 offen offset:1024 sc1
    v_mfma_f32_16x16x32_bf16 v[240:243], v[40:43], v[104:107], v[240:243]
    ds_read_b64_tr_b16 v[32:33], v52 offset:128
    v_fma_mix_f32 v51, v119, v7, v15 op_sel:[1,0,0] op_sel_hi:[1,0,0]
    v_cvt_pk_bf16_f32 v119, v50, v51
    v_mfma_f32_16x16x32_bf16 v[244:247], v[40:43], v[108:111], v[244:247]
    ds_read_b64_tr_b16 v[34:35], v52 offset:4480
    ds_read_b128 v[4:7], v54 offset:1808
    v_mfma_f32_16x16x32_bf16 v[252:255], v[44:47], v[108:111], v[252:255]
    s_waitcnt vmcnt(10) lgkmcnt(7)
    ds_read_b64_tr_b16 v[36:37], v53 offset:128
    ds_read_b128 v[12:15], v54 offset:1840
    v_mfma_f32_16x16x32_bf16 v[248:251], v[44:47], v[104:107], v[248:251]
    s_mov_b32 s71, 2375680
    ds_read_b64_tr_b16 v[38:39], v53 offset:4480
    v_mfma_f32_16x16x32_bf16 v[128:131], v[16:19], v[112:115], v[128:131]
    s_add_u32 m0, s70, 35904
    ds_read_b64_tr_b16 v[40:41], v52 offset:192
    v_fma_mix_f32 v48, v120, v0, v8 op_sel_hi:[1,0,0]
    v_fma_mix_f32 v49, v120, v1, v9 op_sel:[1,0,0] op_sel_hi:[1,0,0]
    v_mfma_f32_16x16x32_bf16 v[132:135], v[16:19], v[116:119], v[132:135]
    ds_read_b64_tr_b16 v[42:43], v52 offset:4544
    buffer_load_dwordx4 v56, s[4:7], s71 offen lds
    v_mfma_f32_16x16x32_bf16 v[140:143], v[20:23], v[116:119], v[140:143]
    s_waitcnt vmcnt(10) lgkmcnt(8)
    ds_read_b64_tr_b16 v[44:45], v53 offset:192
    v_cvt_pk_bf16_f32 v120, v48, v49
    v_mfma_f32_16x16x32_bf16 v[136:139], v[20:23], v[112:115], v[136:139]
    s_mov_b32 s71, 2424832
    ds_read_b64_tr_b16 v[46:47], v53 offset:4544
    v_fma_mix_f32 v50, v124, v0, v8 op_sel_hi:[1,0,0]
    v_mfma_f32_16x16x32_bf16 v[144:147], v[24:27], v[112:115], v[144:147]
    s_add_u32 m0, s70, 36992
    ds_read_b64_tr_b16 v[16:17], v52 offset:256
    v_fma_mix_f32 v51, v124, v1, v9 op_sel:[1,0,0] op_sel_hi:[1,0,0]
    v_cvt_pk_bf16_f32 v124, v50, v51
    v_mfma_f32_16x16x32_bf16 v[148:151], v[24:27], v[116:119], v[148:151]
    ds_read_b64_tr_b16 v[18:19], v52 offset:4608
    buffer_load_dwordx4 v56, s[4:7], s71 offen lds
    v_mfma_f32_16x16x32_bf16 v[156:159], v[28:31], v[116:119], v[156:159]
    s_waitcnt lgkmcnt(6)
    ds_read_b64_tr_b16 v[20:21], v53 offset:256
    v_fma_mix_f32 v48, v121, v2, v10 op_sel_hi:[1,0,0]
    v_mfma_f32_16x16x32_bf16 v[152:155], v[28:31], v[112:115], v[152:155]
    s_mov_b32 s71, 2441216
    ds_read_b64_tr_b16 v[22:23], v53 offset:4608
    v_fma_mix_f32 v49, v121, v3, v11 op_sel:[1,0,0] op_sel_hi:[1,0,0]
    v_mfma_f32_16x16x32_bf16 v[160:163], v[32:35], v[112:115], v[160:163]
    s_add_u32 m0, s70, 38080
    ds_read_b64_tr_b16 v[24:25], v52 offset:320
    v_cvt_pk_bf16_f32 v121, v48, v49
    v_fma_mix_f32 v50, v125, v2, v10 op_sel_hi:[1,0,0]
    v_mfma_f32_16x16x32_bf16 v[164:167], v[32:35], v[116:119], v[164:167]
    ds_read_b64_tr_b16 v[26:27], v52 offset:4672
    buffer_load_dwordx4 v56, s[4:7], s71 offen lds
    v_mfma_f32_16x16x32_bf16 v[172:175], v[36:39], v[116:119], v[172:175]
    s_waitcnt lgkmcnt(6)
    ds_read_b64_tr_b16 v[28:29], v53 offset:320
    v_fma_mix_f32 v51, v125, v3, v11 op_sel:[1,0,0] op_sel_hi:[1,0,0]
    v_mfma_f32_16x16x32_bf16 v[168:171], v[36:39], v[112:115], v[168:171]
    s_mov_b32 s71, 2621440
    ds_read_b64_tr_b16 v[30:31], v53 offset:4672
    v_cvt_pk_bf16_f32 v125, v50, v51
    v_mfma_f32_16x16x32_bf16 v[176:179], v[40:43], v[112:115], v[176:179]
    s_add_u32 m0, s70, 104448
    ds_read_b64_tr_b16 v[32:33], v52 offset:384
    ds_read_b128 v[0:3], v54 offset:2048
    ds_read_b128 v[8:11], v54 offset:2080
    v_mfma_f32_16x16x32_bf16 v[180:183], v[40:43], v[116:119], v[180:183]
    ds_read_b64_tr_b16 v[34:35], v52 offset:4736
    buffer_load_dwordx4 v56, s[4:7], s71 offen lds
    v_mfma_f32_16x16x32_bf16 v[188:191], v[44:47], v[116:119], v[188:191]
    ds_read_b64_tr_b16 v[36:37], v53 offset:384
    v_fma_mix_f32 v48, v122, v4, v12 op_sel_hi:[1,0,0]
    v_mfma_f32_16x16x32_bf16 v[184:187], v[44:47], v[112:115], v[184:187]
    s_waitcnt lgkmcnt(8)
    ds_read_b64_tr_b16 v[38:39], v53 offset:4736
    v_fma_mix_f32 v49, v122, v5, v13 op_sel:[1,0,0] op_sel_hi:[1,0,0]
    v_mfma_f32_16x16x32_bf16 v[192:195], v[16:19], v[112:115], v[192:195]
    ds_read_b64_tr_b16 v[40:41], v52 offset:448
    v_cvt_pk_bf16_f32 v122, v48, v49
    v_fma_mix_f32 v50, v126, v4, v12 op_sel_hi:[1,0,0]
    v_mfma_f32_16x16x32_bf16 v[196:199], v[16:19], v[116:119], v[196:199]
    s_waitcnt lgkmcnt(8)
    ds_read_b64_tr_b16 v[42:43], v52 offset:4800
    v_fma_mix_f32 v51, v126, v5, v13 op_sel:[1,0,0] op_sel_hi:[1,0,0]
    v_mfma_f32_16x16x32_bf16 v[204:207], v[20:23], v[116:119], v[204:207]
    s_mov_b32 s71, 2637824
    ds_read_b64_tr_b16 v[44:45], v53 offset:448
    v_add_u32 v52, 4294915072, v52
    v_mfma_f32_16x16x32_bf16 v[200:203], v[20:23], v[112:115], v[200:203]
    s_add_u32 m0, s70, 105536
    ds_read_b64_tr_b16 v[46:47], v53 offset:4800
    v_add_u32 v53, 4294915072, v53
    v_mfma_f32_16x16x32_bf16 v[208:211], v[24:27], v[112:115], v[208:211]
    s_barrier
    ds_read_b64_tr_b16 v[16:17], v52 offset:0
    v_mfma_f32_16x16x32_bf16 v[212:215], v[24:27], v[116:119], v[212:215]
    s_waitcnt lgkmcnt(6)
    ds_read_b64_tr_b16 v[18:19], v52 offset:4352
    buffer_load_dwordx4 v56, s[4:7], s71 offen lds
    v_mfma_f32_16x16x32_bf16 v[220:223], v[28:31], v[116:119], v[220:223]
    ds_read_b64_tr_b16 v[20:21], v53 offset:0
    buffer_load_dwordx4 v[80:83], v55, s[36:39], s44 offen offset:2048 sc1
    v_mfma_f32_16x16x32_bf16 v[216:219], v[28:31], v[112:115], v[216:219]
    ds_read_b64_tr_b16 v[22:23], v53 offset:4352
    v_cvt_pk_bf16_f32 v126, v50, v51
    v_mfma_f32_16x16x32_bf16 v[224:227], v[32:35], v[112:115], v[224:227]
    ds_read_b64_tr_b16 v[24:25], v52 offset:64
    v_fma_mix_f32 v48, v123, v6, v14 op_sel_hi:[1,0,0]
    v_fma_mix_f32 v49, v123, v7, v15 op_sel:[1,0,0] op_sel_hi:[1,0,0]
    v_mfma_f32_16x16x32_bf16 v[228:231], v[32:35], v[116:119], v[228:231]
    s_waitcnt lgkmcnt(6)
    ds_read_b64_tr_b16 v[26:27], v52 offset:4416
    v_cvt_pk_bf16_f32 v123, v48, v49
    v_mfma_f32_16x16x32_bf16 v[236:239], v[36:39], v[116:119], v[236:239]
    ds_read_b64_tr_b16 v[28:29], v53 offset:64
    buffer_load_dwordx4 v[84:87], v55, s[36:39], s72 offen offset:2048 sc1
    v_mfma_f32_16x16x32_bf16 v[232:235], v[36:39], v[112:115], v[232:235]
    ds_read_b64_tr_b16 v[30:31], v53 offset:4416
    v_fma_mix_f32 v50, v127, v6, v14 op_sel_hi:[1,0,0]
    v_mfma_f32_16x16x32_bf16 v[240:243], v[40:43], v[112:115], v[240:243]
    ds_read_b64_tr_b16 v[32:33], v52 offset:128
    v_fma_mix_f32 v51, v127, v7, v15 op_sel:[1,0,0] op_sel_hi:[1,0,0]
    v_cvt_pk_bf16_f32 v127, v50, v51
    v_mfma_f32_16x16x32_bf16 v[244:247], v[40:43], v[116:119], v[244:247]
    s_waitcnt lgkmcnt(6)
    ds_read_b64_tr_b16 v[34:35], v52 offset:4480
    ds_read_b128 v[4:7], v54 offset:2064
    v_mfma_f32_16x16x32_bf16 v[252:255], v[44:47], v[116:119], v[252:255]
    s_waitcnt vmcnt(10)
    ds_read_b64_tr_b16 v[36:37], v53 offset:128
    ds_read_b128 v[12:15], v54 offset:2096
    v_mfma_f32_16x16x32_bf16 v[248:251], v[44:47], v[112:115], v[248:251]
    s_mov_b32 s71, 2686976
    ds_read_b64_tr_b16 v[38:39], v53 offset:4480
    v_mfma_f32_16x16x32_bf16 v[128:131], v[16:19], v[120:123], v[128:131]
    s_add_u32 m0, s70, 106624
    ds_read_b64_tr_b16 v[40:41], v52 offset:192
    v_fma_mix_f32 v48, v64, v0, v8 op_sel_hi:[1,0,0]
    v_fma_mix_f32 v49, v64, v1, v9 op_sel:[1,0,0] op_sel_hi:[1,0,0]
    v_mfma_f32_16x16x32_bf16 v[132:135], v[16:19], v[124:127], v[132:135]
    s_waitcnt lgkmcnt(8)
    ds_read_b64_tr_b16 v[42:43], v52 offset:4544
    buffer_load_dwordx4 v56, s[4:7], s71 offen lds
    v_mfma_f32_16x16x32_bf16 v[140:143], v[20:23], v[124:127], v[140:143]
    s_waitcnt vmcnt(10)
    ds_read_b64_tr_b16 v[44:45], v53 offset:192
    v_cvt_pk_bf16_f32 v64, v48, v49
    v_mfma_f32_16x16x32_bf16 v[136:139], v[20:23], v[120:123], v[136:139]
    s_mov_b32 s71, 2703360
    ds_read_b64_tr_b16 v[46:47], v53 offset:4544
    v_fma_mix_f32 v50, v68, v0, v8 op_sel_hi:[1,0,0]
    v_mfma_f32_16x16x32_bf16 v[144:147], v[24:27], v[120:123], v[144:147]
    s_add_u32 m0, s70, 107712
    ds_read_b64_tr_b16 v[16:17], v52 offset:256
    v_fma_mix_f32 v51, v68, v1, v9 op_sel:[1,0,0] op_sel_hi:[1,0,0]
    v_cvt_pk_bf16_f32 v68, v50, v51
    v_mfma_f32_16x16x32_bf16 v[148:151], v[24:27], v[124:127], v[148:151]
    s_waitcnt lgkmcnt(6)
    ds_read_b64_tr_b16 v[18:19], v52 offset:4608
    buffer_load_dwordx4 v56, s[4:7], s71 offen lds
    v_mfma_f32_16x16x32_bf16 v[156:159], v[28:31], v[124:127], v[156:159]
    ds_read_b64_tr_b16 v[20:21], v53 offset:256
    v_fma_mix_f32 v48, v65, v2, v10 op_sel_hi:[1,0,0]
    v_mfma_f32_16x16x32_bf16 v[152:155], v[28:31], v[120:123], v[152:155]
    s_mov_b32 s71, 2883584
    ds_read_b64_tr_b16 v[22:23], v53 offset:4608
    v_fma_mix_f32 v49, v65, v3, v11 op_sel:[1,0,0] op_sel_hi:[1,0,0]
    v_mfma_f32_16x16x32_bf16 v[160:163], v[32:35], v[120:123], v[160:163]
    s_add_u32 m0, s70, 52224
    ds_read_b64_tr_b16 v[24:25], v52 offset:320
    v_cvt_pk_bf16_f32 v65, v48, v49
    v_fma_mix_f32 v50, v69, v2, v10 op_sel_hi:[1,0,0]
    v_mfma_f32_16x16x32_bf16 v[164:167], v[32:35], v[124:127], v[164:167]
    s_waitcnt lgkmcnt(6)
    ds_read_b64_tr_b16 v[26:27], v52 offset:4672
    buffer_load_dwordx4 v56, s[4:7], s71 offen lds
    v_mfma_f32_16x16x32_bf16 v[172:175], v[36:39], v[124:127], v[172:175]
    ds_read_b64_tr_b16 v[28:29], v53 offset:320
    v_fma_mix_f32 v51, v69, v3, v11 op_sel:[1,0,0] op_sel_hi:[1,0,0]
    v_mfma_f32_16x16x32_bf16 v[168:171], v[36:39], v[120:123], v[168:171]
    s_mov_b32 s71, 2899968
    ds_read_b64_tr_b16 v[30:31], v53 offset:4672
    v_cvt_pk_bf16_f32 v69, v50, v51
    v_mfma_f32_16x16x32_bf16 v[176:179], v[40:43], v[120:123], v[176:179]
    s_add_u32 m0, s70, 53312
    ds_read_b64_tr_b16 v[32:33], v52 offset:384
    ds_read_b128 v[0:3], v54 offset:2304
    ds_read_b128 v[8:11], v54 offset:2336
    v_mfma_f32_16x16x32_bf16 v[180:183], v[40:43], v[124:127], v[180:183]
    s_waitcnt lgkmcnt(8)
    ds_read_b64_tr_b16 v[34:35], v52 offset:4736
    buffer_load_dwordx4 v56, s[4:7], s71 offen lds
    v_mfma_f32_16x16x32_bf16 v[188:191], v[44:47], v[124:127], v[188:191]
    ds_read_b64_tr_b16 v[36:37], v53 offset:384
    v_fma_mix_f32 v48, v66, v4, v12 op_sel_hi:[1,0,0]
    v_mfma_f32_16x16x32_bf16 v[184:187], v[44:47], v[120:123], v[184:187]
    ds_read_b64_tr_b16 v[38:39], v53 offset:4736
    v_fma_mix_f32 v49, v66, v5, v13 op_sel:[1,0,0] op_sel_hi:[1,0,0]
    v_mfma_f32_16x16x32_bf16 v[192:195], v[16:19], v[120:123], v[192:195]
    ds_read_b64_tr_b16 v[40:41], v52 offset:448
    v_cvt_pk_bf16_f32 v66, v48, v49
    v_fma_mix_f32 v50, v70, v4, v12 op_sel_hi:[1,0,0]
    v_mfma_f32_16x16x32_bf16 v[196:199], v[16:19], v[124:127], v[196:199]
    s_waitcnt lgkmcnt(8)
    ds_read_b64_tr_b16 v[42:43], v52 offset:4800
    v_fma_mix_f32 v51, v70, v5, v13 op_sel:[1,0,0] op_sel_hi:[1,0,0]
    v_mfma_f32_16x16x32_bf16 v[204:207], v[20:23], v[124:127], v[204:207]
    s_mov_b32 s71, 2949120
    ds_read_b64_tr_b16 v[44:45], v53 offset:448
    v_add_u32 v52, 69632, v52
    v_mfma_f32_16x16x32_bf16 v[200:203], v[20:23], v[120:123], v[200:203]
    s_add_u32 m0, s70, 54400
    ds_read_b64_tr_b16 v[46:47], v53 offset:4800
    v_add_u32 v53, 69632, v53
    v_mfma_f32_16x16x32_bf16 v[208:211], v[24:27], v[120:123], v[208:211]
    s_barrier
    ds_read_b64_tr_b16 v[16:17], v52 offset:0
    v_mfma_f32_16x16x32_bf16 v[212:215], v[24:27], v[124:127], v[212:215]
    s_waitcnt lgkmcnt(6)
    ds_read_b64_tr_b16 v[18:19], v52 offset:4352
    buffer_load_dwordx4 v56, s[4:7], s71 offen lds
    v_mfma_f32_16x16x32_bf16 v[220:223], v[28:31], v[124:127], v[220:223]
    ds_read_b64_tr_b16 v[20:21], v53 offset:0
    buffer_load_dwordx4 v[88:91], v55, s[36:39], s44 offen offset:3072 sc1
    v_mfma_f32_16x16x32_bf16 v[216:219], v[28:31], v[120:123], v[216:219]
    ds_read_b64_tr_b16 v[22:23], v53 offset:4352
    v_cvt_pk_bf16_f32 v70, v50, v51
    v_mfma_f32_16x16x32_bf16 v[224:227], v[32:35], v[120:123], v[224:227]
    ds_read_b64_tr_b16 v[24:25], v52 offset:64
    v_fma_mix_f32 v48, v67, v6, v14 op_sel_hi:[1,0,0]
    v_fma_mix_f32 v49, v67, v7, v15 op_sel:[1,0,0] op_sel_hi:[1,0,0]
    v_mfma_f32_16x16x32_bf16 v[228:231], v[32:35], v[124:127], v[228:231]
    s_waitcnt lgkmcnt(6)
    ds_read_b64_tr_b16 v[26:27], v52 offset:4416
    v_cvt_pk_bf16_f32 v67, v48, v49
    v_mfma_f32_16x16x32_bf16 v[236:239], v[36:39], v[124:127], v[236:239]
    s_add_u32 s44, s44, 4096
    ds_read_b64_tr_b16 v[28:29], v53 offset:64
    buffer_load_dwordx4 v[92:95], v55, s[36:39], s72 offen offset:3072 sc1
    s_add_u32 s72, s72, 4096
    v_mfma_f32_16x16x32_bf16 v[232:235], v[36:39], v[120:123], v[232:235]
    ds_read_b64_tr_b16 v[30:31], v53 offset:4416
    v_fma_mix_f32 v50, v71, v6, v14 op_sel_hi:[1,0,0]
    v_mfma_f32_16x16x32_bf16 v[240:243], v[40:43], v[120:123], v[240:243]
    ds_read_b64_tr_b16 v[32:33], v52 offset:128
    v_fma_mix_f32 v51, v71, v7, v15 op_sel:[1,0,0] op_sel_hi:[1,0,0]
    v_cvt_pk_bf16_f32 v71, v50, v51
    v_mfma_f32_16x16x32_bf16 v[244:247], v[40:43], v[124:127], v[244:247]
    s_waitcnt lgkmcnt(6)
    ds_read_b64_tr_b16 v[34:35], v52 offset:4480
    ds_read_b128 v[4:7], v54 offset:2320
    v_mfma_f32_16x16x32_bf16 v[252:255], v[44:47], v[124:127], v[252:255]
    s_waitcnt vmcnt(15)
    ds_read_b64_tr_b16 v[36:37], v53 offset:128
    ds_read_b128 v[12:15], v54 offset:2352
    v_mfma_f32_16x16x32_bf16 v[248:251], v[44:47], v[120:123], v[248:251]
    s_mov_b32 s71, 2965504
    ds_read_b64_tr_b16 v[38:39], v53 offset:4480
    v_mfma_f32_16x16x32_bf16 v[128:131], v[16:19], v[64:67], v[128:131]
    s_add_u32 m0, s70, 55488
    ds_read_b64_tr_b16 v[40:41], v52 offset:192
    v_fma_mix_f32 v48, v72, v0, v8 op_sel_hi:[1,0,0]
    v_fma_mix_f32 v49, v72, v1, v9 op_sel:[1,0,0] op_sel_hi:[1,0,0]
    v_mfma_f32_16x16x32_bf16 v[132:135], v[16:19], v[68:71], v[132:135]
    s_waitcnt vmcnt(14) lgkmcnt(8)
    ds_read_b64_tr_b16 v[42:43], v52 offset:4544
    buffer_load_dwordx4 v56, s[4:7], s71 offen lds
    v_mfma_f32_16x16x32_bf16 v[140:143], v[20:23], v[68:71], v[140:143]
    s_mov_b32 s71, 3145728
    ds_read_b64_tr_b16 v[44:45], v53 offset:192
    v_cvt_pk_bf16_f32 v72, v48, v49
    v_mfma_f32_16x16x32_bf16 v[136:139], v[20:23], v[64:67], v[136:139]
    s_add_u32 m0, s70, 121856
    ds_read_b64_tr_b16 v[46:47], v53 offset:4544
    v_fma_mix_f32 v50, v76, v0, v8 op_sel_hi:[1,0,0]
    v_fma_mix_f32 v51, v76, v1, v9 op_sel:[1,0,0] op_sel_hi:[1,0,0]
    v_mfma_f32_16x16x32_bf16 v[144:147], v[24:27], v[64:67], v[144:147]
    s_waitcnt lgkmcnt(7)
    ds_read_b64_tr_b16 v[16:17], v52 offset:256
    buffer_load_dwordx4 v56, s[4:7], s71 offen lds
    v_mfma_f32_16x16x32_bf16 v[148:151], v[24:27], v[68:71], v[148:151]
    s_mov_b32 s71, 3162112
    ds_read_b64_tr_b16 v[18:19], v52 offset:4608
    v_cvt_pk_bf16_f32 v76, v50, v51
    v_mfma_f32_16x16x32_bf16 v[156:159], v[28:31], v[68:71], v[156:159]
    s_add_u32 m0, s70, 122944
    ds_read_b64_tr_b16 v[20:21], v53 offset:256
    v_fma_mix_f32 v48, v73, v2, v10 op_sel_hi:[1,0,0]
    v_fma_mix_f32 v49, v73, v3, v11 op_sel:[1,0,0] op_sel_hi:[1,0,0]
    v_mfma_f32_16x16x32_bf16 v[152:155], v[28:31], v[64:67], v[152:155]
    ds_read_b64_tr_b16 v[22:23], v53 offset:4608
    buffer_load_dwordx4 v56, s[4:7], s71 offen lds
    v_mfma_f32_16x16x32_bf16 v[160:163], v[32:35], v[64:67], v[160:163]
    s_waitcnt lgkmcnt(6)
    ds_read_b64_tr_b16 v[24:25], v52 offset:320
    v_cvt_pk_bf16_f32 v73, v48, v49
    v_mfma_f32_16x16x32_bf16 v[164:167], v[32:35], v[68:71], v[164:167]
    s_mov_b32 s71, 3211264
    ds_read_b64_tr_b16 v[26:27], v52 offset:4672
    v_fma_mix_f32 v50, v77, v2, v10 op_sel_hi:[1,0,0]
    v_fma_mix_f32 v51, v77, v3, v11 op_sel:[1,0,0] op_sel_hi:[1,0,0]
    v_mfma_f32_16x16x32_bf16 v[172:175], v[36:39], v[68:71], v[172:175]
    s_add_u32 m0, s70, 124032
    ds_read_b64_tr_b16 v[28:29], v53 offset:320
    v_cvt_pk_bf16_f32 v77, v50, v51
    v_mfma_f32_16x16x32_bf16 v[168:171], v[36:39], v[64:67], v[168:171]
    s_waitcnt lgkmcnt(6)
    ds_read_b64_tr_b16 v[30:31], v53 offset:4672
    buffer_load_dwordx4 v56, s[4:7], s71 offen lds
    v_mfma_f32_16x16x32_bf16 v[176:179], v[40:43], v[64:67], v[176:179]
    s_mov_b32 s71, 3227648
    ds_read_b64_tr_b16 v[32:33], v52 offset:384
    ds_read_b128 v[0:3], v54 offset:2560
    ds_read_b128 v[8:11], v54 offset:2592
    v_mfma_f32_16x16x32_bf16 v[180:183], v[40:43], v[68:71], v[180:183]
    s_add_u32 m0, s70, 125120
    ds_read_b64_tr_b16 v[34:35], v52 offset:4736
    v_fma_mix_f32 v48, v74, v4, v12 op_sel_hi:[1,0,0]
    v_mfma_f32_16x16x32_bf16 v[188:191], v[44:47], v[68:71], v[188:191]
    ds_read_b64_tr_b16 v[36:37], v53 offset:384
    buffer_load_dwordx4 v56, s[4:7], s71 offen lds
    v_mfma_f32_16x16x32_bf16 v[184:187], v[44:47], v[64:67], v[184:187]
    s_waitcnt lgkmcnt(8)
    ds_read_b64_tr_b16 v[38:39], v53 offset:4736
    v_fma_mix_f32 v49, v74, v5, v13 op_sel:[1,0,0] op_sel_hi:[1,0,0]
    v_cvt_pk_bf16_f32 v74, v48, v49
    v_mfma_f32_16x16x32_bf16 v[192:195], v[16:19], v[64:67], v[192:195]
    ds_read_b64_tr_b16 v[40:41], v52 offset:448
    v_fma_mix_f32 v50, v78, v4, v12 op_sel_hi:[1,0,0]
    v_mfma_f32_16x16x32_bf16 v[196:199], v[16:19], v[68:71], v[196:199]
    ds_read_b64_tr_b16 v[42:43], v52 offset:4800
    buffer_load_dwordx4 v[96:99], v55, s[36:39], s44 offen offset:0 sc1
    v_mfma_f32_16x16x32_bf16 v[204:207], v[20:23], v[68:71], v[204:207]
    ds_read_b64_tr_b16 v[44:45], v53 offset:448
    v_add_u32 v52, 4294915072, v52
    v_mfma_f32_16x16x32_bf16 v[200:203], v[20:23], v[64:67], v[200:203]
    s_waitcnt lgkmcnt(6)
    ds_read_b64_tr_b16 v[46:47], v53 offset:4800
    v_add_u32 v53, 4294915072, v53
    v_mfma_f32_16x16x32_bf16 v[208:211], v[24:27], v[64:67], v[208:211]
    s_waitcnt vmcnt(17)
    s_barrier
    ds_read_b64_tr_b16 v[16:17], v52 offset:0
    v_mfma_f32_16x16x32_bf16 v[212:215], v[24:27], v[68:71], v[212:215]
    s_waitcnt lgkmcnt(6)
    ds_read_b64_tr_b16 v[18:19], v52 offset:4352
    buffer_load_dwordx4 v[100:103], v55, s[36:39], s72 offen offset:0 sc1
    v_mfma_f32_16x16x32_bf16 v[220:223], v[28:31], v[68:71], v[220:223]
    s_add_u32 s68, s68, 16384
    ds_read_b64_tr_b16 v[20:21], v53 offset:0
    v_fma_mix_f32 v51, v78, v5, v13 op_sel:[1,0,0] op_sel_hi:[1,0,0]
    v_cvt_pk_bf16_f32 v78, v50, v51
    v_mfma_f32_16x16x32_bf16 v[216:219], v[28:31], v[64:67], v[216:219]
    s_mov_b32 m0, 139264
    ds_read_b64_tr_b16 v[22:23], v53 offset:4352
    v_fma_mix_f32 v48, v75, v6, v14 op_sel_hi:[1,0,0]
    v_mfma_f32_16x16x32_bf16 v[224:227], v[32:35], v[64:67], v[224:227]
    s_waitcnt lgkmcnt(6)
    ds_read_b64_tr_b16 v[24:25], v52 offset:64
    buffer_load_dword v57, s[64:67], s68 offen lds
    v_mfma_f32_16x16x32_bf16 v[228:231], v[32:35], v[68:71], v[228:231]
    s_add_u32 s68, s68, 16384
    ds_read_b64_tr_b16 v[26:27], v52 offset:4416
    v_fma_mix_f32 v49, v75, v7, v15 op_sel:[1,0,0] op_sel_hi:[1,0,0]
    v_cvt_pk_bf16_f32 v75, v48, v49
    v_mfma_f32_16x16x32_bf16 v[236:239], v[36:39], v[68:71], v[236:239]
    s_mov_b32 m0, 139264
    ds_read_b64_tr_b16 v[28:29], v53 offset:64
    v_fma_mix_f32 v50, v79, v6, v14 op_sel_hi:[1,0,0]
    v_mfma_f32_16x16x32_bf16 v[232:235], v[36:39], v[64:67], v[232:235]
    ds_read_b64_tr_b16 v[30:31], v53 offset:4416
    buffer_load_dword v57, s[64:67], s68 offen lds
    v_mfma_f32_16x16x32_bf16 v[240:243], v[40:43], v[64:67], v[240:243]
    ds_read_b64_tr_b16 v[32:33], v52 offset:128
    v_fma_mix_f32 v51, v79, v7, v15 op_sel:[1,0,0] op_sel_hi:[1,0,0]
    v_cvt_pk_bf16_f32 v79, v50, v51
    v_mfma_f32_16x16x32_bf16 v[244:247], v[40:43], v[68:71], v[244:247]
    s_waitcnt vmcnt(17) lgkmcnt(6)
    ds_read_b64_tr_b16 v[34:35], v52 offset:4480
    ds_read_b128 v[4:7], v54 offset:2576
    v_mfma_f32_16x16x32_bf16 v[252:255], v[44:47], v[68:71], v[252:255]
    s_mov_b32 s71, 3407872
    ds_read_b64_tr_b16 v[36:37], v53 offset:128
    ds_read_b128 v[12:15], v54 offset:2608
    v_mfma_f32_16x16x32_bf16 v[248:251], v[44:47], v[64:67], v[248:251]
    s_add_u32 s68, s68, 16384
    ds_read_b64_tr_b16 v[38:39], v53 offset:4480
    v_mfma_f32_16x16x32_bf16 v[128:131], v[16:19], v[72:75], v[128:131]
    s_add_u32 m0, s70, 139520
    ds_read_b64_tr_b16 v[40:41], v52 offset:192
    v_fma_mix_f32 v48, v80, v0, v8 op_sel_hi:[1,0,0]
    v_fma_mix_f32 v49, v80, v1, v9 op_sel:[1,0,0] op_sel_hi:[1,0,0]
    v_mfma_f32_16x16x32_bf16 v[132:135], v[16:19], v[76:79], v[132:135]
    s_waitcnt lgkmcnt(8)
    ds_read_b64_tr_b16 v[42:43], v52 offset:4544
    buffer_load_dwordx4 v56, s[4:7], s71 offen lds
    v_mfma_f32_16x16x32_bf16 v[140:143], v[20:23], v[76:79], v[140:143]
    ds_read_b64_tr_b16 v[44:45], v53 offset:192
    v_cvt_pk_bf16_f32 v80, v48, v49
    v_mfma_f32_16x16x32_bf16 v[136:139], v[20:23], v[72:75], v[136:139]
    s_waitcnt vmcnt(17) lgkmcnt(8)
    ds_read_b64_tr_b16 v[46:47], v53 offset:4544
    v_fma_mix_f32 v50, v84, v0, v8 op_sel_hi:[1,0,0]
    v_mfma_f32_16x16x32_bf16 v[144:147], v[24:27], v[72:75], v[144:147]
    s_mov_b32 s71, 3424256
    ds_read_b64_tr_b16 v[16:17], v52 offset:256
    v_fma_mix_f32 v51, v84, v1, v9 op_sel:[1,0,0] op_sel_hi:[1,0,0]
    v_cvt_pk_bf16_f32 v84, v50, v51
    v_mfma_f32_16x16x32_bf16 v[148:151], v[24:27], v[76:79], v[148:151]
    s_add_u32 m0, s70, 140608
    ds_read_b64_tr_b16 v[18:19], v52 offset:4608
    v_fma_mix_f32 v48, v81, v2, v10 op_sel_hi:[1,0,0]
    v_mfma_f32_16x16x32_bf16 v[156:159], v[28:31], v[76:79], v[156:159]
    ds_read_b64_tr_b16 v[20:21], v53 offset:256
    buffer_load_dwordx4 v56, s[4:7], s71 offen lds
    v_mfma_f32_16x16x32_bf16 v[152:155], v[28:31], v[72:75], v[152:155]
    s_waitcnt lgkmcnt(6)
    ds_read_b64_tr_b16 v[22:23], v53 offset:4608
    v_fma_mix_f32 v49, v81, v3, v11 op_sel:[1,0,0] op_sel_hi:[1,0,0]
    v_mfma_f32_16x16x32_bf16 v[160:163], v[32:35], v[72:75], v[160:163]
    ds_read_b64_tr_b16 v[24:25], v52 offset:320
    v_cvt_pk_bf16_f32 v81, v48, v49
    v_mfma_f32_16x16x32_bf16 v[164:167], v[32:35], v[76:79], v[164:167]
    s_mov_b32 s71, 3473408
    ds_read_b64_tr_b16 v[26:27], v52 offset:4672
    v_fma_mix_f32 v50, v85, v2, v10 op_sel_hi:[1,0,0]
    v_fma_mix_f32 v51, v85, v3, v11 op_sel:[1,0,0] op_sel_hi:[1,0,0]
    v_mfma_f32_16x16x32_bf16 v[172:175], v[36:39], v[76:79], v[172:175]
    s_add_u32 m0, s70, 141696
    ds_read_b64_tr_b16 v[28:29], v53 offset:320
    v_cvt_pk_bf16_f32 v85, v50, v51
    v_mfma_f32_16x16x32_bf16 v[168:171], v[36:39], v[72:75], v[168:171]
    s_waitcnt lgkmcnt(6)
    ds_read_b64_tr_b16 v[30:31], v53 offset:4672
    buffer_load_dwordx4 v56, s[4:7], s71 offen lds
    v_mfma_f32_16x16x32_bf16 v[176:179], v[40:43], v[72:75], v[176:179]
    ds_read_b64_tr_b16 v[32:33], v52 offset:384
    ds_read_b128 v[0:3], v54 offset:2816
    v_mfma_f32_16x16x32_bf16 v[180:183], v[40:43], v[76:79], v[180:183]
    s_waitcnt lgkmcnt(7)
    ds_read_b64_tr_b16 v[34:35], v52 offset:4736
    ds_read_b128 v[8:11], v54 offset:2848
    v_mfma_f32_16x16x32_bf16 v[188:191], v[44:47], v[76:79], v[188:191]
    s_mov_b32 s71, 3489792
    ds_read_b64_tr_b16 v[36:37], v53 offset:384
    v_fma_mix_f32 v48, v82, v4, v12 op_sel_hi:[1,0,0]
    v_fma_mix_f32 v49, v82, v5, v13 op_sel:[1,0,0] op_sel_hi:[1,0,0]
    v_mfma_f32_16x16x32_bf16 v[184:187], v[44:47], v[72:75], v[184:187]
    s_add_u32 m0, s70, 142784
    ds_read_b64_tr_b16 v[38:39], v53 offset:4736
    v_cvt_pk_bf16_f32 v82, v48, v49
    v_mfma_f32_16x16x32_bf16 v[192:195], v[16:19], v[72:75], v[192:195]
    ds_read_b64_tr_b16 v[40:41], v52 offset:448
    buffer_load_dwordx4 v56, s[4:7], s71 offen lds
    v_mfma_f32_16x16x32_bf16 v[196:199], v[16:19], v[76:79], v[196:199]
    s_waitcnt lgkmcnt(8)
    ds_read_b64_tr_b16 v[42:43], v52 offset:4800
    v_fma_mix_f32 v50, v86, v4, v12 op_sel_hi:[1,0,0]
    v_mfma_f32_16x16x32_bf16 v[204:207], v[20:23], v[76:79], v[204:207]
    ds_read_b64_tr_b16 v[44:45], v53 offset:448
    v_add_u32 v52, 69632, v52
    v_mfma_f32_16x16x32_bf16 v[200:203], v[20:23], v[72:75], v[200:203]
    ds_read_b64_tr_b16 v[46:47], v53 offset:4800
    v_add_u32 v53, 69632, v53
    v_mfma_f32_16x16x32_bf16 v[208:211], v[24:27], v[72:75], v[208:211]
    s_waitcnt vmcnt(18)
    s_barrier
    ds_read_b64_tr_b16 v[16:17], v52 offset:0
    v_mfma_f32_16x16x32_bf16 v[212:215], v[24:27], v[76:79], v[212:215]
    s_waitcnt lgkmcnt(6)
    ds_read_b64_tr_b16 v[18:19], v52 offset:4352
    buffer_load_dwordx4 v[104:107], v55, s[36:39], s44 offen offset:1024 sc1
    v_mfma_f32_16x16x32_bf16 v[220:223], v[28:31], v[76:79], v[220:223]
    ds_read_b64_tr_b16 v[20:21], v53 offset:0
    v_fma_mix_f32 v51, v86, v5, v13 op_sel:[1,0,0] op_sel_hi:[1,0,0]
    v_cvt_pk_bf16_f32 v86, v50, v51
    v_mfma_f32_16x16x32_bf16 v[216:219], v[28:31], v[72:75], v[216:219]
    ds_read_b64_tr_b16 v[22:23], v53 offset:4352
    v_fma_mix_f32 v48, v83, v6, v14 op_sel_hi:[1,0,0]
    v_mfma_f32_16x16x32_bf16 v[224:227], v[32:35], v[72:75], v[224:227]
    ds_read_b64_tr_b16 v[24:25], v52 offset:64
    v_fma_mix_f32 v49, v83, v7, v15 op_sel:[1,0,0] op_sel_hi:[1,0,0]
    v_mfma_f32_16x16x32_bf16 v[228:231], v[32:35], v[76:79], v[228:231]
    s_waitcnt lgkmcnt(6)
    ds_read_b64_tr_b16 v[26:27], v52 offset:4416
    v_cvt_pk_bf16_f32 v83, v48, v49
    v_mfma_f32_16x16x32_bf16 v[236:239], v[36:39], v[76:79], v[236:239]
    ds_read_b64_tr_b16 v[28:29], v53 offset:64
    buffer_load_dwordx4 v[108:111], v55, s[36:39], s72 offen offset:1024 sc1
    v_mfma_f32_16x16x32_bf16 v[232:235], v[36:39], v[72:75], v[232:235]
    ds_read_b64_tr_b16 v[30:31], v53 offset:4416
    v_fma_mix_f32 v50, v87, v6, v14 op_sel_hi:[1,0,0]
    v_fma_mix_f32 v51, v87, v7, v15 op_sel:[1,0,0] op_sel_hi:[1,0,0]
    v_mfma_f32_16x16x32_bf16 v[240:243], v[40:43], v[72:75], v[240:243]
    ds_read_b64_tr_b16 v[32:33], v52 offset:128
    v_cvt_pk_bf16_f32 v87, v50, v51
    v_mfma_f32_16x16x32_bf16 v[244:247], v[40:43], v[76:79], v[244:247]
    s_waitcnt lgkmcnt(6)
    ds_read_b64_tr_b16 v[34:35], v52 offset:4480
    ds_read_b128 v[4:7], v54 offset:2832
    v_mfma_f32_16x16x32_bf16 v[252:255], v[44:47], v[76:79], v[252:255]
    ds_read_b64_tr_b16 v[36:37], v53 offset:128
    ds_read_b128 v[12:15], v54 offset:2864
    v_mfma_f32_16x16x32_bf16 v[248:251], v[44:47], v[72:75], v[248:251]
    ds_read_b64_tr_b16 v[38:39], v53 offset:4480
    v_mfma_f32_16x16x32_bf16 v[128:131], v[16:19], v[80:83], v[128:131]
    s_waitcnt vmcnt(16)
    ds_read_b64_tr_b16 v[40:41], v52 offset:192
    v_fma_mix_f32 v48, v88, v0, v8 op_sel_hi:[1,0,0]
    v_mfma_f32_16x16x32_bf16 v[132:135], v[16:19], v[84:87], v[132:135]
    s_waitcnt lgkmcnt(8)
    ds_read_b64_tr_b16 v[42:43], v52 offset:4544
    v_fma_mix_f32 v49, v88, v1, v9 op_sel:[1,0,0] op_sel_hi:[1,0,0]
    v_mfma_f32_16x16x32_bf16 v[140:143], v[20:23], v[84:87], v[140:143]
    ds_read_b64_tr_b16 v[44:45], v53 offset:192
    v_cvt_pk_bf16_f32 v88, v48, v49
    v_mfma_f32_16x16x32_bf16 v[136:139], v[20:23], v[80:83], v[136:139]
    s_waitcnt vmcnt(15)
    ds_read_b64_tr_b16 v[46:47], v53 offset:4544
    v_fma_mix_f32 v50, v92, v0, v8 op_sel_hi:[1,0,0]
    v_mfma_f32_16x16x32_bf16 v[144:147], v[24:27], v[80:83], v[144:147]
    ds_read_b64_tr_b16 v[16:17], v52 offset:256
    v_fma_mix_f32 v51, v92, v1, v9 op_sel:[1,0,0] op_sel_hi:[1,0,0]
    v_mfma_f32_16x16x32_bf16 v[148:151], v[24:27], v[84:87], v[148:151]
    s_waitcnt lgkmcnt(6)
    ds_read_b64_tr_b16 v[18:19], v52 offset:4608
    v_cvt_pk_bf16_f32 v92, v50, v51
    v_mfma_f32_16x16x32_bf16 v[156:159], v[28:31], v[84:87], v[156:159]
    ds_read_b64_tr_b16 v[20:21], v53 offset:256
    v_fma_mix_f32 v48, v89, v2, v10 op_sel_hi:[1,0,0]
    v_mfma_f32_16x16x32_bf16 v[152:155], v[28:31], v[80:83], v[152:155]
    ds_read_b64_tr_b16 v[22:23], v53 offset:4608
    v_fma_mix_f32 v49, v89, v3, v11 op_sel:[1,0,0] op_sel_hi:[1,0,0]
    v_mfma_f32_16x16x32_bf16 v[160:163], v[32:35], v[80:83], v[160:163]
    ds_read_b64_tr_b16 v[24:25], v52 offset:320
    v_cvt_pk_bf16_f32 v89, v48, v49
    v_mfma_f32_16x16x32_bf16 v[164:167], v[32:35], v[84:87], v[164:167]
    s_waitcnt lgkmcnt(6)
    ds_read_b64_tr_b16 v[26:27], v52 offset:4672
    v_fma_mix_f32 v50, v93, v2, v10 op_sel_hi:[1,0,0]
    v_mfma_f32_16x16x32_bf16 v[172:175], v[36:39], v[84:87], v[172:175]
    ds_read_b64_tr_b16 v[28:29], v53 offset:320
    v_fma_mix_f32 v51, v93, v3, v11 op_sel:[1,0,0] op_sel_hi:[1,0,0]
    v_mfma_f32_16x16x32_bf16 v[168:171], v[36:39], v[80:83], v[168:171]
    ds_read_b64_tr_b16 v[30:31], v53 offset:4672
    v_cvt_pk_bf16_f32 v93, v50, v51
    v_mfma_f32_16x16x32_bf16 v[176:179], v[40:43], v[80:83], v[176:179]
    ds_read_b64_tr_b16 v[32:33], v52 offset:384
    ds_read_b128 v[0:3], v54 offset:3072
    v_mfma_f32_16x16x32_bf16 v[180:183], v[40:43], v[84:87], v[180:183]
    s_waitcnt lgkmcnt(7)
    ds_read_b64_tr_b16 v[34:35], v52 offset:4736
    ds_read_b128 v[8:11], v54 offset:3104
    v_mfma_f32_16x16x32_bf16 v[188:191], v[44:47], v[84:87], v[188:191]
    ds_read_b64_tr_b16 v[36:37], v53 offset:384
    v_fma_mix_f32 v48, v90, v4, v12 op_sel_hi:[1,0,0]
    v_mfma_f32_16x16x32_bf16 v[184:187], v[44:47], v[80:83], v[184:187]
    ds_read_b64_tr_b16 v[38:39], v53 offset:4736
    v_fma_mix_f32 v49, v90, v5, v13 op_sel:[1,0,0] op_sel_hi:[1,0,0]
    v_mfma_f32_16x16x32_bf16 v[192:195], v[16:19], v[80:83], v[192:195]
    ds_read_b64_tr_b16 v[40:41], v52 offset:448
    v_cvt_pk_bf16_f32 v90, v48, v49
    v_mfma_f32_16x16x32_bf16 v[196:199], v[16:19], v[84:87], v[196:199]
    s_waitcnt lgkmcnt(8)
    ds_read_b64_tr_b16 v[42:43], v52 offset:4800
    v_fma_mix_f32 v50, v94, v4, v12 op_sel_hi:[1,0,0]
    v_mfma_f32_16x16x32_bf16 v[204:207], v[20:23], v[84:87], v[204:207]
    ds_read_b64_tr_b16 v[44:45], v53 offset:448
    v_add_u32 v52, 4294915072, v52
    v_mfma_f32_16x16x32_bf16 v[200:203], v[20:23], v[80:83], v[200:203]
    ds_read_b64_tr_b16 v[46:47], v53 offset:4800
    v_add_u32 v53, 4294915072, v53
    v_mfma_f32_16x16x32_bf16 v[208:211], v[24:27], v[80:83], v[208:211]
    s_waitcnt vmcnt(14)
    s_barrier
    ds_read_b64_tr_b16 v[16:17], v52 offset:0
    v_mfma_f32_16x16x32_bf16 v[212:215], v[24:27], v[84:87], v[212:215]
    s_waitcnt lgkmcnt(6)
    ds_read_b64_tr_b16 v[18:19], v52 offset:4352
    v_fma_mix_f32 v51, v94, v5, v13 op_sel:[1,0,0] op_sel_hi:[1,0,0]
    v_mfma_f32_16x16x32_bf16 v[220:223], v[28:31], v[84:87], v[220:223]
    ds_read_b64_tr_b16 v[20:21], v53 offset:0
    v_cvt_pk_bf16_f32 v94, v50, v51
    v_mfma_f32_16x16x32_bf16 v[216:219], v[28:31], v[80:83], v[216:219]
    ds_read_b64_tr_b16 v[22:23], v53 offset:4352
    v_fma_mix_f32 v48, v91, v6, v14 op_sel_hi:[1,0,0]
    v_mfma_f32_16x16x32_bf16 v[224:227], v[32:35], v[80:83], v[224:227]
    ds_read_b64_tr_b16 v[24:25], v52 offset:64
    v_fma_mix_f32 v49, v91, v7, v15 op_sel:[1,0,0] op_sel_hi:[1,0,0]
    v_mfma_f32_16x16x32_bf16 v[228:231], v[32:35], v[84:87], v[228:231]
    s_waitcnt lgkmcnt(6)
    ds_read_b64_tr_b16 v[26:27], v52 offset:4416
    v_cvt_pk_bf16_f32 v91, v48, v49
    v_mfma_f32_16x16x32_bf16 v[236:239], v[36:39], v[84:87], v[236:239]
    ds_read_b64_tr_b16 v[28:29], v53 offset:64
    v_fma_mix_f32 v50, v95, v6, v14 op_sel_hi:[1,0,0]
    v_mfma_f32_16x16x32_bf16 v[232:235], v[36:39], v[80:83], v[232:235]
    ds_read_b64_tr_b16 v[30:31], v53 offset:4416
    v_fma_mix_f32 v51, v95, v7, v15 op_sel:[1,0,0] op_sel_hi:[1,0,0]
    v_mfma_f32_16x16x32_bf16 v[240:243], v[40:43], v[80:83], v[240:243]
    ds_read_b64_tr_b16 v[32:33], v52 offset:128
    v_cvt_pk_bf16_f32 v95, v50, v51
    v_mfma_f32_16x16x32_bf16 v[244:247], v[40:43], v[84:87], v[244:247]
    s_waitcnt lgkmcnt(6)
    ds_read_b64_tr_b16 v[34:35], v52 offset:4480
    ds_read_b128 v[4:7], v54 offset:3088
    v_mfma_f32_16x16x32_bf16 v[252:255], v[44:47], v[84:87], v[252:255]
    ds_read_b64_tr_b16 v[36:37], v53 offset:128
    ds_read_b128 v[12:15], v54 offset:3120
    v_mfma_f32_16x16x32_bf16 v[248:251], v[44:47], v[80:83], v[248:251]
    ds_read_b64_tr_b16 v[38:39], v53 offset:4480
    v_mfma_f32_16x16x32_bf16 v[128:131], v[16:19], v[88:91], v[128:131]
    s_waitcnt vmcnt(9)
    ds_read_b64_tr_b16 v[40:41], v52 offset:192
    v_fma_mix_f32 v48, v96, v0, v8 op_sel_hi:[1,0,0]
    v_mfma_f32_16x16x32_bf16 v[132:135], v[16:19], v[92:95], v[132:135]
    s_waitcnt lgkmcnt(8)
    ds_read_b64_tr_b16 v[42:43], v52 offset:4544
    v_fma_mix_f32 v49, v96, v1, v9 op_sel:[1,0,0] op_sel_hi:[1,0,0]
    v_mfma_f32_16x16x32_bf16 v[140:143], v[20:23], v[92:95], v[140:143]
    ds_read_b64_tr_b16 v[44:45], v53 offset:192
    v_cvt_pk_bf16_f32 v96, v48, v49
    v_mfma_f32_16x16x32_bf16 v[136:139], v[20:23], v[88:91], v[136:139]
    s_waitcnt vmcnt(8)
    ds_read_b64_tr_b16 v[46:47], v53 offset:4544
    v_fma_mix_f32 v50, v100, v0, v8 op_sel_hi:[1,0,0]
    v_mfma_f32_16x16x32_bf16 v[144:147], v[24:27], v[88:91], v[144:147]
    ds_read_b64_tr_b16 v[16:17], v52 offset:256
    v_fma_mix_f32 v51, v100, v1, v9 op_sel:[1,0,0] op_sel_hi:[1,0,0]
    v_mfma_f32_16x16x32_bf16 v[148:151], v[24:27], v[92:95], v[148:151]
    s_waitcnt lgkmcnt(6)
    ds_read_b64_tr_b16 v[18:19], v52 offset:4608
    v_cvt_pk_bf16_f32 v100, v50, v51
    v_mfma_f32_16x16x32_bf16 v[156:159], v[28:31], v[92:95], v[156:159]
    ds_read_b64_tr_b16 v[20:21], v53 offset:256
    v_fma_mix_f32 v48, v97, v2, v10 op_sel_hi:[1,0,0]
    v_mfma_f32_16x16x32_bf16 v[152:155], v[28:31], v[88:91], v[152:155]
    ds_read_b64_tr_b16 v[22:23], v53 offset:4608
    v_fma_mix_f32 v49, v97, v3, v11 op_sel:[1,0,0] op_sel_hi:[1,0,0]
    v_mfma_f32_16x16x32_bf16 v[160:163], v[32:35], v[88:91], v[160:163]
    ds_read_b64_tr_b16 v[24:25], v52 offset:320
    v_cvt_pk_bf16_f32 v97, v48, v49
    v_mfma_f32_16x16x32_bf16 v[164:167], v[32:35], v[92:95], v[164:167]
    s_waitcnt lgkmcnt(6)
    ds_read_b64_tr_b16 v[26:27], v52 offset:4672
    v_fma_mix_f32 v50, v101, v2, v10 op_sel_hi:[1,0,0]
    v_mfma_f32_16x16x32_bf16 v[172:175], v[36:39], v[92:95], v[172:175]
    ds_read_b64_tr_b16 v[28:29], v53 offset:320
    v_fma_mix_f32 v51, v101, v3, v11 op_sel:[1,0,0] op_sel_hi:[1,0,0]
    v_mfma_f32_16x16x32_bf16 v[168:171], v[36:39], v[88:91], v[168:171]
    ds_read_b64_tr_b16 v[30:31], v53 offset:4672
    v_cvt_pk_bf16_f32 v101, v50, v51
    v_mfma_f32_16x16x32_bf16 v[176:179], v[40:43], v[88:91], v[176:179]
    ds_read_b64_tr_b16 v[32:33], v52 offset:384
    ds_read_b128 v[0:3], v54 offset:3328
    v_mfma_f32_16x16x32_bf16 v[180:183], v[40:43], v[92:95], v[180:183]
    s_waitcnt lgkmcnt(7)
    ds_read_b64_tr_b16 v[34:35], v52 offset:4736
    ds_read_b128 v[8:11], v54 offset:3360
    v_mfma_f32_16x16x32_bf16 v[188:191], v[44:47], v[92:95], v[188:191]
    ds_read_b64_tr_b16 v[36:37], v53 offset:384
    v_fma_mix_f32 v48, v98, v4, v12 op_sel_hi:[1,0,0]
    v_mfma_f32_16x16x32_bf16 v[184:187], v[44:47], v[88:91], v[184:187]
    ds_read_b64_tr_b16 v[38:39], v53 offset:4736
    v_fma_mix_f32 v49, v98, v5, v13 op_sel:[1,0,0] op_sel_hi:[1,0,0]
    v_mfma_f32_16x16x32_bf16 v[192:195], v[16:19], v[88:91], v[192:195]
    ds_read_b64_tr_b16 v[40:41], v52 offset:448
    v_cvt_pk_bf16_f32 v98, v48, v49
    v_mfma_f32_16x16x32_bf16 v[196:199], v[16:19], v[92:95], v[196:199]
    s_waitcnt lgkmcnt(8)
    ds_read_b64_tr_b16 v[42:43], v52 offset:4800
    v_fma_mix_f32 v50, v102, v4, v12 op_sel_hi:[1,0,0]
    v_mfma_f32_16x16x32_bf16 v[204:207], v[20:23], v[92:95], v[204:207]
    ds_read_b64_tr_b16 v[44:45], v53 offset:448
    v_add_u32 v52, 69632, v52
    v_mfma_f32_16x16x32_bf16 v[200:203], v[20:23], v[88:91], v[200:203]
    ds_read_b64_tr_b16 v[46:47], v53 offset:4800
    v_add_u32 v53, 69632, v53
    v_mfma_f32_16x16x32_bf16 v[208:211], v[24:27], v[88:91], v[208:211]
    s_barrier
    ds_read_b64_tr_b16 v[16:17], v52 offset:0
    v_mfma_f32_16x16x32_bf16 v[212:215], v[24:27], v[92:95], v[212:215]
    s_waitcnt lgkmcnt(6)
    ds_read_b64_tr_b16 v[18:19], v52 offset:4352
    v_fma_mix_f32 v51, v102, v5, v13 op_sel:[1,0,0] op_sel_hi:[1,0,0]
    v_mfma_f32_16x16x32_bf16 v[220:223], v[28:31], v[92:95], v[220:223]
    ds_read_b64_tr_b16 v[20:21], v53 offset:0
    v_cvt_pk_bf16_f32 v102, v50, v51
    v_mfma_f32_16x16x32_bf16 v[216:219], v[28:31], v[88:91], v[216:219]
    ds_read_b64_tr_b16 v[22:23], v53 offset:4352
    v_fma_mix_f32 v48, v99, v6, v14 op_sel_hi:[1,0,0]
    v_mfma_f32_16x16x32_bf16 v[224:227], v[32:35], v[88:91], v[224:227]
    ds_read_b64_tr_b16 v[24:25], v52 offset:64
    v_fma_mix_f32 v49, v99, v7, v15 op_sel:[1,0,0] op_sel_hi:[1,0,0]
    v_mfma_f32_16x16x32_bf16 v[228:231], v[32:35], v[92:95], v[228:231]
    s_waitcnt lgkmcnt(6)
    ds_read_b64_tr_b16 v[26:27], v52 offset:4416
    v_cvt_pk_bf16_f32 v99, v48, v49
    v_mfma_f32_16x16x32_bf16 v[236:239], v[36:39], v[92:95], v[236:239]
    ds_read_b64_tr_b16 v[28:29], v53 offset:64
    v_fma_mix_f32 v50, v103, v6, v14 op_sel_hi:[1,0,0]
    v_mfma_f32_16x16x32_bf16 v[232:235], v[36:39], v[88:91], v[232:235]
    ds_read_b64_tr_b16 v[30:31], v53 offset:4416
    v_fma_mix_f32 v51, v103, v7, v15 op_sel:[1,0,0] op_sel_hi:[1,0,0]
    v_mfma_f32_16x16x32_bf16 v[240:243], v[40:43], v[88:91], v[240:243]
    v_mbcnt_lo_u32_b32 v58, -1, 0
    v_mbcnt_hi_u32_b32 v58, -1, v58
    v_min_u32 v58, 55, v58
    v_mul_u32_u24 v58, 640, v58
    ds_read_b64_tr_b16 v[32:33], v52 offset:128
    v_cvt_pk_bf16_f32 v103, v50, v51
    v_mfma_f32_16x16x32_bf16 v[244:247], v[40:43], v[92:95], v[244:247]
    s_waitcnt lgkmcnt(6)
    ds_read_b64_tr_b16 v[34:35], v52 offset:4480
    ds_read_b128 v[4:7], v54 offset:3344
    v_mfma_f32_16x16x32_bf16 v[252:255], v[44:47], v[92:95], v[252:255]
    s_waitcnt vmcnt(1)
    ds_read_b64_tr_b16 v[36:37], v53 offset:128
    ds_read_b128 v[12:15], v54 offset:3376
    v_mfma_f32_16x16x32_bf16 v[248:251], v[44:47], v[88:91], v[248:251]
    s_mov_b32 s79, 0x20000
    ds_read_b64_tr_b16 v[38:39], v53 offset:4480
    v_mfma_f32_16x16x32_bf16 v[128:131], v[16:19], v[96:99], v[128:131]
    s_mov_b32 s78, 35840
    ds_read_b64_tr_b16 v[40:41], v52 offset:192
    s_add_u32 s76, s56, 43641856
    s_addc_u32 s77, s57, 0
    v_fma_mix_f32 v48, v104, v0, v8 op_sel_hi:[1,0,0]
    v_mfma_f32_16x16x32_bf16 v[132:135], v[16:19], v[100:103], v[132:135]
    s_waitcnt lgkmcnt(8)
    ds_read_b64_tr_b16 v[42:43], v52 offset:4544
    buffer_load_dword v59, v58, s[76:79], 0 offen sc1
    v_mfma_f32_16x16x32_bf16 v[140:143], v[20:23], v[100:103], v[140:143]
    ds_read_b64_tr_b16 v[44:45], v53 offset:192
    v_fma_mix_f32 v49, v104, v1, v9 op_sel:[1,0,0] op_sel_hi:[1,0,0]
    v_mfma_f32_16x16x32_bf16 v[136:139], v[20:23], v[96:99], v[136:139]
    ds_read_b64_tr_b16 v[46:47], v53 offset:4544
    v_cvt_pk_bf16_f32 v104, v48, v49
    v_mfma_f32_16x16x32_bf16 v[144:147], v[24:27], v[96:99], v[144:147]
    s_waitcnt vmcnt(1)
    ds_read_b64_tr_b16 v[16:17], v52 offset:256
    v_fma_mix_f32 v50, v108, v0, v8 op_sel_hi:[1,0,0]
    v_mfma_f32_16x16x32_bf16 v[148:151], v[24:27], v[100:103], v[148:151]
    s_waitcnt lgkmcnt(6)
    ds_read_b64_tr_b16 v[18:19], v52 offset:4608
    v_fma_mix_f32 v51, v108, v1, v9 op_sel:[1,0,0] op_sel_hi:[1,0,0]
    v_mfma_f32_16x16x32_bf16 v[156:159], v[28:31], v[100:103], v[156:159]
    ds_read_b64_tr_b16 v[20:21], v53 offset:256
    v_cvt_pk_bf16_f32 v108, v50, v51
    v_mfma_f32_16x16x32_bf16 v[152:155], v[28:31], v[96:99], v[152:155]
    ds_read_b64_tr_b16 v[22:23], v53 offset:4608
    v_fma_mix_f32 v48, v105, v2, v10 op_sel_hi:[1,0,0]
    v_mfma_f32_16x16x32_bf16 v[160:163], v[32:35], v[96:99], v[160:163]
    ds_read_b64_tr_b16 v[24:25], v52 offset:320
    v_fma_mix_f32 v49, v105, v3, v11 op_sel:[1,0,0] op_sel_hi:[1,0,0]
    v_mfma_f32_16x16x32_bf16 v[164:167], v[32:35], v[100:103], v[164:167]
    s_waitcnt lgkmcnt(6)
    ds_read_b64_tr_b16 v[26:27], v52 offset:4672
    v_mfma_f32_16x16x32_bf16 v[172:175], v[36:39], v[100:103], v[172:175]
    ds_read_b64_tr_b16 v[28:29], v53 offset:320
    v_cvt_pk_bf16_f32 v105, v48, v49
    v_mfma_f32_16x16x32_bf16 v[168:171], v[36:39], v[96:99], v[168:171]
    ds_read_b64_tr_b16 v[30:31], v53 offset:4672
    v_fma_mix_f32 v50, v109, v2, v10 op_sel_hi:[1,0,0]
    v_mfma_f32_16x16x32_bf16 v[176:179], v[40:43], v[96:99], v[176:179]
    ds_read_b64_tr_b16 v[32:33], v52 offset:384
    v_fma_mix_f32 v51, v109, v3, v11 op_sel:[1,0,0] op_sel_hi:[1,0,0]
    v_mfma_f32_16x16x32_bf16 v[180:183], v[40:43], v[100:103], v[180:183]
    s_waitcnt lgkmcnt(6)
    ds_read_b64_tr_b16 v[34:35], v52 offset:4736
    v_cvt_pk_bf16_f32 v109, v50, v51
    v_mfma_f32_16x16x32_bf16 v[188:191], v[44:47], v[100:103], v[188:191]
    ds_read_b64_tr_b16 v[36:37], v53 offset:384
    v_fma_mix_f32 v48, v106, v4, v12 op_sel_hi:[1,0,0]
    v_mfma_f32_16x16x32_bf16 v[184:187], v[44:47], v[96:99], v[184:187]
    ds_read_b64_tr_b16 v[38:39], v53 offset:4736
    v_fma_mix_f32 v49, v106, v5, v13 op_sel:[1,0,0] op_sel_hi:[1,0,0]
    v_mfma_f32_16x16x32_bf16 v[192:195], v[16:19], v[96:99], v[192:195]
    ds_read_b64_tr_b16 v[40:41], v52 offset:448
    v_cvt_pk_bf16_f32 v106, v48, v49
    v_mfma_f32_16x16x32_bf16 v[196:199], v[16:19], v[100:103], v[196:199]
    s_waitcnt lgkmcnt(6)
    ds_read_b64_tr_b16 v[42:43], v52 offset:4800
    v_fma_mix_f32 v50, v110, v4, v12 op_sel_hi:[1,0,0]
    v_mfma_f32_16x16x32_bf16 v[204:207], v[20:23], v[100:103], v[204:207]
    ds_read_b64_tr_b16 v[44:45], v53 offset:448
    v_add_u32 v52, 17664, v52
    v_mfma_f32_16x16x32_bf16 v[200:203], v[20:23], v[96:99], v[200:203]
    ds_read_b64_tr_b16 v[46:47], v53 offset:4800
    v_add_u32 v53, 17664, v53
    v_mfma_f32_16x16x32_bf16 v[208:211], v[24:27], v[96:99], v[208:211]
    s_barrier
    ds_read_b64_tr_b16 v[16:17], v52 offset:0
    v_mfma_f32_16x16x32_bf16 v[212:215], v[24:27], v[100:103], v[212:215]
    s_waitcnt lgkmcnt(6)
    ds_read_b64_tr_b16 v[18:19], v52 offset:4352
    v_mfma_f32_16x16x32_bf16 v[220:223], v[28:31], v[100:103], v[220:223]
    ds_read_b64_tr_b16 v[20:21], v53 offset:0
    v_fma_mix_f32 v51, v110, v5, v13 op_sel:[1,0,0] op_sel_hi:[1,0,0]
    v_mfma_f32_16x16x32_bf16 v[216:219], v[28:31], v[96:99], v[216:219]
    ds_read_b64_tr_b16 v[22:23], v53 offset:4352
    v_cvt_pk_bf16_f32 v110, v50, v51
    v_mfma_f32_16x16x32_bf16 v[224:227], v[32:35], v[96:99], v[224:227]
    ds_read_b64_tr_b16 v[24:25], v52 offset:64
    v_fma_mix_f32 v48, v107, v6, v14 op_sel_hi:[1,0,0]
    v_mfma_f32_16x16x32_bf16 v[228:231], v[32:35], v[100:103], v[228:231]
    s_waitcnt lgkmcnt(6)
    ds_read_b64_tr_b16 v[26:27], v52 offset:4416
    v_fma_mix_f32 v49, v107, v7, v15 op_sel:[1,0,0] op_sel_hi:[1,0,0]
    v_mfma_f32_16x16x32_bf16 v[236:239], v[36:39], v[100:103], v[236:239]
    ds_read_b64_tr_b16 v[28:29], v53 offset:64
    v_cvt_pk_bf16_f32 v107, v48, v49
    v_mfma_f32_16x16x32_bf16 v[232:235], v[36:39], v[96:99], v[232:235]
    ds_read_b64_tr_b16 v[30:31], v53 offset:4416
    v_fma_mix_f32 v50, v111, v6, v14 op_sel_hi:[1,0,0]
    v_mfma_f32_16x16x32_bf16 v[240:243], v[40:43], v[96:99], v[240:243]
    ds_read_b64_tr_b16 v[32:33], v52 offset:128
    v_fma_mix_f32 v51, v111, v7, v15 op_sel:[1,0,0] op_sel_hi:[1,0,0]
    v_mfma_f32_16x16x32_bf16 v[244:247], v[40:43], v[100:103], v[244:247]
    s_waitcnt lgkmcnt(6)
    ds_read_b64_tr_b16 v[34:35], v52 offset:4480
    v_cvt_pk_bf16_f32 v111, v50, v51
    v_mfma_f32_16x16x32_bf16 v[252:255], v[44:47], v[100:103], v[252:255]
    ds_read_b64_tr_b16 v[36:37], v53 offset:128
    v_mfma_f32_16x16x32_bf16 v[248:251], v[44:47], v[96:99], v[248:251]
    ds_read_b64_tr_b16 v[38:39], v53 offset:4480
    v_mfma_f32_16x16x32_bf16 v[128:131], v[16:19], v[104:107], v[128:131]
    s_add_u32 m0, s16, 0
    ds_read_b64_tr_b16 v[40:41], v52 offset:192
    v_mfma_f32_16x16x32_bf16 v[132:135], v[16:19], v[108:111], v[132:135]
    s_waitcnt lgkmcnt(6)
    ds_read_b64_tr_b16 v[42:43], v52 offset:4544
    buffer_load_dwordx4 v57, s[8:11], s20 offen offset:0 lds
    v_mfma_f32_16x16x32_bf16 v[140:143], v[20:23], v[108:111], v[140:143]
    ds_read_b64_tr_b16 v[44:45], v53 offset:192
    v_mfma_f32_16x16x32_bf16 v[136:139], v[20:23], v[104:107], v[136:139]
    s_add_u32 m0, s16, 64
    ds_read_b64_tr_b16 v[46:47], v53 offset:4544
    v_mfma_f32_16x16x32_bf16 v[144:147], v[24:27], v[104:107], v[144:147]
    ds_read_b64_tr_b16 v[16:17], v52 offset:256
    buffer_load_dwordx4 v57, s[8:11], s20 offen offset:1024 lds
    v_mfma_f32_16x16x32_bf16 v[148:151], v[24:27], v[108:111], v[148:151]
    s_waitcnt lgkmcnt(6)
    ds_read_b64_tr_b16 v[18:19], v52 offset:4608
    v_mfma_f32_16x16x32_bf16 v[156:159], v[28:31], v[108:111], v[156:159]
    ds_read_b64_tr_b16 v[20:21], v53 offset:256
    v_mfma_f32_16x16x32_bf16 v[152:155], v[28:31], v[104:107], v[152:155]
    s_add_u32 m0, s16, 128
    ds_read_b64_tr_b16 v[22:23], v53 offset:4608
    v_mfma_f32_16x16x32_bf16 v[160:163], v[32:35], v[104:107], v[160:163]
    ds_read_b64_tr_b16 v[24:25], v52 offset:320
    buffer_load_dwordx4 v57, s[8:11], s20 offen offset:2048 lds
    v_mfma_f32_16x16x32_bf16 v[164:167], v[32:35], v[108:111], v[164:167]
    s_waitcnt lgkmcnt(6)
    ds_read_b64_tr_b16 v[26:27], v52 offset:4672
    v_mfma_f32_16x16x32_bf16 v[172:175], v[36:39], v[108:111], v[172:175]
    ds_read_b64_tr_b16 v[28:29], v53 offset:320
    v_mfma_f32_16x16x32_bf16 v[168:171], v[36:39], v[104:107], v[168:171]
    s_add_u32 m0, s16, 192
    ds_read_b64_tr_b16 v[30:31], v53 offset:4672
    v_mfma_f32_16x16x32_bf16 v[176:179], v[40:43], v[104:107], v[176:179]
    ds_read_b64_tr_b16 v[32:33], v52 offset:384
    buffer_load_dwordx4 v57, s[8:11], s20 offen offset:3072 lds
    v_mfma_f32_16x16x32_bf16 v[180:183], v[40:43], v[108:111], v[180:183]
    s_waitcnt lgkmcnt(6)
    ds_read_b64_tr_b16 v[34:35], v52 offset:4736
    v_mfma_f32_16x16x32_bf16 v[188:191], v[44:47], v[108:111], v[188:191]
    ds_read_b64_tr_b16 v[36:37], v53 offset:384
    v_mfma_f32_16x16x32_bf16 v[184:187], v[44:47], v[104:107], v[184:187]
    s_add_u32 m0, s16, 4352
    ds_read_b64_tr_b16 v[38:39], v53 offset:4736
    v_mfma_f32_16x16x32_bf16 v[192:195], v[16:19], v[104:107], v[192:195]
    ds_read_b64_tr_b16 v[40:41], v52 offset:448
    buffer_load_dwordx4 v57, s[8:11], s21 offen offset:0 lds
    v_mfma_f32_16x16x32_bf16 v[196:199], v[16:19], v[108:111], v[196:199]
    s_waitcnt lgkmcnt(6)
    ds_read_b64_tr_b16 v[42:43], v52 offset:4800
    v_mfma_f32_16x16x32_bf16 v[204:207], v[20:23], v[108:111], v[204:207]
    ds_read_b64_tr_b16 v[44:45], v53 offset:448
    v_mfma_f32_16x16x32_bf16 v[200:203], v[20:23], v[104:107], v[200:203]
    s_add_u32 m0, s16, 4416
    ds_read_b64_tr_b16 v[46:47], v53 offset:4800
    v_mfma_f32_16x16x32_bf16 v[208:211], v[24:27], v[104:107], v[208:211]
    s_barrier
    v_mfma_f32_16x16x32_bf16 v[212:215], v[24:27], v[108:111], v[212:215]
    s_waitcnt lgkmcnt(5)
    buffer_load_dwordx4 v57, s[8:11], s21 offen offset:1024 lds
    v_mfma_f32_16x16x32_bf16 v[220:223], v[28:31], v[108:111], v[220:223]
    s_add_u32 m0, s16, 4480
    v_mfma_f32_16x16x32_bf16 v[216:219], v[28:31], v[104:107], v[216:219]
    buffer_load_dwordx4 v57, s[8:11], s21 offen offset:2048 lds
    v_mfma_f32_16x16x32_bf16 v[224:227], v[32:35], v[104:107], v[224:227]
    v_mfma_f32_16x16x32_bf16 v[228:231], v[32:35], v[108:111], v[228:231]
    s_waitcnt lgkmcnt(1)
    v_mfma_f32_16x16x32_bf16 v[236:239], v[36:39], v[108:111], v[236:239]
    s_add_u32 m0, s16, 4544
    v_mfma_f32_16x16x32_bf16 v[232:235], v[36:39], v[104:107], v[232:235]
    buffer_load_dwordx4 v57, s[8:11], s21 offen offset:3072 lds
    v_mfma_f32_16x16x32_bf16 v[240:243], v[40:43], v[104:107], v[240:243]
    v_mfma_f32_16x16x32_bf16 v[244:247], v[40:43], v[108:111], v[244:247]
    s_waitcnt vmcnt(8) lgkmcnt(0)
    v_mfma_f32_16x16x32_bf16 v[252:255], v[44:47], v[108:111], v[252:255]
    s_add_u32 s21, s21, 16384
    v_mfma_f32_16x16x32_bf16 v[248:251], v[44:47], v[104:107], v[248:251]
    s_add_u32 s20, s20, 16384
    s_nop 7
    s_load_dwordx4 s[48:51], s[0:1], 56
    s_load_dwordx2 s[52:53], s[0:1], 72
    s_load_dwordx2 s[36:37], s[0:1], 0
    s_load_dwordx2 s[38:39], s[0:1], 96
    s_load_dwordx2 s[44:45], s[0:1], 48
    v_mbcnt_lo_u32_b32 v64, -1, 0
    v_mbcnt_hi_u32_b32 v64, -1, v64
    s_mul_i32 s32, s31, 17408
    s_add_u32 s32, s32, 34816
    s_add_u32 s33, s32, s73
    s_xor_b32 s34, s30, 1
    s_mul_i32 s34, s34, 69632
    s_add_u32 s34, s34, s32
    v_lshlrev_b32 v65, 4, v64
    v_add_u32 v66, s34, v65
    v_add_u32 v65, s33, v65
    v_mov_b32 v67, v57
    v_cmp_ne_u32 vcc, s99, v59
    s_nop 0
    s_cbranch_vccnz P0_late
P0_lateok:
    v_cvt_pk_bf16_f32 v0, v128, v129
    v_cvt_pk_bf16_f32 v1, v130, v131
    v_cvt_pk_bf16_f32 v2, v136, v137
    v_cvt_pk_bf16_f32 v3, v138, v139
    v_cvt_pk_bf16_f32 v32, v132, v133
    v_cvt_pk_bf16_f32 v33, v134, v135
    v_cvt_pk_bf16_f32 v34, v140, v141
    v_cvt_pk_bf16_f32 v35, v142, v143
    v_permlane32_swap_b32 v0, v2
    v_permlane32_swap_b32 v1, v3
    v_permlane32_swap_b32 v32, v34
    v_permlane32_swap_b32 v33, v35
    v_permlane16_swap_b32 v0, v2
    v_permlane16_swap_b32 v1, v3
    v_permlane16_swap_b32 v32, v34
    v_permlane16_swap_b32 v33, v35
    s_add_u32 m0, s17, 0
    ds_write_b128 v65, v[0:3] offset:0
    ds_write_b128 v65, v[32:35] offset:8192
    buffer_load_dwordx4 v67, s[8:11], s20 offen offset:0 lds
    v_cvt_pk_bf16_f32 v4, v144, v145
    v_cvt_pk_bf16_f32 v5, v146, v147
    v_cvt_pk_bf16_f32 v6, v152, v153
    v_cvt_pk_bf16_f32 v7, v154, v155
    v_cvt_pk_bf16_f32 v36, v148, v149
    v_cvt_pk_bf16_f32 v37, v150, v151
    v_cvt_pk_bf16_f32 v38, v156, v157
    v_cvt_pk_bf16_f32 v39, v158, v159
    v_permlane32_swap_b32 v4, v6
    v_permlane32_swap_b32 v5, v7
    v_permlane32_swap_b32 v36, v38
    v_permlane32_swap_b32 v37, v39
    v_permlane16_swap_b32 v4, v6
    v_permlane16_swap_b32 v5, v7
    v_permlane16_swap_b32 v36, v38
    v_permlane16_swap_b32 v37, v39
    s_add_u32 m0, s17, 64
    ds_write_b128 v65, v[4:7] offset:1024
    ds_write_b128 v65, v[36:39] offset:9216
    buffer_load_dwordx4 v67, s[8:11], s20 offen offset:1024 lds
    v_cvt_pk_bf16_f32 v8, v160, v161
    v_cvt_pk_bf16_f32 v9, v162, v163
    v_cvt_pk_bf16_f32 v10, v168, v169
    v_cvt_pk_bf16_f32 v11, v170, v171
    v_cvt_pk_bf16_f32 v40, v164, v165
    v_cvt_pk_bf16_f32 v41, v166, v167
    v_cvt_pk_bf16_f32 v42, v172, v173
    v_cvt_pk_bf16_f32 v43, v174, v175
    v_permlane32_swap_b32 v8, v10
    v_permlane32_swap_b32 v9, v11
    v_permlane32_swap_b32 v40, v42
    v_permlane32_swap_b32 v41, v43
    v_permlane16_swap_b32 v8, v10
    v_permlane16_swap_b32 v9, v11
    v_permlane16_swap_b32 v40, v42
    v_permlane16_swap_b32 v41, v43
    s_add_u32 m0, s17, 128
    ds_write_b128 v65, v[8:11] offset:2048
    ds_write_b128 v65, v[40:43] offset:10240
    buffer_load_dwordx4 v67, s[8:11], s20 offen offset:2048 lds
    v_cvt_pk_bf16_f32 v12, v176, v177
    v_cvt_pk_bf16_f32 v13, v178, v179
    v_cvt_pk_bf16_f32 v14, v184, v185
    v_cvt_pk_bf16_f32 v15, v186, v187
    v_cvt_pk_bf16_f32 v44, v180, v181
    v_cvt_pk_bf16_f32 v45, v182, v183
    v_cvt_pk_bf16_f32 v46, v188, v189
    v_cvt_pk_bf16_f32 v47, v190, v191
    v_permlane32_swap_b32 v12, v14
    v_permlane32_swap_b32 v13, v15
    v_permlane32_swap_b32 v44, v46
    v_permlane32_swap_b32 v45, v47
    v_permlane16_swap_b32 v12, v14
    v_permlane16_swap_b32 v13, v15
    v_permlane16_swap_b32 v44, v46
    v_permlane16_swap_b32 v45, v47
    s_add_u32 m0, s17, 192
    ds_write_b128 v65, v[12:15] offset:3072
    ds_write_b128 v65, v[44:47] offset:11264
    buffer_load_dwordx4 v67, s[8:11], s20 offen offset:3072 lds
    v_cvt_pk_bf16_f32 v16, v192, v193
    v_cvt_pk_bf16_f32 v17, v194, v195
    v_cvt_pk_bf16_f32 v18, v200, v201
    v_cvt_pk_bf16_f32 v19, v202, v203
    v_cvt_pk_bf16_f32 v48, v196, v197
    v_cvt_pk_bf16_f32 v49, v198, v199
    v_cvt_pk_bf16_f32 v50, v204, v205
    v_cvt_pk_bf16_f32 v51, v206, v207
    v_permlane32_swap_b32 v16, v18
    v_permlane32_swap_b32 v17, v19
    v_permlane32_swap_b32 v48, v50
    v_permlane32_swap_b32 v49, v51
    v_permlane16_swap_b32 v16, v18
    v_permlane16_swap_b32 v17, v19
    v_permlane16_swap_b32 v48, v50
    v_permlane16_swap_b32 v49, v51
    s_add_u32 m0, s17, 4352
    ds_write_b128 v65, v[16:19] offset:4096
    ds_write_b128 v65, v[48:51] offset:12288
    buffer_load_dwordx4 v67, s[8:11], s21 offen offset:0 lds
    v_cvt_pk_bf16_f32 v20, v208, v209
    v_cvt_pk_bf16_f32 v21, v210, v211
    v_cvt_pk_bf16_f32 v22, v216, v217
    v_cvt_pk_bf16_f32 v23, v218, v219
    v_cvt_pk_bf16_f32 v52, v212, v213
    v_cvt_pk_bf16_f32 v53, v214, v215
    v_cvt_pk_bf16_f32 v54, v220, v221
    v_cvt_pk_bf16_f32 v55, v222, v223
    v_permlane32_swap_b32 v20, v22
    v_permlane32_swap_b32 v21, v23
    v_permlane32_swap_b32 v52, v54
    v_permlane32_swap_b32 v53, v55
    v_permlane16_swap_b32 v20, v22
    v_permlane16_swap_b32 v21, v23
    v_permlane16_swap_b32 v52, v54
    v_permlane16_swap_b32 v53, v55
    s_add_u32 m0, s17, 4416
    ds_write_b128 v65, v[20:23] offset:5120
    ds_write_b128 v65, v[52:55] offset:13312
    buffer_load_dwordx4 v67, s[8:11], s21 offen offset:1024 lds
    v_cvt_pk_bf16_f32 v24, v224, v225
    v_cvt_pk_bf16_f32 v25, v226, v227
    v_cvt_pk_bf16_f32 v26, v232, v233
    v_cvt_pk_bf16_f32 v27, v234, v235
    v_cvt_pk_bf16_f32 v56, v228, v229
    v_cvt_pk_bf16_f32 v57, v230, v231
    v_cvt_pk_bf16_f32 v58, v236, v237
    v_cvt_pk_bf16_f32 v59, v238, v239
    v_permlane32_swap_b32 v24, v26
    v_permlane32_swap_b32 v25, v27
    v_permlane32_swap_b32 v56, v58
    v_permlane32_swap_b32 v57, v59
    v_permlane16_swap_b32 v24, v26
    v_permlane16_swap_b32 v25, v27
    v_permlane16_swap_b32 v56, v58
    v_permlane16_swap_b32 v57, v59
    s_add_u32 m0, s17, 4480
    ds_write_b128 v65, v[24:27] offset:6144
    ds_write_b128 v65, v[56:59] offset:14336
    buffer_load_dwordx4 v67, s[8:11], s21 offen offset:2048 lds
    v_cvt_pk_bf16_f32 v28, v240, v241
    v_cvt_pk_bf16_f32 v29, v242, v243
    v_cvt_pk_bf16_f32 v30, v248, v249
    v_cvt_pk_bf16_f32 v31, v250, v251
    v_cvt_pk_bf16_f32 v60, v244, v245
    v_cvt_pk_bf16_f32 v61, v246, v247
    v_cvt_pk_bf16_f32 v62, v252, v253
    v_cvt_pk_bf16_f32 v63, v254, v255
    v_permlane32_swap_b32 v28, v30
    v_permlane32_swap_b32 v29, v31
    v_permlane32_swap_b32 v60, v62
    v_permlane32_swap_b32 v61, v63
    v_permlane16_swap_b32 v28, v30
    v_permlane16_swap_b32 v29, v31
    v_permlane16_swap_b32 v60, v62
    v_permlane16_swap_b32 v61, v63
    s_add_u32 m0, s17, 4544
    ds_write_b128 v65, v[28:31] offset:7168
    ds_write_b128 v65, v[60:63] offset:15360
    buffer_load_dwordx4 v67, s[8:11], s21 offen offset:3072 lds
    s_add_u32 s20, s20, 16384
    s_add_u32 s21, s21, 16384
    v_mov_b32 v255, v67
    v_and_b32 v68, 15, v64
    v_lshrrev_b32 v69, 4, v64
    v_lshrrev_b32 v70, 1, v68
    v_mul_u32_u24 v70, 1088, v70
    v_and_b32 v71, 1, v68
    v_lshl_add_u32 v70, v71, 9, v70
    v_lshlrev_b32 v72, 1, v71
    v_xor_b32 v72, v72, v69
    v_lshl_add_u32 v70, v72, 4, v70
    v_add_u32 v252, s73, v70
    v_lshrrev_b32 v70, 2, v68
    v_lshl_add_u32 v70, v69, 2, v70
    v_and_b32 v71, 1, v70
    v_lshrrev_b32 v70, 1, v70
    v_mul_u32_u24 v70, 1088, v70
    v_lshl_add_u32 v70, v71, 9, v70
    v_and_b32 v72, 3, v64
    v_lshl_add_u32 v70, v72, 3, v70
    v_add_u32 v70, 34816, v70
    v_add_u32 v70, s73, v70
    v_lshl_add_u32 v253, v71, 5, v70
    v_xor_b32 v71, 1, v71
    v_lshl_add_u32 v254, v71, 5, v70
    v_mov_b32 v248, v66
    s_waitcnt vmcnt(8) lgkmcnt(0)
    s_barrier
    ds_read_b128 v[192:195], v252 offset:0
    ds_read_b128 v[196:199], v252 offset:64
    ds_read_b128 v[200:203], v252 offset:128
    ds_read_b128 v[204:207], v252 offset:192
    ds_read_b128 v[64:67], v248 offset:0
    ds_read_b128 v[68:71], v248 offset:1024
    ds_read_b128 v[72:75], v248 offset:2048
    ds_read_b128 v[76:79], v248 offset:3072
    ds_read_b128 v[80:83], v248 offset:4096
    ds_read_b128 v[84:87], v248 offset:5120
    ds_read_b128 v[88:91], v248 offset:6144
    ds_read_b128 v[92:95], v248 offset:7168
    ds_read_b128 v[96:99], v248 offset:8192
    ds_read_b128 v[100:103], v248 offset:9216
    ds_read_b128 v[104:107], v248 offset:10240
    ds_read_b128 v[108:111], v248 offset:11264
    ds_read_b128 v[112:115], v248 offset:12288
    ds_read_b128 v[116:119], v248 offset:13312
    ds_read_b128 v[120:123], v248 offset:14336
    ds_read_b128 v[124:127], v248 offset:15360
    s_waitcnt lgkmcnt(15)
    v_mfma_f32_16x16x32_bf16 v[128:131], v[192:195], v[0:3], 0
    v_mfma_f32_16x16x32_bf16 v[128:131], v[196:199], v[4:7], v[128:131]
    ds_read_b128 v[208:211], v252 offset:256
    v_mfma_f32_16x16x32_bf16 v[128:131], v[200:203], v[8:11], v[128:131]
    v_mfma_f32_16x16x32_bf16 v[128:131], v[204:207], v[12:15], v[128:131]
    ds_read_b128 v[212:215], v252 offset:320
    v_mfma_f32_16x16x32_bf16 v[132:135], v[204:207], v[44:47], 0
    v_mfma_f32_16x16x32_bf16 v[132:135], v[200:203], v[40:43], v[132:135]
    ds_read_b128 v[216:219], v252 offset:384
    v_mfma_f32_16x16x32_bf16 v[132:135], v[196:199], v[36:39], v[132:135]
    v_mfma_f32_16x16x32_bf16 v[132:135], v[192:195], v[32:35], v[132:135]
    ds_read_b128 v[220:223], v252 offset:448
    v_mfma_f32_16x16x32_bf16 v[136:139], v[192:195], v[64:67], 0
    s_waitcnt lgkmcnt(3)
    v_mfma_f32_16x16x32_bf16 v[136:139], v[196:199], v[68:71], v[136:139]
    v_mfma_f32_16x16x32_bf16 v[136:139], v[200:203], v[72:75], v[136:139]
    v_mfma_f32_16x16x32_bf16 v[136:139], v[204:207], v[76:79], v[136:139]
    v_mfma_f32_16x16x32_bf16 v[140:143], v[204:207], v[108:111], 0
    v_mfma_f32_16x16x32_bf16 v[140:143], v[200:203], v[104:107], v[140:143]
    v_mfma_f32_16x16x32_bf16 v[140:143], v[196:199], v[100:103], v[140:143]
    v_mfma_f32_16x16x32_bf16 v[140:143], v[192:195], v[96:99], v[140:143]
    v_mfma_f32_16x16x32_bf16 v[128:131], v[208:211], v[16:19], v[128:131]
    s_waitcnt lgkmcnt(0)
    s_barrier
    v_mfma_f32_16x16x32_bf16 v[128:131], v[212:215], v[20:23], v[128:131]
    s_add_u32 m0, s18, 0
    ds_read_b128 v[192:195], v252 offset:8704
    v_mfma_f32_16x16x32_bf16 v[128:131], v[216:219], v[24:27], v[128:131]
    buffer_load_dwordx4 v255, s[12:15], s22 offen offset:0 lds
    v_mfma_f32_16x16x32_bf16 v[128:131], v[220:223], v[28:31], v[128:131]
    ds_read_b128 v[196:199], v252 offset:8768
    v_mfma_f32_16x16x32_bf16 v[132:135], v[220:223], v[60:63], v[132:135]
    v_mfma_f32_16x16x32_bf16 v[132:135], v[216:219], v[56:59], v[132:135]
    s_add_u32 m0, s18, 64
    ds_read_b128 v[200:203], v252 offset:8832
    v_mfma_f32_16x16x32_bf16 v[132:135], v[212:215], v[52:55], v[132:135]
    buffer_load_dwordx4 v255, s[12:15], s22 offen offset:1024 lds
    v_mfma_f32_16x16x32_bf16 v[132:135], v[208:211], v[48:51], v[132:135]
    ds_read_b128 v[204:207], v252 offset:8896
    v_mfma_f32_16x16x32_bf16 v[136:139], v[208:211], v[80:83], v[136:139]
    v_mfma_f32_16x16x32_bf16 v[136:139], v[212:215], v[84:87], v[136:139]
    s_add_u32 m0, s18, 128
    v_mfma_f32_16x16x32_bf16 v[136:139], v[216:219], v[88:91], v[136:139]
    buffer_load_dwordx4 v255, s[12:15], s22 offen offset:2048 lds
    v_mfma_f32_16x16x32_bf16 v[136:139], v[220:223], v[92:95], v[136:139]
    v_mfma_f32_16x16x32_bf16 v[140:143], v[220:223], v[124:127], v[140:143]
    v_mfma_f32_16x16x32_bf16 v[140:143], v[216:219], v[120:123], v[140:143]
    s_add_u32 m0, s18, 192
    v_mfma_f32_16x16x32_bf16 v[140:143], v[212:215], v[116:119], v[140:143]
    buffer_load_dwordx4 v255, s[12:15], s22 offen offset:3072 lds
    v_mfma_f32_16x16x32_bf16 v[140:143], v[208:211], v[112:115], v[140:143]
    s_waitcnt lgkmcnt(0)
    v_mfma_f32_16x16x32_bf16 v[144:147], v[192:195], v[0:3], 0
    v_mfma_f32_16x16x32_bf16 v[144:147], v[196:199], v[4:7], v[144:147]
    s_add_u32 m0, s18, 4352
    ds_read_b128 v[208:211], v252 offset:8960
    v_mfma_f32_16x16x32_bf16 v[144:147], v[200:203], v[8:11], v[144:147]
    buffer_load_dwordx4 v255, s[12:15], s23 offen offset:0 lds
    v_mfma_f32_16x16x32_bf16 v[144:147], v[204:207], v[12:15], v[144:147]
    ds_read_b128 v[212:215], v252 offset:9024
    v_mfma_f32_16x16x32_bf16 v[148:151], v[204:207], v[44:47], 0
    v_mfma_f32_16x16x32_bf16 v[148:151], v[200:203], v[40:43], v[148:151]
    s_add_u32 m0, s18, 4416
    ds_read_b128 v[216:219], v252 offset:9088
    v_mfma_f32_16x16x32_bf16 v[148:151], v[196:199], v[36:39], v[148:151]
    buffer_load_dwordx4 v255, s[12:15], s23 offen offset:1024 lds
    v_mfma_f32_16x16x32_bf16 v[148:151], v[192:195], v[32:35], v[148:151]
    ds_read_b128 v[220:223], v252 offset:9152
    v_mfma_f32_16x16x32_bf16 v[152:155], v[192:195], v[64:67], 0
    v_mbcnt_lo_u32_b32 v224, -1, 0
    v_mbcnt_hi_u32_b32 v224, -1, v224
    v_mfma_f32_16x16x32_bf16 v[152:155], v[196:199], v[68:71], v[152:155]
    s_add_u32 m0, s18, 4480
    s_lshl_b32 s32, s27, 10
    v_lshlrev_b32 v224, 4, v224
    v_mfma_f32_16x16x32_bf16 v[152:155], v[200:203], v[72:75], v[152:155]
    buffer_load_dwordx4 v255, s[12:15], s23 offen offset:2048 lds
    v_mfma_f32_16x16x32_bf16 v[152:155], v[204:207], v[76:79], v[152:155]
    v_max3_f32 v248, v128, v129, v130
    v_max_f32 v248, v248, v131
    v_mfma_f32_16x16x32_bf16 v[156:159], v[204:207], v[108:111], 0
    v_max3_f32 v249, v132, v133, v134
    v_max_f32 v249, v249, v135
    v_mfma_f32_16x16x32_bf16 v[156:159], v[200:203], v[104:107], v[156:159]
    s_add_u32 m0, s18, 4544
    v_max3_f32 v250, v136, v137, v138
    v_max_f32 v250, v250, v139
    v_mfma_f32_16x16x32_bf16 v[156:159], v[196:199], v[100:103], v[156:159]
    s_waitcnt lgkmcnt(0)
    buffer_load_dwordx4 v255, s[12:15], s23 offen offset:3072 lds
    v_mfma_f32_16x16x32_bf16 v[156:159], v[192:195], v[96:99], v[156:159]
    s_add_u32 s23, s23, 16384
    v_max3_f32 v251, v140, v141, v142
    v_max_f32 v251, v251, v143
    v_mfma_f32_16x16x32_bf16 v[144:147], v[208:211], v[16:19], v[144:147]
    s_add_u32 s22, s22, 16384
    s_add_u32 s33, s32, 156928
    v_add_u32 v224, s33, v224
    v_mfma_f32_16x16x32_bf16 v[144:147], v[212:215], v[20:23], v[144:147]
    s_lshl_b32 s33, s30, 12
    s_sub_u32 s33, 2048, s33
    v_add_u32 v228, s33, v224
    v_mfma_f32_16x16x32_bf16 v[144:147], v[216:219], v[24:27], v[144:147]
    s_waitcnt vmcnt(8) lgkmcnt(0)
    s_barrier
    ds_read_b128 v[192:195], v252 offset:17408
    s_add_u32 m0, s16, 0
    v_mfma_f32_16x16x32_bf16 v[144:147], v[220:223], v[28:31], v[144:147]
    buffer_load_dwordx4 v255, s[8:11], s20 offen offset:0 lds
    s_add_u32 m0, s16, 64
    v_mfma_f32_16x16x32_bf16 v[148:151], v[220:223], v[60:63], v[148:151]
    ds_read_b128 v[196:199], v252 offset:17472
    buffer_load_dwordx4 v255, s[8:11], s20 offen offset:1024 lds
    s_add_u32 m0, s16, 128
    v_mfma_f32_16x16x32_bf16 v[148:151], v[216:219], v[56:59], v[148:151]
    buffer_load_dwordx4 v255, s[8:11], s20 offen offset:2048 lds
    s_add_u32 m0, s16, 192
    v_mfma_f32_16x16x32_bf16 v[148:151], v[212:215], v[52:55], v[148:151]
    ds_read_b128 v[200:203], v252 offset:17536
    buffer_load_dwordx4 v255, s[8:11], s20 offen offset:3072 lds
    v_mfma_f32_16x16x32_bf16 v[148:151], v[208:211], v[48:51], v[148:151]
    s_add_u32 m0, s16, 4352
    v_mfma_f32_16x16x32_bf16 v[152:155], v[208:211], v[80:83], v[152:155]
    ds_read_b128 v[204:207], v252 offset:17600
    buffer_load_dwordx4 v255, s[8:11], s21 offen offset:0 lds
    s_add_u32 m0, s16, 4416
    v_mfma_f32_16x16x32_bf16 v[152:155], v[212:215], v[84:87], v[152:155]
    buffer_load_dwordx4 v255, s[8:11], s21 offen offset:1024 lds
    s_add_u32 m0, s16, 4480
    v_mfma_f32_16x16x32_bf16 v[152:155], v[216:219], v[88:91], v[152:155]
    buffer_load_dwordx4 v255, s[8:11], s21 offen offset:2048 lds
    s_add_u32 m0, s16, 4544
    v_mfma_f32_16x16x32_bf16 v[152:155], v[220:223], v[92:95], v[152:155]
    buffer_load_dwordx4 v255, s[8:11], s21 offen offset:3072 lds
    v_mfma_f32_16x16x32_bf16 v[156:159], v[220:223], v[124:127], v[156:159]
    s_add_u32 s20, s20, 16384
    v_mfma_f32_16x16x32_bf16 v[156:159], v[216:219], v[120:123], v[156:159]
    s_mov_b32 m0, 139264
    s_nop 0
    buffer_load_dword v255, s[64:67], s68 offen lds
    s_add_u32 s68, s68, 16384
    v_mfma_f32_16x16x32_bf16 v[156:159], v[212:215], v[116:119], v[156:159]
    s_mov_b32 m0, 139264
    s_nop 0
    buffer_load_dword v255, s[64:67], s68 offen lds
    s_add_u32 s68, s68, 16384
    v_mfma_f32_16x16x32_bf16 v[156:159], v[208:211], v[112:115], v[156:159]
    s_mov_b32 m0, 139264
    s_nop 0
    buffer_load_dword v255, s[64:67], s68 offen lds
    s_add_u32 s68, s68, 16384
    s_add_u32 s21, s21, 16384
    v_max3_f32 v248, v248, v144, v145
    v_max3_f32 v248, v248, v146, v147
    v_max3_f32 v249, v249, v148, v149
    v_max3_f32 v249, v249, v150, v151
    v_max3_f32 v250, v250, v152, v153
    v_max3_f32 v250, v250, v154, v155
    s_nop 1
    v_max3_f32 v251, v251, v156, v157
    v_max3_f32 v251, v251, v158, v159
    v_mov_b32 v244, v248
    v_mov_b32 v245, v249
    v_mov_b32 v246, v250
    v_mov_b32 v247, v251
    s_nop 1
    v_permlane16_swap_b32 v248, v244
    v_permlane16_swap_b32 v249, v245
    v_permlane16_swap_b32 v250, v246
    v_permlane16_swap_b32 v251, v247
    s_nop 1
    v_max_f32 v248, v248, v244
    v_max_f32 v249, v249, v245
    v_max_f32 v250, v250, v246
    v_max_f32 v251, v251, v247
    v_mov_b32 v244, v248
    v_mov_b32 v245, v249
    v_mov_b32 v246, v250
    v_mov_b32 v247, v251
    s_nop 1
    v_permlane32_swap_b32 v248, v244
    v_permlane32_swap_b32 v249, v245
    v_permlane32_swap_b32 v250, v246
    v_permlane32_swap_b32 v251, v247
    s_nop 1
    v_max_f32 v248, v248, v244
    v_max_f32 v249, v249, v245
    v_max_f32 v250, v250, v246
    v_max_f32 v251, v251, v247
    ds_write_b128 v224, v[248:251]
    s_waitcnt lgkmcnt(0)
    s_barrier
    ds_read_b128 v[240:243], v228
    s_waitcnt lgkmcnt(0)
    v_max_f32 v244, v248, v242
    v_add_f32 v244, s26, v244
    v_max_f32 v245, v249, v243
    v_add_f32 v245, s26, v245
    v_max_f32 v246, v250, v240
    v_add_f32 v246, s26, v246
    v_max_f32 v247, v251, v241
    v_add_f32 v247, s26, v247
    v_sub_f32 v128, v128, v244
    v_sub_f32 v129, v129, v244
    v_sub_f32 v130, v130, v244
    v_sub_f32 v131, v131, v244
    v_sub_f32 v144, v144, v244
    v_sub_f32 v145, v145, v244
    v_sub_f32 v146, v146, v244
    v_sub_f32 v147, v147, v244
    v_exp_f32 v248, v128
    v_exp_f32 v249, v129
    v_exp_f32 v250, v130
    v_exp_f32 v251, v131
    v_sub_f32 v224, 0, v244
    v_sub_f32 v225, 0, v244
    v_sub_f32 v226, 0, v244
    v_sub_f32 v227, 0, v244
    v_add_f32 v240, v248, v249
    v_cvt_pk_bf16_f32 v160, v248, v249
    v_add_f32 v240, v240, v250
    v_add_f32 v240, v240, v251
    v_cvt_pk_bf16_f32 v161, v250, v251
    v_exp_f32 v248, v144
    v_exp_f32 v249, v145
    v_exp_f32 v250, v146
    v_exp_f32 v251, v147
    v_add_f32 v240, v240, v248
    v_add_f32 v240, v240, v249
    v_cvt_pk_bf16_f32 v162, v248, v249
    v_add_f32 v240, v240, v250
    v_add_f32 v240, v240, v251
    v_cvt_pk_bf16_f32 v163, v250, v251
    v_sub_f32 v132, v132, v245
    v_sub_f32 v133, v133, v245
    v_sub_f32 v134, v134, v245
    v_sub_f32 v135, v135, v245
    v_sub_f32 v148, v148, v245
    v_sub_f32 v149, v149, v245
    v_sub_f32 v150, v150, v245
    v_sub_f32 v151, v151, v245
    v_exp_f32 v248, v132
    v_exp_f32 v249, v133
    v_exp_f32 v250, v134
    v_exp_f32 v251, v135
    v_sub_f32 v228, 0, v245
    v_sub_f32 v229, 0, v245
    v_sub_f32 v230, 0, v245
    v_sub_f32 v231, 0, v245
    v_add_f32 v241, v248, v249
    v_cvt_pk_bf16_f32 v164, v248, v249
    v_add_f32 v241, v241, v250
    v_add_f32 v241, v241, v251
    v_cvt_pk_bf16_f32 v165, v250, v251
    v_exp_f32 v248, v148
    v_exp_f32 v249, v149
    v_exp_f32 v250, v150
    v_exp_f32 v251, v151
    v_add_f32 v241, v241, v248
    v_add_f32 v241, v241, v249
    v_cvt_pk_bf16_f32 v166, v248, v249
    v_add_f32 v241, v241, v250
    v_add_f32 v241, v241, v251
    v_cvt_pk_bf16_f32 v167, v250, v251
    v_sub_f32 v136, v136, v246
    v_sub_f32 v137, v137, v246
    v_sub_f32 v138, v138, v246
    v_sub_f32 v139, v139, v246
    v_sub_f32 v152, v152, v246
    v_sub_f32 v153, v153, v246
    v_sub_f32 v154, v154, v246
    v_sub_f32 v155, v155, v246
    v_exp_f32 v248, v136
    v_exp_f32 v249, v137
    v_exp_f32 v250, v138
    v_exp_f32 v251, v139
    v_sub_f32 v232, 0, v246
    v_sub_f32 v233, 0, v246
    v_sub_f32 v234, 0, v246
    v_sub_f32 v235, 0, v246
    v_add_f32 v242, v248, v249
    v_cvt_pk_bf16_f32 v168, v248, v249
    v_add_f32 v242, v242, v250
    v_add_f32 v242, v242, v251
    v_cvt_pk_bf16_f32 v169, v250, v251
    v_exp_f32 v248, v152
    v_exp_f32 v249, v153
    v_exp_f32 v250, v154
    v_exp_f32 v251, v155
    v_add_f32 v242, v242, v248
    v_add_f32 v242, v242, v249
    v_cvt_pk_bf16_f32 v170, v248, v249
    v_add_f32 v242, v242, v250
    v_add_f32 v242, v242, v251
    v_cvt_pk_bf16_f32 v171, v250, v251
    v_sub_f32 v140, v140, v247
    v_sub_f32 v141, v141, v247
    v_sub_f32 v142, v142, v247
    v_sub_f32 v143, v143, v247
    v_sub_f32 v156, v156, v247
    v_sub_f32 v157, v157, v247
    v_sub_f32 v158, v158, v247
    v_sub_f32 v159, v159, v247
    v_exp_f32 v248, v140
    v_exp_f32 v249, v141
    v_exp_f32 v250, v142
    v_exp_f32 v251, v143
    v_sub_f32 v236, 0, v247
    v_sub_f32 v237, 0, v247
    v_sub_f32 v238, 0, v247
    v_sub_f32 v239, 0, v247
    v_add_f32 v243, v248, v249
    v_cvt_pk_bf16_f32 v172, v248, v249
    v_add_f32 v243, v243, v250
    v_add_f32 v243, v243, v251
    v_cvt_pk_bf16_f32 v173, v250, v251
    v_exp_f32 v248, v156
    v_exp_f32 v249, v157
    v_exp_f32 v250, v158
    v_exp_f32 v251, v159
    v_add_f32 v243, v243, v248
    v_add_f32 v243, v243, v249
    v_cvt_pk_bf16_f32 v174, v248, v249
    v_add_f32 v243, v243, v250
    v_add_f32 v243, v243, v251
    v_cvt_pk_bf16_f32 v175, v250, v251
    v_mfma_f32_16x16x32_bf16 v[128:131], v[192:195], v[0:3], v[224:227]
    v_mfma_f32_16x16x32_bf16 v[128:131], v[196:199], v[4:7], v[128:131]
    s_add_u32 m0, s19, 0
    ds_read_b128 v[208:211], v252 offset:17664
    v_mfma_f32_16x16x32_bf16 v[128:131], v[200:203], v[8:11], v[128:131]
    buffer_load_dwordx4 v255, s[12:15], s22 offen offset:0 lds
    v_mfma_f32_16x16x32_bf16 v[128:131], v[204:207], v[12:15], v[128:131]
    ds_read_b128 v[212:215], v252 offset:17728
    v_mfma_f32_16x16x32_bf16 v[132:135], v[204:207], v[44:47], v[228:231]
    v_mfma_f32_16x16x32_bf16 v[132:135], v[200:203], v[40:43], v[132:135]
    s_add_u32 m0, s19, 64
    ds_read_b128 v[216:219], v252 offset:17792
    v_mfma_f32_16x16x32_bf16 v[132:135], v[196:199], v[36:39], v[132:135]
    buffer_load_dwordx4 v255, s[12:15], s22 offen offset:1024 lds
    v_mfma_f32_16x16x32_bf16 v[132:135], v[192:195], v[32:35], v[132:135]
    ds_read_b128 v[220:223], v252 offset:17856
    v_mfma_f32_16x16x32_bf16 v[136:139], v[192:195], v[64:67], v[232:235]
    s_add_u32 m0, s19, 128
    v_mfma_f32_16x16x32_bf16 v[136:139], v[196:199], v[68:71], v[136:139]
    buffer_load_dwordx4 v255, s[12:15], s22 offen offset:2048 lds
    v_mfma_f32_16x16x32_bf16 v[136:139], v[200:203], v[72:75], v[136:139]
    s_add_u32 m0, s19, 192
    v_mfma_f32_16x16x32_bf16 v[136:139], v[204:207], v[76:79], v[136:139]
    buffer_load_dwordx4 v255, s[12:15], s22 offen offset:3072 lds
    v_mfma_f32_16x16x32_bf16 v[140:143], v[204:207], v[108:111], v[236:239]
    s_add_u32 m0, s19, 4352
    v_mfma_f32_16x16x32_bf16 v[140:143], v[200:203], v[104:107], v[140:143]
    buffer_load_dwordx4 v255, s[12:15], s23 offen offset:0 lds
    v_mfma_f32_16x16x32_bf16 v[140:143], v[196:199], v[100:103], v[140:143]
    s_add_u32 m0, s19, 4416
    v_mfma_f32_16x16x32_bf16 v[140:143], v[192:195], v[96:99], v[140:143]
    s_waitcnt lgkmcnt(0)
    buffer_load_dwordx4 v255, s[12:15], s23 offen offset:1024 lds
    v_mfma_f32_16x16x32_bf16 v[128:131], v[208:211], v[16:19], v[128:131]
    v_mfma_f32_16x16x32_bf16 v[128:131], v[212:215], v[20:23], v[128:131]
    s_add_u32 m0, s19, 4480
    ds_read_b128 v[192:195], v252 offset:26112
    v_mfma_f32_16x16x32_bf16 v[128:131], v[216:219], v[24:27], v[128:131]
    buffer_load_dwordx4 v255, s[12:15], s23 offen offset:2048 lds
    v_mfma_f32_16x16x32_bf16 v[128:131], v[220:223], v[28:31], v[128:131]
    ds_read_b128 v[196:199], v252 offset:26176
    v_mfma_f32_16x16x32_bf16 v[132:135], v[220:223], v[60:63], v[132:135]
    v_mfma_f32_16x16x32_bf16 v[132:135], v[216:219], v[56:59], v[132:135]
    s_add_u32 m0, s19, 4544
    ds_read_b128 v[200:203], v252 offset:26240
    v_mfma_f32_16x16x32_bf16 v[132:135], v[212:215], v[52:55], v[132:135]
    buffer_load_dwordx4 v255, s[12:15], s23 offen offset:3072 lds
    v_mfma_f32_16x16x32_bf16 v[132:135], v[208:211], v[48:51], v[132:135]
    s_add_u32 s22, s22, 16384
    ds_read_b128 v[204:207], v252 offset:26304
    v_mfma_f32_16x16x32_bf16 v[136:139], v[208:211], v[80:83], v[136:139]
    s_add_u32 s23, s23, 16384
    v_exp_f32 v248, v128
    v_mfma_f32_16x16x32_bf16 v[136:139], v[212:215], v[84:87], v[136:139]
    v_exp_f32 v249, v129
    v_mfma_f32_16x16x32_bf16 v[136:139], v[216:219], v[88:91], v[136:139]
    v_exp_f32 v250, v130
    v_mfma_f32_16x16x32_bf16 v[136:139], v[220:223], v[92:95], v[136:139]
    v_exp_f32 v251, v131
    v_mfma_f32_16x16x32_bf16 v[140:143], v[220:223], v[124:127], v[140:143]
    v_add_f32 v244, v240, v248
    v_add_f32 v244, v244, v249
    v_mfma_f32_16x16x32_bf16 v[140:143], v[216:219], v[120:123], v[140:143]
    v_cvt_pk_bf16_f32 v176, v248, v249
    v_add_f32 v244, v244, v250
    v_mfma_f32_16x16x32_bf16 v[140:143], v[212:215], v[116:119], v[140:143]
    v_exp_f32 v248, v132
    v_mfma_f32_16x16x32_bf16 v[140:143], v[208:211], v[112:115], v[140:143]
    s_waitcnt lgkmcnt(0)
    v_exp_f32 v249, v133
    v_mfma_f32_16x16x32_bf16 v[144:147], v[192:195], v[0:3], v[224:227]
    v_add_f32 v244, v244, v251
    v_cvt_pk_bf16_f32 v177, v250, v251
    v_mfma_f32_16x16x32_bf16 v[144:147], v[196:199], v[4:7], v[144:147]
    ds_read_b128 v[208:211], v252 offset:26368
    v_add_f32 v245, v241, v248
    v_mfma_f32_16x16x32_bf16 v[144:147], v[200:203], v[8:11], v[144:147]
    v_exp_f32 v250, v134
    v_mfma_f32_16x16x32_bf16 v[144:147], v[204:207], v[12:15], v[144:147]
    ds_read_b128 v[212:215], v252 offset:26432
    v_add_f32 v245, v245, v249
    v_mfma_f32_16x16x32_bf16 v[148:151], v[204:207], v[44:47], v[228:231]
    v_exp_f32 v251, v135
    v_mfma_f32_16x16x32_bf16 v[148:151], v[200:203], v[40:43], v[148:151]
    ds_read_b128 v[216:219], v252 offset:26496
    v_cvt_pk_bf16_f32 v180, v248, v249
    v_mfma_f32_16x16x32_bf16 v[148:151], v[196:199], v[36:39], v[148:151]
    v_exp_f32 v248, v136
    v_mfma_f32_16x16x32_bf16 v[148:151], v[192:195], v[32:35], v[148:151]
    ds_read_b128 v[220:223], v252 offset:26560
    v_add_f32 v245, v245, v250
    v_mfma_f32_16x16x32_bf16 v[152:155], v[192:195], v[64:67], v[232:235]
    v_exp_f32 v249, v137
    v_mfma_f32_16x16x32_bf16 v[152:155], v[196:199], v[68:71], v[152:155]
    v_add_f32 v245, v245, v251
    v_cvt_pk_bf16_f32 v181, v250, v251
    v_mfma_f32_16x16x32_bf16 v[152:155], v[200:203], v[72:75], v[152:155]
    v_exp_f32 v250, v138
    v_mfma_f32_16x16x32_bf16 v[152:155], v[204:207], v[76:79], v[152:155]
    v_exp_f32 v251, v139
    v_mfma_f32_16x16x32_bf16 v[156:159], v[204:207], v[108:111], v[236:239]
    v_add_f32 v246, v242, v248
    v_add_f32 v246, v246, v249
    v_mfma_f32_16x16x32_bf16 v[156:159], v[200:203], v[104:107], v[156:159]
    v_cvt_pk_bf16_f32 v184, v248, v249
    v_add_f32 v246, v246, v250
    v_mfma_f32_16x16x32_bf16 v[156:159], v[196:199], v[100:103], v[156:159]
    v_exp_f32 v248, v140
    v_mfma_f32_16x16x32_bf16 v[156:159], v[192:195], v[96:99], v[156:159]
    s_waitcnt lgkmcnt(0)
    v_exp_f32 v249, v141
    v_mfma_f32_16x16x32_bf16 v[144:147], v[208:211], v[16:19], v[144:147]
    v_add_f32 v246, v246, v251
    v_cvt_pk_bf16_f32 v185, v250, v251
    v_mfma_f32_16x16x32_bf16 v[144:147], v[212:215], v[20:23], v[144:147]
    v_exp_f32 v250, v142
    v_mfma_f32_16x16x32_bf16 v[144:147], v[216:219], v[24:27], v[144:147]
    s_waitcnt vmcnt(19) lgkmcnt(0)
    s_barrier
    ds_read_b64_tr_b16 v[192:193], v253 offset:0
    v_add_f32 v247, v243, v248
    v_mfma_f32_16x16x32_bf16 v[144:147], v[220:223], v[28:31], v[144:147]
    ds_read_b64_tr_b16 v[194:195], v253 offset:8704
    v_add_f32 v247, v247, v249
    v_mfma_f32_16x16x32_bf16 v[148:151], v[220:223], v[60:63], v[148:151]
    ds_read_b64_tr_b16 v[196:197], v254 offset:0
    v_cvt_pk_bf16_f32 v188, v248, v249
    v_mfma_f32_16x16x32_bf16 v[148:151], v[216:219], v[56:59], v[148:151]
    ds_read_b64_tr_b16 v[198:199], v254 offset:8704
    v_add_f32 v247, v247, v250
    v_mfma_f32_16x16x32_bf16 v[148:151], v[212:215], v[52:55], v[148:151]
    ds_read_b64_tr_b16 v[200:201], v253 offset:64
    v_mfma_f32_16x16x32_bf16 v[148:151], v[208:211], v[48:51], v[148:151]
    ds_read_b64_tr_b16 v[202:203], v253 offset:8768
    v_mfma_f32_16x16x32_bf16 v[152:155], v[208:211], v[80:83], v[152:155]
    ds_read_b64_tr_b16 v[204:205], v254 offset:64
    v_mfma_f32_16x16x32_bf16 v[152:155], v[212:215], v[84:87], v[152:155]
    ds_read_b64_tr_b16 v[206:207], v254 offset:8768
    v_mfma_f32_16x16x32_bf16 v[152:155], v[216:219], v[88:91], v[152:155]
    v_exp_f32 v251, v143
    v_mfma_f32_16x16x32_bf16 v[152:155], v[220:223], v[92:95], v[152:155]
    v_exp_f32 v248, v144
    v_mfma_f32_16x16x32_bf16 v[156:159], v[220:223], v[124:127], v[156:159]
    v_exp_f32 v249, v145
    v_mfma_f32_16x16x32_bf16 v[156:159], v[216:219], v[120:123], v[156:159]
    v_add_f32 v247, v247, v251
    v_cvt_pk_bf16_f32 v189, v250, v251
    v_mfma_f32_16x16x32_bf16 v[156:159], v[212:215], v[116:119], v[156:159]
    v_exp_f32 v250, v146
    v_mfma_f32_16x16x32_bf16 v[156:159], v[208:211], v[112:115], v[156:159]
    s_waitcnt lgkmcnt(1)
    v_exp_f32 v251, v147
    v_mfma_f32_16x16x32_bf16 a[0:3], v[192:195], v[160:163], 0
    ds_read_b64_tr_b16 v[208:209], v253 offset:128
    v_add_f32 v244, v244, v248
    v_mfma_f32_16x16x32_bf16 a[4:7], v[192:195], v[164:167], 0
    s_add_u32 m0, s17, 0
    ds_read_b64_tr_b16 v[210:211], v253 offset:8832
    v_add_f32 v244, v244, v249
    v_mfma_f32_16x16x32_bf16 a[8:11], v[192:195], v[168:171], 0
    buffer_load_dwordx4 v255, s[8:11], s20 offen offset:0 lds
    v_mfma_f32_16x16x32_bf16 a[12:15], v[192:195], v[172:175], 0
    ds_read_b64_tr_b16 v[212:213], v254 offset:128
    v_cvt_pk_bf16_f32 v178, v248, v249
    v_mfma_f32_16x16x32_bf16 a[28:31], v[196:199], v[172:175], 0
    ds_read_b64_tr_b16 v[214:215], v254 offset:8832
    v_add_f32 v244, v244, v250
    v_mfma_f32_16x16x32_bf16 a[24:27], v[196:199], v[168:171], 0
    v_exp_f32 v248, v148
    v_mfma_f32_16x16x32_bf16 a[20:23], v[196:199], v[164:167], 0
    ds_read_b64_tr_b16 v[216:217], v253 offset:192
    v_add_f32 v244, v244, v251
    v_mfma_f32_16x16x32_bf16 a[16:19], v[196:199], v[160:163], 0
    v_exp_f32 v249, v149
    v_mfma_f32_16x16x32_bf16 a[32:35], v[200:203], v[160:163], 0
    s_add_u32 m0, s17, 64
    ds_read_b64_tr_b16 v[218:219], v253 offset:8896
    v_cvt_pk_bf16_f32 v179, v250, v251
    v_mfma_f32_16x16x32_bf16 a[36:39], v[200:203], v[164:167], 0
    buffer_load_dwordx4 v255, s[8:11], s20 offen offset:1024 lds
    v_mfma_f32_16x16x32_bf16 a[40:43], v[200:203], v[168:171], 0
    ds_read_b64_tr_b16 v[220:221], v254 offset:192
    v_add_f32 v245, v245, v248
    v_mfma_f32_16x16x32_bf16 a[44:47], v[200:203], v[172:175], 0
    s_waitcnt lgkmcnt(3)
    ds_read_b64_tr_b16 v[222:223], v254 offset:8896
    v_add_f32 v245, v245, v249
    v_mfma_f32_16x16x32_bf16 a[60:63], v[204:207], v[172:175], 0
    v_exp_f32 v250, v150
    v_mfma_f32_16x16x32_bf16 a[56:59], v[204:207], v[168:171], 0
    ds_read_b64_tr_b16 v[192:193], v253 offset:256
    v_cvt_pk_bf16_f32 v182, v248, v249
    v_mfma_f32_16x16x32_bf16 a[52:55], v[204:207], v[164:167], 0
    v_exp_f32 v251, v151
    v_mfma_f32_16x16x32_bf16 a[48:51], v[204:207], v[160:163], 0
    s_add_u32 m0, s17, 128
    ds_read_b64_tr_b16 v[194:195], v253 offset:8960
    v_add_f32 v245, v245, v250
    v_mfma_f32_16x16x32_bf16 a[64:67], v[208:211], v[160:163], 0
    buffer_load_dwordx4 v255, s[8:11], s20 offen offset:2048 lds
    v_mfma_f32_16x16x32_bf16 a[68:71], v[208:211], v[164:167], 0
    ds_read_b64_tr_b16 v[196:197], v254 offset:256
    v_add_f32 v245, v245, v251
    v_mfma_f32_16x16x32_bf16 a[72:75], v[208:211], v[168:171], 0
    ds_read_b64_tr_b16 v[198:199], v254 offset:8960
    v_cvt_pk_bf16_f32 v183, v250, v251
    v_mfma_f32_16x16x32_bf16 a[76:79], v[208:211], v[172:175], 0
    v_exp_f32 v248, v152
    v_mfma_f32_16x16x32_bf16 a[92:95], v[212:215], v[172:175], 0
    ds_read_b64_tr_b16 v[200:201], v253 offset:320
    v_add_f32 v246, v246, v248
    v_mfma_f32_16x16x32_bf16 a[88:91], v[212:215], v[168:171], 0
    v_exp_f32 v249, v153
    v_mfma_f32_16x16x32_bf16 a[84:87], v[212:215], v[164:167], 0
    s_add_u32 m0, s17, 192
    ds_read_b64_tr_b16 v[202:203], v253 offset:9024
    v_add_f32 v246, v246, v249
    v_mfma_f32_16x16x32_bf16 a[80:83], v[212:215], v[160:163], 0
    s_waitcnt lgkmcnt(4)
    buffer_load_dwordx4 v255, s[8:11], s20 offen offset:3072 lds
    v_mfma_f32_16x16x32_bf16 a[96:99], v[216:219], v[160:163], 0
    ds_read_b64_tr_b16 v[204:205], v254 offset:320
    v_cvt_pk_bf16_f32 v186, v248, v249
    v_mfma_f32_16x16x32_bf16 a[100:103], v[216:219], v[164:167], 0
    ds_read_b64_tr_b16 v[206:207], v254 offset:9024
    v_mfma_f32_16x16x32_bf16 a[104:107], v[216:219], v[168:171], 0
    v_exp_f32 v250, v154
    v_mfma_f32_16x16x32_bf16 a[108:111], v[216:219], v[172:175], 0
    ds_read_b64_tr_b16 v[208:209], v253 offset:384
    v_add_f32 v246, v246, v250
    v_mfma_f32_16x16x32_bf16 a[124:127], v[220:223], v[172:175], 0
    v_exp_f32 v251, v155
    v_mfma_f32_16x16x32_bf16 a[120:123], v[220:223], v[168:171], 0
    s_add_u32 m0, s17, 4352
    ds_read_b64_tr_b16 v[210:211], v253 offset:9088
    v_add_f32 v246, v246, v251
    v_mfma_f32_16x16x32_bf16 a[116:119], v[220:223], v[164:167], 0
    buffer_load_dwordx4 v255, s[8:11], s21 offen offset:0 lds
    v_mfma_f32_16x16x32_bf16 a[112:115], v[220:223], v[160:163], 0
    ds_read_b64_tr_b16 v[212:213], v254 offset:384
    v_cvt_pk_bf16_f32 v187, v250, v251
    v_mfma_f32_16x16x32_bf16 a[128:131], v[192:195], v[160:163], 0
    ds_read_b64_tr_b16 v[214:215], v254 offset:9088
    v_mfma_f32_16x16x32_bf16 a[132:135], v[192:195], v[164:167], 0
    v_exp_f32 v248, v156
    v_mfma_f32_16x16x32_bf16 a[136:139], v[192:195], v[168:171], 0
    ds_read_b64_tr_b16 v[216:217], v253 offset:448
    v_add_f32 v247, v247, v248
    v_mfma_f32_16x16x32_bf16 a[140:143], v[192:195], v[172:175], 0
    s_waitcnt lgkmcnt(4)
    v_exp_f32 v249, v157
    v_mfma_f32_16x16x32_bf16 a[156:159], v[196:199], v[172:175], 0
    s_add_u32 m0, s17, 4416
    ds_read_b64_tr_b16 v[218:219], v253 offset:9152
    v_add_f32 v247, v247, v249
    v_mfma_f32_16x16x32_bf16 a[152:155], v[196:199], v[168:171], 0
    buffer_load_dwordx4 v255, s[8:11], s21 offen offset:1024 lds
    v_mfma_f32_16x16x32_bf16 a[148:151], v[196:199], v[164:167], 0
    ds_read_b64_tr_b16 v[220:221], v254 offset:448
    v_cvt_pk_bf16_f32 v190, v248, v249
    v_mfma_f32_16x16x32_bf16 a[144:147], v[196:199], v[160:163], 0
    v_exp_f32 v250, v158
    v_mfma_f32_16x16x32_bf16 a[160:163], v[200:203], v[160:163], 0
    ds_read_b64_tr_b16 v[222:223], v254 offset:9152
    v_add_f32 v247, v247, v250
    v_mfma_f32_16x16x32_bf16 a[164:167], v[200:203], v[164:167], 0
    s_add_u32 m0, s17, 4480
    v_exp_f32 v251, v159
    v_mfma_f32_16x16x32_bf16 a[168:171], v[200:203], v[168:171], 0
    buffer_load_dwordx4 v255, s[8:11], s21 offen offset:2048 lds
    v_mfma_f32_16x16x32_bf16 a[172:175], v[200:203], v[172:175], 0
    v_add_f32 v247, v247, v251
    v_cvt_pk_bf16_f32 v191, v250, v251
    v_mfma_f32_16x16x32_bf16 a[188:191], v[204:207], v[172:175], 0
    v_max3_f32 v248, v244, v245, v246
    v_max_f32 v248, v248, v247
    v_mfma_f32_16x16x32_bf16 a[184:187], v[204:207], v[168:171], 0
    s_add_u32 m0, s17, 4544
    v_cmp_lt_f32 vcc, s25, v248
    v_mfma_f32_16x16x32_bf16 a[180:183], v[204:207], v[164:167], 0
    s_waitcnt lgkmcnt(1)
    buffer_load_dwordx4 v255, s[8:11], s21 offen offset:3072 lds
    v_mfma_f32_16x16x32_bf16 a[176:179], v[204:207], v[160:163], 0
    s_add_u32 s20, s20, 16384
    v_mfma_f32_16x16x32_bf16 a[192:195], v[208:211], v[160:163], 0
    s_add_u32 s21, s21, 16384
    v_mfma_f32_16x16x32_bf16 a[196:199], v[208:211], v[164:167], 0
    s_mov_b32 m0, 139264
    v_mfma_f32_16x16x32_bf16 a[200:203], v[208:211], v[168:171], 0
    s_waitcnt vmcnt(19) lgkmcnt(0)
    s_barrier
    ds_read_b128 v[192:195], v252 offset:0
    v_mfma_f32_16x16x32_bf16 a[204:207], v[208:211], v[172:175], 0
    buffer_load_dword v255, s[64:67], s68 offen lds
    v_mfma_f32_16x16x32_bf16 a[220:223], v[212:215], v[172:175], 0
    s_add_u32 s68, s68, 16384
    ds_read_b128 v[196:199], v252 offset:64
    v_mfma_f32_16x16x32_bf16 a[216:219], v[212:215], v[168:171], 0
    v_mfma_f32_16x16x32_bf16 a[212:215], v[212:215], v[164:167], 0
    ds_read_b128 v[200:203], v252 offset:128
    v_mfma_f32_16x16x32_bf16 a[208:211], v[212:215], v[160:163], 0
    v_mfma_f32_16x16x32_bf16 a[224:227], v[216:219], v[160:163], 0
    ds_read_b128 v[204:207], v252 offset:192
    v_mfma_f32_16x16x32_bf16 a[228:231], v[216:219], v[164:167], 0
    v_mfma_f32_16x16x32_bf16 a[232:235], v[216:219], v[168:171], 0
    v_mfma_f32_16x16x32_bf16 a[236:239], v[216:219], v[172:175], 0
    v_mfma_f32_16x16x32_bf16 a[252:255], v[220:223], v[172:175], 0
    v_mfma_f32_16x16x32_bf16 a[248:251], v[220:223], v[168:171], 0
    v_mfma_f32_16x16x32_bf16 a[244:247], v[220:223], v[164:167], 0
    s_waitcnt lgkmcnt(0)
    v_mfma_f32_16x16x32_bf16 a[240:243], v[220:223], v[160:163], 0
    s_cbranch_vccnz L_slow_p0
L_back_p0:
    s_mov_b32 s24, 14
.p2align 6
K2_loop:
    v_mfma_f32_16x16x32_bf16 v[128:131], v[192:195], v[0:3], v[224:227]
    v_mfma_f32_16x16x32_bf16 v[128:131], v[196:199], v[4:7], v[128:131]
    s_add_u32 m0, s18, 0
    ds_read_b128 v[208:211], v252 offset:256
    v_mfma_f32_16x16x32_bf16 v[128:131], v[200:203], v[8:11], v[128:131]
    buffer_load_dwordx4 v255, s[12:15], s22 offen offset:0 lds
    v_mfma_f32_16x16x32_bf16 v[128:131], v[204:207], v[12:15], v[128:131]
    ds_read_b128 v[212:215], v252 offset:320
    v_mfma_f32_16x16x32_bf16 v[132:135], v[204:207], v[44:47], v[228:231]
    v_mfma_f32_16x16x32_bf16 v[132:135], v[200:203], v[40:43], v[132:135]
    s_add_u32 m0, s18, 64
    ds_read_b128 v[216:219], v252 offset:384
    v_mfma_f32_16x16x32_bf16 v[132:135], v[196:199], v[36:39], v[132:135]
    buffer_load_dwordx4 v255, s[12:15], s22 offen offset:1024 lds
    v_mfma_f32_16x16x32_bf16 v[132:135], v[192:195], v[32:35], v[132:135]
    ds_read_b128 v[220:223], v252 offset:448
    v_mfma_f32_16x16x32_bf16 v[136:139], v[192:195], v[64:67], v[232:235]
    s_add_u32 m0, s18, 128
    v_mfma_f32_16x16x32_bf16 v[136:139], v[196:199], v[68:71], v[136:139]
    buffer_load_dwordx4 v255, s[12:15], s22 offen offset:2048 lds
    v_mfma_f32_16x16x32_bf16 v[136:139], v[200:203], v[72:75], v[136:139]
    s_add_u32 m0, s18, 192
    v_mfma_f32_16x16x32_bf16 v[136:139], v[204:207], v[76:79], v[136:139]
    buffer_load_dwordx4 v255, s[12:15], s22 offen offset:3072 lds
    v_mfma_f32_16x16x32_bf16 v[140:143], v[204:207], v[108:111], v[236:239]
    s_add_u32 m0, s18, 4352
    v_mfma_f32_16x16x32_bf16 v[140:143], v[200:203], v[104:107], v[140:143]
    buffer_load_dwordx4 v255, s[12:15], s23 offen offset:0 lds
    v_mfma_f32_16x16x32_bf16 v[140:143], v[196:199], v[100:103], v[140:143]
    s_add_u32 m0, s18, 4416
    v_mfma_f32_16x16x32_bf16 v[140:143], v[192:195], v[96:99], v[140:143]
    s_waitcnt lgkmcnt(0)
    buffer_load_dwordx4 v255, s[12:15], s23 offen offset:1024 lds
    v_mfma_f32_16x16x32_bf16 v[128:131], v[208:211], v[16:19], v[128:131]
    v_mfma_f32_16x16x32_bf16 v[128:131], v[212:215], v[20:23], v[128:131]
    s_add_u32 m0, s18, 4480
    ds_read_b128 v[192:195], v252 offset:8704
    v_mfma_f32_16x16x32_bf16 v[128:131], v[216:219], v[24:27], v[128:131]
    buffer_load_dwordx4 v255, s[12:15], s23 offen offset:2048 lds
    v_mfma_f32_16x16x32_bf16 v[128:131], v[220:223], v[28:31], v[128:131]
    ds_read_b128 v[196:199], v252 offset:8768
    v_mfma_f32_16x16x32_bf16 v[132:135], v[220:223], v[60:63], v[132:135]
    v_mfma_f32_16x16x32_bf16 v[132:135], v[216:219], v[56:59], v[132:135]
    s_add_u32 m0, s18, 4544
    ds_read_b128 v[200:203], v252 offset:8832
    v_mfma_f32_16x16x32_bf16 v[132:135], v[212:215], v[52:55], v[132:135]
    buffer_load_dwordx4 v255, s[12:15], s23 offen offset:3072 lds
    v_mfma_f32_16x16x32_bf16 v[132:135], v[208:211], v[48:51], v[132:135]
    s_add_u32 s22, s22, 16384
    ds_read_b128 v[204:207], v252 offset:8896
    v_mfma_f32_16x16x32_bf16 v[136:139], v[208:211], v[80:83], v[136:139]
    s_add_u32 s23, s23, 16384
    v_exp_f32 v248, v128
    v_mfma_f32_16x16x32_bf16 v[136:139], v[212:215], v[84:87], v[136:139]
    v_exp_f32 v249, v129
    v_mfma_f32_16x16x32_bf16 v[136:139], v[216:219], v[88:91], v[136:139]
    v_exp_f32 v250, v130
    v_mfma_f32_16x16x32_bf16 v[136:139], v[220:223], v[92:95], v[136:139]
    v_exp_f32 v251, v131
    v_mfma_f32_16x16x32_bf16 v[140:143], v[220:223], v[124:127], v[140:143]
    v_add_f32 v240, v244, v248
    v_add_f32 v240, v240, v249
    v_mfma_f32_16x16x32_bf16 v[140:143], v[216:219], v[120:123], v[140:143]
    v_cvt_pk_bf16_f32 v160, v248, v249
    v_add_f32 v240, v240, v250
    v_mfma_f32_16x16x32_bf16 v[140:143], v[212:215], v[116:119], v[140:143]
    v_exp_f32 v248, v132
    v_mfma_f32_16x16x32_bf16 v[140:143], v[208:211], v[112:115], v[140:143]
    s_waitcnt lgkmcnt(0)
    v_exp_f32 v249, v133
    v_mfma_f32_16x16x32_bf16 v[144:147], v[192:195], v[0:3], v[224:227]
    v_add_f32 v240, v240, v251
    v_cvt_pk_bf16_f32 v161, v250, v251
    v_mfma_f32_16x16x32_bf16 v[144:147], v[196:199], v[4:7], v[144:147]
    ds_read_b128 v[208:211], v252 offset:8960
    v_add_f32 v241, v245, v248
    v_mfma_f32_16x16x32_bf16 v[144:147], v[200:203], v[8:11], v[144:147]
    v_exp_f32 v250, v134
    v_mfma_f32_16x16x32_bf16 v[144:147], v[204:207], v[12:15], v[144:147]
    ds_read_b128 v[212:215], v252 offset:9024
    v_add_f32 v241, v241, v249
    v_mfma_f32_16x16x32_bf16 v[148:151], v[204:207], v[44:47], v[228:231]
    v_exp_f32 v251, v135
    v_mfma_f32_16x16x32_bf16 v[148:151], v[200:203], v[40:43], v[148:151]
    ds_read_b128 v[216:219], v252 offset:9088
    v_cvt_pk_bf16_f32 v164, v248, v249
    v_mfma_f32_16x16x32_bf16 v[148:151], v[196:199], v[36:39], v[148:151]
    v_exp_f32 v248, v136
    v_mfma_f32_16x16x32_bf16 v[148:151], v[192:195], v[32:35], v[148:151]
    ds_read_b128 v[220:223], v252 offset:9152
    v_add_f32 v241, v241, v250
    v_mfma_f32_16x16x32_bf16 v[152:155], v[192:195], v[64:67], v[232:235]
    v_exp_f32 v249, v137
    v_mfma_f32_16x16x32_bf16 v[152:155], v[196:199], v[68:71], v[152:155]
    v_add_f32 v241, v241, v251
    v_cvt_pk_bf16_f32 v165, v250, v251
    v_mfma_f32_16x16x32_bf16 v[152:155], v[200:203], v[72:75], v[152:155]
    v_exp_f32 v250, v138
    v_mfma_f32_16x16x32_bf16 v[152:155], v[204:207], v[76:79], v[152:155]
    v_exp_f32 v251, v139
    v_mfma_f32_16x16x32_bf16 v[156:159], v[204:207], v[108:111], v[236:239]
    v_add_f32 v242, v246, v248
    v_add_f32 v242, v242, v249
    v_mfma_f32_16x16x32_bf16 v[156:159], v[200:203], v[104:107], v[156:159]
    v_cvt_pk_bf16_f32 v168, v248, v249
    v_add_f32 v242, v242, v250
    v_mfma_f32_16x16x32_bf16 v[156:159], v[196:199], v[100:103], v[156:159]
    v_exp_f32 v248, v140
    v_mfma_f32_16x16x32_bf16 v[156:159], v[192:195], v[96:99], v[156:159]
    s_waitcnt lgkmcnt(0)
    v_exp_f32 v249, v141
    v_mfma_f32_16x16x32_bf16 v[144:147], v[208:211], v[16:19], v[144:147]
    v_add_f32 v242, v242, v251
    v_cvt_pk_bf16_f32 v169, v250, v251
    v_mfma_f32_16x16x32_bf16 v[144:147], v[212:215], v[20:23], v[144:147]
    v_exp_f32 v250, v142
    v_mfma_f32_16x16x32_bf16 v[144:147], v[216:219], v[24:27], v[144:147]
    s_waitcnt vmcnt(17) lgkmcnt(0)
    s_barrier
    ds_read_b64_tr_b16 v[192:193], v253 offset:17408
    v_add_f32 v243, v247, v248
    v_mfma_f32_16x16x32_bf16 v[144:147], v[220:223], v[28:31], v[144:147]
    ds_read_b64_tr_b16 v[194:195], v253 offset:26112
    v_add_f32 v243, v243, v249
    v_mfma_f32_16x16x32_bf16 v[148:151], v[220:223], v[60:63], v[148:151]
    ds_read_b64_tr_b16 v[196:197], v254 offset:17408
    v_cvt_pk_bf16_f32 v172, v248, v249
    v_mfma_f32_16x16x32_bf16 v[148:151], v[216:219], v[56:59], v[148:151]
    ds_read_b64_tr_b16 v[198:199], v254 offset:26112
    v_add_f32 v243, v243, v250
    v_mfma_f32_16x16x32_bf16 v[148:151], v[212:215], v[52:55], v[148:151]
    ds_read_b64_tr_b16 v[200:201], v253 offset:17472
    v_mfma_f32_16x16x32_bf16 v[148:151], v[208:211], v[48:51], v[148:151]
    ds_read_b64_tr_b16 v[202:203], v253 offset:26176
    v_mfma_f32_16x16x32_bf16 v[152:155], v[208:211], v[80:83], v[152:155]
    ds_read_b64_tr_b16 v[204:205], v254 offset:17472
    v_mfma_f32_16x16x32_bf16 v[152:155], v[212:215], v[84:87], v[152:155]
    ds_read_b64_tr_b16 v[206:207], v254 offset:26176
    v_mfma_f32_16x16x32_bf16 v[152:155], v[216:219], v[88:91], v[152:155]
    v_exp_f32 v251, v143
    v_mfma_f32_16x16x32_bf16 v[152:155], v[220:223], v[92:95], v[152:155]
    v_exp_f32 v248, v144
    v_mfma_f32_16x16x32_bf16 v[156:159], v[220:223], v[124:127], v[156:159]
    v_exp_f32 v249, v145
    v_mfma_f32_16x16x32_bf16 v[156:159], v[216:219], v[120:123], v[156:159]
    v_add_f32 v243, v243, v251
    v_cvt_pk_bf16_f32 v173, v250, v251
    v_mfma_f32_16x16x32_bf16 v[156:159], v[212:215], v[116:119], v[156:159]
    v_exp_f32 v250, v146
    v_mfma_f32_16x16x32_bf16 v[156:159], v[208:211], v[112:115], v[156:159]
    s_waitcnt lgkmcnt(1)
    v_exp_f32 v251, v147
    v_mfma_f32_16x16x32_bf16 a[0:3], v[192:195], v[176:179], a[0:3]
    ds_read_b64_tr_b16 v[208:209], v253 offset:17536
    v_add_f32 v240, v240, v248
    v_mfma_f32_16x16x32_bf16 a[4:7], v[192:195], v[180:183], a[4:7]
    s_add_u32 m0, s16, 0
    ds_read_b64_tr_b16 v[210:211], v253 offset:26240
    v_add_f32 v240, v240, v249
    v_mfma_f32_16x16x32_bf16 a[8:11], v[192:195], v[184:187], a[8:11]
    buffer_load_dwordx4 v255, s[8:11], s20 offen offset:0 lds
    v_mfma_f32_16x16x32_bf16 a[12:15], v[192:195], v[188:191], a[12:15]
    ds_read_b64_tr_b16 v[212:213], v254 offset:17536
    v_cvt_pk_bf16_f32 v162, v248, v249
    v_mfma_f32_16x16x32_bf16 a[28:31], v[196:199], v[188:191], a[28:31]
    ds_read_b64_tr_b16 v[214:215], v254 offset:26240
    v_add_f32 v240, v240, v250
    v_mfma_f32_16x16x32_bf16 a[24:27], v[196:199], v[184:187], a[24:27]
    v_exp_f32 v248, v148
    v_mfma_f32_16x16x32_bf16 a[20:23], v[196:199], v[180:183], a[20:23]
    ds_read_b64_tr_b16 v[216:217], v253 offset:17600
    v_add_f32 v240, v240, v251
    v_mfma_f32_16x16x32_bf16 a[16:19], v[196:199], v[176:179], a[16:19]
    v_exp_f32 v249, v149
    v_mfma_f32_16x16x32_bf16 a[32:35], v[200:203], v[176:179], a[32:35]
    s_add_u32 m0, s16, 64
    ds_read_b64_tr_b16 v[218:219], v253 offset:26304
    v_cvt_pk_bf16_f32 v163, v250, v251
    v_mfma_f32_16x16x32_bf16 a[36:39], v[200:203], v[180:183], a[36:39]
    buffer_load_dwordx4 v255, s[8:11], s20 offen offset:1024 lds
    v_mfma_f32_16x16x32_bf16 a[40:43], v[200:203], v[184:187], a[40:43]
    ds_read_b64_tr_b16 v[220:221], v254 offset:17600
    v_add_f32 v241, v241, v248
    v_mfma_f32_16x16x32_bf16 a[44:47], v[200:203], v[188:191], a[44:47]
    s_waitcnt lgkmcnt(3)
    ds_read_b64_tr_b16 v[222:223], v254 offset:26304
    v_add_f32 v241, v241, v249
    v_mfma_f32_16x16x32_bf16 a[60:63], v[204:207], v[188:191], a[60:63]
    v_exp_f32 v250, v150
    v_mfma_f32_16x16x32_bf16 a[56:59], v[204:207], v[184:187], a[56:59]
    ds_read_b64_tr_b16 v[192:193], v253 offset:17664
    v_cvt_pk_bf16_f32 v166, v248, v249
    v_mfma_f32_16x16x32_bf16 a[52:55], v[204:207], v[180:183], a[52:55]
    v_exp_f32 v251, v151
    v_mfma_f32_16x16x32_bf16 a[48:51], v[204:207], v[176:179], a[48:51]
    s_add_u32 m0, s16, 128
    ds_read_b64_tr_b16 v[194:195], v253 offset:26368
    v_add_f32 v241, v241, v250
    v_mfma_f32_16x16x32_bf16 a[64:67], v[208:211], v[176:179], a[64:67]
    buffer_load_dwordx4 v255, s[8:11], s20 offen offset:2048 lds
    v_mfma_f32_16x16x32_bf16 a[68:71], v[208:211], v[180:183], a[68:71]
    ds_read_b64_tr_b16 v[196:197], v254 offset:17664
    v_add_f32 v241, v241, v251
    v_mfma_f32_16x16x32_bf16 a[72:75], v[208:211], v[184:187], a[72:75]
    ds_read_b64_tr_b16 v[198:199], v254 offset:26368
    v_cvt_pk_bf16_f32 v167, v250, v251
    v_mfma_f32_16x16x32_bf16 a[76:79], v[208:211], v[188:191], a[76:79]
    v_exp_f32 v248, v152
    v_mfma_f32_16x16x32_bf16 a[92:95], v[212:215], v[188:191], a[92:95]
    ds_read_b64_tr_b16 v[200:201], v253 offset:17728
    v_add_f32 v242, v242, v248
    v_mfma_f32_16x16x32_bf16 a[88:91], v[212:215], v[184:187], a[88:91]
    v_exp_f32 v249, v153
    v_mfma_f32_16x16x32_bf16 a[84:87], v[212:215], v[180:183], a[84:87]
    s_add_u32 m0, s16, 192
    ds_read_b64_tr_b16 v[202:203], v253 offset:26432
    v_add_f32 v242, v242, v249
    v_mfma_f32_16x16x32_bf16 a[80:83], v[212:215], v[176:179], a[80:83]
    s_waitcnt lgkmcnt(4)
    buffer_load_dwordx4 v255, s[8:11], s20 offen offset:3072 lds
    v_mfma_f32_16x16x32_bf16 a[96:99], v[216:219], v[176:179], a[96:99]
    ds_read_b64_tr_b16 v[204:205], v254 offset:17728
    v_cvt_pk_bf16_f32 v170, v248, v249
    v_mfma_f32_16x16x32_bf16 a[100:103], v[216:219], v[180:183], a[100:103]
    ds_read_b64_tr_b16 v[206:207], v254 offset:26432
    v_mfma_f32_16x16x32_bf16 a[104:107], v[216:219], v[184:187], a[104:107]
    v_exp_f32 v250, v154
    v_mfma_f32_16x16x32_bf16 a[108:111], v[216:219], v[188:191], a[108:111]
    ds_read_b64_tr_b16 v[208:209], v253 offset:17792
    v_add_f32 v242, v242, v250
    v_mfma_f32_16x16x32_bf16 a[124:127], v[220:223], v[188:191], a[124:127]
    v_exp_f32 v251, v155
    v_mfma_f32_16x16x32_bf16 a[120:123], v[220:223], v[184:187], a[120:123]
    s_add_u32 m0, s16, 4352
    ds_read_b64_tr_b16 v[210:211], v253 offset:26496
    v_add_f32 v242, v242, v251
    v_mfma_f32_16x16x32_bf16 a[116:119], v[220:223], v[180:183], a[116:119]
    buffer_load_dwordx4 v255, s[8:11], s21 offen offset:0 lds
    v_mfma_f32_16x16x32_bf16 a[112:115], v[220:223], v[176:179], a[112:115]
    ds_read_b64_tr_b16 v[212:213], v254 offset:17792
    v_cvt_pk_bf16_f32 v171, v250, v251
    v_mfma_f32_16x16x32_bf16 a[128:131], v[192:195], v[176:179], a[128:131]
    ds_read_b64_tr_b16 v[214:215], v254 offset:26496
    v_mfma_f32_16x16x32_bf16 a[132:135], v[192:195], v[180:183], a[132:135]
    v_exp_f32 v248, v156
    v_mfma_f32_16x16x32_bf16 a[136:139], v[192:195], v[184:187], a[136:139]
    ds_read_b64_tr_b16 v[216:217], v253 offset:17856
    v_add_f32 v243, v243, v248
    v_mfma_f32_16x16x32_bf16 a[140:143], v[192:195], v[188:191], a[140:143]
    s_waitcnt lgkmcnt(4)
    v_exp_f32 v249, v157
    v_mfma_f32_16x16x32_bf16 a[156:159], v[196:199], v[188:191], a[156:159]
    s_add_u32 m0, s16, 4416
    ds_read_b64_tr_b16 v[218:219], v253 offset:26560
    v_add_f32 v243, v243, v249
    v_mfma_f32_16x16x32_bf16 a[152:155], v[196:199], v[184:187], a[152:155]
    buffer_load_dwordx4 v255, s[8:11], s21 offen offset:1024 lds
    v_mfma_f32_16x16x32_bf16 a[148:151], v[196:199], v[180:183], a[148:151]
    ds_read_b64_tr_b16 v[220:221], v254 offset:17856
    v_cvt_pk_bf16_f32 v174, v248, v249
    v_mfma_f32_16x16x32_bf16 a[144:147], v[196:199], v[176:179], a[144:147]
    v_exp_f32 v250, v158
    v_mfma_f32_16x16x32_bf16 a[160:163], v[200:203], v[176:179], a[160:163]
    ds_read_b64_tr_b16 v[222:223], v254 offset:26560
    v_add_f32 v243, v243, v250
    v_mfma_f32_16x16x32_bf16 a[164:167], v[200:203], v[180:183], a[164:167]
    s_add_u32 m0, s16, 4480
    v_exp_f32 v251, v159
    v_mfma_f32_16x16x32_bf16 a[168:171], v[200:203], v[184:187], a[168:171]
    buffer_load_dwordx4 v255, s[8:11], s21 offen offset:2048 lds
    v_mfma_f32_16x16x32_bf16 a[172:175], v[200:203], v[188:191], a[172:175]
    v_add_f32 v243, v243, v251
    v_cvt_pk_bf16_f32 v175, v250, v251
    v_mfma_f32_16x16x32_bf16 a[188:191], v[204:207], v[188:191], a[188:191]
    v_max3_f32 v248, v240, v241, v242
    v_max_f32 v248, v248, v243
    v_mfma_f32_16x16x32_bf16 a[184:187], v[204:207], v[184:187], a[184:187]
    s_add_u32 m0, s16, 4544
    v_cmp_lt_f32 vcc, s25, v248
    v_mfma_f32_16x16x32_bf16 a[180:183], v[204:207], v[180:183], a[180:183]
    s_waitcnt lgkmcnt(1)
    buffer_load_dwordx4 v255, s[8:11], s21 offen offset:3072 lds
    v_mfma_f32_16x16x32_bf16 a[176:179], v[204:207], v[176:179], a[176:179]
    s_add_u32 s20, s20, 16384
    v_mfma_f32_16x16x32_bf16 a[192:195], v[208:211], v[176:179], a[192:195]
    s_add_u32 s21, s21, 16384
    v_mfma_f32_16x16x32_bf16 a[196:199], v[208:211], v[180:183], a[196:199]
    s_mov_b32 m0, 139264
    v_mfma_f32_16x16x32_bf16 a[200:203], v[208:211], v[184:187], a[200:203]
    s_waitcnt vmcnt(17) lgkmcnt(0)
    s_barrier
    ds_read_b128 v[192:195], v252 offset:17408
    v_mfma_f32_16x16x32_bf16 a[204:207], v[208:211], v[188:191], a[204:207]
    buffer_load_dword v255, s[64:67], s68 offen lds
    v_mfma_f32_16x16x32_bf16 a[220:223], v[212:215], v[188:191], a[220:223]
    s_add_u32 s68, s68, 16384
    ds_read_b128 v[196:199], v252 offset:17472
    v_mfma_f32_16x16x32_bf16 a[216:219], v[212:215], v[184:187], a[216:219]
    v_mfma_f32_16x16x32_bf16 a[212:215], v[212:215], v[180:183], a[212:215]
    ds_read_b128 v[200:203], v252 offset:17536
    v_mfma_f32_16x16x32_bf16 a[208:211], v[212:215], v[176:179], a[208:211]
    v_mfma_f32_16x16x32_bf16 a[224:227], v[216:219], v[176:179], a[224:227]
    ds_read_b128 v[204:207], v252 offset:17600
    v_mfma_f32_16x16x32_bf16 a[228:231], v[216:219], v[180:183], a[228:231]
    v_mfma_f32_16x16x32_bf16 a[232:235], v[216:219], v[184:187], a[232:235]
    v_mfma_f32_16x16x32_bf16 a[236:239], v[216:219], v[188:191], a[236:239]
    v_mfma_f32_16x16x32_bf16 a[252:255], v[220:223], v[188:191], a[252:255]
    v_mfma_f32_16x16x32_bf16 a[248:251], v[220:223], v[184:187], a[248:251]
    v_mfma_f32_16x16x32_bf16 a[244:247], v[220:223], v[180:183], a[244:247]
    s_waitcnt lgkmcnt(0)
    v_mfma_f32_16x16x32_bf16 a[240:243], v[220:223], v[176:179], a[240:243]
    s_cbranch_vccnz L_slow_a
L_back_a:
    v_mfma_f32_16x16x32_bf16 v[128:131], v[192:195], v[0:3], v[224:227]
    v_mfma_f32_16x16x32_bf16 v[128:131], v[196:199], v[4:7], v[128:131]
    s_add_u32 m0, s19, 0
    ds_read_b128 v[208:211], v252 offset:17664
    v_mfma_f32_16x16x32_bf16 v[128:131], v[200:203], v[8:11], v[128:131]
    buffer_load_dwordx4 v255, s[12:15], s22 offen offset:0 lds
    v_mfma_f32_16x16x32_bf16 v[128:131], v[204:207], v[12:15], v[128:131]
    ds_read_b128 v[212:215], v252 offset:17728
    v_mfma_f32_16x16x32_bf16 v[132:135], v[204:207], v[44:47], v[228:231]
    v_mfma_f32_16x16x32_bf16 v[132:135], v[200:203], v[40:43], v[132:135]
    s_add_u32 m0, s19, 64
    ds_read_b128 v[216:219], v252 offset:17792
    v_mfma_f32_16x16x32_bf16 v[132:135], v[196:199], v[36:39], v[132:135]
    buffer_load_dwordx4 v255, s[12:15], s22 offen offset:1024 lds
    v_mfma_f32_16x16x32_bf16 v[132:135], v[192:195], v[32:35], v[132:135]
    ds_read_b128 v[220:223], v252 offset:17856
    v_mfma_f32_16x16x32_bf16 v[136:139], v[192:195], v[64:67], v[232:235]
    s_add_u32 m0, s19, 128
    v_mfma_f32_16x16x32_bf16 v[136:139], v[196:199], v[68:71], v[136:139]
    buffer_load_dwordx4 v255, s[12:15], s22 offen offset:2048 lds
    v_mfma_f32_16x16x32_bf16 v[136:139], v[200:203], v[72:75], v[136:139]
    s_add_u32 m0, s19, 192
    v_mfma_f32_16x16x32_bf16 v[136:139], v[204:207], v[76:79], v[136:139]
    buffer_load_dwordx4 v255, s[12:15], s22 offen offset:3072 lds
    v_mfma_f32_16x16x32_bf16 v[140:143], v[204:207], v[108:111], v[236:239]
    s_add_u32 m0, s19, 4352
    v_mfma_f32_16x16x32_bf16 v[140:143], v[200:203], v[104:107], v[140:143]
    buffer_load_dwordx4 v255, s[12:15], s23 offen offset:0 lds
    v_mfma_f32_16x16x32_bf16 v[140:143], v[196:199], v[100:103], v[140:143]
    s_add_u32 m0, s19, 4416
    v_mfma_f32_16x16x32_bf16 v[140:143], v[192:195], v[96:99], v[140:143]
    s_waitcnt lgkmcnt(0)
    buffer_load_dwordx4 v255, s[12:15], s23 offen offset:1024 lds
    v_mfma_f32_16x16x32_bf16 v[128:131], v[208:211], v[16:19], v[128:131]
    v_mfma_f32_16x16x32_bf16 v[128:131], v[212:215], v[20:23], v[128:131]
    s_add_u32 m0, s19, 4480
    ds_read_b128 v[192:195], v252 offset:26112
    v_mfma_f32_16x16x32_bf16 v[128:131], v[216:219], v[24:27], v[128:131]
    buffer_load_dwordx4 v255, s[12:15], s23 offen offset:2048 lds
    v_mfma_f32_16x16x32_bf16 v[128:131], v[220:223], v[28:31], v[128:131]
    ds_read_b128 v[196:199], v252 offset:26176
    v_mfma_f32_16x16x32_bf16 v[132:135], v[220:223], v[60:63], v[132:135]
    v_mfma_f32_16x16x32_bf16 v[132:135], v[216:219], v[56:59], v[132:135]
    s_add_u32 m0, s19, 4544
    ds_read_b128 v[200:203], v252 offset:26240
    v_mfma_f32_16x16x32_bf16 v[132:135], v[212:215], v[52:55], v[132:135]
    buffer_load_dwordx4 v255, s[12:15], s23 offen offset:3072 lds
    v_mfma_f32_16x16x32_bf16 v[132:135], v[208:211], v[48:51], v[132:135]
    s_add_u32 s22, s22, 16384
    ds_read_b128 v[204:207], v252 offset:26304
    v_mfma_f32_16x16x32_bf16 v[136:139], v[208:211], v[80:83], v[136:139]
    s_add_u32 s23, s23, 16384
    v_exp_f32 v248, v128
    v_mfma_f32_16x16x32_bf16 v[136:139], v[212:215], v[84:87], v[136:139]
    v_exp_f32 v249, v129
    v_mfma_f32_16x16x32_bf16 v[136:139], v[216:219], v[88:91], v[136:139]
    v_exp_f32 v250, v130
    v_mfma_f32_16x16x32_bf16 v[136:139], v[220:223], v[92:95], v[136:139]
    v_exp_f32 v251, v131
    v_mfma_f32_16x16x32_bf16 v[140:143], v[220:223], v[124:127], v[140:143]
    v_add_f32 v244, v240, v248
    v_add_f32 v244, v244, v249
    v_mfma_f32_16x16x32_bf16 v[140:143], v[216:219], v[120:123], v[140:143]
    v_cvt_pk_bf16_f32 v176, v248, v249
    v_add_f32 v244, v244, v250
    v_mfma_f32_16x16x32_bf16 v[140:143], v[212:215], v[116:119], v[140:143]
    v_exp_f32 v248, v132
    v_mfma_f32_16x16x32_bf16 v[140:143], v[208:211], v[112:115], v[140:143]
    s_waitcnt lgkmcnt(0)
    v_exp_f32 v249, v133
    v_mfma_f32_16x16x32_bf16 v[144:147], v[192:195], v[0:3], v[224:227]
    v_add_f32 v244, v244, v251
    v_cvt_pk_bf16_f32 v177, v250, v251
    v_mfma_f32_16x16x32_bf16 v[144:147], v[196:199], v[4:7], v[144:147]
    ds_read_b128 v[208:211], v252 offset:26368
    v_add_f32 v245, v241, v248
    v_mfma_f32_16x16x32_bf16 v[144:147], v[200:203], v[8:11], v[144:147]
    v_exp_f32 v250, v134
    v_mfma_f32_16x16x32_bf16 v[144:147], v[204:207], v[12:15], v[144:147]
    ds_read_b128 v[212:215], v252 offset:26432
    v_add_f32 v245, v245, v249
    v_mfma_f32_16x16x32_bf16 v[148:151], v[204:207], v[44:47], v[228:231]
    v_exp_f32 v251, v135
    v_mfma_f32_16x16x32_bf16 v[148:151], v[200:203], v[40:43], v[148:151]
    ds_read_b128 v[216:219], v252 offset:26496
    v_cvt_pk_bf16_f32 v180, v248, v249
    v_mfma_f32_16x16x32_bf16 v[148:151], v[196:199], v[36:39], v[148:151]
    v_exp_f32 v248, v136
    v_mfma_f32_16x16x32_bf16 v[148:151], v[192:195], v[32:35], v[148:151]
    ds_read_b128 v[220:223], v252 offset:26560
    v_add_f32 v245, v245, v250
    v_mfma_f32_16x16x32_bf16 v[152:155], v[192:195], v[64:67], v[232:235]
    v_exp_f32 v249, v137
    v_mfma_f32_16x16x32_bf16 v[152:155], v[196:199], v[68:71], v[152:155]
    v_add_f32 v245, v245, v251
    v_cvt_pk_bf16_f32 v181, v250, v251
    v_mfma_f32_16x16x32_bf16 v[152:155], v[200:203], v[72:75], v[152:155]
    v_exp_f32 v250, v138
    v_mfma_f32_16x16x32_bf16 v[152:155], v[204:207], v[76:79], v[152:155]
    v_exp_f32 v251, v139
    v_mfma_f32_16x16x32_bf16 v[156:159], v[204:207], v[108:111], v[236:239]
    v_add_f32 v246, v242, v248
    v_add_f32 v246, v246, v249
    v_mfma_f32_16x16x32_bf16 v[156:159], v[200:203], v[104:107], v[156:159]
    v_cvt_pk_bf16_f32 v184, v248, v249
    v_add_f32 v246, v246, v250
    v_mfma_f32_16x16x32_bf16 v[156:159], v[196:199], v[100:103], v[156:159]
    v_exp_f32 v248, v140
    v_mfma_f32_16x16x32_bf16 v[156:159], v[192:195], v[96:99], v[156:159]
    s_waitcnt lgkmcnt(0)
    v_exp_f32 v249, v141
    v_mfma_f32_16x16x32_bf16 v[144:147], v[208:211], v[16:19], v[144:147]
    v_add_f32 v246, v246, v251
    v_cvt_pk_bf16_f32 v185, v250, v251
    v_mfma_f32_16x16x32_bf16 v[144:147], v[212:215], v[20:23], v[144:147]
    v_exp_f32 v250, v142
    v_mfma_f32_16x16x32_bf16 v[144:147], v[216:219], v[24:27], v[144:147]
    s_waitcnt vmcnt(17) lgkmcnt(0)
    s_barrier
    ds_read_b64_tr_b16 v[192:193], v253 offset:0
    v_add_f32 v247, v243, v248
    v_mfma_f32_16x16x32_bf16 v[144:147], v[220:223], v[28:31], v[144:147]
    ds_read_b64_tr_b16 v[194:195], v253 offset:8704
    v_add_f32 v247, v247, v249
    v_mfma_f32_16x16x32_bf16 v[148:151], v[220:223], v[60:63], v[148:151]
    ds_read_b64_tr_b16 v[196:197], v254 offset:0
    v_cvt_pk_bf16_f32 v188, v248, v249
    v_mfma_f32_16x16x32_bf16 v[148:151], v[216:219], v[56:59], v[148:151]
    ds_read_b64_tr_b16 v[198:199], v254 offset:8704
    v_add_f32 v247, v247, v250
    v_mfma_f32_16x16x32_bf16 v[148:151], v[212:215], v[52:55], v[148:151]
    ds_read_b64_tr_b16 v[200:201], v253 offset:64
    v_mfma_f32_16x16x32_bf16 v[148:151], v[208:211], v[48:51], v[148:151]
    ds_read_b64_tr_b16 v[202:203], v253 offset:8768
    v_mfma_f32_16x16x32_bf16 v[152:155], v[208:211], v[80:83], v[152:155]
    ds_read_b64_tr_b16 v[204:205], v254 offset:64
    v_mfma_f32_16x16x32_bf16 v[152:155], v[212:215], v[84:87], v[152:155]
    ds_read_b64_tr_b16 v[206:207], v254 offset:8768
    v_mfma_f32_16x16x32_bf16 v[152:155], v[216:219], v[88:91], v[152:155]
    v_exp_f32 v251, v143
    v_mfma_f32_16x16x32_bf16 v[152:155], v[220:223], v[92:95], v[152:155]
    v_exp_f32 v248, v144
    v_mfma_f32_16x16x32_bf16 v[156:159], v[220:223], v[124:127], v[156:159]
    v_exp_f32 v249, v145
    v_mfma_f32_16x16x32_bf16 v[156:159], v[216:219], v[120:123], v[156:159]
    v_add_f32 v247, v247, v251
    v_cvt_pk_bf16_f32 v189, v250, v251
    v_mfma_f32_16x16x32_bf16 v[156:159], v[212:215], v[116:119], v[156:159]
    v_exp_f32 v250, v146
    v_mfma_f32_16x16x32_bf16 v[156:159], v[208:211], v[112:115], v[156:159]
    s_waitcnt lgkmcnt(1)
    v_exp_f32 v251, v147
    v_mfma_f32_16x16x32_bf16 a[0:3], v[192:195], v[160:163], a[0:3]
    ds_read_b64_tr_b16 v[208:209], v253 offset:128
    v_add_f32 v244, v244, v248
    v_mfma_f32_16x16x32_bf16 a[4:7], v[192:195], v[164:167], a[4:7]
    s_add_u32 m0, s17, 0
    ds_read_b64_tr_b16 v[210:211], v253 offset:8832
    v_add_f32 v244, v244, v249
    v_mfma_f32_16x16x32_bf16 a[8:11], v[192:195], v[168:171], a[8:11]
    buffer_load_dwordx4 v255, s[8:11], s20 offen offset:0 lds
    v_mfma_f32_16x16x32_bf16 a[12:15], v[192:195], v[172:175], a[12:15]
    ds_read_b64_tr_b16 v[212:213], v254 offset:128
    v_cvt_pk_bf16_f32 v178, v248, v249
    v_mfma_f32_16x16x32_bf16 a[28:31], v[196:199], v[172:175], a[28:31]
    ds_read_b64_tr_b16 v[214:215], v254 offset:8832
    v_add_f32 v244, v244, v250
    v_mfma_f32_16x16x32_bf16 a[24:27], v[196:199], v[168:171], a[24:27]
    v_exp_f32 v248, v148
    v_mfma_f32_16x16x32_bf16 a[20:23], v[196:199], v[164:167], a[20:23]
    ds_read_b64_tr_b16 v[216:217], v253 offset:192
    v_add_f32 v244, v244, v251
    v_mfma_f32_16x16x32_bf16 a[16:19], v[196:199], v[160:163], a[16:19]
    v_exp_f32 v249, v149
    v_mfma_f32_16x16x32_bf16 a[32:35], v[200:203], v[160:163], a[32:35]
    s_add_u32 m0, s17, 64
    ds_read_b64_tr_b16 v[218:219], v253 offset:8896
    v_cvt_pk_bf16_f32 v179, v250, v251
    v_mfma_f32_16x16x32_bf16 a[36:39], v[200:203], v[164:167], a[36:39]
    buffer_load_dwordx4 v255, s[8:11], s20 offen offset:1024 lds
    v_mfma_f32_16x16x32_bf16 a[40:43], v[200:203], v[168:171], a[40:43]
    ds_read_b64_tr_b16 v[220:221], v254 offset:192
    v_add_f32 v245, v245, v248
    v_mfma_f32_16x16x32_bf16 a[44:47], v[200:203], v[172:175], a[44:47]
    s_waitcnt lgkmcnt(3)
    ds_read_b64_tr_b16 v[222:223], v254 offset:8896
    v_add_f32 v245, v245, v249
    v_mfma_f32_16x16x32_bf16 a[60:63], v[204:207], v[172:175], a[60:63]
    v_exp_f32 v250, v150
    v_mfma_f32_16x16x32_bf16 a[56:59], v[204:207], v[168:171], a[56:59]
    ds_read_b64_tr_b16 v[192:193], v253 offset:256
    v_cvt_pk_bf16_f32 v182, v248, v249
    v_mfma_f32_16x16x32_bf16 a[52:55], v[204:207], v[164:167], a[52:55]
    v_exp_f32 v251, v151
    v_mfma_f32_16x16x32_bf16 a[48:51], v[204:207], v[160:163], a[48:51]
    s_add_u32 m0, s17, 128
    ds_read_b64_tr_b16 v[194:195], v253 offset:8960
    v_add_f32 v245, v245, v250
    v_mfma_f32_16x16x32_bf16 a[64:67], v[208:211], v[160:163], a[64:67]
    buffer_load_dwordx4 v255, s[8:11], s20 offen offset:2048 lds
    v_mfma_f32_16x16x32_bf16 a[68:71], v[208:211], v[164:167], a[68:71]
    ds_read_b64_tr_b16 v[196:197], v254 offset:256
    v_add_f32 v245, v245, v251
    v_mfma_f32_16x16x32_bf16 a[72:75], v[208:211], v[168:171], a[72:75]
    ds_read_b64_tr_b16 v[198:199], v254 offset:8960
    v_cvt_pk_bf16_f32 v183, v250, v251
    v_mfma_f32_16x16x32_bf16 a[76:79], v[208:211], v[172:175], a[76:79]
    v_exp_f32 v248, v152
    v_mfma_f32_16x16x32_bf16 a[92:95], v[212:215], v[172:175], a[92:95]
    ds_read_b64_tr_b16 v[200:201], v253 offset:320
    v_add_f32 v246, v246, v248
    v_mfma_f32_16x16x32_bf16 a[88:91], v[212:215], v[168:171], a[88:91]
    v_exp_f32 v249, v153
    v_mfma_f32_16x16x32_bf16 a[84:87], v[212:215], v[164:167], a[84:87]
    s_add_u32 m0, s17, 192
    ds_read_b64_tr_b16 v[202:203], v253 offset:9024
    v_add_f32 v246, v246, v249
    v_mfma_f32_16x16x32_bf16 a[80:83], v[212:215], v[160:163], a[80:83]
    s_waitcnt lgkmcnt(4)
    buffer_load_dwordx4 v255, s[8:11], s20 offen offset:3072 lds
    v_mfma_f32_16x16x32_bf16 a[96:99], v[216:219], v[160:163], a[96:99]
    ds_read_b64_tr_b16 v[204:205], v254 offset:320
    v_cvt_pk_bf16_f32 v186, v248, v249
    v_mfma_f32_16x16x32_bf16 a[100:103], v[216:219], v[164:167], a[100:103]
    ds_read_b64_tr_b16 v[206:207], v254 offset:9024
    v_mfma_f32_16x16x32_bf16 a[104:107], v[216:219], v[168:171], a[104:107]
    v_exp_f32 v250, v154
    v_mfma_f32_16x16x32_bf16 a[108:111], v[216:219], v[172:175], a[108:111]
    ds_read_b64_tr_b16 v[208:209], v253 offset:384
    v_add_f32 v246, v246, v250
    v_mfma_f32_16x16x32_bf16 a[124:127], v[220:223], v[172:175], a[124:127]
    v_exp_f32 v251, v155
    v_mfma_f32_16x16x32_bf16 a[120:123], v[220:223], v[168:171], a[120:123]
    s_add_u32 m0, s17, 4352
    ds_read_b64_tr_b16 v[210:211], v253 offset:9088
    v_add_f32 v246, v246, v251
    v_mfma_f32_16x16x32_bf16 a[116:119], v[220:223], v[164:167], a[116:119]
    buffer_load_dwordx4 v255, s[8:11], s21 offen offset:0 lds
    v_mfma_f32_16x16x32_bf16 a[112:115], v[220:223], v[160:163], a[112:115]
    ds_read_b64_tr_b16 v[212:213], v254 offset:384
    v_cvt_pk_bf16_f32 v187, v250, v251
    v_mfma_f32_16x16x32_bf16 a[128:131], v[192:195], v[160:163], a[128:131]
    ds_read_b64_tr_b16 v[214:215], v254 offset:9088
    v_mfma_f32_16x16x32_bf16 a[132:135], v[192:195], v[164:167], a[132:135]
    v_exp_f32 v248, v156
    v_mfma_f32_16x16x32_bf16 a[136:139], v[192:195], v[168:171], a[136:139]
    ds_read_b64_tr_b16 v[216:217], v253 offset:448
    v_add_f32 v247, v247, v248
    v_mfma_f32_16x16x32_bf16 a[140:143], v[192:195], v[172:175], a[140:143]
    s_waitcnt lgkmcnt(4)
    v_exp_f32 v249, v157
    v_mfma_f32_16x16x32_bf16 a[156:159], v[196:199], v[172:175], a[156:159]
    s_add_u32 m0, s17, 4416
    ds_read_b64_tr_b16 v[218:219], v253 offset:9152
    v_add_f32 v247, v247, v249
    v_mfma_f32_16x16x32_bf16 a[152:155], v[196:199], v[168:171], a[152:155]
    buffer_load_dwordx4 v255, s[8:11], s21 offen offset:1024 lds
    v_mfma_f32_16x16x32_bf16 a[148:151], v[196:199], v[164:167], a[148:151]
    ds_read_b64_tr_b16 v[220:221], v254 offset:448
    v_cvt_pk_bf16_f32 v190, v248, v249
    v_mfma_f32_16x16x32_bf16 a[144:147], v[196:199], v[160:163], a[144:147]
    v_exp_f32 v250, v158
    v_mfma_f32_16x16x32_bf16 a[160:163], v[200:203], v[160:163], a[160:163]
    ds_read_b64_tr_b16 v[222:223], v254 offset:9152
    v_add_f32 v247, v247, v250
    v_mfma_f32_16x16x32_bf16 a[164:167], v[200:203], v[164:167], a[164:167]
    s_add_u32 m0, s17, 4480
    v_exp_f32 v251, v159
    v_mfma_f32_16x16x32_bf16 a[168:171], v[200:203], v[168:171], a[168:171]
    buffer_load_dwordx4 v255, s[8:11], s21 offen offset:2048 lds
    v_mfma_f32_16x16x32_bf16 a[172:175], v[200:203], v[172:175], a[172:175]
    v_add_f32 v247, v247, v251
    v_cvt_pk_bf16_f32 v191, v250, v251
    v_mfma_f32_16x16x32_bf16 a[188:191], v[204:207], v[172:175], a[188:191]
    v_max3_f32 v248, v244, v245, v246
    v_max_f32 v248, v248, v247
    v_mfma_f32_16x16x32_bf16 a[184:187], v[204:207], v[168:171], a[184:187]
    s_add_u32 m0, s17, 4544
    v_cmp_lt_f32 vcc, s25, v248
    v_mfma_f32_16x16x32_bf16 a[180:183], v[204:207], v[164:167], a[180:183]
    s_waitcnt lgkmcnt(1)
    buffer_load_dwordx4 v255, s[8:11], s21 offen offset:3072 lds
    v_mfma_f32_16x16x32_bf16 a[176:179], v[204:207], v[160:163], a[176:179]
    s_add_u32 s20, s20, 16384
    v_mfma_f32_16x16x32_bf16 a[192:195], v[208:211], v[160:163], a[192:195]
    s_add_u32 s21, s21, 16384
    v_mfma_f32_16x16x32_bf16 a[196:199], v[208:211], v[164:167], a[196:199]
    s_mov_b32 m0, 139264
    v_mfma_f32_16x16x32_bf16 a[200:203], v[208:211], v[168:171], a[200:203]
    s_waitcnt vmcnt(17) lgkmcnt(0)
    s_barrier
    ds_read_b128 v[192:195], v252 offset:0
    v_mfma_f32_16x16x32_bf16 a[204:207], v[208:211], v[172:175], a[204:207]
    buffer_load_dword v255, s[64:67], s68 offen lds
    v_mfma_f32_16x16x32_bf16 a[220:223], v[212:215], v[172:175], a[220:223]
    s_add_u32 s68, s68, 16384
    ds_read_b128 v[196:199], v252 offset:64
    v_mfma_f32_16x16x32_bf16 a[216:219], v[212:215], v[168:171], a[216:219]
    v_mfma_f32_16x16x32_bf16 a[212:215], v[212:215], v[164:167], a[212:215]
    ds_read_b128 v[200:203], v252 offset:128
    v_mfma_f32_16x16x32_bf16 a[208:211], v[212:215], v[160:163], a[208:211]
    v_mfma_f32_16x16x32_bf16 a[224:227], v[216:219], v[160:163], a[224:227]
    ds_read_b128 v[204:207], v252 offset:192
    v_mfma_f32_16x16x32_bf16 a[228:231], v[216:219], v[164:167], a[228:231]
    v_mfma_f32_16x16x32_bf16 a[232:235], v[216:219], v[168:171], a[232:235]
    v_mfma_f32_16x16x32_bf16 a[236:239], v[216:219], v[172:175], a[236:239]
    v_mfma_f32_16x16x32_bf16 a[252:255], v[220:223], v[172:175], a[252:255]
    s_sub_u32 s24, s24, 1
    v_mfma_f32_16x16x32_bf16 a[248:251], v[220:223], v[168:171], a[248:251]
    s_cmp_lg_u32 s24, 0
    v_mfma_f32_16x16x32_bf16 a[244:247], v[220:223], v[164:167], a[244:247]
    s_waitcnt lgkmcnt(0)
    v_mfma_f32_16x16x32_bf16 a[240:243], v[220:223], v[160:163], a[240:243]
    s_cbranch_vccnz L_slow_b
L_back_b:
    s_cbranch_scc1 K2_loop
    v_mfma_f32_16x16x32_bf16 v[128:131], v[192:195], v[0:3], v[224:227]
    v_mfma_f32_16x16x32_bf16 v[128:131], v[196:199], v[4:7], v[128:131]
    s_add_u32 m0, s18, 0
    ds_read_b128 v[208:211], v252 offset:256
    v_mfma_f32_16x16x32_bf16 v[128:131], v[200:203], v[8:11], v[128:131]
    buffer_load_dwordx4 v255, s[12:15], s22 offen offset:0 lds
    v_mfma_f32_16x16x32_bf16 v[128:131], v[204:207], v[12:15], v[128:131]
    ds_read_b128 v[212:215], v252 offset:320
    v_mfma_f32_16x16x32_bf16 v[132:135], v[204:207], v[44:47], v[228:231]
    v_mfma_f32_16x16x32_bf16 v[132:135], v[200:203], v[40:43], v[132:135]
    s_add_u32 m0, s18, 64
    ds_read_b128 v[216:219], v252 offset:384
    v_mfma_f32_16x16x32_bf16 v[132:135], v[196:199], v[36:39], v[132:135]
    buffer_load_dwordx4 v255, s[12:15], s22 offen offset:1024 lds
    v_mfma_f32_16x16x32_bf16 v[132:135], v[192:195], v[32:35], v[132:135]
    ds_read_b128 v[220:223], v252 offset:448
    v_mfma_f32_16x16x32_bf16 v[136:139], v[192:195], v[64:67], v[232:235]
    s_add_u32 m0, s18, 128
    v_mfma_f32_16x16x32_bf16 v[136:139], v[196:199], v[68:71], v[136:139]
    buffer_load_dwordx4 v255, s[12:15], s22 offen offset:2048 lds
    v_mfma_f32_16x16x32_bf16 v[136:139], v[200:203], v[72:75], v[136:139]
    s_add_u32 m0, s18, 192
    v_mfma_f32_16x16x32_bf16 v[136:139], v[204:207], v[76:79], v[136:139]
    buffer_load_dwordx4 v255, s[12:15], s22 offen offset:3072 lds
    v_mfma_f32_16x16x32_bf16 v[140:143], v[204:207], v[108:111], v[236:239]
    s_add_u32 m0, s18, 4352
    v_mfma_f32_16x16x32_bf16 v[140:143], v[200:203], v[104:107], v[140:143]
    buffer_load_dwordx4 v255, s[12:15], s23 offen offset:0 lds
    v_mfma_f32_16x16x32_bf16 v[140:143], v[196:199], v[100:103], v[140:143]
    s_add_u32 m0, s18, 4416
    v_mfma_f32_16x16x32_bf16 v[140:143], v[192:195], v[96:99], v[140:143]
    s_waitcnt lgkmcnt(0)
    buffer_load_dwordx4 v255, s[12:15], s23 offen offset:1024 lds
    v_mfma_f32_16x16x32_bf16 v[128:131], v[208:211], v[16:19], v[128:131]
    v_mfma_f32_16x16x32_bf16 v[128:131], v[212:215], v[20:23], v[128:131]
    s_add_u32 m0, s18, 4480
    ds_read_b128 v[192:195], v252 offset:8704
    v_mfma_f32_16x16x32_bf16 v[128:131], v[216:219], v[24:27], v[128:131]
    buffer_load_dwordx4 v255, s[12:15], s23 offen offset:2048 lds
    v_mfma_f32_16x16x32_bf16 v[128:131], v[220:223], v[28:31], v[128:131]
    ds_read_b128 v[196:199], v252 offset:8768
    v_mfma_f32_16x16x32_bf16 v[132:135], v[220:223], v[60:63], v[132:135]
    v_mfma_f32_16x16x32_bf16 v[132:135], v[216:219], v[56:59], v[132:135]
    s_add_u32 m0, s18, 4544
    ds_read_b128 v[200:203], v252 offset:8832
    v_mfma_f32_16x16x32_bf16 v[132:135], v[212:215], v[52:55], v[132:135]
    buffer_load_dwordx4 v255, s[12:15], s23 offen offset:3072 lds
    v_mfma_f32_16x16x32_bf16 v[132:135], v[208:211], v[48:51], v[132:135]
    s_add_u32 s22, s22, 16384
    ds_read_b128 v[204:207], v252 offset:8896
    v_mfma_f32_16x16x32_bf16 v[136:139], v[208:211], v[80:83], v[136:139]
    s_add_u32 s23, s23, 16384
    v_exp_f32 v248, v128
    v_mfma_f32_16x16x32_bf16 v[136:139], v[212:215], v[84:87], v[136:139]
    v_exp_f32 v249, v129
    v_mfma_f32_16x16x32_bf16 v[136:139], v[216:219], v[88:91], v[136:139]
    v_exp_f32 v250, v130
    v_mfma_f32_16x16x32_bf16 v[136:139], v[220:223], v[92:95], v[136:139]
    v_exp_f32 v251, v131
    v_mfma_f32_16x16x32_bf16 v[140:143], v[220:223], v[124:127], v[140:143]
    v_add_f32 v240, v244, v248
    v_add_f32 v240, v240, v249
    v_mfma_f32_16x16x32_bf16 v[140:143], v[216:219], v[120:123], v[140:143]
    v_cvt_pk_bf16_f32 v160, v248, v249
    v_add_f32 v240, v240, v250
    v_mfma_f32_16x16x32_bf16 v[140:143], v[212:215], v[116:119], v[140:143]
    v_exp_f32 v248, v132
    v_mfma_f32_16x16x32_bf16 v[140:143], v[208:211], v[112:115], v[140:143]
    s_waitcnt lgkmcnt(0)
    v_exp_f32 v249, v133
    v_mfma_f32_16x16x32_bf16 v[144:147], v[192:195], v[0:3], v[224:227]
    v_add_f32 v240, v240, v251
    v_cvt_pk_bf16_f32 v161, v250, v251
    v_mfma_f32_16x16x32_bf16 v[144:147], v[196:199], v[4:7], v[144:147]
    ds_read_b128 v[208:211], v252 offset:8960
    v_add_f32 v241, v245, v248
    v_mfma_f32_16x16x32_bf16 v[144:147], v[200:203], v[8:11], v[144:147]
    v_exp_f32 v250, v134
    v_mfma_f32_16x16x32_bf16 v[144:147], v[204:207], v[12:15], v[144:147]
    ds_read_b128 v[212:215], v252 offset:9024
    v_add_f32 v241, v241, v249
    v_mfma_f32_16x16x32_bf16 v[148:151], v[204:207], v[44:47], v[228:231]
    v_exp_f32 v251, v135
    v_mfma_f32_16x16x32_bf16 v[148:151], v[200:203], v[40:43], v[148:151]
    ds_read_b128 v[216:219], v252 offset:9088
    v_cvt_pk_bf16_f32 v164, v248, v249
    v_mfma_f32_16x16x32_bf16 v[148:151], v[196:199], v[36:39], v[148:151]
    v_exp_f32 v248, v136
    v_mfma_f32_16x16x32_bf16 v[148:151], v[192:195], v[32:35], v[148:151]
    ds_read_b128 v[220:223], v252 offset:9152
    v_add_f32 v241, v241, v250
    v_mfma_f32_16x16x32_bf16 v[152:155], v[192:195], v[64:67], v[232:235]
    v_exp_f32 v249, v137
    v_mfma_f32_16x16x32_bf16 v[152:155], v[196:199], v[68:71], v[152:155]
    v_add_f32 v241, v241, v251
    v_cvt_pk_bf16_f32 v165, v250, v251
    v_mfma_f32_16x16x32_bf16 v[152:155], v[200:203], v[72:75], v[152:155]
    v_exp_f32 v250, v138
    v_mfma_f32_16x16x32_bf16 v[152:155], v[204:207], v[76:79], v[152:155]
    v_exp_f32 v251, v139
    v_mfma_f32_16x16x32_bf16 v[156:159], v[204:207], v[108:111], v[236:239]
    v_add_f32 v242, v246, v248
    v_add_f32 v242, v242, v249
    v_mfma_f32_16x16x32_bf16 v[156:159], v[200:203], v[104:107], v[156:159]
    v_cvt_pk_bf16_f32 v168, v248, v249
    v_add_f32 v242, v242, v250
    v_mfma_f32_16x16x32_bf16 v[156:159], v[196:199], v[100:103], v[156:159]
    v_exp_f32 v248, v140
    v_mfma_f32_16x16x32_bf16 v[156:159], v[192:195], v[96:99], v[156:159]
    s_waitcnt lgkmcnt(0)
    v_exp_f32 v249, v141
    v_mfma_f32_16x16x32_bf16 v[144:147], v[208:211], v[16:19], v[144:147]
    v_add_f32 v242, v242, v251
    v_cvt_pk_bf16_f32 v169, v250, v251
    v_mfma_f32_16x16x32_bf16 v[144:147], v[212:215], v[20:23], v[144:147]
    v_exp_f32 v250, v142
    v_mfma_f32_16x16x32_bf16 v[144:147], v[216:219], v[24:27], v[144:147]
    s_waitcnt vmcnt(17) lgkmcnt(0)
    s_barrier
    ds_read_b64_tr_b16 v[192:193], v253 offset:17408
    v_add_f32 v243, v247, v248
    v_mfma_f32_16x16x32_bf16 v[144:147], v[220:223], v[28:31], v[144:147]
    ds_read_b64_tr_b16 v[194:195], v253 offset:26112
    v_add_f32 v243, v243, v249
    v_mfma_f32_16x16x32_bf16 v[148:151], v[220:223], v[60:63], v[148:151]
    ds_read_b64_tr_b16 v[196:197], v254 offset:17408
    v_cvt_pk_bf16_f32 v172, v248, v249
    v_mfma_f32_16x16x32_bf16 v[148:151], v[216:219], v[56:59], v[148:151]
    ds_read_b64_tr_b16 v[198:199], v254 offset:26112
    v_add_f32 v243, v243, v250
    v_mfma_f32_16x16x32_bf16 v[148:151], v[212:215], v[52:55], v[148:151]
    ds_read_b64_tr_b16 v[200:201], v253 offset:17472
    v_mfma_f32_16x16x32_bf16 v[148:151], v[208:211], v[48:51], v[148:151]
    ds_read_b64_tr_b16 v[202:203], v253 offset:26176
    v_mfma_f32_16x16x32_bf16 v[152:155], v[208:211], v[80:83], v[152:155]
    ds_read_b64_tr_b16 v[204:205], v254 offset:17472
    v_mfma_f32_16x16x32_bf16 v[152:155], v[212:215], v[84:87], v[152:155]
    ds_read_b64_tr_b16 v[206:207], v254 offset:26176
    v_mfma_f32_16x16x32_bf16 v[152:155], v[216:219], v[88:91], v[152:155]
    v_exp_f32 v251, v143
    v_mfma_f32_16x16x32_bf16 v[152:155], v[220:223], v[92:95], v[152:155]
    v_exp_f32 v248, v144
    v_mfma_f32_16x16x32_bf16 v[156:159], v[220:223], v[124:127], v[156:159]
    v_exp_f32 v249, v145
    v_mfma_f32_16x16x32_bf16 v[156:159], v[216:219], v[120:123], v[156:159]
    v_add_f32 v243, v243, v251
    v_cvt_pk_bf16_f32 v173, v250, v251
    v_mfma_f32_16x16x32_bf16 v[156:159], v[212:215], v[116:119], v[156:159]
    v_exp_f32 v250, v146
    v_mfma_f32_16x16x32_bf16 v[156:159], v[208:211], v[112:115], v[156:159]
    s_waitcnt lgkmcnt(1)
    v_exp_f32 v251, v147
    v_mfma_f32_16x16x32_bf16 a[0:3], v[192:195], v[176:179], a[0:3]
    ds_read_b64_tr_b16 v[208:209], v253 offset:17536
    v_add_f32 v240, v240, v248
    v_mfma_f32_16x16x32_bf16 a[4:7], v[192:195], v[180:183], a[4:7]
    s_lshl_b32 s33, s29, 2
    ds_read_b64_tr_b16 v[210:211], v253 offset:26240
    v_add_f32 v240, v240, v249
    v_mfma_f32_16x16x32_bf16 a[8:11], v[192:195], v[184:187], a[8:11]
    s_mul_i32 s32, s28, 229376
    s_add_u32 s33, s33, s27
    s_mul_i32 s33, s33, 3584
    s_add_u32 s32, s32, s33
    v_cvt_pk_bf16_f32 v162, v248, v249
    v_add_f32 v240, v240, v250
    v_mfma_f32_16x16x32_bf16 a[12:15], v[192:195], v[188:191], a[12:15]
    s_mov_b32 m0, 139264
    ds_read_b64_tr_b16 v[212:213], v254 offset:17536
    v_add_f32 v240, v240, v251
    v_mfma_f32_16x16x32_bf16 a[28:31], v[196:199], v[188:191], a[28:31]
    s_mov_b32 s62, 3584
    ds_read_b64_tr_b16 v[214:215], v254 offset:26240
    v_cvt_pk_bf16_f32 v163, v250, v251
    v_mfma_f32_16x16x32_bf16 a[24:27], v[196:199], v[184:187], a[24:27]
    s_add_u32 s60, s54, s32
    s_addc_u32 s61, s55, 0
    v_exp_f32 v248, v148
    v_mfma_f32_16x16x32_bf16 a[20:23], v[196:199], v[180:183], a[20:23]
    ds_read_b64_tr_b16 v[216:217], v253 offset:17600
    v_add_f32 v241, v241, v248
    v_mfma_f32_16x16x32_bf16 a[16:19], v[196:199], v[176:179], a[16:19]
    v_exp_f32 v249, v149
    v_mfma_f32_16x16x32_bf16 a[32:35], v[200:203], v[176:179], a[32:35]
    ds_read_b64_tr_b16 v[218:219], v253 offset:26304
    v_add_f32 v241, v241, v249
    v_mfma_f32_16x16x32_bf16 a[36:39], v[200:203], v[180:183], a[36:39]
    v_exp_f32 v250, v150
    v_mfma_f32_16x16x32_bf16 a[40:43], v[200:203], v[184:187], a[40:43]
    ds_read_b64_tr_b16 v[220:221], v254 offset:17600
    v_cvt_pk_bf16_f32 v166, v248, v249
    v_mfma_f32_16x16x32_bf16 a[44:47], v[200:203], v[188:191], a[44:47]
    s_waitcnt lgkmcnt(3)
    ds_read_b64_tr_b16 v[222:223], v254 offset:26304
    v_add_f32 v241, v241, v250
    v_mfma_f32_16x16x32_bf16 a[60:63], v[204:207], v[188:191], a[60:63]
    v_exp_f32 v251, v151
    v_mfma_f32_16x16x32_bf16 a[56:59], v[204:207], v[184:187], a[56:59]
    ds_read_b64_tr_b16 v[192:193], v253 offset:17664
    v_add_f32 v241, v241, v251
    v_mfma_f32_16x16x32_bf16 a[52:55], v[204:207], v[180:183], a[52:55]
    v_exp_f32 v248, v152
    v_mfma_f32_16x16x32_bf16 a[48:51], v[204:207], v[176:179], a[48:51]
    ds_read_b64_tr_b16 v[194:195], v253 offset:26368
    v_cvt_pk_bf16_f32 v167, v250, v251
    v_mfma_f32_16x16x32_bf16 a[64:67], v[208:211], v[176:179], a[64:67]
    v_exp_f32 v249, v153
    v_mfma_f32_16x16x32_bf16 a[68:71], v[208:211], v[180:183], a[68:71]
    ds_read_b64_tr_b16 v[196:197], v254 offset:17664
    v_add_f32 v242, v242, v248
    v_mfma_f32_16x16x32_bf16 a[72:75], v[208:211], v[184:187], a[72:75]
    ds_read_b64_tr_b16 v[198:199], v254 offset:26368
    v_add_f32 v242, v242, v249
    v_mfma_f32_16x16x32_bf16 a[76:79], v[208:211], v[188:191], a[76:79]
    v_exp_f32 v250, v154
    v_mfma_f32_16x16x32_bf16 a[92:95], v[212:215], v[188:191], a[92:95]
    ds_read_b64_tr_b16 v[200:201], v253 offset:17728
    v_cvt_pk_bf16_f32 v170, v248, v249
    v_mfma_f32_16x16x32_bf16 a[88:91], v[212:215], v[184:187], a[88:91]
    v_exp_f32 v251, v155
    v_mfma_f32_16x16x32_bf16 a[84:87], v[212:215], v[180:183], a[84:87]
    ds_read_b64_tr_b16 v[202:203], v253 offset:26432
    v_add_f32 v242, v242, v250
    v_mfma_f32_16x16x32_bf16 a[80:83], v[212:215], v[176:179], a[80:83]
    s_waitcnt lgkmcnt(4)
    v_exp_f32 v248, v156
    v_mfma_f32_16x16x32_bf16 a[96:99], v[216:219], v[176:179], a[96:99]
    ds_read_b64_tr_b16 v[204:205], v254 offset:17728
    v_add_f32 v242, v242, v251
    v_mfma_f32_16x16x32_bf16 a[100:103], v[216:219], v[180:183], a[100:103]
    ds_read_b64_tr_b16 v[206:207], v254 offset:26432
    v_cvt_pk_bf16_f32 v171, v250, v251
    v_mfma_f32_16x16x32_bf16 a[104:107], v[216:219], v[184:187], a[104:107]
    v_exp_f32 v249, v157
    v_mfma_f32_16x16x32_bf16 a[108:111], v[216:219], v[188:191], a[108:111]
    ds_read_b64_tr_b16 v[208:209], v253 offset:17792
    v_add_f32 v243, v243, v248
    v_mfma_f32_16x16x32_bf16 a[124:127], v[220:223], v[188:191], a[124:127]
    v_exp_f32 v250, v158
    v_mfma_f32_16x16x32_bf16 a[120:123], v[220:223], v[184:187], a[120:123]
    ds_read_b64_tr_b16 v[210:211], v253 offset:26496
    v_add_f32 v243, v243, v249
    v_mfma_f32_16x16x32_bf16 a[116:119], v[220:223], v[180:183], a[116:119]
    v_exp_f32 v251, v159
    v_mfma_f32_16x16x32_bf16 a[112:115], v[220:223], v[176:179], a[112:115]
    ds_read_b64_tr_b16 v[212:213], v254 offset:17792
    v_cvt_pk_bf16_f32 v174, v248, v249
    v_mfma_f32_16x16x32_bf16 a[128:131], v[192:195], v[176:179], a[128:131]
    ds_read_b64_tr_b16 v[214:215], v254 offset:26496
    v_add_f32 v243, v243, v250
    v_mfma_f32_16x16x32_bf16 a[132:135], v[192:195], v[180:183], a[132:135]
    v_add_f32 v243, v243, v251
    v_cvt_pk_bf16_f32 v175, v250, v251
    v_mfma_f32_16x16x32_bf16 a[136:139], v[192:195], v[184:187], a[136:139]
    ds_read_b64_tr_b16 v[216:217], v253 offset:17856
    v_max3_f32 v248, v240, v241, v242
    v_mfma_f32_16x16x32_bf16 a[140:143], v[192:195], v[188:191], a[140:143]
    s_waitcnt lgkmcnt(4)
    v_max_f32 v248, v248, v243
    v_cmp_lt_f32 vcc, s25, v248
    v_mfma_f32_16x16x32_bf16 a[156:159], v[196:199], v[188:191], a[156:159]
    ds_read_b64_tr_b16 v[218:219], v253 offset:26560
    v_mfma_f32_16x16x32_bf16 a[152:155], v[196:199], v[184:187], a[152:155]
    v_mfma_f32_16x16x32_bf16 a[148:151], v[196:199], v[180:183], a[148:151]
    ds_read_b64_tr_b16 v[220:221], v254 offset:17856
    v_mfma_f32_16x16x32_bf16 a[144:147], v[196:199], v[176:179], a[144:147]
    v_mfma_f32_16x16x32_bf16 a[160:163], v[200:203], v[176:179], a[160:163]
    ds_read_b64_tr_b16 v[222:223], v254 offset:26560
    v_mfma_f32_16x16x32_bf16 a[164:167], v[200:203], v[180:183], a[164:167]
    v_mfma_f32_16x16x32_bf16 a[168:171], v[200:203], v[184:187], a[168:171]
    v_mfma_f32_16x16x32_bf16 a[172:175], v[200:203], v[188:191], a[172:175]
    v_mfma_f32_16x16x32_bf16 a[188:191], v[204:207], v[188:191], a[188:191]
    s_getpc_b64 s[58:59]
K2_pc:
    s_add_u32 s58, s58, L_back_p29-K2_pc
    s_addc_u32 s59, s59, 0
    v_mfma_f32_16x16x32_bf16 a[184:187], v[204:207], v[184:187], a[184:187]
    v_mfma_f32_16x16x32_bf16 a[180:183], v[204:207], v[180:183], a[180:183]
    s_lshr_b32 s35, s2, 3
    s_lshl_b32 s35, s35, 2
    s_add_u32 s35, s35, s27
    s_lshl_b32 s35, s35, 8
    v_mfma_f32_16x16x32_bf16 a[176:179], v[204:207], v[176:179], a[176:179]
    s_waitcnt lgkmcnt(0)
    v_mfma_f32_16x16x32_bf16 a[192:195], v[208:211], v[176:179], a[192:195]
    v_mfma_f32_16x16x32_bf16 a[196:199], v[208:211], v[180:183], a[196:199]
    v_mfma_f32_16x16x32_bf16 a[200:203], v[208:211], v[184:187], a[200:203]
    s_waitcnt vmcnt(9) lgkmcnt(0)
    s_barrier
    ds_read_b128 v[192:195], v252 offset:17408
    v_mfma_f32_16x16x32_bf16 a[204:207], v[208:211], v[188:191], a[204:207]
    v_mfma_f32_16x16x32_bf16 a[220:223], v[212:215], v[188:191], a[220:223]
    ds_read_b128 v[196:199], v252 offset:17472
    v_mfma_f32_16x16x32_bf16 a[216:219], v[212:215], v[184:187], a[216:219]
    v_lshlrev_b32 v249, 2, v255
    v_mfma_f32_16x16x32_bf16 a[212:215], v[212:215], v[180:183], a[212:215]
    ds_read_b128 v[200:203], v252 offset:17536
    v_mfma_f32_16x16x32_bf16 a[208:211], v[212:215], v[176:179], a[208:211]
    buffer_load_dword v249, s[60:63], 0 offen lds
    v_mfma_f32_16x16x32_bf16 a[224:227], v[216:219], v[176:179], a[224:227]
    s_mov_b32 s62, 1792
    ds_read_b128 v[204:207], v252 offset:17600
    s_lshl_b32 s32, s2, 2
    s_add_u32 s32, s32, s27
    s_mul_i32 s32, s32, 1792
    v_mfma_f32_16x16x32_bf16 a[228:231], v[216:219], v[180:183], a[228:231]
    s_add_u32 s60, s36, s32
    s_addc_u32 s61, s37, 0
    v_mfma_f32_16x16x32_bf16 a[232:235], v[216:219], v[184:187], a[232:235]
    buffer_load_dword v249, s[60:63], 0 offen lds
    v_mfma_f32_16x16x32_bf16 a[236:239], v[216:219], v[188:191], a[236:239]
    v_mfma_f32_16x16x32_bf16 a[252:255], v[220:223], v[188:191], a[252:255]
    v_and_b32 v250, 0xc0, v255
    v_add_u32 v250, s35, v250
    v_mfma_f32_16x16x32_bf16 a[248:251], v[220:223], v[184:187], a[248:251]
    v_min_u32 v250, K2_end-L_back_p29, v250
    v_mov_b32 v251, s59
    v_mfma_f32_16x16x32_bf16 a[244:247], v[220:223], v[180:183], a[244:247]
    v_add_co_u32 v250, s[78:79], s58, v250
    s_waitcnt lgkmcnt(0)
    v_mfma_f32_16x16x32_bf16 a[240:243], v[220:223], v[176:179], a[240:243]
    s_nop 0
    v_addc_co_u32 v251, s[78:79], 0, v251, s[78:79]
    global_load_lds_dword v[250:251], off
    s_cbranch_vccnz L_slow_p29
L_back_p29:
    v_mfma_f32_16x16x32_bf16 v[128:131], v[192:195], v[0:3], v[224:227]
    v_mfma_f32_16x16x32_bf16 v[128:131], v[196:199], v[4:7], v[128:131]
    s_add_u32 m0, s19, 0
    ds_read_b128 v[208:211], v252 offset:17664
    v_mfma_f32_16x16x32_bf16 v[128:131], v[200:203], v[8:11], v[128:131]
    buffer_load_dwordx4 v255, s[12:15], s22 offen offset:0 lds
    v_mfma_f32_16x16x32_bf16 v[128:131], v[204:207], v[12:15], v[128:131]
    ds_read_b128 v[212:215], v252 offset:17728
    v_mfma_f32_16x16x32_bf16 v[132:135], v[204:207], v[44:47], v[228:231]
    v_mfma_f32_16x16x32_bf16 v[132:135], v[200:203], v[40:43], v[132:135]
    s_add_u32 m0, s19, 64
    ds_read_b128 v[216:219], v252 offset:17792
    v_mfma_f32_16x16x32_bf16 v[132:135], v[196:199], v[36:39], v[132:135]
    buffer_load_dwordx4 v255, s[12:15], s22 offen offset:1024 lds
    v_mfma_f32_16x16x32_bf16 v[132:135], v[192:195], v[32:35], v[132:135]
    ds_read_b128 v[220:223], v252 offset:17856
    v_mfma_f32_16x16x32_bf16 v[136:139], v[192:195], v[64:67], v[232:235]
    s_add_u32 m0, s19, 128
    v_mfma_f32_16x16x32_bf16 v[136:139], v[196:199], v[68:71], v[136:139]
    buffer_load_dwordx4 v255, s[12:15], s22 offen offset:2048 lds
    v_mfma_f32_16x16x32_bf16 v[136:139], v[200:203], v[72:75], v[136:139]
    s_add_u32 m0, s19, 192
    v_mfma_f32_16x16x32_bf16 v[136:139], v[204:207], v[76:79], v[136:139]
    buffer_load_dwordx4 v255, s[12:15], s22 offen offset:3072 lds
    v_mfma_f32_16x16x32_bf16 v[140:143], v[204:207], v[108:111], v[236:239]
    s_add_u32 m0, s19, 4352
    v_mfma_f32_16x16x32_bf16 v[140:143], v[200:203], v[104:107], v[140:143]
    buffer_load_dwordx4 v255, s[12:15], s23 offen offset:0 lds
    v_mfma_f32_16x16x32_bf16 v[140:143], v[196:199], v[100:103], v[140:143]
    s_add_u32 m0, s19, 4416
    v_mfma_f32_16x16x32_bf16 v[140:143], v[192:195], v[96:99], v[140:143]
    s_waitcnt lgkmcnt(0)
    buffer_load_dwordx4 v255, s[12:15], s23 offen offset:1024 lds
    v_mfma_f32_16x16x32_bf16 v[128:131], v[208:211], v[16:19], v[128:131]
    v_mfma_f32_16x16x32_bf16 v[128:131], v[212:215], v[20:23], v[128:131]
    s_add_u32 m0, s19, 4480
    ds_read_b128 v[192:195], v252 offset:26112
    v_mfma_f32_16x16x32_bf16 v[128:131], v[216:219], v[24:27], v[128:131]
    buffer_load_dwordx4 v255, s[12:15], s23 offen offset:2048 lds
    v_mfma_f32_16x16x32_bf16 v[128:131], v[220:223], v[28:31], v[128:131]
    ds_read_b128 v[196:199], v252 offset:26176
    v_mfma_f32_16x16x32_bf16 v[132:135], v[220:223], v[60:63], v[132:135]
    v_mfma_f32_16x16x32_bf16 v[132:135], v[216:219], v[56:59], v[132:135]
    s_add_u32 m0, s19, 4544
    ds_read_b128 v[200:203], v252 offset:26240
    v_mfma_f32_16x16x32_bf16 v[132:135], v[212:215], v[52:55], v[132:135]
    buffer_load_dwordx4 v255, s[12:15], s23 offen offset:3072 lds
    v_mfma_f32_16x16x32_bf16 v[132:135], v[208:211], v[48:51], v[132:135]
    s_add_u32 s22, s22, 16384
    ds_read_b128 v[204:207], v252 offset:26304
    v_mfma_f32_16x16x32_bf16 v[136:139], v[208:211], v[80:83], v[136:139]
    s_add_u32 s23, s23, 16384
    v_exp_f32 v248, v128
    v_mfma_f32_16x16x32_bf16 v[136:139], v[212:215], v[84:87], v[136:139]
    v_exp_f32 v249, v129
    v_mfma_f32_16x16x32_bf16 v[136:139], v[216:219], v[88:91], v[136:139]
    v_exp_f32 v250, v130
    v_mfma_f32_16x16x32_bf16 v[136:139], v[220:223], v[92:95], v[136:139]
    v_exp_f32 v251, v131
    v_mfma_f32_16x16x32_bf16 v[140:143], v[220:223], v[124:127], v[140:143]
    v_add_f32 v244, v240, v248
    v_add_f32 v244, v244, v249
    v_mfma_f32_16x16x32_bf16 v[140:143], v[216:219], v[120:123], v[140:143]
    v_cvt_pk_bf16_f32 v176, v248, v249
    v_add_f32 v244, v244, v250
    v_mfma_f32_16x16x32_bf16 v[140:143], v[212:215], v[116:119], v[140:143]
    v_exp_f32 v248, v132
    v_mfma_f32_16x16x32_bf16 v[140:143], v[208:211], v[112:115], v[140:143]
    s_waitcnt lgkmcnt(0)
    v_exp_f32 v249, v133
    v_mfma_f32_16x16x32_bf16 v[144:147], v[192:195], v[0:3], v[224:227]
    v_add_f32 v244, v244, v251
    v_cvt_pk_bf16_f32 v177, v250, v251
    v_mfma_f32_16x16x32_bf16 v[144:147], v[196:199], v[4:7], v[144:147]
    ds_read_b128 v[208:211], v252 offset:26368
    v_add_f32 v245, v241, v248
    v_mfma_f32_16x16x32_bf16 v[144:147], v[200:203], v[8:11], v[144:147]
    v_exp_f32 v250, v134
    v_mfma_f32_16x16x32_bf16 v[144:147], v[204:207], v[12:15], v[144:147]
    ds_read_b128 v[212:215], v252 offset:26432
    v_add_f32 v245, v245, v249
    v_mfma_f32_16x16x32_bf16 v[148:151], v[204:207], v[44:47], v[228:231]
    v_exp_f32 v251, v135
    v_mfma_f32_16x16x32_bf16 v[148:151], v[200:203], v[40:43], v[148:151]
    ds_read_b128 v[216:219], v252 offset:26496
    v_cvt_pk_bf16_f32 v180, v248, v249
    v_mfma_f32_16x16x32_bf16 v[148:151], v[196:199], v[36:39], v[148:151]
    v_exp_f32 v248, v136
    v_mfma_f32_16x16x32_bf16 v[148:151], v[192:195], v[32:35], v[148:151]
    ds_read_b128 v[220:223], v252 offset:26560
    v_add_f32 v245, v245, v250
    v_mfma_f32_16x16x32_bf16 v[152:155], v[192:195], v[64:67], v[232:235]
    v_exp_f32 v249, v137
    v_mfma_f32_16x16x32_bf16 v[152:155], v[196:199], v[68:71], v[152:155]
    v_add_f32 v245, v245, v251
    v_cvt_pk_bf16_f32 v181, v250, v251
    v_mfma_f32_16x16x32_bf16 v[152:155], v[200:203], v[72:75], v[152:155]
    v_exp_f32 v250, v138
    v_mfma_f32_16x16x32_bf16 v[152:155], v[204:207], v[76:79], v[152:155]
    v_exp_f32 v251, v139
    v_mfma_f32_16x16x32_bf16 v[156:159], v[204:207], v[108:111], v[236:239]
    v_add_f32 v246, v242, v248
    v_add_f32 v246, v246, v249
    v_mfma_f32_16x16x32_bf16 v[156:159], v[200:203], v[104:107], v[156:159]
    v_cvt_pk_bf16_f32 v184, v248, v249
    v_add_f32 v246, v246, v250
    v_mfma_f32_16x16x32_bf16 v[156:159], v[196:199], v[100:103], v[156:159]
    v_exp_f32 v248, v140
    v_mfma_f32_16x16x32_bf16 v[156:159], v[192:195], v[96:99], v[156:159]
    s_waitcnt lgkmcnt(0)
    v_exp_f32 v249, v141
    v_mfma_f32_16x16x32_bf16 v[144:147], v[208:211], v[16:19], v[144:147]
    v_add_f32 v246, v246, v251
    v_cvt_pk_bf16_f32 v185, v250, v251
    v_mfma_f32_16x16x32_bf16 v[144:147], v[212:215], v[20:23], v[144:147]
    v_exp_f32 v250, v142
    v_mfma_f32_16x16x32_bf16 v[144:147], v[216:219], v[24:27], v[144:147]
    s_waitcnt vmcnt(11) lgkmcnt(0)
    s_barrier
    ds_read_b64_tr_b16 v[192:193], v253 offset:0
    v_add_f32 v247, v243, v248
    v_mfma_f32_16x16x32_bf16 v[144:147], v[220:223], v[28:31], v[144:147]
    ds_read_b64_tr_b16 v[194:195], v253 offset:8704
    v_add_f32 v247, v247, v249
    v_mfma_f32_16x16x32_bf16 v[148:151], v[220:223], v[60:63], v[148:151]
    ds_read_b64_tr_b16 v[196:197], v254 offset:0
    v_cvt_pk_bf16_f32 v188, v248, v249
    v_mfma_f32_16x16x32_bf16 v[148:151], v[216:219], v[56:59], v[148:151]
    ds_read_b64_tr_b16 v[198:199], v254 offset:8704
    v_add_f32 v247, v247, v250
    v_mfma_f32_16x16x32_bf16 v[148:151], v[212:215], v[52:55], v[148:151]
    ds_read_b64_tr_b16 v[200:201], v253 offset:64
    v_mfma_f32_16x16x32_bf16 v[148:151], v[208:211], v[48:51], v[148:151]
    ds_read_b64_tr_b16 v[202:203], v253 offset:8768
    v_mfma_f32_16x16x32_bf16 v[152:155], v[208:211], v[80:83], v[152:155]
    ds_read_b64_tr_b16 v[204:205], v254 offset:64
    v_mfma_f32_16x16x32_bf16 v[152:155], v[212:215], v[84:87], v[152:155]
    ds_read_b64_tr_b16 v[206:207], v254 offset:8768
    v_mfma_f32_16x16x32_bf16 v[152:155], v[216:219], v[88:91], v[152:155]
    v_exp_f32 v251, v143
    v_mfma_f32_16x16x32_bf16 v[152:155], v[220:223], v[92:95], v[152:155]
    v_exp_f32 v248, v144
    v_mfma_f32_16x16x32_bf16 v[156:159], v[220:223], v[124:127], v[156:159]
    v_exp_f32 v249, v145
    v_mfma_f32_16x16x32_bf16 v[156:159], v[216:219], v[120:123], v[156:159]
    v_add_f32 v247, v247, v251
    v_cvt_pk_bf16_f32 v189, v250, v251
    v_mfma_f32_16x16x32_bf16 v[156:159], v[212:215], v[116:119], v[156:159]
    v_exp_f32 v250, v146
    v_mfma_f32_16x16x32_bf16 v[156:159], v[208:211], v[112:115], v[156:159]
    s_waitcnt lgkmcnt(1)
    v_exp_f32 v251, v147
    v_mfma_f32_16x16x32_bf16 a[0:3], v[192:195], v[160:163], a[0:3]
    ds_read_b64_tr_b16 v[208:209], v253 offset:128
    s_lshr_b32 s32, s2, 3
    s_lshl_b32 s32, s32, 2
    v_add_f32 v244, v244, v248
    v_mfma_f32_16x16x32_bf16 a[4:7], v[192:195], v[164:167], a[4:7]
    ds_read_b64_tr_b16 v[210:211], v253 offset:8832
    s_add_u32 s32, s32, s27
    s_and_b32 s33, s2, 7
    v_add_f32 v244, v244, v249
    v_mfma_f32_16x16x32_bf16 a[8:11], v[192:195], v[168:171], a[8:11]
    s_mul_i32 s34, s33, 200704
    s_mul_i32 s35, s32, 1568
    v_lshlrev_b32 v0, 1, v255
    v_lshrrev_b32 v1, 8, v255
    v_mfma_f32_16x16x32_bf16 a[12:15], v[192:195], v[172:175], a[12:15]
    ds_read_b64_tr_b16 v[212:213], v254 offset:128
    s_add_u32 s34, s34, s35
    s_mul_i32 s33, s33, 448
    v_cvt_pk_bf16_f32 v178, v248, v249
    v_mfma_f32_16x16x32_bf16 a[28:31], v[196:199], v[172:175], a[28:31]
    ds_read_b64_tr_b16 v[214:215], v254 offset:8832
    s_mul_i32 s32, s32, 14336
    s_add_u32 s32, s32, s33
    v_add_f32 v244, v244, v250
    v_mfma_f32_16x16x32_bf16 a[24:27], v[196:199], v[168:171], a[24:27]
    s_sub_u32 s33, 1605632, s32
    s_cselect_b32 s33, 0, s33
    v_exp_f32 v248, v148
    v_mfma_f32_16x16x32_bf16 a[20:23], v[196:199], v[164:167], a[20:23]
    ds_read_b64_tr_b16 v[216:217], v253 offset:192
    s_mov_b32 m0, 139264
    s_mov_b32 s62, 1568
    v_add_f32 v244, v244, v251
    v_mfma_f32_16x16x32_bf16 a[16:19], v[196:199], v[160:163], a[16:19]
    s_add_u32 s60, s52, s34
    s_addc_u32 s61, s53, 0
    v_exp_f32 v249, v149
    v_mfma_f32_16x16x32_bf16 a[32:35], v[200:203], v[160:163], a[32:35]
    ds_read_b64_tr_b16 v[218:219], v253 offset:8896
    v_cvt_pk_bf16_f32 v179, v250, v251
    v_mfma_f32_16x16x32_bf16 a[36:39], v[200:203], v[164:167], a[36:39]
    buffer_load_dword v0, s[60:63], 0 offen lds
    v_mfma_f32_16x16x32_bf16 a[40:43], v[200:203], v[168:171], a[40:43]
    ds_read_b64_tr_b16 v[220:221], v254 offset:192
    v_add_f32 v245, v245, v248
    v_mfma_f32_16x16x32_bf16 a[44:47], v[200:203], v[172:175], a[44:47]
    s_waitcnt lgkmcnt(3)
    ds_read_b64_tr_b16 v[222:223], v254 offset:8896
    v_add_f32 v245, v245, v249
    v_mfma_f32_16x16x32_bf16 a[60:63], v[204:207], v[172:175], a[60:63]
    s_add_u32 s60, s48, s32
    s_addc_u32 s61, s49, 0
    v_mul_u32_u24 v1, 3584, v1
    v_cvt_pk_bf16_f32 v182, v248, v249
    v_mfma_f32_16x16x32_bf16 a[56:59], v[204:207], v[168:171], a[56:59]
    ds_read_b64_tr_b16 v[192:193], v253 offset:256
    v_mfma_f32_16x16x32_bf16 a[52:55], v[204:207], v[164:167], a[52:55]
    s_mov_b32 s62, s33
    v_and_b32 v0, 0x1e0, v0
    v_min_u32 v0, 444, v0
    v_mfma_f32_16x16x32_bf16 a[48:51], v[204:207], v[160:163], a[48:51]
    ds_read_b64_tr_b16 v[194:195], v253 offset:8960
    v_mfma_f32_16x16x32_bf16 a[64:67], v[208:211], v[160:163], a[64:67]
    v_add_u32 v1, v1, v0
    v_mfma_f32_16x16x32_bf16 a[68:71], v[208:211], v[164:167], a[68:71]
    ds_read_b64_tr_b16 v[196:197], v254 offset:256
    v_mfma_f32_16x16x32_bf16 a[72:75], v[208:211], v[168:171], a[72:75]
    ds_read_b64_tr_b16 v[198:199], v254 offset:8960
    v_mfma_f32_16x16x32_bf16 a[76:79], v[208:211], v[172:175], a[76:79]
    buffer_load_dword v1, s[60:63], 0 offen lds
    v_mfma_f32_16x16x32_bf16 a[92:95], v[212:215], v[172:175], a[92:95]
    ds_read_b64_tr_b16 v[200:201], v253 offset:320
    v_mfma_f32_16x16x32_bf16 a[88:91], v[212:215], v[168:171], a[88:91]
    s_add_u32 s60, s50, s32
    s_addc_u32 s61, s51, 0
    v_exp_f32 v250, v150
    v_mfma_f32_16x16x32_bf16 a[84:87], v[212:215], v[164:167], a[84:87]
    ds_read_b64_tr_b16 v[202:203], v253 offset:9024
    v_add_f32 v245, v245, v250
    v_mfma_f32_16x16x32_bf16 a[80:83], v[212:215], v[160:163], a[80:83]
    s_waitcnt lgkmcnt(4)
    buffer_load_dword v1, s[60:63], 0 offen lds
    v_mfma_f32_16x16x32_bf16 a[96:99], v[216:219], v[160:163], a[96:99]
    ds_read_b64_tr_b16 v[204:205], v254 offset:320
    v_mfma_f32_16x16x32_bf16 a[100:103], v[216:219], v[164:167], a[100:103]
    ds_read_b64_tr_b16 v[206:207], v254 offset:9024
    v_mfma_f32_16x16x32_bf16 a[104:107], v[216:219], v[168:171], a[104:107]
    v_exp_f32 v251, v151
    v_mfma_f32_16x16x32_bf16 a[108:111], v[216:219], v[172:175], a[108:111]
    ds_read_b64_tr_b16 v[208:209], v253 offset:384
    v_add_f32 v245, v245, v251
    v_mfma_f32_16x16x32_bf16 a[124:127], v[220:223], v[172:175], a[124:127]
    v_exp_f32 v248, v152
    v_mfma_f32_16x16x32_bf16 a[120:123], v[220:223], v[168:171], a[120:123]
    ds_read_b64_tr_b16 v[210:211], v253 offset:9088
    v_cvt_pk_bf16_f32 v183, v250, v251
    v_mfma_f32_16x16x32_bf16 a[116:119], v[220:223], v[164:167], a[116:119]
    v_exp_f32 v249, v153
    v_mfma_f32_16x16x32_bf16 a[112:115], v[220:223], v[160:163], a[112:115]
    ds_read_b64_tr_b16 v[212:213], v254 offset:384
    v_add_f32 v246, v246, v248
    v_mfma_f32_16x16x32_bf16 a[128:131], v[192:195], v[160:163], a[128:131]
    ds_read_b64_tr_b16 v[214:215], v254 offset:9088
    v_add_f32 v246, v246, v249
    v_mfma_f32_16x16x32_bf16 a[132:135], v[192:195], v[164:167], a[132:135]
    v_exp_f32 v250, v154
    v_mfma_f32_16x16x32_bf16 a[136:139], v[192:195], v[168:171], a[136:139]
    ds_read_b64_tr_b16 v[216:217], v253 offset:448
    v_cvt_pk_bf16_f32 v186, v248, v249
    v_mfma_f32_16x16x32_bf16 a[140:143], v[192:195], v[172:175], a[140:143]
    s_waitcnt lgkmcnt(4)
    v_exp_f32 v251, v155
    v_mfma_f32_16x16x32_bf16 a[156:159], v[196:199], v[172:175], a[156:159]
    ds_read_b64_tr_b16 v[218:219], v253 offset:9152
    v_add_f32 v246, v246, v250
    v_mfma_f32_16x16x32_bf16 a[152:155], v[196:199], v[168:171], a[152:155]
    v_exp_f32 v248, v156
    v_mfma_f32_16x16x32_bf16 a[148:151], v[196:199], v[164:167], a[148:151]
    ds_read_b64_tr_b16 v[220:221], v254 offset:448
    v_add_f32 v246, v246, v251
    v_mfma_f32_16x16x32_bf16 a[144:147], v[196:199], v[160:163], a[144:147]
    v_exp_f32 v249, v157
    v_mfma_f32_16x16x32_bf16 a[160:163], v[200:203], v[160:163], a[160:163]
    ds_read_b64_tr_b16 v[222:223], v254 offset:9152
    v_cvt_pk_bf16_f32 v187, v250, v251
    v_mfma_f32_16x16x32_bf16 a[164:167], v[200:203], v[164:167], a[164:167]
    v_exp_f32 v250, v158
    v_mfma_f32_16x16x32_bf16 a[168:171], v[200:203], v[168:171], a[168:171]
    v_exp_f32 v251, v159
    v_mfma_f32_16x16x32_bf16 a[172:175], v[200:203], v[172:175], a[172:175]
    v_add_f32 v247, v247, v248
    v_add_f32 v247, v247, v249
    v_mfma_f32_16x16x32_bf16 a[188:191], v[204:207], v[172:175], a[188:191]
    v_cvt_pk_bf16_f32 v190, v248, v249
    v_add_f32 v247, v247, v250
    v_mfma_f32_16x16x32_bf16 a[184:187], v[204:207], v[168:171], a[184:187]
    v_add_f32 v247, v247, v251
    v_cvt_pk_bf16_f32 v191, v250, v251
    v_mfma_f32_16x16x32_bf16 a[180:183], v[204:207], v[164:167], a[180:183]
    v_max3_f32 v248, v244, v245, v246
    v_max_f32 v248, v248, v247
    v_mfma_f32_16x16x32_bf16 a[176:179], v[204:207], v[160:163], a[176:179]
    s_waitcnt lgkmcnt(0)
    v_cmp_lt_f32 vcc, s25, v248
    v_mfma_f32_16x16x32_bf16 a[192:195], v[208:211], v[160:163], a[192:195]
    v_mfma_f32_16x16x32_bf16 a[196:199], v[208:211], v[164:167], a[196:199]
    v_mfma_f32_16x16x32_bf16 a[200:203], v[208:211], v[168:171], a[200:203]
    s_waitcnt vmcnt(3) lgkmcnt(0)
    s_barrier
    ds_read_b64_tr_b16 v[192:193], v253 offset:17408
    v_mfma_f32_16x16x32_bf16 a[204:207], v[208:211], v[172:175], a[204:207]
    ds_read_b64_tr_b16 v[194:195], v253 offset:26112
    v_mfma_f32_16x16x32_bf16 a[220:223], v[212:215], v[172:175], a[220:223]
    ds_read_b64_tr_b16 v[196:197], v254 offset:17408
    v_mfma_f32_16x16x32_bf16 a[216:219], v[212:215], v[168:171], a[216:219]
    ds_read_b64_tr_b16 v[198:199], v254 offset:26112
    v_mfma_f32_16x16x32_bf16 a[212:215], v[212:215], v[164:167], a[212:215]
    ds_read_b64_tr_b16 v[200:201], v253 offset:17472
    v_mfma_f32_16x16x32_bf16 a[208:211], v[212:215], v[160:163], a[208:211]
    ds_read_b64_tr_b16 v[202:203], v253 offset:26176
    v_mfma_f32_16x16x32_bf16 a[224:227], v[216:219], v[160:163], a[224:227]
    ds_read_b64_tr_b16 v[204:205], v254 offset:17472
    v_mfma_f32_16x16x32_bf16 a[228:231], v[216:219], v[164:167], a[228:231]
    ds_read_b64_tr_b16 v[206:207], v254 offset:26176
    v_mfma_f32_16x16x32_bf16 a[232:235], v[216:219], v[168:171], a[232:235]
    v_mfma_f32_16x16x32_bf16 a[236:239], v[216:219], v[172:175], a[236:239]
    v_mfma_f32_16x16x32_bf16 a[252:255], v[220:223], v[172:175], a[252:255]
    v_mfma_f32_16x16x32_bf16 a[248:251], v[220:223], v[168:171], a[248:251]
    v_mfma_f32_16x16x32_bf16 a[244:247], v[220:223], v[164:167], a[244:247]
    s_waitcnt lgkmcnt(0)
    v_mfma_f32_16x16x32_bf16 a[240:243], v[220:223], v[160:163], a[240:243]
    s_cbranch_vccnz L_slow_p30
L_back_p30:
    v_mfma_f32_16x16x32_bf16 a[0:3], v[192:195], v[176:179], a[0:3]
    s_mul_i32 s32, s28, 229376
    ds_read_b64_tr_b16 v[208:209], v253 offset:17536
    s_mul_i32 s33, s27, 57344
    s_add_u32 s32, s32, s33
    s_sub_u32 s33, 3670016, s32
    s_add_u32 s4, s54, s32
    s_addc_u32 s5, s55, 0
    s_mov_b32 s6, s33
    s_lshl_b32 s70, s27, 13
    s_mul_i32 s32, s31, 24576
    s_add_u32 s76, s32, s73
    s_lshl_b32 s32, s27, 13
    s_add_u32 s77, s32, 131072
    v_mfma_f32_16x16x32_bf16 a[4:7], v[192:195], v[180:183], a[4:7]
    ds_read_b64_tr_b16 v[210:211], v253 offset:26240
    v_mbcnt_lo_u32_b32 v0, -1, 0
    v_mbcnt_hi_u32_b32 v0, -1, v0
    v_mfma_f32_16x16x32_bf16 a[8:11], v[192:195], v[184:187], a[8:11]
    v_lshrrev_b32 v1, 3, v0
    v_mul_u32_u24 v1, 896, v1
    v_mfma_f32_16x16x32_bf16 a[12:15], v[192:195], v[188:191], a[12:15]
    ds_read_b64_tr_b16 v[212:213], v254 offset:17536
    v_lshrrev_b32 v2, 4, v0
    v_lshlrev_b32 v2, 1, v2
    v_mfma_f32_16x16x32_bf16 a[28:31], v[196:199], v[188:191], a[28:31]
    ds_read_b64_tr_b16 v[214:215], v254 offset:26240
    v_and_b32 v3, 7, v0
    v_xor_b32 v2, v2, v3
    v_mfma_f32_16x16x32_bf16 a[24:27], v[196:199], v[184:187], a[24:27]
    v_lshl_add_u32 v4, v2, 4, v1
    v_lshlrev_b32 v1, 4, v0
    v_mfma_f32_16x16x32_bf16 a[20:23], v[196:199], v[180:183], a[20:23]
    ds_read_b64_tr_b16 v[216:217], v253 offset:17600
    v_add_u32 v252, s76, v1
    v_add_u32 v255, s77, v1
    v_mfma_f32_16x16x32_bf16 a[16:19], v[196:199], v[176:179], a[16:19]
    v_mfma_f32_16x16x32_bf16 a[32:35], v[200:203], v[176:179], a[32:35]
    ds_read_b64_tr_b16 v[218:219], v253 offset:26304
    v_mov_b32 v8, v244
    ds_write_b128 v252, a[8:11] offset:0
    v_mfma_f32_16x16x32_bf16 a[36:39], v[200:203], v[180:183], a[36:39]
    v_mov_b32 v9, v245
    v_mfma_f32_16x16x32_bf16 a[40:43], v[200:203], v[184:187], a[40:43]
    ds_read_b64_tr_b16 v[220:221], v254 offset:17600
    v_mov_b32 v10, v246
    ds_write_b128 v252, a[12:15] offset:1024
    v_mfma_f32_16x16x32_bf16 a[44:47], v[200:203], v[188:191], a[44:47]
    ds_read_b64_tr_b16 v[222:223], v254 offset:26304
    v_mov_b32 v11, v247
    v_mfma_f32_16x16x32_bf16 a[60:63], v[204:207], v[188:191], a[60:63]
    s_nop 1
    v_permlane16_swap_b32 v244, v8
    ds_write_b128 v252, a[24:27] offset:2048
    v_mfma_f32_16x16x32_bf16 a[56:59], v[204:207], v[184:187], a[56:59]
    ds_read_b64_tr_b16 v[192:193], v253 offset:17664
    v_permlane16_swap_b32 v245, v9
    v_mfma_f32_16x16x32_bf16 a[52:55], v[204:207], v[180:183], a[52:55]
    v_permlane16_swap_b32 v246, v10
    ds_write_b128 v252, a[28:31] offset:3072
    v_mfma_f32_16x16x32_bf16 a[48:51], v[204:207], v[176:179], a[48:51]
    s_waitcnt lgkmcnt(6)
    ds_read_b64_tr_b16 v[194:195], v253 offset:26368
    v_permlane16_swap_b32 v247, v11
    v_mfma_f32_16x16x32_bf16 a[64:67], v[208:211], v[176:179], a[64:67]
    s_nop 1
    v_add_f32 v244, v244, v8
    ds_write_b128 v252, a[40:43] offset:4096
    v_mfma_f32_16x16x32_bf16 a[68:71], v[208:211], v[180:183], a[68:71]
    ds_read_b64_tr_b16 v[196:197], v254 offset:17664
    v_add_f32 v245, v245, v9
    v_mfma_f32_16x16x32_bf16 a[72:75], v[208:211], v[184:187], a[72:75]
    ds_read_b64_tr_b16 v[198:199], v254 offset:26368
    v_add_f32 v246, v246, v10
    ds_write_b128 v252, a[44:47] offset:5120
    v_mfma_f32_16x16x32_bf16 a[76:79], v[208:211], v[188:191], a[76:79]
    v_add_f32 v247, v247, v11
    v_mfma_f32_16x16x32_bf16 a[92:95], v[212:215], v[188:191], a[92:95]
    ds_read_b64_tr_b16 v[200:201], v253 offset:17728
    v_mov_b32 v8, v244
    ds_write_b128 v252, a[56:59] offset:6144
    v_mfma_f32_16x16x32_bf16 a[88:91], v[212:215], v[184:187], a[88:91]
    v_mov_b32 v9, v245
    v_mfma_f32_16x16x32_bf16 a[84:87], v[212:215], v[180:183], a[84:87]
    ds_read_b64_tr_b16 v[202:203], v253 offset:26432
    v_mov_b32 v10, v246
    ds_write_b128 v252, a[60:63] offset:7168
    v_mfma_f32_16x16x32_bf16 a[80:83], v[212:215], v[176:179], a[80:83]
    v_mov_b32 v11, v247
    v_mfma_f32_16x16x32_bf16 a[96:99], v[216:219], v[176:179], a[96:99]
    ds_read_b64_tr_b16 v[204:205], v254 offset:17728
    s_nop 1
    v_permlane32_swap_b32 v244, v8
    ds_write_b128 v252, a[72:75] offset:8192
    v_mfma_f32_16x16x32_bf16 a[100:103], v[216:219], v[180:183], a[100:103]
    ds_read_b64_tr_b16 v[206:207], v254 offset:26432
    v_permlane32_swap_b32 v245, v9
    v_mfma_f32_16x16x32_bf16 a[104:107], v[216:219], v[184:187], a[104:107]
    v_permlane32_swap_b32 v246, v10
    ds_write_b128 v252, a[76:79] offset:9216
    v_mfma_f32_16x16x32_bf16 a[108:111], v[216:219], v[188:191], a[108:111]
    s_waitcnt lgkmcnt(6)
    ds_read_b64_tr_b16 v[208:209], v253 offset:17792
    v_permlane32_swap_b32 v247, v11
    v_mfma_f32_16x16x32_bf16 a[124:127], v[220:223], v[188:191], a[124:127]
    s_nop 1
    v_add_f32 v244, v244, v8
    ds_write_b128 v252, a[88:91] offset:10240
    v_mfma_f32_16x16x32_bf16 a[120:123], v[220:223], v[184:187], a[120:123]
    ds_read_b64_tr_b16 v[210:211], v253 offset:26496
    v_add_f32 v245, v245, v9
    v_mfma_f32_16x16x32_bf16 a[116:119], v[220:223], v[180:183], a[116:119]
    v_add_f32 v246, v246, v10
    ds_write_b128 v252, a[92:95] offset:11264
    v_mfma_f32_16x16x32_bf16 a[112:115], v[220:223], v[176:179], a[112:115]
    ds_read_b64_tr_b16 v[212:213], v254 offset:17792
    v_add_f32 v247, v247, v11
    v_mfma_f32_16x16x32_bf16 a[128:131], v[192:195], v[176:179], a[128:131]
    ds_read_b64_tr_b16 v[214:215], v254 offset:26496
    v_and_b32 v5, 15, v0
    ds_write_b128 v252, a[104:107] offset:12288
    v_mfma_f32_16x16x32_bf16 a[132:135], v[192:195], v[180:183], a[132:135]
    v_lshlrev_b32 v5, 3, v5
    v_mfma_f32_16x16x32_bf16 a[136:139], v[192:195], v[184:187], a[136:139]
    s_lshl_b32 s32, s27, 8
    ds_read_b64_tr_b16 v[216:217], v253 offset:17856
    s_add_u32 s32, s32, 49152
    v_add_u32 v5, s32, v5
    ds_write_b128 v252, a[108:111] offset:13312
    v_mfma_f32_16x16x32_bf16 a[140:143], v[192:195], v[188:191], a[140:143]
    v_mov_b32 v8, v246
    v_mfma_f32_16x16x32_bf16 a[156:159], v[196:199], v[188:191], a[156:159]
    ds_read_b64_tr_b16 v[218:219], v253 offset:26560
    v_mov_b32 v9, v232
    ds_write_b128 v252, a[120:123] offset:14336
    v_mfma_f32_16x16x32_bf16 a[152:155], v[196:199], v[184:187], a[152:155]
    v_mov_b32 v10, v247
    v_mfma_f32_16x16x32_bf16 a[148:151], v[196:199], v[180:183], a[148:151]
    ds_read_b64_tr_b16 v[220:221], v254 offset:17856
    v_mov_b32 v11, v236
    ds_write_b128 v252, a[124:127] offset:15360
    v_mfma_f32_16x16x32_bf16 a[144:147], v[196:199], v[176:179], a[144:147]
    s_waitcnt lgkmcnt(6)
    ds_write_b64 v5, v[8:9]
    v_mfma_f32_16x16x32_bf16 a[160:163], v[200:203], v[176:179], a[160:163]
    ds_read_b64_tr_b16 v[222:223], v254 offset:26560
    ds_write_b64 v5, v[10:11] offset:128
    ds_write_b128 v252, a[136:139] offset:16384
    v_mfma_f32_16x16x32_bf16 a[164:167], v[200:203], v[180:183], a[164:167]
    s_xor_b32 s32, s30, 1
    s_mul_i32 s32, s32, 69632
    s_sub_u32 s32, s32, s73
    v_mfma_f32_16x16x32_bf16 a[168:171], v[200:203], v[184:187], a[168:171]
    ds_write_b128 v252, a[140:143] offset:17408
    v_add_u32 v248, s32, v252
    v_xor_b32 v249, 16384, v255
    v_mfma_f32_16x16x32_bf16 a[172:175], v[200:203], v[188:191], a[172:175]
    v_xor_b32 v250, 512, v5
    v_mov_b32 v242, v4
    v_bfe_u32 v3, v0, 3, 1
    v_mfma_f32_16x16x32_bf16 a[188:191], v[204:207], v[188:191], a[188:191]
    ds_write_b128 v252, a[152:155] offset:18432
    v_mul_u32_u24 v3, 114688, v3
    v_and_b32 v6, 7, v0
    v_mfma_f32_16x16x32_bf16 a[184:187], v[204:207], v[184:187], a[184:187]
    v_lshl_add_u32 v3, v6, 4, v3
    v_lshrrev_b32 v2, 4, v0
    v_lshl_add_u32 v243, v2, 7, v3
    v_mfma_f32_16x16x32_bf16 a[180:183], v[204:207], v[180:183], a[180:183]
    ds_write_b128 v252, a[156:159] offset:19456
    v_lshrrev_b32 v3, 2, v0
    v_lshlrev_b32 v6, 7, v3
    v_mfma_f32_16x16x32_bf16 a[176:179], v[204:207], v[176:179], a[176:179]
    v_and_b32 v7, 3, v0
    v_lshl_add_u32 v6, v7, 3, v6
    v_bfe_u32 v3, v0, 3, 2
    v_mfma_f32_16x16x32_bf16 a[192:195], v[208:211], v[176:179], a[192:195]
    ds_write_b128 v252, a[168:171] offset:20480
    v_lshlrev_b32 v251, 7, v0
    s_mov_b32 s74, 0
    v_mfma_f32_16x16x32_bf16 a[196:199], v[208:211], v[180:183], a[196:199]
    s_mov_b32 s75, 229376
    s_lshl_b32 s32, s29, 7
    s_lshl_b32 s33, s31, 6
    v_mfma_f32_16x16x32_bf16 a[200:203], v[208:211], v[184:187], a[200:203]
    ds_write_b128 v252, a[172:175] offset:21504
    s_add_u32 s32, s32, s33
    s_lshl_b32 s33, s30, 5
    v_mfma_f32_16x16x32_bf16 a[204:207], v[208:211], v[188:191], a[204:207]
    s_add_u32 s32, s32, s33
    s_lshl_b32 s32, s32, 7
    s_lshl_b32 s33, s28, 2
    v_mfma_f32_16x16x32_bf16 a[220:223], v[212:215], v[188:191], a[220:223]
    ds_write_b128 v252, a[184:187] offset:22528
    s_add_u32 s32, s32, s33
    s_add_u32 s32, s32, 43253760
    v_mfma_f32_16x16x32_bf16 a[216:219], v[212:215], v[184:187], a[216:219]
    s_add_u32 s60, s56, s32
    s_addc_u32 s61, s57, 0
    s_mov_b32 s62, 4036
    v_mfma_f32_16x16x32_bf16 a[212:215], v[212:215], v[180:183], a[212:215]
    ds_write_b128 v252, a[188:191] offset:23552
    s_mov_b32 s63, 0x20000
    v_xor_b32 v7, 0, v3
    v_mfma_f32_16x16x32_bf16 a[208:211], v[212:215], v[176:179], a[208:211]
    v_lshl_add_u32 v232, v7, 5, v6
    v_xor_b32 v7, 1, v3
    v_lshl_add_u32 v233, v7, 5, v6
    s_waitcnt vmcnt(0) lgkmcnt(0)
    s_barrier
    v_mfma_f32_16x16x32_bf16 a[224:227], v[216:219], v[176:179], a[224:227]
    ds_write_b128 v255, a[200:203] offset:0
    v_xor_b32 v7, 2, v3
    v_lshl_add_u32 v234, v7, 5, v6
    v_mfma_f32_16x16x32_bf16 a[228:231], v[216:219], v[180:183], a[228:231]
    v_xor_b32 v7, 3, v3
    v_lshl_add_u32 v235, v7, 5, v6
    ds_read_b64 v[200:201], v250
    ds_read_b64 v[202:203], v250 offset:128
    v_mfma_f32_16x16x32_bf16 a[232:235], v[216:219], v[184:187], a[232:235]
    ds_write_b128 v255, a[204:207] offset:1024
    v_mfma_f32_16x16x32_bf16 a[236:239], v[216:219], v[188:191], a[236:239]
    v_mfma_f32_16x16x32_bf16 a[252:255], v[220:223], v[188:191], a[252:255]
    ds_write_b128 v255, a[216:219] offset:2048
    v_mfma_f32_16x16x32_bf16 a[248:251], v[220:223], v[184:187], a[248:251]
    v_mfma_f32_16x16x32_bf16 a[244:247], v[220:223], v[180:183], a[244:247]
    ds_write_b128 v255, a[220:223] offset:3072
    v_mfma_f32_16x16x32_bf16 a[240:243], v[220:223], v[176:179], a[240:243]
    s_waitcnt lgkmcnt(3)
    ds_read_b128 v[0:3], v248 offset:0
    ds_read_b128 v[4:7], v248 offset:1024
    ds_read_b128 v[8:11], v248 offset:2048
    ds_read_b128 v[12:15], v248 offset:3072
    ds_read_b128 v[16:19], v248 offset:4096
    ds_read_b128 v[20:23], v248 offset:5120
    ds_read_b128 v[24:27], v248 offset:6144
    ds_read_b128 v[28:31], v248 offset:7168
    ds_write_b128 v255, a[232:235] offset:4096
    ds_write_b128 v255, a[236:239] offset:5120
    ds_write_b128 v255, a[248:251] offset:6144
    ds_write_b128 v255, a[252:255] offset:7168
    v_min_f32 v236, v224, v201
    v_sub_f32 v204, v236, v224
    v_sub_f32 v206, v236, v201
    v_exp_f32 v204, v204
    v_exp_f32 v206, v206
    v_cmp_neq_f32 s[78:79], v224, v201
    v_mul_f32 v237, v244, v204
    v_fmac_f32 v237, v200, v206
    v_rcp_f32 v237, v237
    v_min_f32 v236, v228, v203
    v_sub_f32 v205, v236, v228
    v_sub_f32 v207, v236, v203
    v_exp_f32 v205, v205
    v_exp_f32 v207, v207
    v_cmp_neq_f32 s[58:59], v228, v203
    v_mul_f32 v238, v245, v205
    v_fmac_f32 v238, v202, v207
    v_rcp_f32 v238, v238
    s_mov_b64 exec, 0xffff
    buffer_store_dword v237, v251, s[60:63], 0 offen sc1
    buffer_store_dword v237, v251, s[60:63], 0 offen offset:64 sc1
    buffer_store_dword v238, v251, s[60:63], 0 offen offset:2048 sc1
    buffer_store_dword v238, v251, s[60:63], 0 offen offset:2112 sc1
    s_mov_b64 exec, -1
    s_or_b64 s[78:79], s[78:79], s[58:59]
    s_cmp_lg_u64 s[78:79], 0
    s_cbranch_scc1 K2_comb_general
    ds_read_b128 v[32:35], v248 offset:8192
    ds_read_b128 v[36:39], v248 offset:9216
    v_accvgpr_read_b32 v192, a0
    v_accvgpr_read_b32 v193, a1
    v_accvgpr_read_b32 v194, a2
    v_accvgpr_read_b32 v195, a3
    s_waitcnt lgkmcnt(13)
    v_add_f32 v0, v0, v192
    v_add_f32 v1, v1, v193
    v_add_f32 v2, v2, v194
    v_add_f32 v3, v3, v195
    v_cvt_pk_bf16_f32 v128, v0, v1
    v_cvt_pk_bf16_f32 v129, v2, v3
    ds_read_b128 v[40:43], v248 offset:10240
    ds_read_b128 v[44:47], v248 offset:11264
    v_accvgpr_read_b32 v192, a4
    v_accvgpr_read_b32 v193, a5
    v_accvgpr_read_b32 v194, a6
    v_accvgpr_read_b32 v195, a7
    s_waitcnt lgkmcnt(14)
    v_add_f32 v4, v4, v192
    v_add_f32 v5, v5, v193
    v_add_f32 v6, v6, v194
    v_add_f32 v7, v7, v195
    v_cvt_pk_bf16_f32 v160, v4, v5
    v_cvt_pk_bf16_f32 v161, v6, v7
    ds_read_b128 v[48:51], v248 offset:12288
    ds_read_b128 v[52:55], v248 offset:13312
    v_accvgpr_read_b32 v192, a16
    v_accvgpr_read_b32 v193, a17
    v_accvgpr_read_b32 v194, a18
    v_accvgpr_read_b32 v195, a19
    s_waitcnt lgkmcnt(15)
    v_add_f32 v8, v8, v192
    v_add_f32 v9, v9, v193
    v_add_f32 v10, v10, v194
    v_add_f32 v11, v11, v195
    v_cvt_pk_bf16_f32 v130, v8, v9
    v_cvt_pk_bf16_f32 v131, v10, v11
    ds_read_b128 v[56:59], v248 offset:14336
    ds_read_b128 v[60:63], v248 offset:15360
    v_accvgpr_read_b32 v192, a20
    v_accvgpr_read_b32 v193, a21
    v_accvgpr_read_b32 v194, a22
    v_accvgpr_read_b32 v195, a23
    s_waitcnt lgkmcnt(15)
    v_add_f32 v12, v12, v192
    v_add_f32 v13, v13, v193
    v_add_f32 v14, v14, v194
    v_add_f32 v15, v15, v195
    v_cvt_pk_bf16_f32 v162, v12, v13
    v_cvt_pk_bf16_f32 v163, v14, v15
    ds_read_b128 v[64:67], v248 offset:16384
    ds_read_b128 v[68:71], v248 offset:17408
    v_accvgpr_read_b32 v192, a32
    v_accvgpr_read_b32 v193, a33
    v_accvgpr_read_b32 v194, a34
    v_accvgpr_read_b32 v195, a35
    v_add_f32 v16, v16, v192
    v_add_f32 v17, v17, v193
    v_add_f32 v18, v18, v194
    v_add_f32 v19, v19, v195
    v_cvt_pk_bf16_f32 v132, v16, v17
    v_cvt_pk_bf16_f32 v133, v18, v19
    ds_read_b128 v[72:75], v248 offset:18432
    ds_read_b128 v[76:79], v248 offset:19456
    v_accvgpr_read_b32 v192, a36
    v_accvgpr_read_b32 v193, a37
    v_accvgpr_read_b32 v194, a38
    v_accvgpr_read_b32 v195, a39
    s_waitcnt lgkmcnt(15)
    v_add_f32 v20, v20, v192
    v_add_f32 v21, v21, v193
    v_add_f32 v22, v22, v194
    v_add_f32 v23, v23, v195
    v_cvt_pk_bf16_f32 v164, v20, v21
    v_cvt_pk_bf16_f32 v165, v22, v23
    ds_read_b128 v[80:83], v248 offset:20480
    ds_read_b128 v[84:87], v248 offset:21504
    v_accvgpr_read_b32 v192, a48
    v_accvgpr_read_b32 v193, a49
    v_accvgpr_read_b32 v194, a50
    v_accvgpr_read_b32 v195, a51
    v_add_f32 v24, v24, v192
    v_add_f32 v25, v25, v193
    v_add_f32 v26, v26, v194
    v_add_f32 v27, v27, v195
    v_cvt_pk_bf16_f32 v134, v24, v25
    v_cvt_pk_bf16_f32 v135, v26, v27
    ds_read_b128 v[88:91], v248 offset:22528
    ds_read_b128 v[92:95], v248 offset:23552
    v_accvgpr_read_b32 v192, a52
    v_accvgpr_read_b32 v193, a53
    v_accvgpr_read_b32 v194, a54
    v_accvgpr_read_b32 v195, a55
    v_add_f32 v28, v28, v192
    v_add_f32 v29, v29, v193
    v_add_f32 v30, v30, v194
    v_add_f32 v31, v31, v195
    v_cvt_pk_bf16_f32 v166, v28, v29
    v_cvt_pk_bf16_f32 v167, v30, v31
    v_accvgpr_read_b32 v192, a64
    v_accvgpr_read_b32 v193, a65
    v_accvgpr_read_b32 v194, a66
    v_accvgpr_read_b32 v195, a67
    s_waitcnt lgkmcnt(15)
    v_add_f32 v32, v32, v192
    v_add_f32 v33, v33, v193
    v_add_f32 v34, v34, v194
    v_add_f32 v35, v35, v195
    v_cvt_pk_bf16_f32 v136, v32, v33
    v_cvt_pk_bf16_f32 v137, v34, v35
    v_accvgpr_read_b32 v192, a68
    v_accvgpr_read_b32 v193, a69
    v_accvgpr_read_b32 v194, a70
    v_accvgpr_read_b32 v195, a71
    s_waitcnt lgkmcnt(14)
    v_add_f32 v36, v36, v192
    v_add_f32 v37, v37, v193
    v_add_f32 v38, v38, v194
    v_add_f32 v39, v39, v195
    v_cvt_pk_bf16_f32 v168, v36, v37
    v_cvt_pk_bf16_f32 v169, v38, v39
    s_waitcnt lgkmcnt(0)
    s_barrier
    ds_read_b128 v[96:99], v249 offset:0
    s_add_u32 m0, s70, 0
    s_mov_b32 s71, 0
    v_accvgpr_read_b32 v192, a80
    v_accvgpr_read_b32 v193, a81
    v_accvgpr_read_b32 v194, a82
    v_accvgpr_read_b32 v195, a83
    buffer_load_dwordx4 v242, s[4:7], s71 offen lds
    v_add_f32 v40, v40, v192
    v_add_f32 v41, v41, v193
    v_add_f32 v42, v42, v194
    v_add_f32 v43, v43, v195
    v_cvt_pk_bf16_f32 v138, v40, v41
    v_cvt_pk_bf16_f32 v139, v42, v43
    ds_read_b128 v[100:103], v249 offset:1024
    s_add_u32 m0, s70, 1024
    s_mov_b32 s71, 7168
    v_accvgpr_read_b32 v192, a84
    v_accvgpr_read_b32 v193, a85
    v_accvgpr_read_b32 v194, a86
    v_accvgpr_read_b32 v195, a87
    buffer_load_dwordx4 v242, s[4:7], s71 offen lds
    v_add_f32 v44, v44, v192
    v_add_f32 v45, v45, v193
    v_add_f32 v46, v46, v194
    v_add_f32 v47, v47, v195
    v_cvt_pk_bf16_f32 v170, v44, v45
    v_cvt_pk_bf16_f32 v171, v46, v47
    ds_read_b128 v[104:107], v249 offset:2048
    v_accvgpr_read_b32 v192, a96
    v_accvgpr_read_b32 v193, a97
    v_accvgpr_read_b32 v194, a98
    v_accvgpr_read_b32 v195, a99
    v_add_f32 v48, v48, v192
    v_add_f32 v49, v49, v193
    v_add_f32 v50, v50, v194
    v_add_f32 v51, v51, v195
    v_cvt_pk_bf16_f32 v140, v48, v49
    v_cvt_pk_bf16_f32 v141, v50, v51
    ds_read_b128 v[108:111], v249 offset:3072
    s_add_u32 m0, s70, 2048
    s_mov_b32 s71, 14336
    v_accvgpr_read_b32 v192, a100
    v_accvgpr_read_b32 v193, a101
    v_accvgpr_read_b32 v194, a102
    v_accvgpr_read_b32 v195, a103
    buffer_load_dwordx4 v242, s[4:7], s71 offen lds
    v_add_f32 v52, v52, v192
    v_add_f32 v53, v53, v193
    v_add_f32 v54, v54, v194
    v_add_f32 v55, v55, v195
    v_cvt_pk_bf16_f32 v172, v52, v53
    v_cvt_pk_bf16_f32 v173, v54, v55
    ds_read_b128 v[112:115], v249 offset:4096
    v_accvgpr_read_b32 v192, a112
    v_accvgpr_read_b32 v193, a113
    v_accvgpr_read_b32 v194, a114
    v_accvgpr_read_b32 v195, a115
    v_add_f32 v56, v56, v192
    v_add_f32 v57, v57, v193
    v_add_f32 v58, v58, v194
    v_add_f32 v59, v59, v195
    v_cvt_pk_bf16_f32 v142, v56, v57
    v_cvt_pk_bf16_f32 v143, v58, v59
    ds_read_b128 v[116:119], v249 offset:5120
    s_add_u32 m0, s70, 3072
    s_mov_b32 s71, 21504
    v_accvgpr_read_b32 v192, a116
    v_accvgpr_read_b32 v193, a117
    v_accvgpr_read_b32 v194, a118
    v_accvgpr_read_b32 v195, a119
    buffer_load_dwordx4 v242, s[4:7], s71 offen lds
    v_add_f32 v60, v60, v192
    v_add_f32 v61, v61, v193
    v_add_f32 v62, v62, v194
    v_add_f32 v63, v63, v195
    v_cvt_pk_bf16_f32 v174, v60, v61
    v_cvt_pk_bf16_f32 v175, v62, v63
    ds_read_b128 v[120:123], v249 offset:6144
    v_accvgpr_read_b32 v192, a128
    v_accvgpr_read_b32 v193, a129
    v_accvgpr_read_b32 v194, a130
    v_accvgpr_read_b32 v195, a131
    v_add_f32 v64, v64, v192
    v_add_f32 v65, v65, v193
    v_add_f32 v66, v66, v194
    v_add_f32 v67, v67, v195
    v_cvt_pk_bf16_f32 v144, v64, v65
    v_cvt_pk_bf16_f32 v145, v66, v67
    ds_read_b128 v[124:127], v249 offset:7168
    s_add_u32 m0, s70, 4096
    s_mov_b32 s71, 28672
    v_accvgpr_read_b32 v192, a132
    v_accvgpr_read_b32 v193, a133
    v_accvgpr_read_b32 v194, a134
    v_accvgpr_read_b32 v195, a135
    buffer_load_dwordx4 v242, s[4:7], s71 offen lds
    v_add_f32 v68, v68, v192
    v_add_f32 v69, v69, v193
    v_add_f32 v70, v70, v194
    v_add_f32 v71, v71, v195
    v_cvt_pk_bf16_f32 v176, v68, v69
    v_cvt_pk_bf16_f32 v177, v70, v71
    v_accvgpr_read_b32 v192, a144
    v_accvgpr_read_b32 v193, a145
    v_accvgpr_read_b32 v194, a146
    v_accvgpr_read_b32 v195, a147
    v_add_f32 v72, v72, v192
    v_add_f32 v73, v73, v193
    v_add_f32 v74, v74, v194
    v_add_f32 v75, v75, v195
    v_cvt_pk_bf16_f32 v146, v72, v73
    v_cvt_pk_bf16_f32 v147, v74, v75
    s_add_u32 m0, s70, 5120
    s_mov_b32 s71, 35840
    v_accvgpr_read_b32 v192, a148
    v_accvgpr_read_b32 v193, a149
    v_accvgpr_read_b32 v194, a150
    v_accvgpr_read_b32 v195, a151
    buffer_load_dwordx4 v242, s[4:7], s71 offen lds
    v_add_f32 v76, v76, v192
    v_add_f32 v77, v77, v193
    v_add_f32 v78, v78, v194
    v_add_f32 v79, v79, v195
    v_cvt_pk_bf16_f32 v178, v76, v77
    v_cvt_pk_bf16_f32 v179, v78, v79
    v_accvgpr_read_b32 v192, a160
    v_accvgpr_read_b32 v193, a161
    v_accvgpr_read_b32 v194, a162
    v_accvgpr_read_b32 v195, a163
    v_add_f32 v80, v80, v192
    v_add_f32 v81, v81, v193
    v_add_f32 v82, v82, v194
    v_add_f32 v83, v83, v195
    v_cvt_pk_bf16_f32 v148, v80, v81
    v_cvt_pk_bf16_f32 v149, v82, v83
    s_add_u32 m0, s70, 6144
    s_mov_b32 s71, 43008
    v_accvgpr_read_b32 v192, a164
    v_accvgpr_read_b32 v193, a165
    v_accvgpr_read_b32 v194, a166
    v_accvgpr_read_b32 v195, a167
    buffer_load_dwordx4 v242, s[4:7], s71 offen lds
    v_add_f32 v84, v84, v192
    v_add_f32 v85, v85, v193
    v_add_f32 v86, v86, v194
    v_add_f32 v87, v87, v195
    v_cvt_pk_bf16_f32 v180, v84, v85
    v_cvt_pk_bf16_f32 v181, v86, v87
    s_add_u32 m0, s70, 7168
    s_mov_b32 s71, 50176
    v_accvgpr_read_b32 v192, a176
    v_accvgpr_read_b32 v193, a177
    v_accvgpr_read_b32 v194, a178
    v_accvgpr_read_b32 v195, a179
    buffer_load_dwordx4 v242, s[4:7], s71 offen lds
    v_add_f32 v88, v88, v192
    v_add_f32 v89, v89, v193
    v_add_f32 v90, v90, v194
    v_add_f32 v91, v91, v195
    v_cvt_pk_bf16_f32 v150, v88, v89
    v_cvt_pk_bf16_f32 v151, v90, v91
    v_accvgpr_read_b32 v192, a180
    v_accvgpr_read_b32 v193, a181
    v_accvgpr_read_b32 v194, a182
    v_accvgpr_read_b32 v195, a183
    v_add_f32 v92, v92, v192
    v_add_f32 v93, v93, v193
    v_add_f32 v94, v94, v194
    v_add_f32 v95, v95, v195
    v_cvt_pk_bf16_f32 v182, v92, v93
    v_cvt_pk_bf16_f32 v183, v94, v95
    s_add_u32 m0, s70, 32768
    s_mov_b32 s71, 128
    v_accvgpr_read_b32 v192, a192
    v_accvgpr_read_b32 v193, a193
    v_accvgpr_read_b32 v194, a194
    v_accvgpr_read_b32 v195, a195
    buffer_load_dwordx4 v242, s[4:7], s71 offen lds
    s_waitcnt lgkmcnt(7)
    v_add_f32 v96, v96, v192
    v_add_f32 v97, v97, v193
    v_add_f32 v98, v98, v194
    v_add_f32 v99, v99, v195
    v_cvt_pk_bf16_f32 v152, v96, v97
    v_cvt_pk_bf16_f32 v153, v98, v99
    v_accvgpr_read_b32 v192, a196
    v_accvgpr_read_b32 v193, a197
    v_accvgpr_read_b32 v194, a198
    v_accvgpr_read_b32 v195, a199
    s_waitcnt lgkmcnt(6)
    v_add_f32 v100, v100, v192
    v_add_f32 v101, v101, v193
    v_add_f32 v102, v102, v194
    v_add_f32 v103, v103, v195
    v_cvt_pk_bf16_f32 v184, v100, v101
    v_cvt_pk_bf16_f32 v185, v102, v103
    s_add_u32 m0, s70, 33792
    s_mov_b32 s71, 7296
    v_accvgpr_read_b32 v192, a208
    v_accvgpr_read_b32 v193, a209
    v_accvgpr_read_b32 v194, a210
    v_accvgpr_read_b32 v195, a211
    buffer_load_dwordx4 v242, s[4:7], s71 offen lds
    s_waitcnt lgkmcnt(5)
    v_add_f32 v104, v104, v192
    v_add_f32 v105, v105, v193
    v_add_f32 v106, v106, v194
    v_add_f32 v107, v107, v195
    v_cvt_pk_bf16_f32 v154, v104, v105
    v_cvt_pk_bf16_f32 v155, v106, v107
    v_accvgpr_read_b32 v192, a212
    v_accvgpr_read_b32 v193, a213
    v_accvgpr_read_b32 v194, a214
    v_accvgpr_read_b32 v195, a215
    s_waitcnt lgkmcnt(4)
    v_add_f32 v108, v108, v192
    v_add_f32 v109, v109, v193
    v_add_f32 v110, v110, v194
    v_add_f32 v111, v111, v195
    v_cvt_pk_bf16_f32 v186, v108, v109
    v_cvt_pk_bf16_f32 v187, v110, v111
    s_add_u32 m0, s70, 34816
    s_mov_b32 s71, 14464
    v_accvgpr_read_b32 v192, a224
    v_accvgpr_read_b32 v193, a225
    v_accvgpr_read_b32 v194, a226
    v_accvgpr_read_b32 v195, a227
    buffer_load_dwordx4 v242, s[4:7], s71 offen lds
    s_waitcnt lgkmcnt(3)
    v_add_f32 v112, v112, v192
    v_add_f32 v113, v113, v193
    v_add_f32 v114, v114, v194
    v_add_f32 v115, v115, v195
    v_cvt_pk_bf16_f32 v156, v112, v113
    v_cvt_pk_bf16_f32 v157, v114, v115
    v_accvgpr_read_b32 v192, a228
    v_accvgpr_read_b32 v193, a229
    v_accvgpr_read_b32 v194, a230
    v_accvgpr_read_b32 v195, a231
    s_waitcnt lgkmcnt(2)
    v_add_f32 v116, v116, v192
    v_add_f32 v117, v117, v193
    v_add_f32 v118, v118, v194
    v_add_f32 v119, v119, v195
    v_cvt_pk_bf16_f32 v188, v116, v117
    v_cvt_pk_bf16_f32 v189, v118, v119
    s_add_u32 m0, s70, 35840
    s_mov_b32 s71, 21632
    v_accvgpr_read_b32 v192, a240
    v_accvgpr_read_b32 v193, a241
    v_accvgpr_read_b32 v194, a242
    v_accvgpr_read_b32 v195, a243
    buffer_load_dwordx4 v242, s[4:7], s71 offen lds
    s_waitcnt lgkmcnt(1)
    v_add_f32 v120, v120, v192
    v_add_f32 v121, v121, v193
    v_add_f32 v122, v122, v194
    v_add_f32 v123, v123, v195
    v_cvt_pk_bf16_f32 v158, v120, v121
    v_cvt_pk_bf16_f32 v159, v122, v123
    v_accvgpr_read_b32 v192, a244
    v_accvgpr_read_b32 v193, a245
    v_accvgpr_read_b32 v194, a246
    v_accvgpr_read_b32 v195, a247
    s_waitcnt lgkmcnt(0)
    v_add_f32 v124, v124, v192
    v_add_f32 v125, v125, v193
    v_add_f32 v126, v126, v194
    v_add_f32 v127, v127, v195
    v_cvt_pk_bf16_f32 v190, v124, v125
    v_cvt_pk_bf16_f32 v191, v126, v127
K2_comb_done:
    s_waitcnt vmcnt(4)
    s_barrier
    ds_read_b64_tr_b16 v[192:193], v232 offset:0
    ds_read_b64_tr_b16 v[194:195], v232 offset:2048
    ds_read_b64_tr_b16 v[196:197], v233 offset:0
    ds_read_b64_tr_b16 v[198:199], v233 offset:2048
    ds_read_b64_tr_b16 v[200:201], v232 offset:4096
    ds_read_b64_tr_b16 v[202:203], v232 offset:6144
    ds_read_b64_tr_b16 v[204:205], v233 offset:4096
    ds_read_b64_tr_b16 v[206:207], v233 offset:6144
    ds_read_b64_tr_b16 v[208:209], v232 offset:8192
    ds_read_b64_tr_b16 v[210:211], v232 offset:10240
    ds_read_b64_tr_b16 v[212:213], v233 offset:8192
    ds_read_b64_tr_b16 v[214:215], v233 offset:10240
    s_waitcnt lgkmcnt(10)
    v_mfma_f32_16x16x32_bf16 v[0:3], v[192:195], v[128:131], 0
    ds_read_b64_tr_b16 v[216:217], v232 offset:12288
    v_mfma_f32_16x16x32_bf16 v[4:7], v[192:195], v[160:163], 0
    s_waitcnt lgkmcnt(9)
    ds_read_b64_tr_b16 v[218:219], v232 offset:14336
    v_mfma_f32_16x16x32_bf16 v[12:15], v[196:199], v[160:163], 0
    s_waitcnt lgkmcnt(8)
    ds_read_b64_tr_b16 v[220:221], v233 offset:12288
    v_mbcnt_lo_u32_b32 v240, -1, 0
    v_mfma_f32_16x16x32_bf16 v[8:11], v[196:199], v[128:131], 0
    s_mov_b32 s71, 28800
    ds_read_b64_tr_b16 v[222:223], v233 offset:14336
    v_mbcnt_hi_u32_b32 v240, -1, v240
    v_mfma_f32_16x16x32_bf16 v[0:3], v[200:203], v[132:135], v[0:3]
    s_add_u32 m0, s70, 36864
    ds_read_b64_tr_b16 v[192:193], v232 offset:16384
    v_lshlrev_b32 v240, 4, v240
    v_mfma_f32_16x16x32_bf16 v[4:7], v[200:203], v[164:167], v[4:7]
    s_waitcnt lgkmcnt(9)
    ds_read_b64_tr_b16 v[194:195], v232 offset:18432
    buffer_load_dwordx4 v242, s[4:7], s71 offen lds
    v_mfma_f32_16x16x32_bf16 v[12:15], v[204:207], v[164:167], v[12:15]
    s_add_u32 m0, s70, 37888
    ds_read_b64_tr_b16 v[196:197], v233 offset:16384
    s_mov_b32 s71, 35968
    v_mfma_f32_16x16x32_bf16 v[8:11], v[204:207], v[132:135], v[8:11]
    s_waitcnt lgkmcnt(6)
    ds_read_b64_tr_b16 v[198:199], v233 offset:18432
    buffer_load_dwordx4 v242, s[4:7], s71 offen lds
    v_mfma_f32_16x16x32_bf16 v[0:3], v[208:211], v[136:139], v[0:3]
    s_add_u32 m0, s70, 38912
    ds_read_b64_tr_b16 v[200:201], v232 offset:20480
    s_mov_b32 s71, 43136
    v_mfma_f32_16x16x32_bf16 v[4:7], v[208:211], v[168:171], v[4:7]
    ds_read_b64_tr_b16 v[202:203], v232 offset:22528
    buffer_load_dwordx4 v242, s[4:7], s71 offen lds
    v_mfma_f32_16x16x32_bf16 v[12:15], v[212:215], v[168:171], v[12:15]
    s_waitcnt lgkmcnt(6)
    ds_read_b64_tr_b16 v[204:205], v233 offset:20480
    v_mfma_f32_16x16x32_bf16 v[8:11], v[212:215], v[136:139], v[8:11]
    s_mov_b32 s71, 50304
    ds_read_b64_tr_b16 v[206:207], v233 offset:22528
    v_mfma_f32_16x16x32_bf16 v[0:3], v[216:219], v[140:143], v[0:3]
    s_add_u32 m0, s70, 39936
    ds_read_b64_tr_b16 v[208:209], v232 offset:24576
    v_mfma_f32_16x16x32_bf16 v[4:7], v[216:219], v[172:175], v[4:7]
    ds_read_b64_tr_b16 v[210:211], v232 offset:26624
    buffer_load_dwordx4 v242, s[4:7], s71 offen lds
    v_mfma_f32_16x16x32_bf16 v[12:15], v[220:223], v[172:175], v[12:15]
    s_waitcnt lgkmcnt(6)
    ds_read_b64_tr_b16 v[212:213], v233 offset:24576
    v_mfma_f32_16x16x32_bf16 v[8:11], v[220:223], v[140:143], v[8:11]
    s_mov_b32 s71, 256
    ds_read_b64_tr_b16 v[214:215], v233 offset:26624
    v_mfma_f32_16x16x32_bf16 v[0:3], v[192:195], v[144:147], v[0:3]
    s_add_u32 m0, s70, 65536
    ds_read_b64_tr_b16 v[216:217], v232 offset:28672
    v_mfma_f32_16x16x32_bf16 v[4:7], v[192:195], v[176:179], v[4:7]
    ds_read_b64_tr_b16 v[218:219], v232 offset:30720
    buffer_load_dwordx4 v242, s[4:7], s71 offen lds
    v_mfma_f32_16x16x32_bf16 v[12:15], v[196:199], v[176:179], v[12:15]
    s_waitcnt lgkmcnt(6)
    ds_read_b64_tr_b16 v[220:221], v233 offset:28672
    v_mfma_f32_16x16x32_bf16 v[8:11], v[196:199], v[144:147], v[8:11]
    s_mov_b32 s71, 7424
    ds_read_b64_tr_b16 v[222:223], v233 offset:30720
    v_mfma_f32_16x16x32_bf16 v[0:3], v[200:203], v[148:151], v[0:3]
    s_add_u32 m0, s70, 66560
    ds_read_b64_tr_b16 v[192:193], v234 offset:0
    v_mfma_f32_16x16x32_bf16 v[4:7], v[200:203], v[180:183], v[4:7]
    ds_read_b64_tr_b16 v[194:195], v234 offset:2048
    buffer_load_dwordx4 v242, s[4:7], s71 offen lds
    v_mfma_f32_16x16x32_bf16 v[12:15], v[204:207], v[180:183], v[12:15]
    ds_read_b64_tr_b16 v[196:197], v235 offset:0
    v_mfma_f32_16x16x32_bf16 v[8:11], v[204:207], v[148:151], v[8:11]
    s_waitcnt lgkmcnt(6)
    ds_read_b64_tr_b16 v[198:199], v235 offset:2048
    v_mfma_f32_16x16x32_bf16 v[0:3], v[208:211], v[152:155], v[0:3]
    s_mov_b32 s71, 14592
    ds_read_b64_tr_b16 v[200:201], v234 offset:4096
    v_add_u32 v232, 32768, v232
    v_mfma_f32_16x16x32_bf16 v[4:7], v[208:211], v[184:187], v[4:7]
    s_add_u32 m0, s70, 67584
    ds_read_b64_tr_b16 v[202:203], v234 offset:6144
    v_add_u32 v233, 32768, v233
    v_mfma_f32_16x16x32_bf16 v[12:15], v[212:215], v[184:187], v[12:15]
    s_waitcnt lgkmcnt(6)
    ds_read_b64_tr_b16 v[204:205], v235 offset:4096
    buffer_load_dwordx4 v242, s[4:7], s71 offen lds
    v_mfma_f32_16x16x32_bf16 v[8:11], v[212:215], v[152:155], v[8:11]
    s_mov_b32 s71, 21760
    ds_read_b64_tr_b16 v[206:207], v235 offset:6144
    v_mfma_f32_16x16x32_bf16 v[0:3], v[216:219], v[156:159], v[0:3]
    s_add_u32 m0, s70, 68608
    ds_read_b64_tr_b16 v[208:209], v234 offset:8192
    v_mfma_f32_16x16x32_bf16 v[4:7], v[216:219], v[188:191], v[4:7]
    ds_read_b64_tr_b16 v[210:211], v234 offset:10240
    buffer_load_dwordx4 v242, s[4:7], s71 offen lds
    v_mfma_f32_16x16x32_bf16 v[12:15], v[220:223], v[188:191], v[12:15]
    s_waitcnt lgkmcnt(6)
    ds_read_b64_tr_b16 v[212:213], v235 offset:8192
    v_mfma_f32_16x16x32_bf16 v[8:11], v[220:223], v[156:159], v[8:11]
    s_mov_b32 s71, 28928
    ds_read_b64_tr_b16 v[214:215], v235 offset:10240
    v_mfma_f32_16x16x32_bf16 v[16:19], v[192:195], v[128:131], 0
    s_add_u32 m0, s70, 69632
    ds_read_b64_tr_b16 v[216:217], v234 offset:12288
    v_mfma_f32_16x16x32_bf16 v[20:23], v[192:195], v[160:163], 0
    ds_read_b64_tr_b16 v[218:219], v234 offset:14336
    buffer_load_dwordx4 v242, s[4:7], s71 offen lds
    v_mfma_f32_16x16x32_bf16 v[28:31], v[196:199], v[160:163], 0
    ds_read_b64_tr_b16 v[220:221], v235 offset:12288
    v_mfma_f32_16x16x32_bf16 v[24:27], v[196:199], v[128:131], 0
    s_waitcnt lgkmcnt(6)
    ds_read_b64_tr_b16 v[222:223], v235 offset:14336
    v_mfma_f32_16x16x32_bf16 v[16:19], v[200:203], v[132:135], v[16:19]
    ds_read_b64_tr_b16 v[192:193], v234 offset:16384
    v_cvt_pk_bf16_f32 v64, v0, v1
    v_mfma_f32_16x16x32_bf16 v[20:23], v[200:203], v[164:167], v[20:23]
    ds_read_b64_tr_b16 v[194:195], v234 offset:18432
    v_cvt_pk_bf16_f32 v65, v2, v3
    v_mfma_f32_16x16x32_bf16 v[28:31], v[204:207], v[164:167], v[28:31]
    ds_read_b64_tr_b16 v[196:197], v235 offset:16384
    v_cvt_pk_bf16_f32 v66, v8, v9
    v_mfma_f32_16x16x32_bf16 v[24:27], v[204:207], v[132:135], v[24:27]
    s_waitcnt lgkmcnt(6)
    ds_read_b64_tr_b16 v[198:199], v235 offset:18432
    v_cvt_pk_bf16_f32 v67, v10, v11
    v_mfma_f32_16x16x32_bf16 v[16:19], v[208:211], v[136:139], v[16:19]
    ds_read_b64_tr_b16 v[200:201], v234 offset:20480
    buffer_store_dwordx4 v[64:67], v243, s[40:43], s74 offen offset:0 sc1
    v_mfma_f32_16x16x32_bf16 v[20:23], v[208:211], v[168:171], v[20:23]
    ds_read_b64_tr_b16 v[202:203], v234 offset:22528
    v_cvt_pk_bf16_f32 v68, v4, v5
    v_mfma_f32_16x16x32_bf16 v[28:31], v[212:215], v[168:171], v[28:31]
    ds_read_b64_tr_b16 v[204:205], v235 offset:20480
    v_cvt_pk_bf16_f32 v69, v6, v7
    v_mfma_f32_16x16x32_bf16 v[24:27], v[212:215], v[136:139], v[24:27]
    s_waitcnt lgkmcnt(6)
    ds_read_b64_tr_b16 v[206:207], v235 offset:22528
    v_cvt_pk_bf16_f32 v70, v12, v13
    v_mfma_f32_16x16x32_bf16 v[16:19], v[216:219], v[140:143], v[16:19]
    s_mov_b32 s71, 36096
    ds_read_b64_tr_b16 v[208:209], v234 offset:24576
    v_cvt_pk_bf16_f32 v71, v14, v15
    v_mfma_f32_16x16x32_bf16 v[20:23], v[216:219], v[172:175], v[20:23]
    s_add_u32 m0, s70, 70656
    ds_read_b64_tr_b16 v[210:211], v234 offset:26624
    buffer_store_dwordx4 v[68:71], v243, s[40:43], s75 offen offset:0 sc1
    v_mfma_f32_16x16x32_bf16 v[28:31], v[220:223], v[172:175], v[28:31]
    s_waitcnt lgkmcnt(6)
    ds_read_b64_tr_b16 v[212:213], v235 offset:24576
    buffer_load_dwordx4 v242, s[4:7], s71 offen lds
    v_mfma_f32_16x16x32_bf16 v[24:27], v[220:223], v[140:143], v[24:27]
    s_add_u32 m0, s70, 71680
    ds_read_b64_tr_b16 v[214:215], v235 offset:26624
    s_mov_b32 s71, 43264
    v_mfma_f32_16x16x32_bf16 v[16:19], v[192:195], v[144:147], v[16:19]
    ds_read_b64_tr_b16 v[216:217], v234 offset:28672
    buffer_load_dwordx4 v242, s[4:7], s71 offen lds
    v_mfma_f32_16x16x32_bf16 v[20:23], v[192:195], v[176:179], v[20:23]
    s_add_u32 m0, s70, 72704
    ds_read_b64_tr_b16 v[218:219], v234 offset:30720
    s_mov_b32 s71, 50432
    v_mfma_f32_16x16x32_bf16 v[28:31], v[196:199], v[176:179], v[28:31]
    ds_read_b64_tr_b16 v[220:221], v235 offset:28672
    buffer_load_dwordx4 v242, s[4:7], s71 offen lds
    v_mfma_f32_16x16x32_bf16 v[24:27], v[196:199], v[144:147], v[24:27]
    s_waitcnt lgkmcnt(6)
    ds_read_b64_tr_b16 v[222:223], v235 offset:30720
    v_mfma_f32_16x16x32_bf16 v[16:19], v[200:203], v[148:151], v[16:19]
    s_waitcnt vmcnt(10)
    s_barrier
    ds_read_b64_tr_b16 v[192:193], v232 offset:0
    v_mfma_f32_16x16x32_bf16 v[20:23], v[200:203], v[180:183], v[20:23]
    s_mov_b32 s71, 384
    ds_read_b64_tr_b16 v[194:195], v232 offset:2048
    v_add_u32 v234, 32768, v234
    v_mfma_f32_16x16x32_bf16 v[28:31], v[204:207], v[180:183], v[28:31]
    s_add_u32 m0, s70, 98304
    ds_read_b64_tr_b16 v[196:197], v233 offset:0
    v_add_u32 v235, 32768, v235
    v_mfma_f32_16x16x32_bf16 v[24:27], v[204:207], v[148:151], v[24:27]
    s_waitcnt lgkmcnt(6)
    ds_read_b64_tr_b16 v[198:199], v233 offset:2048
    buffer_load_dwordx4 v242, s[4:7], s71 offen lds
    v_mfma_f32_16x16x32_bf16 v[16:19], v[208:211], v[152:155], v[16:19]
    s_add_u32 m0, s70, 99328
    ds_read_b64_tr_b16 v[200:201], v232 offset:4096
    s_mov_b32 s71, 7552
    v_mfma_f32_16x16x32_bf16 v[20:23], v[208:211], v[184:187], v[20:23]
    ds_read_b64_tr_b16 v[202:203], v232 offset:6144
    buffer_load_dwordx4 v242, s[4:7], s71 offen lds
    v_mfma_f32_16x16x32_bf16 v[28:31], v[212:215], v[184:187], v[28:31]
    s_add_u32 m0, s70, 100352
    ds_read_b64_tr_b16 v[204:205], v233 offset:4096
    s_mov_b32 s71, 14720
    v_mfma_f32_16x16x32_bf16 v[24:27], v[212:215], v[152:155], v[24:27]
    s_waitcnt lgkmcnt(6)
    ds_read_b64_tr_b16 v[206:207], v233 offset:6144
    buffer_load_dwordx4 v242, s[4:7], s71 offen lds
    v_mfma_f32_16x16x32_bf16 v[16:19], v[216:219], v[156:159], v[16:19]
    s_add_u32 m0, s70, 101376
    ds_read_b64_tr_b16 v[208:209], v232 offset:8192
    s_mov_b32 s71, 21888
    v_mfma_f32_16x16x32_bf16 v[20:23], v[216:219], v[188:191], v[20:23]
    ds_read_b64_tr_b16 v[210:211], v232 offset:10240
    buffer_load_dwordx4 v242, s[4:7], s71 offen lds
    v_mfma_f32_16x16x32_bf16 v[28:31], v[220:223], v[188:191], v[28:31]
    s_waitcnt lgkmcnt(6)
    ds_read_b64_tr_b16 v[212:213], v233 offset:8192
    v_mfma_f32_16x16x32_bf16 v[24:27], v[220:223], v[156:159], v[24:27]
    s_mov_b32 s71, 29056
    ds_read_b64_tr_b16 v[214:215], v233 offset:10240
    v_mfma_f32_16x16x32_bf16 v[0:3], v[192:195], v[128:131], 0
    s_add_u32 m0, s70, 102400
    ds_read_b64_tr_b16 v[216:217], v232 offset:12288
    v_mfma_f32_16x16x32_bf16 v[4:7], v[192:195], v[160:163], 0
    ds_read_b64_tr_b16 v[218:219], v232 offset:14336
    buffer_load_dwordx4 v242, s[4:7], s71 offen lds
    v_mfma_f32_16x16x32_bf16 v[12:15], v[196:199], v[160:163], 0
    ds_read_b64_tr_b16 v[220:221], v233 offset:12288
    v_mfma_f32_16x16x32_bf16 v[8:11], v[196:199], v[128:131], 0
    s_waitcnt lgkmcnt(6)
    ds_read_b64_tr_b16 v[222:223], v233 offset:14336
    v_mfma_f32_16x16x32_bf16 v[0:3], v[200:203], v[132:135], v[0:3]
    ds_read_b64_tr_b16 v[192:193], v232 offset:16384
    v_cvt_pk_bf16_f32 v72, v16, v17
    v_mfma_f32_16x16x32_bf16 v[4:7], v[200:203], v[164:167], v[4:7]
    ds_read_b64_tr_b16 v[194:195], v232 offset:18432
    v_cvt_pk_bf16_f32 v73, v18, v19
    v_mfma_f32_16x16x32_bf16 v[12:15], v[204:207], v[164:167], v[12:15]
    ds_read_b64_tr_b16 v[196:197], v233 offset:16384
    v_cvt_pk_bf16_f32 v74, v24, v25
    v_mfma_f32_16x16x32_bf16 v[8:11], v[204:207], v[132:135], v[8:11]
    s_waitcnt lgkmcnt(6)
    ds_read_b64_tr_b16 v[198:199], v233 offset:18432
    v_cvt_pk_bf16_f32 v75, v26, v27
    v_mfma_f32_16x16x32_bf16 v[0:3], v[208:211], v[136:139], v[0:3]
    ds_read_b64_tr_b16 v[200:201], v232 offset:20480
    buffer_store_dwordx4 v[72:75], v243, s[40:43], s74 offen offset:512 sc1
    s_add_u32 s74, s74, 1024
    v_mfma_f32_16x16x32_bf16 v[4:7], v[208:211], v[168:171], v[4:7]
    ds_read_b64_tr_b16 v[202:203], v232 offset:22528
    v_cvt_pk_bf16_f32 v76, v20, v21
    v_mfma_f32_16x16x32_bf16 v[12:15], v[212:215], v[168:171], v[12:15]
    ds_read_b64_tr_b16 v[204:205], v233 offset:20480
    v_cvt_pk_bf16_f32 v77, v22, v23
    v_mfma_f32_16x16x32_bf16 v[8:11], v[212:215], v[136:139], v[8:11]
    s_waitcnt lgkmcnt(6)
    ds_read_b64_tr_b16 v[206:207], v233 offset:22528
    v_cvt_pk_bf16_f32 v78, v28, v29
    v_mfma_f32_16x16x32_bf16 v[0:3], v[216:219], v[140:143], v[0:3]
    s_mov_b32 s71, 36224
    ds_read_b64_tr_b16 v[208:209], v232 offset:24576
    v_cvt_pk_bf16_f32 v79, v30, v31
    v_mfma_f32_16x16x32_bf16 v[4:7], v[216:219], v[172:175], v[4:7]
    s_add_u32 m0, s70, 103424
    ds_read_b64_tr_b16 v[210:211], v232 offset:26624
    buffer_store_dwordx4 v[76:79], v243, s[40:43], s75 offen offset:512 sc1
    s_add_u32 s75, s75, 1024
    v_mfma_f32_16x16x32_bf16 v[12:15], v[220:223], v[172:175], v[12:15]
    s_waitcnt lgkmcnt(6)
    ds_read_b64_tr_b16 v[212:213], v233 offset:24576
    buffer_load_dwordx4 v242, s[4:7], s71 offen lds
    v_mfma_f32_16x16x32_bf16 v[8:11], v[220:223], v[140:143], v[8:11]
    s_add_u32 m0, s70, 104448
    ds_read_b64_tr_b16 v[214:215], v233 offset:26624
    s_mov_b32 s71, 43392
    v_mfma_f32_16x16x32_bf16 v[0:3], v[192:195], v[144:147], v[0:3]
    ds_read_b64_tr_b16 v[216:217], v232 offset:28672
    buffer_load_dwordx4 v242, s[4:7], s71 offen lds
    v_mfma_f32_16x16x32_bf16 v[4:7], v[192:195], v[176:179], v[4:7]
    s_add_u32 m0, s70, 105472
    ds_read_b64_tr_b16 v[218:219], v232 offset:30720
    s_mov_b32 s71, 50560
    v_mfma_f32_16x16x32_bf16 v[12:15], v[196:199], v[176:179], v[12:15]
    s_waitcnt lgkmcnt(6)
    ds_read_b64_tr_b16 v[220:221], v233 offset:28672
    buffer_load_dwordx4 v242, s[4:7], s71 offen lds
    v_mfma_f32_16x16x32_bf16 v[8:11], v[196:199], v[144:147], v[8:11]
    s_add_u32 m0, s70, 131072
    ds_read_b64_tr_b16 v[222:223], v233 offset:30720
    s_mov_b32 s71, 512
    v_mfma_f32_16x16x32_bf16 v[0:3], v[200:203], v[148:151], v[0:3]
    ds_read_b64_tr_b16 v[192:193], v234 offset:0
    buffer_load_dwordx4 v242, s[4:7], s71 offen lds
    v_mfma_f32_16x16x32_bf16 v[4:7], v[200:203], v[180:183], v[4:7]
    s_add_u32 m0, s70, 132096
    ds_read_b64_tr_b16 v[194:195], v234 offset:2048
    s_mov_b32 s71, 7680
    v_mfma_f32_16x16x32_bf16 v[12:15], v[204:207], v[180:183], v[12:15]
    ds_read_b64_tr_b16 v[196:197], v235 offset:0
    buffer_load_dwordx4 v242, s[4:7], s71 offen lds
    v_mfma_f32_16x16x32_bf16 v[8:11], v[204:207], v[148:151], v[8:11]
    s_waitcnt lgkmcnt(6)
    ds_read_b64_tr_b16 v[198:199], v235 offset:2048
    v_mfma_f32_16x16x32_bf16 v[0:3], v[208:211], v[152:155], v[0:3]
    s_mov_b32 s71, 14848
    ds_read_b64_tr_b16 v[200:201], v234 offset:4096
    v_add_u32 v232, 32768, v232
    v_mfma_f32_16x16x32_bf16 v[4:7], v[208:211], v[184:187], v[4:7]
    s_add_u32 m0, s70, 133120
    ds_read_b64_tr_b16 v[202:203], v234 offset:6144
    v_add_u32 v233, 32768, v233
    v_mfma_f32_16x16x32_bf16 v[12:15], v[212:215], v[184:187], v[12:15]
    s_waitcnt lgkmcnt(6)
    ds_read_b64_tr_b16 v[204:205], v235 offset:4096
    buffer_load_dwordx4 v242, s[4:7], s71 offen lds
    v_mfma_f32_16x16x32_bf16 v[8:11], v[212:215], v[152:155], v[8:11]
    s_mov_b32 s71, 22016
    ds_read_b64_tr_b16 v[206:207], v235 offset:6144
    v_mfma_f32_16x16x32_bf16 v[0:3], v[216:219], v[156:159], v[0:3]
    s_add_u32 m0, s70, 134144
    ds_read_b64_tr_b16 v[208:209], v234 offset:8192
    v_mfma_f32_16x16x32_bf16 v[4:7], v[216:219], v[188:191], v[4:7]
    ds_read_b64_tr_b16 v[210:211], v234 offset:10240
    buffer_load_dwordx4 v242, s[4:7], s71 offen lds
    v_mfma_f32_16x16x32_bf16 v[12:15], v[220:223], v[188:191], v[12:15]
    s_waitcnt lgkmcnt(6)
    ds_read_b64_tr_b16 v[212:213], v235 offset:8192
    v_mfma_f32_16x16x32_bf16 v[8:11], v[220:223], v[156:159], v[8:11]
    s_mov_b32 s71, 29184
    ds_read_b64_tr_b16 v[214:215], v235 offset:10240
    v_mfma_f32_16x16x32_bf16 v[16:19], v[192:195], v[128:131], 0
    s_add_u32 m0, s70, 135168
    ds_read_b64_tr_b16 v[216:217], v234 offset:12288
    v_mfma_f32_16x16x32_bf16 v[20:23], v[192:195], v[160:163], 0
    ds_read_b64_tr_b16 v[218:219], v234 offset:14336
    buffer_load_dwordx4 v242, s[4:7], s71 offen lds
    v_mfma_f32_16x16x32_bf16 v[28:31], v[196:199], v[160:163], 0
    ds_read_b64_tr_b16 v[220:221], v235 offset:12288
    v_mfma_f32_16x16x32_bf16 v[24:27], v[196:199], v[128:131], 0
    s_waitcnt lgkmcnt(6)
    ds_read_b64_tr_b16 v[222:223], v235 offset:14336
    v_mfma_f32_16x16x32_bf16 v[16:19], v[200:203], v[132:135], v[16:19]
    ds_read_b64_tr_b16 v[192:193], v234 offset:16384
    v_cvt_pk_bf16_f32 v64, v0, v1
    v_mfma_f32_16x16x32_bf16 v[20:23], v[200:203], v[164:167], v[20:23]
    ds_read_b64_tr_b16 v[194:195], v234 offset:18432
    v_cvt_pk_bf16_f32 v65, v2, v3
    v_mfma_f32_16x16x32_bf16 v[28:31], v[204:207], v[164:167], v[28:31]
    ds_read_b64_tr_b16 v[196:197], v235 offset:16384
    v_cvt_pk_bf16_f32 v66, v8, v9
    v_mfma_f32_16x16x32_bf16 v[24:27], v[204:207], v[132:135], v[24:27]
    s_waitcnt lgkmcnt(6)
    ds_read_b64_tr_b16 v[198:199], v235 offset:18432
    v_cvt_pk_bf16_f32 v67, v10, v11
    v_mfma_f32_16x16x32_bf16 v[16:19], v[208:211], v[136:139], v[16:19]
    ds_read_b64_tr_b16 v[200:201], v234 offset:20480
    buffer_store_dwordx4 v[64:67], v243, s[40:43], s74 offen offset:0 sc1
    v_mfma_f32_16x16x32_bf16 v[20:23], v[208:211], v[168:171], v[20:23]
    ds_read_b64_tr_b16 v[202:203], v234 offset:22528
    v_cvt_pk_bf16_f32 v68, v4, v5
    v_mfma_f32_16x16x32_bf16 v[28:31], v[212:215], v[168:171], v[28:31]
    ds_read_b64_tr_b16 v[204:205], v235 offset:20480
    v_cvt_pk_bf16_f32 v69, v6, v7
    v_mfma_f32_16x16x32_bf16 v[24:27], v[212:215], v[136:139], v[24:27]
    s_waitcnt lgkmcnt(6)
    ds_read_b64_tr_b16 v[206:207], v235 offset:22528
    v_cvt_pk_bf16_f32 v70, v12, v13
    v_mfma_f32_16x16x32_bf16 v[16:19], v[216:219], v[140:143], v[16:19]
    s_mov_b32 s71, 36352
    ds_read_b64_tr_b16 v[208:209], v234 offset:24576
    v_cvt_pk_bf16_f32 v71, v14, v15
    v_mfma_f32_16x16x32_bf16 v[20:23], v[216:219], v[172:175], v[20:23]
    s_add_u32 m0, s70, 136192
    ds_read_b64_tr_b16 v[210:211], v234 offset:26624
    buffer_store_dwordx4 v[68:71], v243, s[40:43], s75 offen offset:0 sc1
    v_mfma_f32_16x16x32_bf16 v[28:31], v[220:223], v[172:175], v[28:31]
    s_waitcnt lgkmcnt(6)
    ds_read_b64_tr_b16 v[212:213], v235 offset:24576
    buffer_load_dwordx4 v242, s[4:7], s71 offen lds
    v_mfma_f32_16x16x32_bf16 v[24:27], v[220:223], v[140:143], v[24:27]
    s_add_u32 m0, s70, 137216
    ds_read_b64_tr_b16 v[214:215], v235 offset:26624
    s_mov_b32 s71, 43520
    v_mfma_f32_16x16x32_bf16 v[16:19], v[192:195], v[144:147], v[16:19]
    ds_read_b64_tr_b16 v[216:217], v234 offset:28672
    buffer_load_dwordx4 v242, s[4:7], s71 offen lds
    v_mfma_f32_16x16x32_bf16 v[20:23], v[192:195], v[176:179], v[20:23]
    s_add_u32 m0, s70, 138240
    ds_read_b64_tr_b16 v[218:219], v234 offset:30720
    s_mov_b32 s71, 50688
    v_mfma_f32_16x16x32_bf16 v[28:31], v[196:199], v[176:179], v[28:31]
    ds_read_b64_tr_b16 v[220:221], v235 offset:28672
    buffer_load_dwordx4 v242, s[4:7], s71 offen lds
    v_mfma_f32_16x16x32_bf16 v[24:27], v[196:199], v[144:147], v[24:27]
    s_waitcnt lgkmcnt(6)
    ds_read_b64_tr_b16 v[222:223], v235 offset:30720
    v_mfma_f32_16x16x32_bf16 v[16:19], v[200:203], v[148:151], v[16:19]
    s_waitcnt vmcnt(20)
    s_barrier
    ds_read_b64_tr_b16 v[192:193], v232 offset:0
    v_mfma_f32_16x16x32_bf16 v[20:23], v[200:203], v[180:183], v[20:23]
    s_mov_b32 s71, 640
    ds_read_b64_tr_b16 v[194:195], v232 offset:2048
    v_add_u32 v234, 32768, v234
    v_mfma_f32_16x16x32_bf16 v[28:31], v[204:207], v[180:183], v[28:31]
    s_add_u32 m0, s70, 0
    ds_read_b64_tr_b16 v[196:197], v233 offset:0
    v_add_u32 v235, 32768, v235
    v_mfma_f32_16x16x32_bf16 v[24:27], v[204:207], v[148:151], v[24:27]
    s_waitcnt lgkmcnt(6)
    ds_read_b64_tr_b16 v[198:199], v233 offset:2048
    buffer_load_dwordx4 v242, s[4:7], s71 offen lds
    v_mfma_f32_16x16x32_bf16 v[16:19], v[208:211], v[152:155], v[16:19]
    ds_read_b64_tr_b16 v[200:201], v232 offset:4096
    v_mfma_f32_16x16x32_bf16 v[20:23], v[208:211], v[184:187], v[20:23]
    s_mov_b32 s71, 7808
    ds_read_b64_tr_b16 v[202:203], v232 offset:6144
    v_mfma_f32_16x16x32_bf16 v[28:31], v[212:215], v[184:187], v[28:31]
    s_add_u32 m0, s70, 1024
    ds_read_b64_tr_b16 v[204:205], v233 offset:4096
    v_mfma_f32_16x16x32_bf16 v[24:27], v[212:215], v[152:155], v[24:27]
    s_waitcnt lgkmcnt(6)
    ds_read_b64_tr_b16 v[206:207], v233 offset:6144
    buffer_load_dwordx4 v242, s[4:7], s71 offen lds
    v_mfma_f32_16x16x32_bf16 v[16:19], v[216:219], v[156:159], v[16:19]
    ds_read_b64_tr_b16 v[208:209], v232 offset:8192
    v_mfma_f32_16x16x32_bf16 v[20:23], v[216:219], v[188:191], v[20:23]
    s_mov_b32 s71, 14976
    ds_read_b64_tr_b16 v[210:211], v232 offset:10240
    v_mfma_f32_16x16x32_bf16 v[28:31], v[220:223], v[188:191], v[28:31]
    s_add_u32 m0, s70, 2048
    ds_read_b64_tr_b16 v[212:213], v233 offset:8192
    v_mfma_f32_16x16x32_bf16 v[24:27], v[220:223], v[156:159], v[24:27]
    s_waitcnt lgkmcnt(6)
    ds_read_b64_tr_b16 v[214:215], v233 offset:10240
    buffer_load_dwordx4 v242, s[4:7], s71 offen lds
    v_mfma_f32_16x16x32_bf16 v[0:3], v[192:195], v[128:131], 0
    ds_read_b64_tr_b16 v[216:217], v232 offset:12288
    v_mfma_f32_16x16x32_bf16 v[4:7], v[192:195], v[160:163], 0
    s_mov_b32 s71, 22144
    ds_read_b64_tr_b16 v[218:219], v232 offset:14336
    v_mfma_f32_16x16x32_bf16 v[12:15], v[196:199], v[160:163], 0
    s_add_u32 m0, s70, 3072
    ds_read_b64_tr_b16 v[220:221], v233 offset:12288
    v_mfma_f32_16x16x32_bf16 v[8:11], v[196:199], v[128:131], 0
    s_waitcnt lgkmcnt(6)
    ds_read_b64_tr_b16 v[222:223], v233 offset:14336
    buffer_load_dwordx4 v242, s[4:7], s71 offen lds
    v_mfma_f32_16x16x32_bf16 v[0:3], v[200:203], v[132:135], v[0:3]
    ds_read_b64_tr_b16 v[192:193], v232 offset:16384
    v_cvt_pk_bf16_f32 v72, v16, v17
    v_mfma_f32_16x16x32_bf16 v[4:7], v[200:203], v[164:167], v[4:7]
    ds_read_b64_tr_b16 v[194:195], v232 offset:18432
    v_cvt_pk_bf16_f32 v73, v18, v19
    v_mfma_f32_16x16x32_bf16 v[12:15], v[204:207], v[164:167], v[12:15]
    ds_read_b64_tr_b16 v[196:197], v233 offset:16384
    v_cvt_pk_bf16_f32 v74, v24, v25
    v_mfma_f32_16x16x32_bf16 v[8:11], v[204:207], v[132:135], v[8:11]
    s_waitcnt lgkmcnt(6)
    ds_read_b64_tr_b16 v[198:199], v233 offset:18432
    v_cvt_pk_bf16_f32 v75, v26, v27
    v_mfma_f32_16x16x32_bf16 v[0:3], v[208:211], v[136:139], v[0:3]
    ds_read_b64_tr_b16 v[200:201], v232 offset:20480
    buffer_store_dwordx4 v[72:75], v243, s[40:43], s74 offen offset:512 sc1
    s_add_u32 s74, s74, 1024
    v_mfma_f32_16x16x32_bf16 v[4:7], v[208:211], v[168:171], v[4:7]
    ds_read_b64_tr_b16 v[202:203], v232 offset:22528
    v_cvt_pk_bf16_f32 v76, v20, v21
    v_mfma_f32_16x16x32_bf16 v[12:15], v[212:215], v[168:171], v[12:15]
    ds_read_b64_tr_b16 v[204:205], v233 offset:20480
    v_cvt_pk_bf16_f32 v77, v22, v23
    v_mfma_f32_16x16x32_bf16 v[8:11], v[212:215], v[136:139], v[8:11]
    s_waitcnt lgkmcnt(6)
    ds_read_b64_tr_b16 v[206:207], v233 offset:22528
    v_cvt_pk_bf16_f32 v78, v28, v29
    v_mfma_f32_16x16x32_bf16 v[0:3], v[216:219], v[140:143], v[0:3]
    s_mov_b32 s71, 29312
    ds_read_b64_tr_b16 v[208:209], v232 offset:24576
    v_cvt_pk_bf16_f32 v79, v30, v31
    v_mfma_f32_16x16x32_bf16 v[4:7], v[216:219], v[172:175], v[4:7]
    s_add_u32 m0, s70, 4096
    ds_read_b64_tr_b16 v[210:211], v232 offset:26624
    buffer_store_dwordx4 v[76:79], v243, s[40:43], s75 offen offset:512 sc1
    s_add_u32 s75, s75, 1024
    v_mfma_f32_16x16x32_bf16 v[12:15], v[220:223], v[172:175], v[12:15]
    s_waitcnt lgkmcnt(6)
    ds_read_b64_tr_b16 v[212:213], v233 offset:24576
    buffer_load_dwordx4 v242, s[4:7], s71 offen lds
    v_mfma_f32_16x16x32_bf16 v[8:11], v[220:223], v[140:143], v[8:11]
    s_add_u32 m0, s70, 5120
    ds_read_b64_tr_b16 v[214:215], v233 offset:26624
    s_mov_b32 s71, 36480
    v_mfma_f32_16x16x32_bf16 v[0:3], v[192:195], v[144:147], v[0:3]
    ds_read_b64_tr_b16 v[216:217], v232 offset:28672
    buffer_load_dwordx4 v242, s[4:7], s71 offen lds
    v_mfma_f32_16x16x32_bf16 v[4:7], v[192:195], v[176:179], v[4:7]
    s_add_u32 m0, s70, 6144
    ds_read_b64_tr_b16 v[218:219], v232 offset:30720
    s_mov_b32 s71, 43648
    v_mfma_f32_16x16x32_bf16 v[12:15], v[196:199], v[176:179], v[12:15]
    s_waitcnt lgkmcnt(6)
    ds_read_b64_tr_b16 v[220:221], v233 offset:28672
    buffer_load_dwordx4 v242, s[4:7], s71 offen lds
    v_mfma_f32_16x16x32_bf16 v[8:11], v[196:199], v[144:147], v[8:11]
    s_add_u32 m0, s70, 7168
    ds_read_b64_tr_b16 v[222:223], v233 offset:30720
    s_mov_b32 s71, 50816
    v_mfma_f32_16x16x32_bf16 v[0:3], v[200:203], v[148:151], v[0:3]
    ds_read_b64_tr_b16 v[192:193], v234 offset:0
    buffer_load_dwordx4 v242, s[4:7], s71 offen lds
    v_mfma_f32_16x16x32_bf16 v[4:7], v[200:203], v[180:183], v[4:7]
    ds_read_b64_tr_b16 v[194:195], v234 offset:2048
    v_mfma_f32_16x16x32_bf16 v[12:15], v[204:207], v[180:183], v[12:15]
    ds_read_b64_tr_b16 v[196:197], v235 offset:0
    v_mfma_f32_16x16x32_bf16 v[8:11], v[204:207], v[148:151], v[8:11]
    s_waitcnt lgkmcnt(6)
    ds_read_b64_tr_b16 v[198:199], v235 offset:2048
    v_mfma_f32_16x16x32_bf16 v[0:3], v[208:211], v[152:155], v[0:3]
    ds_read_b64_tr_b16 v[200:201], v234 offset:4096
    v_add_u32 v232, 32768, v232
    v_mfma_f32_16x16x32_bf16 v[4:7], v[208:211], v[184:187], v[4:7]
    ds_read_b64_tr_b16 v[202:203], v234 offset:6144
    v_add_u32 v233, 32768, v233
    v_mfma_f32_16x16x32_bf16 v[12:15], v[212:215], v[184:187], v[12:15]
    ds_read_b64_tr_b16 v[204:205], v235 offset:4096
    v_mfma_f32_16x16x32_bf16 v[8:11], v[212:215], v[152:155], v[8:11]
    s_waitcnt lgkmcnt(6)
    ds_read_b64_tr_b16 v[206:207], v235 offset:6144
    v_mfma_f32_16x16x32_bf16 v[0:3], v[216:219], v[156:159], v[0:3]
    ds_read_b64_tr_b16 v[208:209], v234 offset:8192
    v_mfma_f32_16x16x32_bf16 v[4:7], v[216:219], v[188:191], v[4:7]
    ds_read_b64_tr_b16 v[210:211], v234 offset:10240
    v_mfma_f32_16x16x32_bf16 v[12:15], v[220:223], v[188:191], v[12:15]
    ds_read_b64_tr_b16 v[212:213], v235 offset:8192
    v_mfma_f32_16x16x32_bf16 v[8:11], v[220:223], v[156:159], v[8:11]
    s_waitcnt lgkmcnt(6)
    ds_read_b64_tr_b16 v[214:215], v235 offset:10240
    v_mfma_f32_16x16x32_bf16 v[16:19], v[192:195], v[128:131], 0
    ds_read_b64_tr_b16 v[216:217], v234 offset:12288
    v_mfma_f32_16x16x32_bf16 v[20:23], v[192:195], v[160:163], 0
    ds_read_b64_tr_b16 v[218:219], v234 offset:14336
    v_mfma_f32_16x16x32_bf16 v[28:31], v[196:199], v[160:163], 0
    ds_read_b64_tr_b16 v[220:221], v235 offset:12288
    v_mfma_f32_16x16x32_bf16 v[24:27], v[196:199], v[128:131], 0
    s_waitcnt lgkmcnt(6)
    ds_read_b64_tr_b16 v[222:223], v235 offset:14336
    v_mfma_f32_16x16x32_bf16 v[16:19], v[200:203], v[132:135], v[16:19]
    ds_read_b64_tr_b16 v[192:193], v234 offset:16384
    v_cvt_pk_bf16_f32 v64, v0, v1
    v_mfma_f32_16x16x32_bf16 v[20:23], v[200:203], v[164:167], v[20:23]
    ds_read_b64_tr_b16 v[194:195], v234 offset:18432
    v_cvt_pk_bf16_f32 v65, v2, v3
    v_mfma_f32_16x16x32_bf16 v[28:31], v[204:207], v[164:167], v[28:31]
    ds_read_b64_tr_b16 v[196:197], v235 offset:16384
    v_cvt_pk_bf16_f32 v66, v8, v9
    v_mfma_f32_16x16x32_bf16 v[24:27], v[204:207], v[132:135], v[24:27]
    s_waitcnt lgkmcnt(6)
    ds_read_b64_tr_b16 v[198:199], v235 offset:18432
    v_cvt_pk_bf16_f32 v67, v10, v11
    v_mfma_f32_16x16x32_bf16 v[16:19], v[208:211], v[136:139], v[16:19]
    ds_read_b64_tr_b16 v[200:201], v234 offset:20480
    buffer_store_dwordx4 v[64:67], v243, s[40:43], s74 offen offset:0 sc1
    s_lshl_b32 s22, s29, 4
    s_add_u32 s22, s22, s28
    v_mfma_f32_16x16x32_bf16 v[20:23], v[208:211], v[168:171], v[20:23]
    ds_read_b64_tr_b16 v[202:203], v234 offset:22528
    v_cvt_pk_bf16_f32 v68, v4, v5
    s_mul_i32 s23, s22, 7168
    s_lshl_b32 s20, s27, 10
    v_mfma_f32_16x16x32_bf16 v[28:31], v[212:215], v[168:171], v[28:31]
    ds_read_b64_tr_b16 v[204:205], v235 offset:20480
    v_cvt_pk_bf16_f32 v69, v6, v7
    s_add_u32 s21, s20, 4096
    s_add_u32 s8, s36, s23
    s_addc_u32 s9, s37, 0
    v_mfma_f32_16x16x32_bf16 v[24:27], v[212:215], v[136:139], v[24:27]
    s_waitcnt lgkmcnt(6)
    ds_read_b64_tr_b16 v[206:207], v235 offset:22528
    v_cvt_pk_bf16_f32 v70, v12, v13
    s_mov_b32 s10, 7168
    s_mov_b32 s11, 0x20000
    v_mfma_f32_16x16x32_bf16 v[16:19], v[216:219], v[140:143], v[16:19]
    ds_read_b64_tr_b16 v[208:209], v234 offset:24576
    v_cvt_pk_bf16_f32 v71, v14, v15
    s_add_u32 s12, s56, 2101248
    s_addc_u32 s13, s57, 0
    v_mfma_f32_16x16x32_bf16 v[20:23], v[216:219], v[172:175], v[20:23]
    ds_read_b64_tr_b16 v[210:211], v234 offset:26624
    buffer_store_dwordx4 v[68:71], v243, s[40:43], s75 offen offset:0 sc1
    s_mov_b32 s14, 7168
    s_mov_b32 s15, 0x20000
    v_mfma_f32_16x16x32_bf16 v[28:31], v[220:223], v[172:175], v[28:31]
    ds_read_b64_tr_b16 v[212:213], v235 offset:24576
    s_mov_b32 s16, s44
    s_mov_b32 s17, s45
    v_mfma_f32_16x16x32_bf16 v[24:27], v[220:223], v[140:143], v[24:27]
    s_waitcnt lgkmcnt(6)
    ds_read_b64_tr_b16 v[214:215], v235 offset:26624
    s_mov_b32 s18, 896
    s_mov_b32 s19, 0x20000
    v_mfma_f32_16x16x32_bf16 v[16:19], v[192:195], v[144:147], v[16:19]
    ds_read_b64_tr_b16 v[216:217], v234 offset:28672
    v_mfma_f32_16x16x32_bf16 v[20:23], v[192:195], v[176:179], v[20:23]
    ds_read_b64_tr_b16 v[218:219], v234 offset:30720
    v_mfma_f32_16x16x32_bf16 v[28:31], v[196:199], v[176:179], v[28:31]
    ds_read_b64_tr_b16 v[220:221], v235 offset:28672
    v_mfma_f32_16x16x32_bf16 v[24:27], v[196:199], v[144:147], v[24:27]
    s_waitcnt lgkmcnt(6)
    ds_read_b64_tr_b16 v[222:223], v235 offset:30720
    v_mfma_f32_16x16x32_bf16 v[16:19], v[200:203], v[148:151], v[16:19]
    s_waitcnt vmcnt(22)
    s_barrier
    ds_read_b64_tr_b16 v[192:193], v232 offset:0
    v_mfma_f32_16x16x32_bf16 v[20:23], v[200:203], v[180:183], v[20:23]
    s_mov_b32 s71, 768
    ds_read_b64_tr_b16 v[194:195], v232 offset:2048
    v_add_u32 v234, 32768, v234
    v_mfma_f32_16x16x32_bf16 v[28:31], v[204:207], v[180:183], v[28:31]
    s_add_u32 m0, s70, 32768
    ds_read_b64_tr_b16 v[196:197], v233 offset:0
    v_add_u32 v235, 32768, v235
    v_mfma_f32_16x16x32_bf16 v[24:27], v[204:207], v[148:151], v[24:27]
    s_waitcnt lgkmcnt(6)
    ds_read_b64_tr_b16 v[198:199], v233 offset:2048
    buffer_load_dwordx4 v242, s[4:7], s71 offen lds
    v_mfma_f32_16x16x32_bf16 v[16:19], v[208:211], v[152:155], v[16:19]
    ds_read_b64_tr_b16 v[200:201], v232 offset:4096
    v_mfma_f32_16x16x32_bf16 v[20:23], v[208:211], v[184:187], v[20:23]
    s_mov_b32 s71, 7936
    ds_read_b64_tr_b16 v[202:203], v232 offset:6144
    v_mfma_f32_16x16x32_bf16 v[28:31], v[212:215], v[184:187], v[28:31]
    s_add_u32 m0, s70, 33792
    ds_read_b64_tr_b16 v[204:205], v233 offset:4096
    v_mfma_f32_16x16x32_bf16 v[24:27], v[212:215], v[152:155], v[24:27]
    s_waitcnt lgkmcnt(6)
    ds_read_b64_tr_b16 v[206:207], v233 offset:6144
    buffer_load_dwordx4 v242, s[4:7], s71 offen lds
    v_mfma_f32_16x16x32_bf16 v[16:19], v[216:219], v[156:159], v[16:19]
    ds_read_b64_tr_b16 v[208:209], v232 offset:8192
    v_mfma_f32_16x16x32_bf16 v[20:23], v[216:219], v[188:191], v[20:23]
    s_mov_b32 s71, 15104
    ds_read_b64_tr_b16 v[210:211], v232 offset:10240
    v_mfma_f32_16x16x32_bf16 v[28:31], v[220:223], v[188:191], v[28:31]
    s_add_u32 m0, s70, 34816
    ds_read_b64_tr_b16 v[212:213], v233 offset:8192
    v_mfma_f32_16x16x32_bf16 v[24:27], v[220:223], v[156:159], v[24:27]
    s_waitcnt lgkmcnt(6)
    ds_read_b64_tr_b16 v[214:215], v233 offset:10240
    buffer_load_dwordx4 v242, s[4:7], s71 offen lds
    v_mfma_f32_16x16x32_bf16 v[0:3], v[192:195], v[128:131], 0
    ds_read_b64_tr_b16 v[216:217], v232 offset:12288
    v_mfma_f32_16x16x32_bf16 v[4:7], v[192:195], v[160:163], 0
    s_mov_b32 s71, 22272
    ds_read_b64_tr_b16 v[218:219], v232 offset:14336
    v_mfma_f32_16x16x32_bf16 v[12:15], v[196:199], v[160:163], 0
    s_add_u32 m0, s70, 35840
    ds_read_b64_tr_b16 v[220:221], v233 offset:12288
    v_mfma_f32_16x16x32_bf16 v[8:11], v[196:199], v[128:131], 0
    s_waitcnt lgkmcnt(6)
    ds_read_b64_tr_b16 v[222:223], v233 offset:14336
    buffer_load_dwordx4 v242, s[4:7], s71 offen lds
    v_mfma_f32_16x16x32_bf16 v[0:3], v[200:203], v[132:135], v[0:3]
    ds_read_b64_tr_b16 v[192:193], v232 offset:16384
    v_cvt_pk_bf16_f32 v72, v16, v17
    v_mfma_f32_16x16x32_bf16 v[4:7], v[200:203], v[164:167], v[4:7]
    ds_read_b64_tr_b16 v[194:195], v232 offset:18432
    v_cvt_pk_bf16_f32 v73, v18, v19
    v_mfma_f32_16x16x32_bf16 v[12:15], v[204:207], v[164:167], v[12:15]
    ds_read_b64_tr_b16 v[196:197], v233 offset:16384
    v_cvt_pk_bf16_f32 v74, v24, v25
    v_mfma_f32_16x16x32_bf16 v[8:11], v[204:207], v[132:135], v[8:11]
    s_waitcnt lgkmcnt(6)
    ds_read_b64_tr_b16 v[198:199], v233 offset:18432
    v_cvt_pk_bf16_f32 v75, v26, v27
    v_mfma_f32_16x16x32_bf16 v[0:3], v[208:211], v[136:139], v[0:3]
    ds_read_b64_tr_b16 v[200:201], v232 offset:20480
    buffer_store_dwordx4 v[72:75], v243, s[40:43], s74 offen offset:512 sc1
    s_add_u32 s74, s74, 1024
    v_mfma_f32_16x16x32_bf16 v[4:7], v[208:211], v[168:171], v[4:7]
    ds_read_b64_tr_b16 v[202:203], v232 offset:22528
    v_cvt_pk_bf16_f32 v76, v20, v21
    v_mfma_f32_16x16x32_bf16 v[12:15], v[212:215], v[168:171], v[12:15]
    ds_read_b64_tr_b16 v[204:205], v233 offset:20480
    v_cvt_pk_bf16_f32 v77, v22, v23
    v_mfma_f32_16x16x32_bf16 v[8:11], v[212:215], v[136:139], v[8:11]
    s_waitcnt lgkmcnt(6)
    ds_read_b64_tr_b16 v[206:207], v233 offset:22528
    v_cvt_pk_bf16_f32 v78, v28, v29
    v_mfma_f32_16x16x32_bf16 v[0:3], v[216:219], v[140:143], v[0:3]
    s_mov_b32 s71, 29440
    ds_read_b64_tr_b16 v[208:209], v232 offset:24576
    v_cvt_pk_bf16_f32 v79, v30, v31
    v_mfma_f32_16x16x32_bf16 v[4:7], v[216:219], v[172:175], v[4:7]
    s_add_u32 m0, s70, 36864
    ds_read_b64_tr_b16 v[210:211], v232 offset:26624
    buffer_store_dwordx4 v[76:79], v243, s[40:43], s75 offen offset:512 sc1
    s_add_u32 s75, s75, 1024
    v_mfma_f32_16x16x32_bf16 v[12:15], v[220:223], v[172:175], v[12:15]
    s_waitcnt lgkmcnt(6)
    ds_read_b64_tr_b16 v[212:213], v233 offset:24576
    buffer_load_dwordx4 v242, s[4:7], s71 offen lds
    v_mfma_f32_16x16x32_bf16 v[8:11], v[220:223], v[140:143], v[8:11]
    s_add_u32 m0, s70, 37888
    ds_read_b64_tr_b16 v[214:215], v233 offset:26624
    s_mov_b32 s71, 36608
    v_mfma_f32_16x16x32_bf16 v[0:3], v[192:195], v[144:147], v[0:3]
    ds_read_b64_tr_b16 v[216:217], v232 offset:28672
    buffer_load_dwordx4 v242, s[4:7], s71 offen lds
    v_mfma_f32_16x16x32_bf16 v[4:7], v[192:195], v[176:179], v[4:7]
    s_add_u32 m0, s70, 38912
    ds_read_b64_tr_b16 v[218:219], v232 offset:30720
    s_mov_b32 s71, 43776
    v_mfma_f32_16x16x32_bf16 v[12:15], v[196:199], v[176:179], v[12:15]
    s_waitcnt lgkmcnt(6)
    ds_read_b64_tr_b16 v[220:221], v233 offset:28672
    buffer_load_dwordx4 v242, s[4:7], s71 offen lds
    v_mfma_f32_16x16x32_bf16 v[8:11], v[196:199], v[144:147], v[8:11]
    s_add_u32 m0, s70, 39936
    ds_read_b64_tr_b16 v[222:223], v233 offset:30720
    s_mov_b32 s71, 50944
    v_mfma_f32_16x16x32_bf16 v[0:3], v[200:203], v[148:151], v[0:3]
    ds_read_b64_tr_b16 v[192:193], v234 offset:0
    buffer_load_dwordx4 v242, s[4:7], s71 offen lds
    s_and_b32 s3, s2, 7
    s_mul_i32 s3, s3, 7
    v_mfma_f32_16x16x32_bf16 v[4:7], v[200:203], v[180:183], v[4:7]
    ds_read_b64_tr_b16 v[194:195], v234 offset:2048
    s_lshr_b32 s46, s2, 3
    s_add_u32 s46, s46, s3
    v_mfma_f32_16x16x32_bf16 v[12:15], v[204:207], v[180:183], v[12:15]
    ds_read_b64_tr_b16 v[196:197], v235 offset:0
    s_lshl_b32 s3, s46, 6
    s_sub_u32 s33, 1605632, s3
    v_mfma_f32_16x16x32_bf16 v[8:11], v[204:207], v[148:151], v[8:11]
    s_waitcnt lgkmcnt(6)
    ds_read_b64_tr_b16 v[198:199], v235 offset:2048
    s_cmp_lt_u32 s2, 56
    s_cselect_b32 s33, s33, 0
    s_cselect_b32 s35, 28672, 0
    s_cselect_b32 s3, s3, 0
    s_cselect_b32 s46, s46, 0
    v_mfma_f32_16x16x32_bf16 v[0:3], v[208:211], v[152:155], v[0:3]
    ds_read_b64_tr_b16 v[200:201], v234 offset:4096
    v_add_u32 v232, 32768, v232
    s_add_u32 s60, s48, s3
    s_addc_u32 s61, s49, 0
    v_mfma_f32_16x16x32_bf16 v[4:7], v[208:211], v[184:187], v[4:7]
    ds_read_b64_tr_b16 v[202:203], v234 offset:6144
    v_add_u32 v233, 32768, v233
    s_mov_b32 s62, s33
    s_mov_b32 s63, 0x20000
    v_mfma_f32_16x16x32_bf16 v[12:15], v[212:215], v[184:187], v[12:15]
    ds_read_b64_tr_b16 v[204:205], v235 offset:4096
    s_add_u32 s76, s50, s3
    s_addc_u32 s77, s51, 0
    v_mfma_f32_16x16x32_bf16 v[8:11], v[212:215], v[152:155], v[8:11]
    s_waitcnt lgkmcnt(6)
    ds_read_b64_tr_b16 v[206:207], v235 offset:6144
    s_mov_b32 s78, s33
    s_mov_b32 s79, 0x20000
    v_mfma_f32_16x16x32_bf16 v[0:3], v[216:219], v[156:159], v[0:3]
    ds_read_b64_tr_b16 v[208:209], v234 offset:8192
    s_mul_i32 s3, s46, 28672
    s_add_u32 s64, s52, s3
    s_addc_u32 s65, s53, 0
    v_mfma_f32_16x16x32_bf16 v[4:7], v[216:219], v[188:191], v[4:7]
    ds_read_b64_tr_b16 v[210:211], v234 offset:10240
    s_mov_b32 s66, s35
    s_mov_b32 s67, 0x20000
    v_mfma_f32_16x16x32_bf16 v[12:15], v[220:223], v[188:191], v[12:15]
    ds_read_b64_tr_b16 v[212:213], v235 offset:8192
    s_mul_i32 s26, s27, 401408
    s_mul_i32 s30, s27, 7168
    v_mfma_f32_16x16x32_bf16 v[8:11], v[220:223], v[156:159], v[8:11]
    s_waitcnt lgkmcnt(6)
    ds_read_b64_tr_b16 v[214:215], v235 offset:10240
    s_mov_b32 s25, s26
    v_mfma_f32_16x16x32_bf16 v[16:19], v[192:195], v[128:131], 0
    ds_read_b64_tr_b16 v[216:217], v234 offset:12288
    v_mfma_f32_16x16x32_bf16 v[20:23], v[192:195], v[160:163], 0
    ds_read_b64_tr_b16 v[218:219], v234 offset:14336
    v_mfma_f32_16x16x32_bf16 v[28:31], v[196:199], v[160:163], 0
    ds_read_b64_tr_b16 v[220:221], v235 offset:12288
    v_mfma_f32_16x16x32_bf16 v[24:27], v[196:199], v[128:131], 0
    s_waitcnt lgkmcnt(6)
    ds_read_b64_tr_b16 v[222:223], v235 offset:14336
    v_mfma_f32_16x16x32_bf16 v[16:19], v[200:203], v[132:135], v[16:19]
    ds_read_b64_tr_b16 v[192:193], v234 offset:16384
    v_cvt_pk_bf16_f32 v64, v0, v1
    v_mfma_f32_16x16x32_bf16 v[20:23], v[200:203], v[164:167], v[20:23]
    ds_read_b64_tr_b16 v[194:195], v234 offset:18432
    v_cvt_pk_bf16_f32 v65, v2, v3
    v_mfma_f32_16x16x32_bf16 v[28:31], v[204:207], v[164:167], v[28:31]
    ds_read_b64_tr_b16 v[196:197], v235 offset:16384
    v_cvt_pk_bf16_f32 v66, v8, v9
    v_mfma_f32_16x16x32_bf16 v[24:27], v[204:207], v[132:135], v[24:27]
    s_waitcnt lgkmcnt(6)
    ds_read_b64_tr_b16 v[198:199], v235 offset:18432
    v_cvt_pk_bf16_f32 v67, v10, v11
    v_mfma_f32_16x16x32_bf16 v[16:19], v[208:211], v[136:139], v[16:19]
    ds_read_b64_tr_b16 v[200:201], v234 offset:20480
    buffer_store_dwordx4 v[64:67], v243, s[40:43], s74 offen offset:0 sc1
    v_mfma_f32_16x16x32_bf16 v[20:23], v[208:211], v[168:171], v[20:23]
    ds_read_b64_tr_b16 v[202:203], v234 offset:22528
    v_cvt_pk_bf16_f32 v68, v4, v5
    v_mfma_f32_16x16x32_bf16 v[28:31], v[212:215], v[168:171], v[28:31]
    ds_read_b64_tr_b16 v[204:205], v235 offset:20480
    v_cvt_pk_bf16_f32 v69, v6, v7
    v_mfma_f32_16x16x32_bf16 v[24:27], v[212:215], v[136:139], v[24:27]
    s_waitcnt lgkmcnt(6)
    ds_read_b64_tr_b16 v[206:207], v235 offset:22528
    v_cvt_pk_bf16_f32 v70, v12, v13
    v_mfma_f32_16x16x32_bf16 v[16:19], v[216:219], v[140:143], v[16:19]
    ds_read_b64_tr_b16 v[208:209], v234 offset:24576
    v_cvt_pk_bf16_f32 v71, v14, v15
    v_mfma_f32_16x16x32_bf16 v[20:23], v[216:219], v[172:175], v[20:23]
    ds_read_b64_tr_b16 v[210:211], v234 offset:26624
    buffer_store_dwordx4 v[68:71], v243, s[40:43], s75 offen offset:0 sc1
    v_mfma_f32_16x16x32_bf16 v[28:31], v[220:223], v[172:175], v[28:31]
    ds_read_b64_tr_b16 v[212:213], v235 offset:24576
    v_lshrrev_b32 v122, 6, v240
    v_mfma_f32_16x16x32_bf16 v[24:27], v[220:223], v[140:143], v[24:27]
    s_waitcnt lgkmcnt(6)
    ds_read_b64_tr_b16 v[214:215], v235 offset:26624
    v_mul_u32_u24 v122, 3584, v122
    v_mfma_f32_16x16x32_bf16 v[16:19], v[192:195], v[144:147], v[16:19]
    ds_read_b64_tr_b16 v[216:217], v234 offset:28672
    v_bfe_u32 v123, v240, 4, 2
    v_mfma_f32_16x16x32_bf16 v[20:23], v[192:195], v[176:179], v[20:23]
    ds_read_b64_tr_b16 v[218:219], v234 offset:30720
    v_lshl_add_u32 v122, v123, 4, v122
    v_mfma_f32_16x16x32_bf16 v[28:31], v[196:199], v[176:179], v[28:31]
    ds_read_b64_tr_b16 v[220:221], v235 offset:28672
    v_mfma_f32_16x16x32_bf16 v[24:27], v[196:199], v[144:147], v[24:27]
    s_waitcnt lgkmcnt(6)
    ds_read_b64_tr_b16 v[222:223], v235 offset:30720
    v_mfma_f32_16x16x32_bf16 v[16:19], v[200:203], v[148:151], v[16:19]
    s_waitcnt vmcnt(24)
    s_barrier
    ds_read_b64_tr_b16 v[192:193], v232 offset:0
    v_mfma_f32_16x16x32_bf16 v[20:23], v[200:203], v[180:183], v[20:23]
    ds_read_b64_tr_b16 v[194:195], v232 offset:2048
    v_add_u32 v234, 32768, v234
    v_mfma_f32_16x16x32_bf16 v[28:31], v[204:207], v[180:183], v[28:31]
    s_add_u32 m0, s20, 65536
    ds_read_b64_tr_b16 v[196:197], v233 offset:0
    v_add_u32 v235, 32768, v235
    v_mfma_f32_16x16x32_bf16 v[24:27], v[204:207], v[148:151], v[24:27]
    s_waitcnt lgkmcnt(6)
    ds_read_b64_tr_b16 v[198:199], v233 offset:2048
    buffer_load_dwordx4 v240, s[8:11], s20 offen lds
    v_mfma_f32_16x16x32_bf16 v[16:19], v[208:211], v[152:155], v[16:19]
    ds_read_b64_tr_b16 v[200:201], v232 offset:4096
    v_mfma_f32_16x16x32_bf16 v[20:23], v[208:211], v[184:187], v[20:23]
    ds_read_b64_tr_b16 v[202:203], v232 offset:6144
    v_mfma_f32_16x16x32_bf16 v[28:31], v[212:215], v[184:187], v[28:31]
    s_waitcnt lgkmcnt(6)
    ds_read_b64_tr_b16 v[204:205], v233 offset:4096
    v_mfma_f32_16x16x32_bf16 v[24:27], v[212:215], v[152:155], v[24:27]
    s_add_u32 m0, s21, 65536
    ds_read_b64_tr_b16 v[206:207], v233 offset:6144
    v_mfma_f32_16x16x32_bf16 v[16:19], v[216:219], v[156:159], v[16:19]
    ds_read_b64_tr_b16 v[208:209], v232 offset:8192
    buffer_load_dwordx4 v240, s[8:11], s21 offen lds
    v_mfma_f32_16x16x32_bf16 v[20:23], v[216:219], v[188:191], v[20:23]
    ds_read_b64_tr_b16 v[210:211], v232 offset:10240
    v_mfma_f32_16x16x32_bf16 v[28:31], v[220:223], v[188:191], v[28:31]
    ds_read_b64_tr_b16 v[212:213], v233 offset:8192
    v_mfma_f32_16x16x32_bf16 v[24:27], v[220:223], v[156:159], v[24:27]
    s_waitcnt lgkmcnt(6)
    ds_read_b64_tr_b16 v[214:215], v233 offset:10240
    v_mfma_f32_16x16x32_bf16 v[0:3], v[192:195], v[128:131], 0
    s_add_u32 m0, s20, 73728
    ds_read_b64_tr_b16 v[216:217], v232 offset:12288
    v_mfma_f32_16x16x32_bf16 v[4:7], v[192:195], v[160:163], 0
    ds_read_b64_tr_b16 v[218:219], v232 offset:14336
    buffer_load_dwordx4 v240, s[12:15], s20 offen lds
    v_mfma_f32_16x16x32_bf16 v[12:15], v[196:199], v[160:163], 0
    ds_read_b64_tr_b16 v[220:221], v233 offset:12288
    v_mfma_f32_16x16x32_bf16 v[8:11], v[196:199], v[128:131], 0
    s_waitcnt lgkmcnt(6)
    ds_read_b64_tr_b16 v[222:223], v233 offset:14336
    v_mfma_f32_16x16x32_bf16 v[0:3], v[200:203], v[132:135], v[0:3]
    ds_read_b64_tr_b16 v[192:193], v232 offset:16384
    v_cvt_pk_bf16_f32 v72, v16, v17
    v_mfma_f32_16x16x32_bf16 v[4:7], v[200:203], v[164:167], v[4:7]
    ds_read_b64_tr_b16 v[194:195], v232 offset:18432
    v_cvt_pk_bf16_f32 v73, v18, v19
    v_mfma_f32_16x16x32_bf16 v[12:15], v[204:207], v[164:167], v[12:15]
    ds_read_b64_tr_b16 v[196:197], v233 offset:16384
    v_cvt_pk_bf16_f32 v74, v24, v25
    v_mfma_f32_16x16x32_bf16 v[8:11], v[204:207], v[132:135], v[8:11]
    s_waitcnt lgkmcnt(6)
    ds_read_b64_tr_b16 v[198:199], v233 offset:18432
    v_cvt_pk_bf16_f32 v75, v26, v27
    v_mfma_f32_16x16x32_bf16 v[0:3], v[208:211], v[136:139], v[0:3]
    ds_read_b64_tr_b16 v[200:201], v232 offset:20480
    buffer_store_dwordx4 v[72:75], v243, s[40:43], s74 offen offset:512 sc1
    s_add_u32 s74, s74, 1024
    v_mfma_f32_16x16x32_bf16 v[4:7], v[208:211], v[168:171], v[4:7]
    ds_read_b64_tr_b16 v[202:203], v232 offset:22528
    v_cvt_pk_bf16_f32 v76, v20, v21
    v_mfma_f32_16x16x32_bf16 v[12:15], v[212:215], v[168:171], v[12:15]
    ds_read_b64_tr_b16 v[204:205], v233 offset:20480
    v_cvt_pk_bf16_f32 v77, v22, v23
    v_mfma_f32_16x16x32_bf16 v[8:11], v[212:215], v[136:139], v[8:11]
    s_waitcnt lgkmcnt(6)
    ds_read_b64_tr_b16 v[206:207], v233 offset:22528
    v_cvt_pk_bf16_f32 v78, v28, v29
    v_mfma_f32_16x16x32_bf16 v[0:3], v[216:219], v[140:143], v[0:3]
    ds_read_b64_tr_b16 v[208:209], v232 offset:24576
    v_cvt_pk_bf16_f32 v79, v30, v31
    v_mfma_f32_16x16x32_bf16 v[4:7], v[216:219], v[172:175], v[4:7]
    s_add_u32 m0, s21, 73728
    ds_read_b64_tr_b16 v[210:211], v232 offset:26624
    buffer_store_dwordx4 v[76:79], v243, s[40:43], s75 offen offset:512 sc1
    s_add_u32 s75, s75, 1024
    v_mfma_f32_16x16x32_bf16 v[12:15], v[220:223], v[172:175], v[12:15]
    s_waitcnt lgkmcnt(6)
    ds_read_b64_tr_b16 v[212:213], v233 offset:24576
    buffer_load_dwordx4 v240, s[12:15], s21 offen lds
    v_mfma_f32_16x16x32_bf16 v[8:11], v[220:223], v[140:143], v[8:11]
    s_mov_b32 m0, 81920
    ds_read_b64_tr_b16 v[214:215], v233 offset:26624
    v_mfma_f32_16x16x32_bf16 v[0:3], v[192:195], v[144:147], v[0:3]
    ds_read_b64_tr_b16 v[216:217], v232 offset:28672
    buffer_load_dwordx4 v240, s[16:19], 0 offen lds
    v_mfma_f32_16x16x32_bf16 v[4:7], v[192:195], v[176:179], v[4:7]
    ds_read_b64_tr_b16 v[218:219], v232 offset:30720
    v_mfma_f32_16x16x32_bf16 v[12:15], v[196:199], v[176:179], v[12:15]
    ds_read_b64_tr_b16 v[220:221], v233 offset:28672
    v_mfma_f32_16x16x32_bf16 v[8:11], v[196:199], v[144:147], v[8:11]
    s_waitcnt lgkmcnt(6)
    ds_read_b64_tr_b16 v[222:223], v233 offset:30720
    v_mfma_f32_16x16x32_bf16 v[0:3], v[200:203], v[148:151], v[0:3]
    ds_read_b64_tr_b16 v[192:193], v234 offset:0
    v_mfma_f32_16x16x32_bf16 v[4:7], v[200:203], v[180:183], v[4:7]
    ds_read_b64_tr_b16 v[194:195], v234 offset:2048
    v_mfma_f32_16x16x32_bf16 v[12:15], v[204:207], v[180:183], v[12:15]
    ds_read_b64_tr_b16 v[196:197], v235 offset:0
    v_mfma_f32_16x16x32_bf16 v[8:11], v[204:207], v[148:151], v[8:11]
    s_waitcnt lgkmcnt(6)
    ds_read_b64_tr_b16 v[198:199], v235 offset:2048
    v_mfma_f32_16x16x32_bf16 v[0:3], v[208:211], v[152:155], v[0:3]
    ds_read_b64_tr_b16 v[200:201], v234 offset:4096
    v_add_u32 v232, 4294836224, v232
    v_mfma_f32_16x16x32_bf16 v[4:7], v[208:211], v[184:187], v[4:7]
    ds_read_b64_tr_b16 v[202:203], v234 offset:6144
    v_add_u32 v233, 4294836224, v233
    v_mfma_f32_16x16x32_bf16 v[12:15], v[212:215], v[184:187], v[12:15]
    ds_read_b64_tr_b16 v[204:205], v235 offset:4096
    v_mfma_f32_16x16x32_bf16 v[8:11], v[212:215], v[152:155], v[8:11]
    s_waitcnt lgkmcnt(6)
    ds_read_b64_tr_b16 v[206:207], v235 offset:6144
    v_mfma_f32_16x16x32_bf16 v[0:3], v[216:219], v[156:159], v[0:3]
    ds_read_b64_tr_b16 v[208:209], v234 offset:8192
    v_mfma_f32_16x16x32_bf16 v[4:7], v[216:219], v[188:191], v[4:7]
    ds_read_b64_tr_b16 v[210:211], v234 offset:10240
    v_mfma_f32_16x16x32_bf16 v[12:15], v[220:223], v[188:191], v[12:15]
    ds_read_b64_tr_b16 v[212:213], v235 offset:8192
    v_mfma_f32_16x16x32_bf16 v[8:11], v[220:223], v[156:159], v[8:11]
    s_waitcnt lgkmcnt(6)
    ds_read_b64_tr_b16 v[214:215], v235 offset:10240
    v_mfma_f32_16x16x32_bf16 v[16:19], v[192:195], v[128:131], 0
    ds_read_b64_tr_b16 v[216:217], v234 offset:12288
    v_mfma_f32_16x16x32_bf16 v[20:23], v[192:195], v[160:163], 0
    ds_read_b64_tr_b16 v[218:219], v234 offset:14336
    v_mfma_f32_16x16x32_bf16 v[28:31], v[196:199], v[160:163], 0
    ds_read_b64_tr_b16 v[220:221], v235 offset:12288
    v_mfma_f32_16x16x32_bf16 v[24:27], v[196:199], v[128:131], 0
    s_waitcnt lgkmcnt(6)
    ds_read_b64_tr_b16 v[222:223], v235 offset:14336
    v_mfma_f32_16x16x32_bf16 v[16:19], v[200:203], v[132:135], v[16:19]
    ds_read_b64_tr_b16 v[192:193], v234 offset:16384
    v_cvt_pk_bf16_f32 v64, v0, v1
    v_mfma_f32_16x16x32_bf16 v[20:23], v[200:203], v[164:167], v[20:23]
    ds_read_b64_tr_b16 v[194:195], v234 offset:18432
    v_cvt_pk_bf16_f32 v65, v2, v3
    v_mfma_f32_16x16x32_bf16 v[28:31], v[204:207], v[164:167], v[28:31]
    ds_read_b64_tr_b16 v[196:197], v235 offset:16384
    v_cvt_pk_bf16_f32 v66, v8, v9
    v_mfma_f32_16x16x32_bf16 v[24:27], v[204:207], v[132:135], v[24:27]
    s_waitcnt lgkmcnt(6)
    ds_read_b64_tr_b16 v[198:199], v235 offset:18432
    v_cvt_pk_bf16_f32 v67, v10, v11
    v_mfma_f32_16x16x32_bf16 v[16:19], v[208:211], v[136:139], v[16:19]
    ds_read_b64_tr_b16 v[200:201], v234 offset:20480
    buffer_store_dwordx4 v[64:67], v243, s[40:43], s74 offen offset:0 sc1
    v_mfma_f32_16x16x32_bf16 v[20:23], v[208:211], v[168:171], v[20:23]
    ds_read_b64_tr_b16 v[202:203], v234 offset:22528
    v_cvt_pk_bf16_f32 v68, v4, v5
    v_mfma_f32_16x16x32_bf16 v[28:31], v[212:215], v[168:171], v[28:31]
    ds_read_b64_tr_b16 v[204:205], v235 offset:20480
    v_cvt_pk_bf16_f32 v69, v6, v7
    v_mfma_f32_16x16x32_bf16 v[24:27], v[212:215], v[136:139], v[24:27]
    s_waitcnt lgkmcnt(6)
    ds_read_b64_tr_b16 v[206:207], v235 offset:22528
    v_cvt_pk_bf16_f32 v70, v12, v13
    v_mfma_f32_16x16x32_bf16 v[16:19], v[216:219], v[140:143], v[16:19]
    ds_read_b64_tr_b16 v[208:209], v234 offset:24576
    v_cvt_pk_bf16_f32 v71, v14, v15
    v_mfma_f32_16x16x32_bf16 v[20:23], v[216:219], v[172:175], v[20:23]
    ds_read_b64_tr_b16 v[210:211], v234 offset:26624
    buffer_store_dwordx4 v[68:71], v243, s[40:43], s75 offen offset:0 sc1
    v_mfma_f32_16x16x32_bf16 v[28:31], v[220:223], v[172:175], v[28:31]
    ds_read_b64_tr_b16 v[212:213], v235 offset:24576
    v_mfma_f32_16x16x32_bf16 v[24:27], v[220:223], v[140:143], v[24:27]
    s_waitcnt lgkmcnt(6)
    ds_read_b64_tr_b16 v[214:215], v235 offset:26624
    v_mfma_f32_16x16x32_bf16 v[16:19], v[192:195], v[144:147], v[16:19]
    ds_read_b64_tr_b16 v[216:217], v234 offset:28672
    v_mfma_f32_16x16x32_bf16 v[20:23], v[192:195], v[176:179], v[20:23]
    ds_read_b64_tr_b16 v[218:219], v234 offset:30720
    v_mfma_f32_16x16x32_bf16 v[28:31], v[196:199], v[176:179], v[28:31]
    ds_read_b64_tr_b16 v[220:221], v235 offset:28672
    v_mfma_f32_16x16x32_bf16 v[24:27], v[196:199], v[144:147], v[24:27]
    s_waitcnt lgkmcnt(6)
    ds_read_b64_tr_b16 v[222:223], v235 offset:30720
    v_mfma_f32_16x16x32_bf16 v[16:19], v[200:203], v[148:151], v[16:19]
    s_waitcnt vmcnt(23)
    s_barrier
    ds_read_b64_tr_b16 v[192:193], v232 offset:0
    v_mfma_f32_16x16x32_bf16 v[20:23], v[200:203], v[180:183], v[20:23]
    s_add_u32 s35, s26, 0
    ds_read_b64_tr_b16 v[194:195], v232 offset:2048
    v_add_u32 v234, 4294836224, v234
    v_mfma_f32_16x16x32_bf16 v[28:31], v[204:207], v[180:183], v[28:31]
    s_add_u32 m0, s30, 98304
    ds_read_b64_tr_b16 v[196:197], v233 offset:0
    v_add_u32 v235, 4294836224, v235
    v_mfma_f32_16x16x32_bf16 v[24:27], v[204:207], v[148:151], v[24:27]
    s_waitcnt lgkmcnt(6)
    ds_read_b64_tr_b16 v[198:199], v233 offset:2048
    buffer_load_dwordx4 v122, s[60:63], s35 offen lds
    v_mfma_f32_16x16x32_bf16 v[16:19], v[208:211], v[152:155], v[16:19]
    ds_read_b64_tr_b16 v[200:201], v232 offset:4096
    v_mfma_f32_16x16x32_bf16 v[20:23], v[208:211], v[184:187], v[20:23]
    ds_read_b64_tr_b16 v[202:203], v232 offset:6144
    v_mfma_f32_16x16x32_bf16 v[28:31], v[212:215], v[184:187], v[28:31]
    ds_read_b64_tr_b16 v[204:205], v233 offset:4096
    v_mfma_f32_16x16x32_bf16 v[24:27], v[212:215], v[152:155], v[24:27]
    s_waitcnt lgkmcnt(6)
    ds_read_b64_tr_b16 v[206:207], v233 offset:6144
    v_mfma_f32_16x16x32_bf16 v[16:19], v[216:219], v[156:159], v[16:19]
    ds_read_b64_tr_b16 v[208:209], v232 offset:8192
    v_mfma_f32_16x16x32_bf16 v[20:23], v[216:219], v[188:191], v[20:23]
    s_add_u32 s35, s26, 57344
    ds_read_b64_tr_b16 v[210:211], v232 offset:10240
    v_mfma_f32_16x16x32_bf16 v[28:31], v[220:223], v[188:191], v[28:31]
    s_add_u32 m0, s30, 99328
    ds_read_b64_tr_b16 v[212:213], v233 offset:8192
    v_mfma_f32_16x16x32_bf16 v[24:27], v[220:223], v[156:159], v[24:27]
    s_waitcnt lgkmcnt(6)
    ds_read_b64_tr_b16 v[214:215], v233 offset:10240
    buffer_load_dwordx4 v122, s[60:63], s35 offen lds
    v_mfma_f32_16x16x32_bf16 v[0:3], v[192:195], v[128:131], 0
    ds_read_b64_tr_b16 v[216:217], v232 offset:12288
    v_mfma_f32_16x16x32_bf16 v[4:7], v[192:195], v[160:163], 0
    ds_read_b64_tr_b16 v[218:219], v232 offset:14336
    v_mfma_f32_16x16x32_bf16 v[12:15], v[196:199], v[160:163], 0
    ds_read_b64_tr_b16 v[220:221], v233 offset:12288
    v_mfma_f32_16x16x32_bf16 v[8:11], v[196:199], v[128:131], 0
    s_waitcnt lgkmcnt(6)
    ds_read_b64_tr_b16 v[222:223], v233 offset:14336
    v_mfma_f32_16x16x32_bf16 v[0:3], v[200:203], v[132:135], v[0:3]
    ds_read_b64_tr_b16 v[192:193], v232 offset:16384
    v_cvt_pk_bf16_f32 v72, v16, v17
    v_mfma_f32_16x16x32_bf16 v[4:7], v[200:203], v[164:167], v[4:7]
    ds_read_b64_tr_b16 v[194:195], v232 offset:18432
    v_cvt_pk_bf16_f32 v73, v18, v19
    v_mfma_f32_16x16x32_bf16 v[12:15], v[204:207], v[164:167], v[12:15]
    ds_read_b64_tr_b16 v[196:197], v233 offset:16384
    v_cvt_pk_bf16_f32 v74, v24, v25
    v_mfma_f32_16x16x32_bf16 v[8:11], v[204:207], v[132:135], v[8:11]
    s_waitcnt lgkmcnt(6)
    ds_read_b64_tr_b16 v[198:199], v233 offset:18432
    v_cvt_pk_bf16_f32 v75, v26, v27
    v_mfma_f32_16x16x32_bf16 v[0:3], v[208:211], v[136:139], v[0:3]
    ds_read_b64_tr_b16 v[200:201], v232 offset:20480
    buffer_store_dwordx4 v[72:75], v243, s[40:43], s74 offen offset:512 sc1
    s_add_u32 s74, s74, 1024
    v_mfma_f32_16x16x32_bf16 v[4:7], v[208:211], v[168:171], v[4:7]
    ds_read_b64_tr_b16 v[202:203], v232 offset:22528
    v_cvt_pk_bf16_f32 v76, v20, v21
    v_mfma_f32_16x16x32_bf16 v[12:15], v[212:215], v[168:171], v[12:15]
    ds_read_b64_tr_b16 v[204:205], v233 offset:20480
    v_cvt_pk_bf16_f32 v77, v22, v23
    v_mfma_f32_16x16x32_bf16 v[8:11], v[212:215], v[136:139], v[8:11]
    s_waitcnt lgkmcnt(6)
    ds_read_b64_tr_b16 v[206:207], v233 offset:22528
    v_cvt_pk_bf16_f32 v78, v28, v29
    v_mfma_f32_16x16x32_bf16 v[0:3], v[216:219], v[140:143], v[0:3]
    s_add_u32 s35, s26, 114688
    ds_read_b64_tr_b16 v[208:209], v232 offset:24576
    v_cvt_pk_bf16_f32 v79, v30, v31
    v_mfma_f32_16x16x32_bf16 v[4:7], v[216:219], v[172:175], v[4:7]
    s_add_u32 m0, s30, 100352
    ds_read_b64_tr_b16 v[210:211], v232 offset:26624
    buffer_store_dwordx4 v[76:79], v243, s[40:43], s75 offen offset:512 sc1
    s_add_u32 s75, s75, 1024
    v_mfma_f32_16x16x32_bf16 v[12:15], v[220:223], v[172:175], v[12:15]
    s_waitcnt lgkmcnt(6)
    ds_read_b64_tr_b16 v[212:213], v233 offset:24576
    buffer_load_dwordx4 v122, s[60:63], s35 offen lds
    v_mfma_f32_16x16x32_bf16 v[8:11], v[220:223], v[140:143], v[8:11]
    s_add_u32 m0, s30, 101376
    ds_read_b64_tr_b16 v[214:215], v233 offset:26624
    s_add_u32 s35, s26, 172032
    v_mfma_f32_16x16x32_bf16 v[0:3], v[192:195], v[144:147], v[0:3]
    ds_read_b64_tr_b16 v[216:217], v232 offset:28672
    buffer_load_dwordx4 v122, s[60:63], s35 offen lds
    v_mfma_f32_16x16x32_bf16 v[4:7], v[192:195], v[176:179], v[4:7]
    ds_read_b64_tr_b16 v[218:219], v232 offset:30720
    v_mfma_f32_16x16x32_bf16 v[12:15], v[196:199], v[176:179], v[12:15]
    ds_read_b64_tr_b16 v[220:221], v233 offset:28672
    v_mfma_f32_16x16x32_bf16 v[8:11], v[196:199], v[144:147], v[8:11]
    s_waitcnt lgkmcnt(6)
    ds_read_b64_tr_b16 v[222:223], v233 offset:30720
    v_mfma_f32_16x16x32_bf16 v[0:3], v[200:203], v[148:151], v[0:3]
    ds_read_b64_tr_b16 v[192:193], v234 offset:0
    v_mfma_f32_16x16x32_bf16 v[4:7], v[200:203], v[180:183], v[4:7]
    s_add_u32 s35, s26, 229376
    ds_read_b64_tr_b16 v[194:195], v234 offset:2048
    v_mfma_f32_16x16x32_bf16 v[12:15], v[204:207], v[180:183], v[12:15]
    s_add_u32 m0, s30, 102400
    ds_read_b64_tr_b16 v[196:197], v235 offset:0
    v_mfma_f32_16x16x32_bf16 v[8:11], v[204:207], v[148:151], v[8:11]
    s_waitcnt lgkmcnt(6)
    ds_read_b64_tr_b16 v[198:199], v235 offset:2048
    buffer_load_dwordx4 v122, s[60:63], s35 offen lds
    v_mfma_f32_16x16x32_bf16 v[0:3], v[208:211], v[152:155], v[0:3]
    ds_read_b64_tr_b16 v[200:201], v234 offset:4096
    v_add_u32 v232, 32768, v232
    v_mfma_f32_16x16x32_bf16 v[4:7], v[208:211], v[184:187], v[4:7]
    ds_read_b64_tr_b16 v[202:203], v234 offset:6144
    v_add_u32 v233, 32768, v233
    v_mfma_f32_16x16x32_bf16 v[12:15], v[212:215], v[184:187], v[12:15]
    ds_read_b64_tr_b16 v[204:205], v235 offset:4096
    v_mfma_f32_16x16x32_bf16 v[8:11], v[212:215], v[152:155], v[8:11]
    s_waitcnt lgkmcnt(6)
    ds_read_b64_tr_b16 v[206:207], v235 offset:6144
    v_mfma_f32_16x16x32_bf16 v[0:3], v[216:219], v[156:159], v[0:3]
    ds_read_b64_tr_b16 v[208:209], v234 offset:8192
    v_mfma_f32_16x16x32_bf16 v[4:7], v[216:219], v[188:191], v[4:7]
    s_add_u32 s35, s26, 286720
    ds_read_b64_tr_b16 v[210:211], v234 offset:10240
    v_mfma_f32_16x16x32_bf16 v[12:15], v[220:223], v[188:191], v[12:15]
    s_add_u32 m0, s30, 103424
    ds_read_b64_tr_b16 v[212:213], v235 offset:8192
    v_mfma_f32_16x16x32_bf16 v[8:11], v[220:223], v[156:159], v[8:11]
    s_waitcnt lgkmcnt(6)
    ds_read_b64_tr_b16 v[214:215], v235 offset:10240
    buffer_load_dwordx4 v122, s[60:63], s35 offen lds
    v_mfma_f32_16x16x32_bf16 v[16:19], v[192:195], v[128:131], 0
    ds_read_b64_tr_b16 v[216:217], v234 offset:12288
    v_mfma_f32_16x16x32_bf16 v[20:23], v[192:195], v[160:163], 0
    ds_read_b64_tr_b16 v[218:219], v234 offset:14336
    v_mfma_f32_16x16x32_bf16 v[28:31], v[196:199], v[160:163], 0
    ds_read_b64_tr_b16 v[220:221], v235 offset:12288
    v_mfma_f32_16x16x32_bf16 v[24:27], v[196:199], v[128:131], 0
    s_waitcnt lgkmcnt(6)
    ds_read_b64_tr_b16 v[222:223], v235 offset:14336
    v_mfma_f32_16x16x32_bf16 v[16:19], v[200:203], v[132:135], v[16:19]
    ds_read_b64_tr_b16 v[192:193], v234 offset:16384
    v_cvt_pk_bf16_f32 v64, v0, v1
    v_mfma_f32_16x16x32_bf16 v[20:23], v[200:203], v[164:167], v[20:23]
    ds_read_b64_tr_b16 v[194:195], v234 offset:18432
    v_cvt_pk_bf16_f32 v65, v2, v3
    v_mfma_f32_16x16x32_bf16 v[28:31], v[204:207], v[164:167], v[28:31]
    ds_read_b64_tr_b16 v[196:197], v235 offset:16384
    v_cvt_pk_bf16_f32 v66, v8, v9
    v_mfma_f32_16x16x32_bf16 v[24:27], v[204:207], v[132:135], v[24:27]
    s_waitcnt lgkmcnt(6)
    ds_read_b64_tr_b16 v[198:199], v235 offset:18432
    v_cvt_pk_bf16_f32 v67, v10, v11
    v_mfma_f32_16x16x32_bf16 v[16:19], v[208:211], v[136:139], v[16:19]
    ds_read_b64_tr_b16 v[200:201], v234 offset:20480
    buffer_store_dwordx4 v[64:67], v243, s[40:43], s74 offen offset:0 sc1
    v_mfma_f32_16x16x32_bf16 v[20:23], v[208:211], v[168:171], v[20:23]
    ds_read_b64_tr_b16 v[202:203], v234 offset:22528
    v_cvt_pk_bf16_f32 v68, v4, v5
    v_mfma_f32_16x16x32_bf16 v[28:31], v[212:215], v[168:171], v[28:31]
    ds_read_b64_tr_b16 v[204:205], v235 offset:20480
    v_cvt_pk_bf16_f32 v69, v6, v7
    v_mfma_f32_16x16x32_bf16 v[24:27], v[212:215], v[136:139], v[24:27]
    s_waitcnt lgkmcnt(6)
    ds_read_b64_tr_b16 v[206:207], v235 offset:22528
    v_cvt_pk_bf16_f32 v70, v12, v13
    v_mfma_f32_16x16x32_bf16 v[16:19], v[216:219], v[140:143], v[16:19]
    s_add_u32 s35, s26, 344064
    ds_read_b64_tr_b16 v[208:209], v234 offset:24576
    v_cvt_pk_bf16_f32 v71, v14, v15
    v_mfma_f32_16x16x32_bf16 v[20:23], v[216:219], v[172:175], v[20:23]
    s_add_u32 m0, s30, 104448
    ds_read_b64_tr_b16 v[210:211], v234 offset:26624
    buffer_store_dwordx4 v[68:71], v243, s[40:43], s75 offen offset:0 sc1
    v_mfma_f32_16x16x32_bf16 v[28:31], v[220:223], v[172:175], v[28:31]
    ds_read_b64_tr_b16 v[212:213], v235 offset:24576
    buffer_load_dwordx4 v122, s[60:63], s35 offen lds
    v_mfma_f32_16x16x32_bf16 v[24:27], v[220:223], v[140:143], v[24:27]
    s_waitcnt lgkmcnt(6)
    ds_read_b64_tr_b16 v[214:215], v235 offset:26624
    v_mfma_f32_16x16x32_bf16 v[16:19], v[192:195], v[144:147], v[16:19]
    ds_read_b64_tr_b16 v[216:217], v234 offset:28672
    v_mfma_f32_16x16x32_bf16 v[20:23], v[192:195], v[176:179], v[20:23]
    ds_read_b64_tr_b16 v[218:219], v234 offset:30720
    v_mfma_f32_16x16x32_bf16 v[28:31], v[196:199], v[176:179], v[28:31]
    ds_read_b64_tr_b16 v[220:221], v235 offset:28672
    v_mfma_f32_16x16x32_bf16 v[24:27], v[196:199], v[144:147], v[24:27]
    s_waitcnt lgkmcnt(6)
    ds_read_b64_tr_b16 v[222:223], v235 offset:30720
    v_mfma_f32_16x16x32_bf16 v[16:19], v[200:203], v[148:151], v[16:19]
    s_waitcnt vmcnt(22)
    s_barrier
    ds_read_b64_tr_b16 v[192:193], v232 offset:0
    v_mfma_f32_16x16x32_bf16 v[20:23], v[200:203], v[180:183], v[20:23]
    s_add_u32 s35, s30, 0
    ds_read_b64_tr_b16 v[194:195], v232 offset:2048
    v_add_u32 v234, 32768, v234
    v_mfma_f32_16x16x32_bf16 v[28:31], v[204:207], v[180:183], v[28:31]
    s_add_u32 m0, s30, 131072
    ds_read_b64_tr_b16 v[196:197], v233 offset:0
    v_add_u32 v235, 32768, v235
    v_mfma_f32_16x16x32_bf16 v[24:27], v[204:207], v[148:151], v[24:27]
    s_waitcnt lgkmcnt(6)
    ds_read_b64_tr_b16 v[198:199], v233 offset:2048
    buffer_load_dwordx4 v240, s[64:67], s35 offen lds
    v_mfma_f32_16x16x32_bf16 v[16:19], v[208:211], v[152:155], v[16:19]
    ds_read_b64_tr_b16 v[200:201], v232 offset:4096
    v_mfma_f32_16x16x32_bf16 v[20:23], v[208:211], v[184:187], v[20:23]
    ds_read_b64_tr_b16 v[202:203], v232 offset:6144
    v_mfma_f32_16x16x32_bf16 v[28:31], v[212:215], v[184:187], v[28:31]
    ds_read_b64_tr_b16 v[204:205], v233 offset:4096
    v_mfma_f32_16x16x32_bf16 v[24:27], v[212:215], v[152:155], v[24:27]
    s_waitcnt lgkmcnt(6)
    ds_read_b64_tr_b16 v[206:207], v233 offset:6144
    v_mfma_f32_16x16x32_bf16 v[16:19], v[216:219], v[156:159], v[16:19]
    s_add_u32 s35, s30, 1024
    ds_read_b64_tr_b16 v[208:209], v232 offset:8192
    v_mfma_f32_16x16x32_bf16 v[20:23], v[216:219], v[188:191], v[20:23]
    s_add_u32 m0, s30, 132096
    ds_read_b64_tr_b16 v[210:211], v232 offset:10240
    v_mfma_f32_16x16x32_bf16 v[28:31], v[220:223], v[188:191], v[28:31]
    ds_read_b64_tr_b16 v[212:213], v233 offset:8192
    buffer_load_dwordx4 v240, s[64:67], s35 offen lds
    v_mfma_f32_16x16x32_bf16 v[24:27], v[220:223], v[156:159], v[24:27]
    s_waitcnt lgkmcnt(6)
    ds_read_b64_tr_b16 v[214:215], v233 offset:10240
    v_mfma_f32_16x16x32_bf16 v[0:3], v[192:195], v[128:131], 0
    ds_read_b64_tr_b16 v[216:217], v232 offset:12288
    v_mfma_f32_16x16x32_bf16 v[4:7], v[192:195], v[160:163], 0
    ds_read_b64_tr_b16 v[218:219], v232 offset:14336
    v_mfma_f32_16x16x32_bf16 v[12:15], v[196:199], v[160:163], 0
    ds_read_b64_tr_b16 v[220:221], v233 offset:12288
    v_mfma_f32_16x16x32_bf16 v[8:11], v[196:199], v[128:131], 0
    s_waitcnt lgkmcnt(6)
    ds_read_b64_tr_b16 v[222:223], v233 offset:14336
    v_mfma_f32_16x16x32_bf16 v[0:3], v[200:203], v[132:135], v[0:3]
    s_barrier
    ds_read_b64_tr_b16 v[192:193], v232 offset:16384
    v_cvt_pk_bf16_f32 v72, v16, v17
    v_mfma_f32_16x16x32_bf16 v[4:7], v[200:203], v[164:167], v[4:7]
    ds_read_b64_tr_b16 v[194:195], v232 offset:18432
    v_cvt_pk_bf16_f32 v73, v18, v19
    v_mfma_f32_16x16x32_bf16 v[12:15], v[204:207], v[164:167], v[12:15]
    ds_read_b64_tr_b16 v[196:197], v233 offset:16384
    v_cvt_pk_bf16_f32 v74, v24, v25
    v_mfma_f32_16x16x32_bf16 v[8:11], v[204:207], v[132:135], v[8:11]
    s_waitcnt lgkmcnt(6)
    ds_read_b64_tr_b16 v[198:199], v233 offset:18432
    v_cvt_pk_bf16_f32 v75, v26, v27
    v_mfma_f32_16x16x32_bf16 v[0:3], v[208:211], v[136:139], v[0:3]
    ds_read_b64_tr_b16 v[200:201], v232 offset:20480
    buffer_store_dwordx4 v[72:75], v243, s[40:43], s74 offen offset:512 sc1
    s_add_u32 s74, s74, 1024
    v_mfma_f32_16x16x32_bf16 v[4:7], v[208:211], v[168:171], v[4:7]
    ds_read_b64_tr_b16 v[202:203], v232 offset:22528
    v_cvt_pk_bf16_f32 v76, v20, v21
    v_mfma_f32_16x16x32_bf16 v[12:15], v[212:215], v[168:171], v[12:15]
    ds_read_b64_tr_b16 v[204:205], v233 offset:20480
    v_cvt_pk_bf16_f32 v77, v22, v23
    v_mfma_f32_16x16x32_bf16 v[8:11], v[212:215], v[136:139], v[8:11]
    s_waitcnt lgkmcnt(6)
    ds_read_b64_tr_b16 v[206:207], v233 offset:22528
    v_cvt_pk_bf16_f32 v78, v28, v29
    v_mfma_f32_16x16x32_bf16 v[0:3], v[216:219], v[140:143], v[0:3]
    s_add_u32 s35, s30, 2048
    ds_read_b64_tr_b16 v[208:209], v232 offset:24576
    v_cvt_pk_bf16_f32 v79, v30, v31
    v_mfma_f32_16x16x32_bf16 v[4:7], v[216:219], v[172:175], v[4:7]
    s_add_u32 m0, s30, 133120
    ds_read_b64_tr_b16 v[210:211], v232 offset:26624
    buffer_store_dwordx4 v[76:79], v243, s[40:43], s75 offen offset:512 sc1
    s_add_u32 s75, s75, 1024
    v_mfma_f32_16x16x32_bf16 v[12:15], v[220:223], v[172:175], v[12:15]
    s_waitcnt lgkmcnt(6)
    ds_read_b64_tr_b16 v[212:213], v233 offset:24576
    buffer_load_dwordx4 v240, s[64:67], s35 offen lds
    v_mfma_f32_16x16x32_bf16 v[8:11], v[220:223], v[140:143], v[8:11]
    s_add_u32 m0, s30, 134144
    ds_read_b64_tr_b16 v[214:215], v233 offset:26624
    s_add_u32 s35, s30, 3072
    v_mfma_f32_16x16x32_bf16 v[0:3], v[192:195], v[144:147], v[0:3]
    ds_read_b64_tr_b16 v[216:217], v232 offset:28672
    buffer_load_dwordx4 v240, s[64:67], s35 offen lds
    v_mfma_f32_16x16x32_bf16 v[4:7], v[192:195], v[176:179], v[4:7]
    s_add_u32 s35, s30, 4096
    ds_read_b64_tr_b16 v[218:219], v232 offset:30720
    v_mfma_f32_16x16x32_bf16 v[12:15], v[196:199], v[176:179], v[12:15]
    s_add_u32 m0, s30, 135168
    ds_read_b64_tr_b16 v[220:221], v233 offset:28672
    v_mfma_f32_16x16x32_bf16 v[8:11], v[196:199], v[144:147], v[8:11]
    s_waitcnt lgkmcnt(6)
    ds_read_b64_tr_b16 v[222:223], v233 offset:30720
    buffer_load_dwordx4 v240, s[64:67], s35 offen lds
    v_mfma_f32_16x16x32_bf16 v[0:3], v[200:203], v[148:151], v[0:3]
    ds_read_b64_tr_b16 v[192:193], v234 offset:0
    v_mfma_f32_16x16x32_bf16 v[4:7], v[200:203], v[180:183], v[4:7]
    ds_read_b64_tr_b16 v[194:195], v234 offset:2048
    v_mfma_f32_16x16x32_bf16 v[12:15], v[204:207], v[180:183], v[12:15]
    ds_read_b64_tr_b16 v[196:197], v235 offset:0
    v_mfma_f32_16x16x32_bf16 v[8:11], v[204:207], v[148:151], v[8:11]
    s_waitcnt lgkmcnt(6)
    ds_read_b64_tr_b16 v[198:199], v235 offset:2048
    v_mfma_f32_16x16x32_bf16 v[0:3], v[208:211], v[152:155], v[0:3]
    s_add_u32 s35, s30, 5120
    ds_read_b64_tr_b16 v[200:201], v234 offset:4096
    v_mfma_f32_16x16x32_bf16 v[4:7], v[208:211], v[184:187], v[4:7]
    s_add_u32 m0, s30, 136192
    ds_read_b64_tr_b16 v[202:203], v234 offset:6144
    v_mfma_f32_16x16x32_bf16 v[12:15], v[212:215], v[184:187], v[12:15]
    ds_read_b64_tr_b16 v[204:205], v235 offset:4096
    buffer_load_dwordx4 v240, s[64:67], s35 offen lds
    v_mfma_f32_16x16x32_bf16 v[8:11], v[212:215], v[152:155], v[8:11]
    s_waitcnt lgkmcnt(6)
    ds_read_b64_tr_b16 v[206:207], v235 offset:6144
    v_mfma_f32_16x16x32_bf16 v[0:3], v[216:219], v[156:159], v[0:3]
    ds_read_b64_tr_b16 v[208:209], v234 offset:8192
    v_mfma_f32_16x16x32_bf16 v[4:7], v[216:219], v[188:191], v[4:7]
    ds_read_b64_tr_b16 v[210:211], v234 offset:10240
    v_mfma_f32_16x16x32_bf16 v[12:15], v[220:223], v[188:191], v[12:15]
    s_waitcnt lgkmcnt(6)
    ds_read_b64_tr_b16 v[212:213], v235 offset:8192
    v_mfma_f32_16x16x32_bf16 v[8:11], v[220:223], v[156:159], v[8:11]
    s_add_u32 s35, s30, 6144
    ds_read_b64_tr_b16 v[214:215], v235 offset:10240
    v_mfma_f32_16x16x32_bf16 v[16:19], v[192:195], v[128:131], 0
    s_add_u32 m0, s30, 137216
    ds_read_b64_tr_b16 v[216:217], v234 offset:12288
    v_mfma_f32_16x16x32_bf16 v[20:23], v[192:195], v[160:163], 0
    ds_read_b64_tr_b16 v[218:219], v234 offset:14336
    buffer_load_dwordx4 v240, s[64:67], s35 offen lds
    v_mfma_f32_16x16x32_bf16 v[28:31], v[196:199], v[160:163], 0
    ds_read_b64_tr_b16 v[220:221], v235 offset:12288
    v_mfma_f32_16x16x32_bf16 v[24:27], v[196:199], v[128:131], 0
    s_waitcnt lgkmcnt(6)
    ds_read_b64_tr_b16 v[222:223], v235 offset:14336
    v_mfma_f32_16x16x32_bf16 v[16:19], v[200:203], v[132:135], v[16:19]
    ds_read_b64_tr_b16 v[192:193], v234 offset:16384
    v_cvt_pk_bf16_f32 v64, v0, v1
    v_mfma_f32_16x16x32_bf16 v[20:23], v[200:203], v[164:167], v[20:23]
    ds_read_b64_tr_b16 v[194:195], v234 offset:18432
    v_cvt_pk_bf16_f32 v65, v2, v3
    v_mfma_f32_16x16x32_bf16 v[28:31], v[204:207], v[164:167], v[28:31]
    ds_read_b64_tr_b16 v[196:197], v235 offset:16384
    v_cvt_pk_bf16_f32 v66, v8, v9
    v_mfma_f32_16x16x32_bf16 v[24:27], v[204:207], v[132:135], v[24:27]
    s_waitcnt lgkmcnt(6)
    ds_read_b64_tr_b16 v[198:199], v235 offset:18432
    v_cvt_pk_bf16_f32 v67, v10, v11
    v_mfma_f32_16x16x32_bf16 v[16:19], v[208:211], v[136:139], v[16:19]
    ds_read_b64_tr_b16 v[200:201], v234 offset:20480
    buffer_store_dwordx4 v[64:67], v243, s[40:43], s74 offen offset:0 sc1
    v_mfma_f32_16x16x32_bf16 v[20:23], v[208:211], v[168:171], v[20:23]
    ds_read_b64_tr_b16 v[202:203], v234 offset:22528
    v_cvt_pk_bf16_f32 v68, v4, v5
    v_mfma_f32_16x16x32_bf16 v[28:31], v[212:215], v[168:171], v[28:31]
    ds_read_b64_tr_b16 v[204:205], v235 offset:20480
    v_cvt_pk_bf16_f32 v69, v6, v7
    v_mfma_f32_16x16x32_bf16 v[24:27], v[212:215], v[136:139], v[24:27]
    s_waitcnt lgkmcnt(6)
    ds_read_b64_tr_b16 v[206:207], v235 offset:22528
    v_cvt_pk_bf16_f32 v70, v12, v13
    v_mfma_f32_16x16x32_bf16 v[16:19], v[216:219], v[140:143], v[16:19]
    ds_read_b64_tr_b16 v[208:209], v234 offset:24576
    v_cvt_pk_bf16_f32 v71, v14, v15
    v_mfma_f32_16x16x32_bf16 v[20:23], v[216:219], v[172:175], v[20:23]
    ds_read_b64_tr_b16 v[210:211], v234 offset:26624
    buffer_store_dwordx4 v[68:71], v243, s[40:43], s75 offen offset:0 sc1
    v_mfma_f32_16x16x32_bf16 v[28:31], v[220:223], v[172:175], v[28:31]
    ds_read_b64_tr_b16 v[212:213], v235 offset:24576
    v_mbcnt_lo_u32_b32 v81, -1, 0
    v_mfma_f32_16x16x32_bf16 v[24:27], v[220:223], v[140:143], v[24:27]
    s_waitcnt lgkmcnt(6)
    ds_read_b64_tr_b16 v[214:215], v235 offset:26624
    v_mbcnt_hi_u32_b32 v81, -1, v81
    v_mfma_f32_16x16x32_bf16 v[16:19], v[192:195], v[144:147], v[16:19]
    ds_read_b64_tr_b16 v[216:217], v234 offset:28672
    v_and_b32 v80, 1, v81
    v_mfma_f32_16x16x32_bf16 v[20:23], v[192:195], v[176:179], v[20:23]
    ds_read_b64_tr_b16 v[218:219], v234 offset:30720
    v_lshlrev_b32 v80, 4, v80
    v_mfma_f32_16x16x32_bf16 v[28:31], v[196:199], v[176:179], v[28:31]
    ds_read_b64_tr_b16 v[220:221], v235 offset:28672
    v_add_u32 v80, s29, v80
    v_mfma_f32_16x16x32_bf16 v[24:27], v[196:199], v[144:147], v[24:27]
    s_waitcnt lgkmcnt(6)
    ds_read_b64_tr_b16 v[222:223], v235 offset:30720
    v_lshlrev_b32 v80, 3, v80
    v_mfma_f32_16x16x32_bf16 v[16:19], v[200:203], v[148:151], v[16:19]
    v_bfe_u32 v81, v81, 1, 3
    v_mfma_f32_16x16x32_bf16 v[20:23], v[200:203], v[180:183], v[20:23]
    v_add_u32 v80, v80, v81
    v_mfma_f32_16x16x32_bf16 v[28:31], v[204:207], v[180:183], v[28:31]
    v_mul_u32_u24 v80, 640, v80
    v_mfma_f32_16x16x32_bf16 v[24:27], v[204:207], v[148:151], v[24:27]
    s_waitcnt lgkmcnt(3)
    v_mfma_f32_16x16x32_bf16 v[16:19], v[208:211], v[152:155], v[16:19]
    s_add_u32 s16, s56, 43516032
    s_addc_u32 s17, s57, 0
    v_mfma_f32_16x16x32_bf16 v[20:23], v[208:211], v[184:187], v[20:23]
    s_mov_b32 s18, 163840
    s_mov_b32 s19, 0x20000
    v_mfma_f32_16x16x32_bf16 v[28:31], v[212:215], v[184:187], v[28:31]
    v_mfma_f32_16x16x32_bf16 v[24:27], v[212:215], v[152:155], v[24:27]
    s_waitcnt lgkmcnt(0)
    v_mfma_f32_16x16x32_bf16 v[16:19], v[216:219], v[156:159], v[16:19]
    v_mfma_f32_16x16x32_bf16 v[20:23], v[216:219], v[188:191], v[20:23]
    v_mfma_f32_16x16x32_bf16 v[28:31], v[220:223], v[188:191], v[28:31]
    v_mfma_f32_16x16x32_bf16 v[24:27], v[220:223], v[156:159], v[24:27]
    buffer_load_dword v81, v80, s[16:19], 0 offen sc1
    s_nop 6
    v_cvt_pk_bf16_f32 v72, v16, v17
    v_cvt_pk_bf16_f32 v73, v18, v19
    v_cvt_pk_bf16_f32 v74, v24, v25
    v_cvt_pk_bf16_f32 v75, v26, v27
    buffer_store_dwordx4 v[72:75], v243, s[40:43], s74 offen offset:512 sc1
    s_add_u32 s74, s74, 1024
    v_cvt_pk_bf16_f32 v76, v20, v21
    v_cvt_pk_bf16_f32 v77, v22, v23
    v_cvt_pk_bf16_f32 v78, v28, v29
    v_cvt_pk_bf16_f32 v79, v30, v31
    buffer_store_dwordx4 v[76:79], v243, s[40:43], s75 offen offset:512 sc1
    s_add_u32 s75, s75, 1024
    s_add_u32 m0, s30, 0
    s_add_u32 s35, s26, 0
    buffer_load_dwordx4 v122, s[76:79], s35 offen lds
    s_add_u32 m0, s30, 1024
    s_add_u32 s35, s26, 57344
    buffer_load_dwordx4 v122, s[76:79], s35 offen lds
    s_add_u32 m0, s30, 2048
    s_add_u32 s35, s26, 114688
    buffer_load_dwordx4 v122, s[76:79], s35 offen lds
    s_add_u32 m0, s30, 3072
    s_add_u32 s35, s26, 172032
    buffer_load_dwordx4 v122, s[76:79], s35 offen lds
    s_add_u32 m0, s30, 4096
    s_add_u32 s35, s26, 229376
    buffer_load_dwordx4 v122, s[76:79], s35 offen lds
    s_add_u32 m0, s30, 5120
    s_add_u32 s35, s26, 286720
    buffer_load_dwordx4 v122, s[76:79], s35 offen lds
    s_add_u32 m0, s30, 6144
    s_add_u32 s35, s26, 344064
    buffer_load_dwordx4 v122, s[76:79], s35 offen lds
    v_mbcnt_lo_u32_b32 v1, -1, 0
    v_mbcnt_hi_u32_b32 v1, -1, v1
    s_mul_i32 s3, s22, 114688
    s_add_u32 s3, s3, 4194304
    s_lshl_b32 s33, s22, 10
    s_add_u32 s33, s33, 43253760
    v_and_b32 v3, 7, v1
    v_lshrrev_b32 v2, 5, v1
    v_bfe_u32 v4, v1, 3, 2
    v_lshlrev_b32 v5, 5, v2
    v_lshl_add_u32 v5, v4, 2, v5
    s_lshl_b32 s32, s27, 6
    v_add_u32 v5, s32, v5
    v_mul_u32_u24 v6, 896, v3
    v_lshl_add_u32 v6, v5, 1, v6
    v_lshlrev_b32 v7, 2, v5
    v_lshlrev_b32 v40, 1, v5
    v_add_u32 v41, 65536, v6
    v_add_u32 v42, 73728, v7
    v_add_u32 v43, 81920, v40
    s_add_u32 s8, s56, s3
    s_addc_u32 s9, s57, 0
    s_mov_b32 s10, 114688
    s_mov_b32 s11, 0x20000
    s_add_u32 s12, s56, s33
    s_addc_u32 s13, s57, 0
    s_mov_b32 s14, 1024
    s_mov_b32 s15, 0x20000
    v_lshlrev_b32 v44, 4, v1
    v_add_u32 v45, s20, v44
    v_add_u32 v46, 4096, v45
    s_cmp_eq_u32 s27, 3
    s_cselect_b32 s32, 0x7fffffff, 0
    v_or_b32 v46, s32, v46
    v_lshlrev_b32 v47, 7, v3
    s_and_b32 s24, s28, 14
    s_add_u32 s24, s24, 2
    s_lshl_b32 s25, s24, 2
    s_and_b32 s24, s24, 15
    s_mul_i32 s24, s24, 7168
    s_lshr_b32 s31, s28, 1
    s_lshl_b32 s31, s31, 1
    s_lshl_b32 s32, 3, s31
    s_andn2_b32 s31, 0xffff, s32
    s_mul_i32 s33, s2, 640
    v_mov_b32 v2, s99
    v_mov_b32 v0, v80
    v_mov_b32 v40, 83968
    v_mov_b32 v55, 0
    ds_write_b32 v40, v55
    s_waitcnt vmcnt(0) lgkmcnt(0)
    s_barrier
    s_cmp_lg_u32 s27, 2
    s_cbranch_scc1 T_f0
    s_mov_b64 exec, 1
    buffer_store_dword v2, off, s[16:19], s33 sc1
    s_mov_b64 exec, -1
T_f0:
    s_cmp_lg_u32 s27, 3
    s_cbranch_scc1 T_f1
    v_mov_b32 v2, v81
    v_cmp_ne_u32 vcc, s99, v81
    s_and_b32 s31, s31, vcc_lo
    s_cbranch_scc0 T_f1
    s_mov_b32 s34, 200000
    s_mov_b64 exec, 0xffff
T_pf1:
    buffer_load_dword v2, v0, s[16:19], 0 offen sc1
    s_waitcnt vmcnt(0)
    v_cmp_ne_u32 vcc, s99, v2
    s_sub_u32 s34, s34, 1
    s_cbranch_scc1 T_pf1_out
    s_and_b32 s35, s31, vcc_lo
    s_cbranch_scc0 T_pf1_out
    s_mov_b64 exec, vcc
    s_sleep 2
    s_branch T_pf1
T_pf1_out:
    s_mov_b64 exec, -1
T_f1:
    s_barrier
    s_cmp_lg_u32 s27, 3
    s_cbranch_scc1 T_f2
    v_cmp_ne_u32 vcc, s99, v2
    s_and_b32 s32, s32, vcc_lo
    s_cbranch_scc0 T_f3
    s_mov_b64 exec, 0
    s_mov_b32 exec_lo, s32
    s_mov_b32 s34, 200000
T_pf2:
    buffer_load_dword v2, v0, s[16:19], 0 offen sc1
    s_waitcnt vmcnt(0)
    v_cmp_ne_u32 vcc, s99, v2
    s_sub_u32 s34, s34, 1
    s_cbranch_scc1 T_pf2_out
    s_cbranch_vccz T_pf2_out
    s_mov_b64 exec, vcc
    s_sleep 1
    s_branch T_pf2
T_pf2_out:
    s_mov_b64 exec, -1
T_f3:
    ds_write_b32 v40, v40
T_f2:
    buffer_load_dwordx4 v[48:51], v47, s[12:15], s25 offen offset:0 sc1
    buffer_load_dwordx4 v[52:55], v47, s[12:15], s25 offen offset:16 sc1
    buffer_load_dwordx4 v[56:59], v47, s[12:15], s25 offen offset:32 sc1
    buffer_load_dwordx2 v[60:61], v47, s[12:15], s25 offen offset:48 sc1
    buffer_load_dwordx4 v[64:67], v45, s[8:11], s24 offen sc1
    buffer_load_dwordx4 v[128:131], v46, s[8:11], s24 offen sc1
    s_add_u32 s24, s24, 7168
    s_cmp_eq_u32 s24, 114688
    s_cselect_b32 s24, 0, s24
    buffer_load_dwordx4 v[68:71], v45, s[8:11], s24 offen sc1
    buffer_load_dwordx4 v[132:135], v46, s[8:11], s24 offen sc1
    s_add_u32 s24, s24, 7168
    s_cmp_eq_u32 s24, 114688
    s_cselect_b32 s24, 0, s24
    buffer_load_dwordx4 v[72:75], v45, s[8:11], s24 offen sc1
    buffer_load_dwordx4 v[136:139], v46, s[8:11], s24 offen sc1
    s_add_u32 s24, s24, 7168
    s_cmp_eq_u32 s24, 114688
    s_cselect_b32 s24, 0, s24
    buffer_load_dwordx4 v[76:79], v45, s[8:11], s24 offen sc1
    buffer_load_dwordx4 v[140:143], v46, s[8:11], s24 offen sc1
    s_add_u32 s24, s24, 7168
    s_cmp_eq_u32 s24, 114688
    s_cselect_b32 s24, 0, s24
    buffer_load_dwordx4 v[80:83], v45, s[8:11], s24 offen sc1
    buffer_load_dwordx4 v[144:147], v46, s[8:11], s24 offen sc1
    s_add_u32 s24, s24, 7168
    s_cmp_eq_u32 s24, 114688
    s_cselect_b32 s24, 0, s24
    buffer_load_dwordx4 v[84:87], v45, s[8:11], s24 offen sc1
    buffer_load_dwordx4 v[148:151], v46, s[8:11], s24 offen sc1
    s_add_u32 s24, s24, 7168
    s_cmp_eq_u32 s24, 114688
    s_cselect_b32 s24, 0, s24
    buffer_load_dwordx4 v[88:91], v45, s[8:11], s24 offen sc1
    buffer_load_dwordx4 v[152:155], v46, s[8:11], s24 offen sc1
    s_add_u32 s24, s24, 7168
    s_cmp_eq_u32 s24, 114688
    s_cselect_b32 s24, 0, s24
    buffer_load_dwordx4 v[92:95], v45, s[8:11], s24 offen sc1
    buffer_load_dwordx4 v[156:159], v46, s[8:11], s24 offen sc1
    s_add_u32 s24, s24, 7168
    s_cmp_eq_u32 s24, 114688
    s_cselect_b32 s24, 0, s24
    buffer_load_dwordx4 v[96:99], v45, s[8:11], s24 offen sc1
    buffer_load_dwordx4 v[160:163], v46, s[8:11], s24 offen sc1
    s_add_u32 s24, s24, 7168
    s_cmp_eq_u32 s24, 114688
    s_cselect_b32 s24, 0, s24
    buffer_load_dwordx4 v[100:103], v45, s[8:11], s24 offen sc1
    buffer_load_dwordx4 v[164:167], v46, s[8:11], s24 offen sc1
    s_add_u32 s24, s24, 7168
    s_cmp_eq_u32 s24, 114688
    s_cselect_b32 s24, 0, s24
    buffer_load_dwordx4 v[104:107], v45, s[8:11], s24 offen sc1
    buffer_load_dwordx4 v[168:171], v46, s[8:11], s24 offen sc1
    s_add_u32 s24, s24, 7168
    s_cmp_eq_u32 s24, 114688
    s_cselect_b32 s24, 0, s24
    buffer_load_dwordx4 v[108:111], v45, s[8:11], s24 offen sc1
    buffer_load_dwordx4 v[172:175], v46, s[8:11], s24 offen sc1
    s_add_u32 s24, s24, 7168
    s_cmp_eq_u32 s24, 114688
    s_cselect_b32 s24, 0, s24
    buffer_load_dwordx4 v[112:115], v45, s[8:11], s24 offen sc1
    buffer_load_dwordx4 v[176:179], v46, s[8:11], s24 offen sc1
    s_add_u32 s24, s24, 7168
    s_cmp_eq_u32 s24, 114688
    s_cselect_b32 s24, 0, s24
    buffer_load_dwordx4 v[116:119], v45, s[8:11], s24 offen sc1
    buffer_load_dwordx4 v[180:183], v46, s[8:11], s24 offen sc1
    s_add_u32 s24, s24, 7168
    s_cmp_eq_u32 s24, 114688
    s_cselect_b32 s24, 0, s24
    s_mov_b32 s34, 3200000
T_f4:
    ds_read_b32 v2, v40
    s_waitcnt lgkmcnt(0)
    v_cmp_eq_u32 vcc, 0, v2
    s_sub_u32 s34, s34, 1
    s_cbranch_scc1 T_f5
    s_cbranch_vccnz T_f4
T_f5:
    buffer_load_dwordx2 v[62:63], v47, s[12:15], s25 offen offset:56 sc1
    buffer_load_dwordx4 v[120:123], v45, s[8:11], s24 offen sc1
    buffer_load_dwordx4 v[184:187], v46, s[8:11], s24 offen sc1
    s_add_u32 s24, s24, 7168
    s_cmp_eq_u32 s24, 114688
    s_cselect_b32 s24, 0, s24
    buffer_load_dwordx4 v[124:127], v45, s[8:11], s24 offen sc1
    buffer_load_dwordx4 v[188:191], v46, s[8:11], s24 offen sc1
    s_add_u32 s24, s24, 7168
    s_cmp_eq_u32 s24, 114688
    s_cselect_b32 s24, 0, s24
    s_cmp_eq_u32 s27, 3
    s_cselect_b32 s3, 0, 512
    s_cselect_b32 s33, 0, 1024
    v_add_u32 v0, s3, v41
    v_add_u32 v2, s33, v42
    v_add_u32 v47, s3, v43
    ds_read_b64 v[8:9], v41
    ds_read_b64 v[10:11], v41 offset:32
    ds_read_b64 v[12:13], v43
    ds_read_b64 v[14:15], v43 offset:32
    ds_read_b128 v[192:195], v42 offset:0
    ds_read_b128 v[196:199], v42 offset:64
    ds_read_b128 v[200:203], v42 offset:1792
    ds_read_b128 v[204:207], v42 offset:1856
    ds_read_b128 v[208:211], v42 offset:3584
    ds_read_b128 v[212:215], v42 offset:3648
    ds_read_b128 v[216:219], v42 offset:5376
    ds_read_b128 v[220:223], v42 offset:5440
    ds_read_b64 v[16:17], v0
    ds_read_b64 v[18:19], v0 offset:32
    ds_read_b64 v[20:21], v47
    ds_read_b64 v[22:23], v47 offset:32
    ds_read_b128 v[224:227], v2 offset:0
    ds_read_b128 v[228:231], v2 offset:64
    ds_read_b128 v[232:235], v2 offset:1792
    ds_read_b128 v[236:239], v2 offset:1856
    ds_read_b128 v[240:243], v2 offset:3584
    ds_read_b128 v[244:247], v2 offset:3648
    ds_read_b128 v[248:251], v2 offset:5376
    ds_read_b128 v[252:255], v2 offset:5440
    s_mul_i32 s3, s22, 1792
    s_add_u32 s3, s3, 42008576
    s_mul_i32 s33, s22, 640
    s_add_u32 s33, s33, 43515904
    s_add_u32 s72, s56, s3
    s_addc_u32 s73, s57, 0
    s_mov_b32 s74, 1792
    s_mov_b32 s75, 0x20000
    s_add_u32 s4, s56, s33
    s_addc_u32 s5, s57, 0
    s_mov_b32 s6, 8
    s_mov_b32 s7, 0x20000
    s_waitcnt vmcnt(32)
    v_lshlrev_b32 v40, 16, v64
    v_and_b32 v41, 0xffff0000, v64
    v_pk_mul_f32 v[24:25], v[40:41], v[48:49] op_sel:[0,0] op_sel_hi:[1,0]
    v_lshlrev_b32 v42, 16, v65
    v_and_b32 v43, 0xffff0000, v65
    v_pk_mul_f32 v[26:27], v[42:43], v[48:49] op_sel:[0,0] op_sel_hi:[1,0]
    v_lshlrev_b32 v40, 16, v66
    v_and_b32 v41, 0xffff0000, v66
    v_pk_mul_f32 v[28:29], v[40:41], v[48:49] op_sel:[0,0] op_sel_hi:[1,0]
    v_lshlrev_b32 v42, 16, v67
    v_and_b32 v43, 0xffff0000, v67
    v_pk_mul_f32 v[30:31], v[42:43], v[48:49] op_sel:[0,0] op_sel_hi:[1,0]
    s_waitcnt vmcnt(31)
    v_lshlrev_b32 v40, 16, v128
    v_and_b32 v41, 0xffff0000, v128
    v_pk_mul_f32 v[32:33], v[40:41], v[48:49] op_sel:[0,0] op_sel_hi:[1,0]
    v_lshlrev_b32 v42, 16, v129
    v_and_b32 v43, 0xffff0000, v129
    v_pk_mul_f32 v[34:35], v[42:43], v[48:49] op_sel:[0,0] op_sel_hi:[1,0]
    v_lshlrev_b32 v40, 16, v130
    v_and_b32 v41, 0xffff0000, v130
    v_pk_mul_f32 v[36:37], v[40:41], v[48:49] op_sel:[0,0] op_sel_hi:[1,0]
    v_lshlrev_b32 v42, 16, v131
    v_and_b32 v43, 0xffff0000, v131
    v_pk_mul_f32 v[38:39], v[42:43], v[48:49] op_sel:[0,0] op_sel_hi:[1,0]
    s_waitcnt vmcnt(30)
    v_lshlrev_b32 v40, 16, v68
    v_and_b32 v41, 0xffff0000, v68
    v_pk_fma_f32 v[24:25], v[40:41], v[48:49], v[24:25] op_sel:[0,1,0] op_sel_hi:[1,1,1]
    v_lshlrev_b32 v42, 16, v69
    v_and_b32 v43, 0xffff0000, v69
    v_pk_fma_f32 v[26:27], v[42:43], v[48:49], v[26:27] op_sel:[0,1,0] op_sel_hi:[1,1,1]
    v_lshlrev_b32 v40, 16, v70
    v_and_b32 v41, 0xffff0000, v70
    v_pk_fma_f32 v[28:29], v[40:41], v[48:49], v[28:29] op_sel:[0,1,0] op_sel_hi:[1,1,1]
    v_lshlrev_b32 v42, 16, v71
    v_and_b32 v43, 0xffff0000, v71
    v_pk_fma_f32 v[30:31], v[42:43], v[48:49], v[30:31] op_sel:[0,1,0] op_sel_hi:[1,1,1]
    s_waitcnt vmcnt(29)
    v_lshlrev_b32 v40, 16, v132
    v_and_b32 v41, 0xffff0000, v132
    v_pk_fma_f32 v[32:33], v[40:41], v[48:49], v[32:33] op_sel:[0,1,0] op_sel_hi:[1,1,1]
    v_lshlrev_b32 v42, 16, v133
    v_and_b32 v43, 0xffff0000, v133
    v_pk_fma_f32 v[34:35], v[42:43], v[48:49], v[34:35] op_sel:[0,1,0] op_sel_hi:[1,1,1]
    v_lshlrev_b32 v40, 16, v134
    v_and_b32 v41, 0xffff0000, v134
    v_pk_fma_f32 v[36:37], v[40:41], v[48:49], v[36:37] op_sel:[0,1,0] op_sel_hi:[1,1,1]
    v_lshlrev_b32 v42, 16, v135
    v_and_b32 v43, 0xffff0000, v135
    v_pk_fma_f32 v[38:39], v[42:43], v[48:49], v[38:39] op_sel:[0,1,0] op_sel_hi:[1,1,1]
    s_waitcnt vmcnt(28)
    v_lshlrev_b32 v40, 16, v72
    v_and_b32 v41, 0xffff0000, v72
    v_pk_fma_f32 v[24:25], v[40:41], v[50:51], v[24:25] op_sel:[0,0,0] op_sel_hi:[1,0,1]
    v_lshlrev_b32 v42, 16, v73
    v_and_b32 v43, 0xffff0000, v73
    v_pk_fma_f32 v[26:27], v[42:43], v[50:51], v[26:27] op_sel:[0,0,0] op_sel_hi:[1,0,1]
    v_lshlrev_b32 v40, 16, v74
    v_and_b32 v41, 0xffff0000, v74
    v_pk_fma_f32 v[28:29], v[40:41], v[50:51], v[28:29] op_sel:[0,0,0] op_sel_hi:[1,0,1]
    v_lshlrev_b32 v42, 16, v75
    v_and_b32 v43, 0xffff0000, v75
    v_pk_fma_f32 v[30:31], v[42:43], v[50:51], v[30:31] op_sel:[0,0,0] op_sel_hi:[1,0,1]
    s_waitcnt vmcnt(27)
    v_lshlrev_b32 v40, 16, v136
    v_and_b32 v41, 0xffff0000, v136
    v_pk_fma_f32 v[32:33], v[40:41], v[50:51], v[32:33] op_sel:[0,0,0] op_sel_hi:[1,0,1]
    v_lshlrev_b32 v42, 16, v137
    v_and_b32 v43, 0xffff0000, v137
    v_pk_fma_f32 v[34:35], v[42:43], v[50:51], v[34:35] op_sel:[0,0,0] op_sel_hi:[1,0,1]
    v_lshlrev_b32 v40, 16, v138
    v_and_b32 v41, 0xffff0000, v138
    v_pk_fma_f32 v[36:37], v[40:41], v[50:51], v[36:37] op_sel:[0,0,0] op_sel_hi:[1,0,1]
    v_lshlrev_b32 v42, 16, v139
    v_and_b32 v43, 0xffff0000, v139
    v_pk_fma_f32 v[38:39], v[42:43], v[50:51], v[38:39] op_sel:[0,0,0] op_sel_hi:[1,0,1]
    s_waitcnt vmcnt(26)
    v_lshlrev_b32 v40, 16, v76
    v_and_b32 v41, 0xffff0000, v76
    v_pk_fma_f32 v[24:25], v[40:41], v[50:51], v[24:25] op_sel:[0,1,0] op_sel_hi:[1,1,1]
    v_lshlrev_b32 v42, 16, v77
    v_and_b32 v43, 0xffff0000, v77
    v_pk_fma_f32 v[26:27], v[42:43], v[50:51], v[26:27] op_sel:[0,1,0] op_sel_hi:[1,1,1]
    v_lshlrev_b32 v40, 16, v78
    v_and_b32 v41, 0xffff0000, v78
    v_pk_fma_f32 v[28:29], v[40:41], v[50:51], v[28:29] op_sel:[0,1,0] op_sel_hi:[1,1,1]
    v_lshlrev_b32 v42, 16, v79
    v_and_b32 v43, 0xffff0000, v79
    v_pk_fma_f32 v[30:31], v[42:43], v[50:51], v[30:31] op_sel:[0,1,0] op_sel_hi:[1,1,1]
    s_waitcnt vmcnt(25)
    v_lshlrev_b32 v40, 16, v140
    v_and_b32 v41, 0xffff0000, v140
    v_pk_fma_f32 v[32:33], v[40:41], v[50:51], v[32:33] op_sel:[0,1,0] op_sel_hi:[1,1,1]
    v_lshlrev_b32 v42, 16, v141
    v_and_b32 v43, 0xffff0000, v141
    v_pk_fma_f32 v[34:35], v[42:43], v[50:51], v[34:35] op_sel:[0,1,0] op_sel_hi:[1,1,1]
    v_lshlrev_b32 v40, 16, v142
    v_and_b32 v41, 0xffff0000, v142
    v_pk_fma_f32 v[36:37], v[40:41], v[50:51], v[36:37] op_sel:[0,1,0] op_sel_hi:[1,1,1]
    v_lshlrev_b32 v42, 16, v143
    v_and_b32 v43, 0xffff0000, v143
    v_pk_fma_f32 v[38:39], v[42:43], v[50:51], v[38:39] op_sel:[0,1,0] op_sel_hi:[1,1,1]
    s_waitcnt vmcnt(24)
    v_lshlrev_b32 v40, 16, v80
    v_and_b32 v41, 0xffff0000, v80
    v_pk_fma_f32 v[24:25], v[40:41], v[52:53], v[24:25] op_sel:[0,0,0] op_sel_hi:[1,0,1]
    v_lshlrev_b32 v42, 16, v81
    v_and_b32 v43, 0xffff0000, v81
    v_pk_fma_f32 v[26:27], v[42:43], v[52:53], v[26:27] op_sel:[0,0,0] op_sel_hi:[1,0,1]
    v_lshlrev_b32 v40, 16, v82
    v_and_b32 v41, 0xffff0000, v82
    v_pk_fma_f32 v[28:29], v[40:41], v[52:53], v[28:29] op_sel:[0,0,0] op_sel_hi:[1,0,1]
    v_lshlrev_b32 v42, 16, v83
    v_and_b32 v43, 0xffff0000, v83
    v_pk_fma_f32 v[30:31], v[42:43], v[52:53], v[30:31] op_sel:[0,0,0] op_sel_hi:[1,0,1]
    s_waitcnt vmcnt(23)
    v_lshlrev_b32 v40, 16, v144
    v_and_b32 v41, 0xffff0000, v144
    v_pk_fma_f32 v[32:33], v[40:41], v[52:53], v[32:33] op_sel:[0,0,0] op_sel_hi:[1,0,1]
    v_lshlrev_b32 v42, 16, v145
    v_and_b32 v43, 0xffff0000, v145
    v_pk_fma_f32 v[34:35], v[42:43], v[52:53], v[34:35] op_sel:[0,0,0] op_sel_hi:[1,0,1]
    v_lshlrev_b32 v40, 16, v146
    v_and_b32 v41, 0xffff0000, v146
    v_pk_fma_f32 v[36:37], v[40:41], v[52:53], v[36:37] op_sel:[0,0,0] op_sel_hi:[1,0,1]
    v_lshlrev_b32 v42, 16, v147
    v_and_b32 v43, 0xffff0000, v147
    v_pk_fma_f32 v[38:39], v[42:43], v[52:53], v[38:39] op_sel:[0,0,0] op_sel_hi:[1,0,1]
    s_waitcnt vmcnt(22)
    v_lshlrev_b32 v40, 16, v84
    v_and_b32 v41, 0xffff0000, v84
    v_pk_fma_f32 v[24:25], v[40:41], v[52:53], v[24:25] op_sel:[0,1,0] op_sel_hi:[1,1,1]
    v_lshlrev_b32 v42, 16, v85
    v_and_b32 v43, 0xffff0000, v85
    v_pk_fma_f32 v[26:27], v[42:43], v[52:53], v[26:27] op_sel:[0,1,0] op_sel_hi:[1,1,1]
    v_lshlrev_b32 v40, 16, v86
    v_and_b32 v41, 0xffff0000, v86
    v_pk_fma_f32 v[28:29], v[40:41], v[52:53], v[28:29] op_sel:[0,1,0] op_sel_hi:[1,1,1]
    v_lshlrev_b32 v42, 16, v87
    v_and_b32 v43, 0xffff0000, v87
    v_pk_fma_f32 v[30:31], v[42:43], v[52:53], v[30:31] op_sel:[0,1,0] op_sel_hi:[1,1,1]
    s_waitcnt vmcnt(21)
    v_lshlrev_b32 v40, 16, v148
    v_and_b32 v41, 0xffff0000, v148
    v_pk_fma_f32 v[32:33], v[40:41], v[52:53], v[32:33] op_sel:[0,1,0] op_sel_hi:[1,1,1]
    v_lshlrev_b32 v42, 16, v149
    v_and_b32 v43, 0xffff0000, v149
    v_pk_fma_f32 v[34:35], v[42:43], v[52:53], v[34:35] op_sel:[0,1,0] op_sel_hi:[1,1,1]
    v_lshlrev_b32 v40, 16, v150
    v_and_b32 v41, 0xffff0000, v150
    v_pk_fma_f32 v[36:37], v[40:41], v[52:53], v[36:37] op_sel:[0,1,0] op_sel_hi:[1,1,1]
    v_lshlrev_b32 v42, 16, v151
    v_and_b32 v43, 0xffff0000, v151
    v_pk_fma_f32 v[38:39], v[42:43], v[52:53], v[38:39] op_sel:[0,1,0] op_sel_hi:[1,1,1]
    s_waitcnt vmcnt(20)
    v_lshlrev_b32 v40, 16, v88
    v_and_b32 v41, 0xffff0000, v88
    v_pk_fma_f32 v[24:25], v[40:41], v[54:55], v[24:25] op_sel:[0,0,0] op_sel_hi:[1,0,1]
    v_lshlrev_b32 v42, 16, v89
    v_and_b32 v43, 0xffff0000, v89
    v_pk_fma_f32 v[26:27], v[42:43], v[54:55], v[26:27] op_sel:[0,0,0] op_sel_hi:[1,0,1]
    v_lshlrev_b32 v40, 16, v90
    v_and_b32 v41, 0xffff0000, v90
    v_pk_fma_f32 v[28:29], v[40:41], v[54:55], v[28:29] op_sel:[0,0,0] op_sel_hi:[1,0,1]
    v_lshlrev_b32 v42, 16, v91
    v_and_b32 v43, 0xffff0000, v91
    v_pk_fma_f32 v[30:31], v[42:43], v[54:55], v[30:31] op_sel:[0,0,0] op_sel_hi:[1,0,1]
    s_waitcnt vmcnt(19)
    v_lshlrev_b32 v40, 16, v152
    v_and_b32 v41, 0xffff0000, v152
    v_pk_fma_f32 v[32:33], v[40:41], v[54:55], v[32:33] op_sel:[0,0,0] op_sel_hi:[1,0,1]
    v_lshlrev_b32 v42, 16, v153
    v_and_b32 v43, 0xffff0000, v153
    v_pk_fma_f32 v[34:35], v[42:43], v[54:55], v[34:35] op_sel:[0,0,0] op_sel_hi:[1,0,1]
    v_lshlrev_b32 v40, 16, v154
    v_and_b32 v41, 0xffff0000, v154
    v_pk_fma_f32 v[36:37], v[40:41], v[54:55], v[36:37] op_sel:[0,0,0] op_sel_hi:[1,0,1]
    v_lshlrev_b32 v42, 16, v155
    v_and_b32 v43, 0xffff0000, v155
    v_pk_fma_f32 v[38:39], v[42:43], v[54:55], v[38:39] op_sel:[0,0,0] op_sel_hi:[1,0,1]
    s_waitcnt vmcnt(18)
    v_lshlrev_b32 v40, 16, v92
    v_and_b32 v41, 0xffff0000, v92
    v_pk_fma_f32 v[24:25], v[40:41], v[54:55], v[24:25] op_sel:[0,1,0] op_sel_hi:[1,1,1]
    v_lshlrev_b32 v42, 16, v93
    v_and_b32 v43, 0xffff0000, v93
    v_pk_fma_f32 v[26:27], v[42:43], v[54:55], v[26:27] op_sel:[0,1,0] op_sel_hi:[1,1,1]
    v_lshlrev_b32 v40, 16, v94
    v_and_b32 v41, 0xffff0000, v94
    v_pk_fma_f32 v[28:29], v[40:41], v[54:55], v[28:29] op_sel:[0,1,0] op_sel_hi:[1,1,1]
    v_lshlrev_b32 v42, 16, v95
    v_and_b32 v43, 0xffff0000, v95
    v_pk_fma_f32 v[30:31], v[42:43], v[54:55], v[30:31] op_sel:[0,1,0] op_sel_hi:[1,1,1]
    s_waitcnt vmcnt(17)
    v_lshlrev_b32 v40, 16, v156
    v_and_b32 v41, 0xffff0000, v156
    v_pk_fma_f32 v[32:33], v[40:41], v[54:55], v[32:33] op_sel:[0,1,0] op_sel_hi:[1,1,1]
    v_lshlrev_b32 v42, 16, v157
    v_and_b32 v43, 0xffff0000, v157
    v_pk_fma_f32 v[34:35], v[42:43], v[54:55], v[34:35] op_sel:[0,1,0] op_sel_hi:[1,1,1]
    v_lshlrev_b32 v40, 16, v158
    v_and_b32 v41, 0xffff0000, v158
    v_pk_fma_f32 v[36:37], v[40:41], v[54:55], v[36:37] op_sel:[0,1,0] op_sel_hi:[1,1,1]
    v_lshlrev_b32 v42, 16, v159
    v_and_b32 v43, 0xffff0000, v159
    v_pk_fma_f32 v[38:39], v[42:43], v[54:55], v[38:39] op_sel:[0,1,0] op_sel_hi:[1,1,1]
    s_waitcnt vmcnt(16)
    v_lshlrev_b32 v40, 16, v96
    v_and_b32 v41, 0xffff0000, v96
    v_pk_fma_f32 v[24:25], v[40:41], v[56:57], v[24:25] op_sel:[0,0,0] op_sel_hi:[1,0,1]
    v_lshlrev_b32 v42, 16, v97
    v_and_b32 v43, 0xffff0000, v97
    v_pk_fma_f32 v[26:27], v[42:43], v[56:57], v[26:27] op_sel:[0,0,0] op_sel_hi:[1,0,1]
    v_lshlrev_b32 v40, 16, v98
    v_and_b32 v41, 0xffff0000, v98
    v_pk_fma_f32 v[28:29], v[40:41], v[56:57], v[28:29] op_sel:[0,0,0] op_sel_hi:[1,0,1]
    v_lshlrev_b32 v42, 16, v99
    v_and_b32 v43, 0xffff0000, v99
    v_pk_fma_f32 v[30:31], v[42:43], v[56:57], v[30:31] op_sel:[0,0,0] op_sel_hi:[1,0,1]
    s_waitcnt vmcnt(15)
    v_lshlrev_b32 v40, 16, v160
    v_and_b32 v41, 0xffff0000, v160
    v_pk_fma_f32 v[32:33], v[40:41], v[56:57], v[32:33] op_sel:[0,0,0] op_sel_hi:[1,0,1]
    v_lshlrev_b32 v42, 16, v161
    v_and_b32 v43, 0xffff0000, v161
    v_pk_fma_f32 v[34:35], v[42:43], v[56:57], v[34:35] op_sel:[0,0,0] op_sel_hi:[1,0,1]
    v_lshlrev_b32 v40, 16, v162
    v_and_b32 v41, 0xffff0000, v162
    v_pk_fma_f32 v[36:37], v[40:41], v[56:57], v[36:37] op_sel:[0,0,0] op_sel_hi:[1,0,1]
    v_lshlrev_b32 v42, 16, v163
    v_and_b32 v43, 0xffff0000, v163
    v_pk_fma_f32 v[38:39], v[42:43], v[56:57], v[38:39] op_sel:[0,0,0] op_sel_hi:[1,0,1]
    s_waitcnt vmcnt(14)
    v_lshlrev_b32 v40, 16, v100
    v_and_b32 v41, 0xffff0000, v100
    v_pk_fma_f32 v[24:25], v[40:41], v[56:57], v[24:25] op_sel:[0,1,0] op_sel_hi:[1,1,1]
    v_lshlrev_b32 v42, 16, v101
    v_and_b32 v43, 0xffff0000, v101
    v_pk_fma_f32 v[26:27], v[42:43], v[56:57], v[26:27] op_sel:[0,1,0] op_sel_hi:[1,1,1]
    v_lshlrev_b32 v40, 16, v102
    v_and_b32 v41, 0xffff0000, v102
    v_pk_fma_f32 v[28:29], v[40:41], v[56:57], v[28:29] op_sel:[0,1,0] op_sel_hi:[1,1,1]
    v_lshlrev_b32 v42, 16, v103
    v_and_b32 v43, 0xffff0000, v103
    v_pk_fma_f32 v[30:31], v[42:43], v[56:57], v[30:31] op_sel:[0,1,0] op_sel_hi:[1,1,1]
    s_waitcnt vmcnt(13)
    v_lshlrev_b32 v40, 16, v164
    v_and_b32 v41, 0xffff0000, v164
    v_pk_fma_f32 v[32:33], v[40:41], v[56:57], v[32:33] op_sel:[0,1,0] op_sel_hi:[1,1,1]
    v_lshlrev_b32 v42, 16, v165
    v_and_b32 v43, 0xffff0000, v165
    v_pk_fma_f32 v[34:35], v[42:43], v[56:57], v[34:35] op_sel:[0,1,0] op_sel_hi:[1,1,1]
    v_lshlrev_b32 v40, 16, v166
    v_and_b32 v41, 0xffff0000, v166
    v_pk_fma_f32 v[36:37], v[40:41], v[56:57], v[36:37] op_sel:[0,1,0] op_sel_hi:[1,1,1]
    v_lshlrev_b32 v42, 16, v167
    v_and_b32 v43, 0xffff0000, v167
    v_pk_fma_f32 v[38:39], v[42:43], v[56:57], v[38:39] op_sel:[0,1,0] op_sel_hi:[1,1,1]
    s_waitcnt vmcnt(12)
    v_lshlrev_b32 v40, 16, v104
    v_and_b32 v41, 0xffff0000, v104
    v_pk_fma_f32 v[24:25], v[40:41], v[58:59], v[24:25] op_sel:[0,0,0] op_sel_hi:[1,0,1]
    v_lshlrev_b32 v42, 16, v105
    v_and_b32 v43, 0xffff0000, v105
    v_pk_fma_f32 v[26:27], v[42:43], v[58:59], v[26:27] op_sel:[0,0,0] op_sel_hi:[1,0,1]
    v_lshlrev_b32 v40, 16, v106
    v_and_b32 v41, 0xffff0000, v106
    v_pk_fma_f32 v[28:29], v[40:41], v[58:59], v[28:29] op_sel:[0,0,0] op_sel_hi:[1,0,1]
    v_lshlrev_b32 v42, 16, v107
    v_and_b32 v43, 0xffff0000, v107
    v_pk_fma_f32 v[30:31], v[42:43], v[58:59], v[30:31] op_sel:[0,0,0] op_sel_hi:[1,0,1]
    s_waitcnt vmcnt(11)
    v_lshlrev_b32 v40, 16, v168
    v_and_b32 v41, 0xffff0000, v168
    v_pk_fma_f32 v[32:33], v[40:41], v[58:59], v[32:33] op_sel:[0,0,0] op_sel_hi:[1,0,1]
    v_lshlrev_b32 v42, 16, v169
    v_and_b32 v43, 0xffff0000, v169
    v_pk_fma_f32 v[34:35], v[42:43], v[58:59], v[34:35] op_sel:[0,0,0] op_sel_hi:[1,0,1]
    v_lshlrev_b32 v40, 16, v170
    v_and_b32 v41, 0xffff0000, v170
    v_pk_fma_f32 v[36:37], v[40:41], v[58:59], v[36:37] op_sel:[0,0,0] op_sel_hi:[1,0,1]
    v_lshlrev_b32 v42, 16, v171
    v_and_b32 v43, 0xffff0000, v171
    v_pk_fma_f32 v[38:39], v[42:43], v[58:59], v[38:39] op_sel:[0,0,0] op_sel_hi:[1,0,1]
    s_waitcnt vmcnt(10)
    v_lshlrev_b32 v40, 16, v108
    v_and_b32 v41, 0xffff0000, v108
    v_pk_fma_f32 v[24:25], v[40:41], v[58:59], v[24:25] op_sel:[0,1,0] op_sel_hi:[1,1,1]
    v_lshlrev_b32 v42, 16, v109
    v_and_b32 v43, 0xffff0000, v109
    v_pk_fma_f32 v[26:27], v[42:43], v[58:59], v[26:27] op_sel:[0,1,0] op_sel_hi:[1,1,1]
    v_lshlrev_b32 v40, 16, v110
    v_and_b32 v41, 0xffff0000, v110
    v_pk_fma_f32 v[28:29], v[40:41], v[58:59], v[28:29] op_sel:[0,1,0] op_sel_hi:[1,1,1]
    v_lshlrev_b32 v42, 16, v111
    v_and_b32 v43, 0xffff0000, v111
    v_pk_fma_f32 v[30:31], v[42:43], v[58:59], v[30:31] op_sel:[0,1,0] op_sel_hi:[1,1,1]
    s_waitcnt vmcnt(9)
    v_lshlrev_b32 v40, 16, v172
    v_and_b32 v41, 0xffff0000, v172
    v_pk_fma_f32 v[32:33], v[40:41], v[58:59], v[32:33] op_sel:[0,1,0] op_sel_hi:[1,1,1]
    v_lshlrev_b32 v42, 16, v173
    v_and_b32 v43, 0xffff0000, v173
    v_pk_fma_f32 v[34:35], v[42:43], v[58:59], v[34:35] op_sel:[0,1,0] op_sel_hi:[1,1,1]
    v_lshlrev_b32 v40, 16, v174
    v_and_b32 v41, 0xffff0000, v174
    v_pk_fma_f32 v[36:37], v[40:41], v[58:59], v[36:37] op_sel:[0,1,0] op_sel_hi:[1,1,1]
    v_lshlrev_b32 v42, 16, v175
    v_and_b32 v43, 0xffff0000, v175
    v_pk_fma_f32 v[38:39], v[42:43], v[58:59], v[38:39] op_sel:[0,1,0] op_sel_hi:[1,1,1]
    s_waitcnt vmcnt(8)
    v_lshlrev_b32 v40, 16, v112
    v_and_b32 v41, 0xffff0000, v112
    v_pk_fma_f32 v[24:25], v[40:41], v[60:61], v[24:25] op_sel:[0,0,0] op_sel_hi:[1,0,1]
    v_lshlrev_b32 v42, 16, v113
    v_and_b32 v43, 0xffff0000, v113
    v_pk_fma_f32 v[26:27], v[42:43], v[60:61], v[26:27] op_sel:[0,0,0] op_sel_hi:[1,0,1]
    v_lshlrev_b32 v40, 16, v114
    v_and_b32 v41, 0xffff0000, v114
    v_pk_fma_f32 v[28:29], v[40:41], v[60:61], v[28:29] op_sel:[0,0,0] op_sel_hi:[1,0,1]
    v_lshlrev_b32 v42, 16, v115
    v_and_b32 v43, 0xffff0000, v115
    v_pk_fma_f32 v[30:31], v[42:43], v[60:61], v[30:31] op_sel:[0,0,0] op_sel_hi:[1,0,1]
    s_waitcnt vmcnt(7)
    v_lshlrev_b32 v40, 16, v176
    v_and_b32 v41, 0xffff0000, v176
    v_pk_fma_f32 v[32:33], v[40:41], v[60:61], v[32:33] op_sel:[0,0,0] op_sel_hi:[1,0,1]
    v_lshlrev_b32 v42, 16, v177
    v_and_b32 v43, 0xffff0000, v177
    v_pk_fma_f32 v[34:35], v[42:43], v[60:61], v[34:35] op_sel:[0,0,0] op_sel_hi:[1,0,1]
    v_lshlrev_b32 v40, 16, v178
    v_and_b32 v41, 0xffff0000, v178
    v_pk_fma_f32 v[36:37], v[40:41], v[60:61], v[36:37] op_sel:[0,0,0] op_sel_hi:[1,0,1]
    v_lshlrev_b32 v42, 16, v179
    v_and_b32 v43, 0xffff0000, v179
    v_pk_fma_f32 v[38:39], v[42:43], v[60:61], v[38:39] op_sel:[0,0,0] op_sel_hi:[1,0,1]
    s_waitcnt vmcnt(6)
    v_lshlrev_b32 v40, 16, v116
    v_and_b32 v41, 0xffff0000, v116
    v_pk_fma_f32 v[24:25], v[40:41], v[60:61], v[24:25] op_sel:[0,1,0] op_sel_hi:[1,1,1]
    v_lshlrev_b32 v42, 16, v117
    v_and_b32 v43, 0xffff0000, v117
    v_pk_fma_f32 v[26:27], v[42:43], v[60:61], v[26:27] op_sel:[0,1,0] op_sel_hi:[1,1,1]
    v_lshlrev_b32 v40, 16, v118
    v_and_b32 v41, 0xffff0000, v118
    v_pk_fma_f32 v[28:29], v[40:41], v[60:61], v[28:29] op_sel:[0,1,0] op_sel_hi:[1,1,1]
    v_lshlrev_b32 v42, 16, v119
    v_and_b32 v43, 0xffff0000, v119
    v_pk_fma_f32 v[30:31], v[42:43], v[60:61], v[30:31] op_sel:[0,1,0] op_sel_hi:[1,1,1]
    s_waitcnt vmcnt(5)
    v_lshlrev_b32 v40, 16, v180
    v_and_b32 v41, 0xffff0000, v180
    v_pk_fma_f32 v[32:33], v[40:41], v[60:61], v[32:33] op_sel:[0,1,0] op_sel_hi:[1,1,1]
    v_lshlrev_b32 v42, 16, v181
    v_and_b32 v43, 0xffff0000, v181
    v_pk_fma_f32 v[34:35], v[42:43], v[60:61], v[34:35] op_sel:[0,1,0] op_sel_hi:[1,1,1]
    v_lshlrev_b32 v40, 16, v182
    v_and_b32 v41, 0xffff0000, v182
    v_pk_fma_f32 v[36:37], v[40:41], v[60:61], v[36:37] op_sel:[0,1,0] op_sel_hi:[1,1,1]
    v_lshlrev_b32 v42, 16, v183
    v_and_b32 v43, 0xffff0000, v183
    v_pk_fma_f32 v[38:39], v[42:43], v[60:61], v[38:39] op_sel:[0,1,0] op_sel_hi:[1,1,1]
    s_waitcnt vmcnt(3)
    v_lshlrev_b32 v40, 16, v120
    v_and_b32 v41, 0xffff0000, v120
    v_pk_fma_f32 v[24:25], v[40:41], v[62:63], v[24:25] op_sel:[0,0,0] op_sel_hi:[1,0,1]
    v_lshlrev_b32 v42, 16, v121
    v_and_b32 v43, 0xffff0000, v121
    v_pk_fma_f32 v[26:27], v[42:43], v[62:63], v[26:27] op_sel:[0,0,0] op_sel_hi:[1,0,1]
    v_lshlrev_b32 v40, 16, v122
    v_and_b32 v41, 0xffff0000, v122
    v_pk_fma_f32 v[28:29], v[40:41], v[62:63], v[28:29] op_sel:[0,0,0] op_sel_hi:[1,0,1]
    v_lshlrev_b32 v42, 16, v123
    v_and_b32 v43, 0xffff0000, v123
    v_pk_fma_f32 v[30:31], v[42:43], v[62:63], v[30:31] op_sel:[0,0,0] op_sel_hi:[1,0,1]
    s_waitcnt vmcnt(2)
    v_lshlrev_b32 v40, 16, v184
    v_and_b32 v41, 0xffff0000, v184
    v_pk_fma_f32 v[32:33], v[40:41], v[62:63], v[32:33] op_sel:[0,0,0] op_sel_hi:[1,0,1]
    v_lshlrev_b32 v42, 16, v185
    v_and_b32 v43, 0xffff0000, v185
    v_pk_fma_f32 v[34:35], v[42:43], v[62:63], v[34:35] op_sel:[0,0,0] op_sel_hi:[1,0,1]
    v_lshlrev_b32 v40, 16, v186
    v_and_b32 v41, 0xffff0000, v186
    v_pk_fma_f32 v[36:37], v[40:41], v[62:63], v[36:37] op_sel:[0,0,0] op_sel_hi:[1,0,1]
    v_lshlrev_b32 v42, 16, v187
    v_and_b32 v43, 0xffff0000, v187
    v_pk_fma_f32 v[38:39], v[42:43], v[62:63], v[38:39] op_sel:[0,0,0] op_sel_hi:[1,0,1]
    s_waitcnt vmcnt(1)
    v_lshlrev_b32 v40, 16, v124
    v_and_b32 v41, 0xffff0000, v124
    v_pk_fma_f32 v[24:25], v[40:41], v[62:63], v[24:25] op_sel:[0,1,0] op_sel_hi:[1,1,1]
    v_lshlrev_b32 v42, 16, v125
    v_and_b32 v43, 0xffff0000, v125
    v_pk_fma_f32 v[26:27], v[42:43], v[62:63], v[26:27] op_sel:[0,1,0] op_sel_hi:[1,1,1]
    v_lshlrev_b32 v40, 16, v126
    v_and_b32 v41, 0xffff0000, v126
    v_pk_fma_f32 v[28:29], v[40:41], v[62:63], v[28:29] op_sel:[0,1,0] op_sel_hi:[1,1,1]
    v_lshlrev_b32 v42, 16, v127
    v_and_b32 v43, 0xffff0000, v127
    v_pk_fma_f32 v[30:31], v[42:43], v[62:63], v[30:31] op_sel:[0,1,0] op_sel_hi:[1,1,1]
    s_waitcnt vmcnt(0)
    v_lshlrev_b32 v40, 16, v188
    v_and_b32 v41, 0xffff0000, v188
    v_pk_fma_f32 v[32:33], v[40:41], v[62:63], v[32:33] op_sel:[0,1,0] op_sel_hi:[1,1,1]
    v_lshlrev_b32 v42, 16, v189
    v_and_b32 v43, 0xffff0000, v189
    v_pk_fma_f32 v[34:35], v[42:43], v[62:63], v[34:35] op_sel:[0,1,0] op_sel_hi:[1,1,1]
    v_lshlrev_b32 v40, 16, v190
    v_and_b32 v41, 0xffff0000, v190
    v_pk_fma_f32 v[36:37], v[40:41], v[62:63], v[36:37] op_sel:[0,1,0] op_sel_hi:[1,1,1]
    v_lshlrev_b32 v42, 16, v191
    v_and_b32 v43, 0xffff0000, v191
    v_pk_fma_f32 v[38:39], v[42:43], v[62:63], v[38:39] op_sel:[0,1,0] op_sel_hi:[1,1,1]
    s_waitcnt lgkmcnt(15)
    v_lshlrev_b32 v40, 16, v8
    v_and_b32 v41, 0xffff0000, v8
    v_pk_fma_f32 v[24:25], v[24:25], v[192:193], v[40:41]
    v_lshlrev_b32 v40, 16, v9
    v_and_b32 v41, 0xffff0000, v9
    v_pk_fma_f32 v[26:27], v[26:27], v[194:195], v[40:41]
    v_lshlrev_b32 v40, 16, v10
    v_and_b32 v41, 0xffff0000, v10
    v_pk_fma_f32 v[28:29], v[28:29], v[196:197], v[40:41]
    v_lshlrev_b32 v40, 16, v11
    v_and_b32 v41, 0xffff0000, v11
    v_pk_fma_f32 v[30:31], v[30:31], v[198:199], v[40:41]
    v_cvt_pk_bf16_f32 v64, v24, v25
    v_lshlrev_b32 v24, 16, v64
    v_and_b32 v25, 0xffff0000, v64
    v_cvt_pk_bf16_f32 v65, v26, v27
    v_lshlrev_b32 v26, 16, v65
    v_and_b32 v27, 0xffff0000, v65
    v_cvt_pk_bf16_f32 v66, v28, v29
    v_lshlrev_b32 v28, 16, v66
    v_and_b32 v29, 0xffff0000, v66
    v_cvt_pk_bf16_f32 v67, v30, v31
    v_lshlrev_b32 v30, 16, v67
    v_and_b32 v31, 0xffff0000, v67
    s_waitcnt lgkmcnt(11)
    v_lshlrev_b32 v40, 16, v16
    v_and_b32 v41, 0xffff0000, v16
    s_waitcnt lgkmcnt(7)
    v_pk_fma_f32 v[32:33], v[32:33], v[224:225], v[40:41]
    v_lshlrev_b32 v40, 16, v17
    v_and_b32 v41, 0xffff0000, v17
    v_pk_fma_f32 v[34:35], v[34:35], v[226:227], v[40:41]
    v_lshlrev_b32 v40, 16, v18
    v_and_b32 v41, 0xffff0000, v18
    s_waitcnt lgkmcnt(6)
    v_pk_fma_f32 v[36:37], v[36:37], v[228:229], v[40:41]
    v_lshlrev_b32 v40, 16, v19
    v_and_b32 v41, 0xffff0000, v19
    v_pk_fma_f32 v[38:39], v[38:39], v[230:231], v[40:41]
    v_cvt_pk_bf16_f32 v68, v32, v33
    v_lshlrev_b32 v32, 16, v68
    v_and_b32 v33, 0xffff0000, v68
    v_cvt_pk_bf16_f32 v69, v34, v35
    v_lshlrev_b32 v34, 16, v69
    v_and_b32 v35, 0xffff0000, v69
    v_cvt_pk_bf16_f32 v70, v36, v37
    v_lshlrev_b32 v36, 16, v70
    v_and_b32 v37, 0xffff0000, v70
    v_cvt_pk_bf16_f32 v71, v38, v39
    v_lshlrev_b32 v38, 16, v71
    v_and_b32 v39, 0xffff0000, v71
    s_cmp_lg_u32 s27, 3
    s_cbranch_scc1 T_z
    v_mov_b32 v32, 0
    v_mov_b32 v33, 0
    v_mov_b32 v34, 0
    v_mov_b32 v35, 0
    v_mov_b32 v36, 0
    v_mov_b32 v37, 0
    v_mov_b32 v38, 0
    v_mov_b32 v39, 0
    v_mov_b32 v20, 0
    v_mov_b32 v21, 0
    v_mov_b32 v22, 0
    v_mov_b32 v23, 0
T_z:
    v_pk_add_f32 v[40:41], v[24:25], v[26:27]
    v_pk_mul_f32 v[52:53], v[24:25], v[24:25]
    v_pk_fma_f32 v[52:53], v[26:27], v[26:27], v[52:53]
    v_pk_add_f32 v[40:41], v[40:41], v[28:29]
    v_pk_fma_f32 v[52:53], v[28:29], v[28:29], v[52:53]
    v_pk_add_f32 v[40:41], v[40:41], v[30:31]
    v_pk_fma_f32 v[52:53], v[30:31], v[30:31], v[52:53]
    v_pk_add_f32 v[40:41], v[40:41], v[32:33]
    v_pk_fma_f32 v[52:53], v[32:33], v[32:33], v[52:53]
    v_pk_add_f32 v[40:41], v[40:41], v[34:35]
    v_pk_fma_f32 v[52:53], v[34:35], v[34:35], v[52:53]
    v_pk_add_f32 v[40:41], v[40:41], v[36:37]
    v_pk_fma_f32 v[52:53], v[36:37], v[36:37], v[52:53]
    v_pk_add_f32 v[40:41], v[40:41], v[38:39]
    v_pk_fma_f32 v[52:53], v[38:39], v[38:39], v[52:53]
    v_add_f32 v42, v40, v41
    v_add_f32 v43, v52, v53
    s_nop 1
    v_add_f32_dpp v42, v42, v42 row_ror:8 row_mask:0xf bank_mask:0xf
    v_add_f32_dpp v43, v43, v43 row_ror:8 row_mask:0xf bank_mask:0xf
    v_mov_b32 v40, v42
    v_mov_b32 v41, v43
    s_nop 1
    v_permlane16_swap_b32 v42, v40
    v_permlane16_swap_b32 v43, v41
    s_nop 1
    v_add_f32 v42, v42, v40
    v_add_f32 v43, v43, v41
    v_mov_b32 v40, v42
    v_mov_b32 v41, v43
    s_nop 1
    v_permlane32_swap_b32 v42, v40
    v_permlane32_swap_b32 v43, v41
    s_nop 1
    v_add_f32 v42, v42, v40
    v_add_f32 v43, v43, v41
    v_lshlrev_b32 v48, 5, v3
    v_add_u32 v48, 82944, v48
    s_lshl_b32 s32, s27, 3
    v_add_u32 v49, s32, v48
    ds_write_b64 v49, v[42:43]
    v_lshlrev_b32 v96, 16, v12
    v_and_b32 v97, 0xffff0000, v12
    v_lshlrev_b32 v98, 16, v13
    v_and_b32 v99, 0xffff0000, v13
    v_lshlrev_b32 v100, 16, v14
    v_and_b32 v101, 0xffff0000, v14
    v_lshlrev_b32 v102, 16, v15
    v_and_b32 v103, 0xffff0000, v15
    v_lshlrev_b32 v104, 16, v20
    v_and_b32 v105, 0xffff0000, v20
    v_lshlrev_b32 v106, 16, v21
    v_and_b32 v107, 0xffff0000, v21
    v_lshlrev_b32 v108, 16, v22
    v_and_b32 v109, 0xffff0000, v22
    v_lshlrev_b32 v110, 16, v23
    v_and_b32 v111, 0xffff0000, v23
    s_waitcnt lgkmcnt(0)
    s_barrier
    ds_read_b128 v[52:55], v48
    ds_read_b128 v[56:59], v48 offset:16
    s_lshl_b32 s3, s22, 3
    s_sub_u32 s3, 4095, s3
    v_sub_u32 v50, s3, v3
    s_lshl_b32 s32, s27, 2
    v_add_u32 v49, s32, v48
    s_waitcnt lgkmcnt(0)
    v_add_f32 v42, v52, v54
    v_add_f32 v43, v53, v55
    v_add_f32 v40, v56, v58
    v_add_f32 v41, v57, v59
    v_add_f32 v42, v42, v40
    v_add_f32 v43, v43, v41
    v_mul_f32 v42, 0x3b124925, v42
    v_mul_f32 v43, 0x3b124925, v43
    v_fma_f32 v43, -v42, v42, v43
    v_max_f32 v43, 0, v43
    v_cvt_pk_bf16_f32 v42, v42, v42
    v_and_b32 v42, 0xffff0000, v42
    v_cvt_pk_bf16_f32 v43, v43, v43
    v_and_b32 v43, 0xffff0000, v43
    v_add_f32 v43, 0x3727c5ac, v43
    v_cvt_pk_bf16_f32 v43, v43, v43
    v_and_b32 v43, 0xffff0000, v43
    v_sqrt_f32 v43, v43
    s_nop 0
    v_cvt_pk_bf16_f32 v43, v43, v43
    v_and_b32 v43, 0xffff0000, v43
    v_rcp_f32 v43, v43
    s_nop 0
    v_pk_add_f32 v[72:73], v[24:25], v[42:43] op_sel_hi:[1,0] neg_lo:[0,1] neg_hi:[0,1]
    v_pk_mul_f32 v[208:209], v[208:209], v[42:43] op_sel:[0,1] op_sel_hi:[1,1]
    v_pk_add_f32 v[74:75], v[26:27], v[42:43] op_sel_hi:[1,0] neg_lo:[0,1] neg_hi:[0,1]
    v_pk_mul_f32 v[210:211], v[210:211], v[42:43] op_sel:[0,1] op_sel_hi:[1,1]
    v_pk_add_f32 v[76:77], v[28:29], v[42:43] op_sel_hi:[1,0] neg_lo:[0,1] neg_hi:[0,1]
    v_pk_mul_f32 v[212:213], v[212:213], v[42:43] op_sel:[0,1] op_sel_hi:[1,1]
    v_pk_add_f32 v[78:79], v[30:31], v[42:43] op_sel_hi:[1,0] neg_lo:[0,1] neg_hi:[0,1]
    v_pk_mul_f32 v[214:215], v[214:215], v[42:43] op_sel:[0,1] op_sel_hi:[1,1]
    v_pk_fma_f32 v[72:73], v[72:73], v[208:209], v[200:201]
    v_pk_fma_f32 v[74:75], v[74:75], v[210:211], v[202:203]
    v_pk_fma_f32 v[76:77], v[76:77], v[212:213], v[204:205]
    v_pk_fma_f32 v[78:79], v[78:79], v[214:215], v[206:207]
    v_cvt_pk_bf16_f32 v88, v72, v73
    v_lshlrev_b32 v72, 16, v88
    v_and_b32 v73, 0xffff0000, v88
    v_cvt_pk_bf16_f32 v89, v74, v75
    v_lshlrev_b32 v74, 16, v89
    v_and_b32 v75, 0xffff0000, v89
    v_cvt_pk_bf16_f32 v90, v76, v77
    v_lshlrev_b32 v76, 16, v90
    v_and_b32 v77, 0xffff0000, v90
    v_cvt_pk_bf16_f32 v91, v78, v79
    v_lshlrev_b32 v78, 16, v91
    v_and_b32 v79, 0xffff0000, v91
    v_pk_add_f32 v[80:81], v[32:33], v[42:43] op_sel_hi:[1,0] neg_lo:[0,1] neg_hi:[0,1]
    v_pk_mul_f32 v[240:241], v[240:241], v[42:43] op_sel:[0,1] op_sel_hi:[1,1]
    v_pk_add_f32 v[82:83], v[34:35], v[42:43] op_sel_hi:[1,0] neg_lo:[0,1] neg_hi:[0,1]
    v_pk_mul_f32 v[242:243], v[242:243], v[42:43] op_sel:[0,1] op_sel_hi:[1,1]
    v_pk_add_f32 v[84:85], v[36:37], v[42:43] op_sel_hi:[1,0] neg_lo:[0,1] neg_hi:[0,1]
    v_pk_mul_f32 v[244:245], v[244:245], v[42:43] op_sel:[0,1] op_sel_hi:[1,1]
    v_pk_add_f32 v[86:87], v[38:39], v[42:43] op_sel_hi:[1,0] neg_lo:[0,1] neg_hi:[0,1]
    v_pk_mul_f32 v[246:247], v[246:247], v[42:43] op_sel:[0,1] op_sel_hi:[1,1]
    v_pk_fma_f32 v[80:81], v[80:81], v[240:241], v[232:233]
    v_pk_fma_f32 v[82:83], v[82:83], v[242:243], v[234:235]
    v_pk_fma_f32 v[84:85], v[84:85], v[244:245], v[236:237]
    v_pk_fma_f32 v[86:87], v[86:87], v[246:247], v[238:239]
    v_cvt_pk_bf16_f32 v92, v80, v81
    v_lshlrev_b32 v80, 16, v92
    v_and_b32 v81, 0xffff0000, v92
    v_cvt_pk_bf16_f32 v93, v82, v83
    v_lshlrev_b32 v82, 16, v93
    v_and_b32 v83, 0xffff0000, v93
    v_cvt_pk_bf16_f32 v94, v84, v85
    v_lshlrev_b32 v84, 16, v94
    v_and_b32 v85, 0xffff0000, v94
    v_cvt_pk_bf16_f32 v95, v86, v87
    v_lshlrev_b32 v86, 16, v95
    v_and_b32 v87, 0xffff0000, v95
    v_pk_mul_f32 v[40:41], v[72:73], v[96:97]
    v_pk_fma_f32 v[40:41], v[74:75], v[98:99], v[40:41]
    v_pk_fma_f32 v[40:41], v[76:77], v[100:101], v[40:41]
    v_pk_fma_f32 v[40:41], v[78:79], v[102:103], v[40:41]
    v_pk_fma_f32 v[40:41], v[80:81], v[104:105], v[40:41]
    v_pk_fma_f32 v[40:41], v[82:83], v[106:107], v[40:41]
    v_pk_fma_f32 v[40:41], v[84:85], v[108:109], v[40:41]
    v_pk_fma_f32 v[40:41], v[86:87], v[110:111], v[40:41]
    v_add_f32 v40, v40, v41
    s_nop 1
    v_add_f32_dpp v40, v40, v40 row_ror:8 row_mask:0xf bank_mask:0xf
    v_mov_b32 v41, v40
    s_nop 1
    v_permlane16_swap_b32 v40, v41
    s_nop 1
    v_add_f32 v40, v40, v41
    v_mov_b32 v41, v40
    s_nop 1
    v_permlane32_swap_b32 v40, v41
    s_nop 1
    v_add_f32 v40, v40, v41
    ds_write_b32 v49, v40 offset:512
    v_min_u32 v64, -2, v64
    v_min_u32 v65, -2, v65
    v_min_u32 v66, -2, v66
    v_min_u32 v67, -2, v67
    v_min_u32 v68, -2, v68
    v_min_u32 v69, -2, v69
    v_min_u32 v70, -2, v70
    v_min_u32 v71, -2, v71
    v_min_u32 v88, -2, v88
    v_min_u32 v89, -2, v89
    v_min_u32 v90, -2, v90
    v_min_u32 v91, -2, v91
    v_min_u32 v92, -2, v92
    v_min_u32 v93, -2, v93
    v_min_u32 v94, -2, v94
    v_min_u32 v95, -2, v95
    v_lshlrev_b32 v2, 1, v5
    v_add_u32 v0, 512, v2
    v_add_u32 v47, 512, v6
    s_cmp_eq_u32 s27, 3
    s_cselect_b32 s32, 0x7fffffff, 0
    v_or_b32 v0, s32, v0
    v_or_b32 v47, s32, v47
    v_lshlrev_b32 v45, 3, v1
    v_or_b32 v45, s20, v45
    v_mov_b32 v51, s99
    s_waitcnt lgkmcnt(0)
    s_barrier
    ds_read_b128 v[52:55], v48 offset:512
    s_waitcnt lgkmcnt(0)
    v_add_f32 v40, v52, v53
    v_add_f32 v41, v54, v55
    v_add_f32 v40, v40, v41
    v_cvt_pk_bf16_f32 v40, v40, v40
    v_ashrrev_i32 v41, 31, v40
    v_or_b32 v41, 0x80000000, v41
    v_xor_b32 v41, v41, v40
    v_and_b32 v41, 0xffff0000, v41
    v_or_b32 v41, v41, v50
    v_mov_b32 v50, v41
    s_nop 1
    v_max_u32_dpp v50, v50, v50 quad_perm:[1,0,3,2] row_mask:0xf bank_mask:0xf
    s_nop 1
    v_max_u32_dpp v50, v50, v50 quad_perm:[2,3,0,1] row_mask:0xf bank_mask:0xf
    s_nop 1
    v_max_u32_dpp v50, v50, v50 row_half_mirror row_mask:0xf bank_mask:0xf
    v_cmp_eq_u32 s[54:55], v41, v50
    buffer_store_dwordx2 v[50:51], v45, s[4:7], 0 offen sc1
    s_mov_b64 exec, s[54:55]
    buffer_store_dwordx2 v[88:89], v2, s[72:75], 0 offen sc1
    buffer_store_dwordx2 v[90:91], v2, s[72:75], 0 offen offset:32 sc1
    buffer_store_dwordx2 v[64:65], v2, s[72:75], 0 offen offset:896 sc1
    buffer_store_dwordx2 v[66:67], v2, s[72:75], 0 offen offset:928 sc1
    buffer_store_dwordx2 v[92:93], v0, s[72:75], 0 offen sc1
    buffer_store_dwordx2 v[94:95], v0, s[72:75], 0 offen offset:32 sc1
    buffer_store_dwordx2 v[68:69], v0, s[72:75], 0 offen offset:896 sc1
    buffer_store_dwordx2 v[70:71], v0, s[72:75], 0 offen offset:928 sc1
    s_mov_b64 exec, -1
    s_add_u32 s8, s38, s23
    s_addc_u32 s9, s39, 0
    s_mov_b32 s10, 7168
    s_mov_b32 s11, 0x20000
    v_mul_f32 v72, v72, v216
    v_mul_f32 v73, v73, v217
    v_mul_f32 v74, v74, v218
    v_mul_f32 v75, v75, v219
    v_mul_f32 v76, v76, v220
    v_mul_f32 v77, v77, v221
    v_mul_f32 v78, v78, v222
    v_mul_f32 v79, v79, v223
    v_cvt_pk_bf16_f32 v73, v72, v73
    v_lshlrev_b32 v72, 16, v73
    v_and_b32 v73, 0xffff0000, v73
    v_cvt_pk_bf16_f32 v75, v74, v75
    v_lshlrev_b32 v74, 16, v75
    v_and_b32 v75, 0xffff0000, v75
    v_cvt_pk_bf16_f32 v77, v76, v77
    v_lshlrev_b32 v76, 16, v77
    v_and_b32 v77, 0xffff0000, v77
    v_cvt_pk_bf16_f32 v79, v78, v79
    v_lshlrev_b32 v78, 16, v79
    v_and_b32 v79, 0xffff0000, v79
    v_add_f32 v72, v72, v24
    v_add_f32 v73, v73, v25
    v_add_f32 v74, v74, v26
    v_add_f32 v75, v75, v27
    v_add_f32 v76, v76, v28
    v_add_f32 v77, v77, v29
    v_add_f32 v78, v78, v30
    v_add_f32 v79, v79, v31
    v_cvt_pk_bf16_f32 v112, v72, v73
    v_cvt_pk_bf16_f32 v113, v74, v75
    v_cvt_pk_bf16_f32 v114, v76, v77
    v_cvt_pk_bf16_f32 v115, v78, v79
    v_mul_f32 v80, v80, v248
    v_mul_f32 v81, v81, v249
    v_mul_f32 v82, v82, v250
    v_mul_f32 v83, v83, v251
    v_mul_f32 v84, v84, v252
    v_mul_f32 v85, v85, v253
    v_mul_f32 v86, v86, v254
    v_mul_f32 v87, v87, v255
    v_cvt_pk_bf16_f32 v81, v80, v81
    v_lshlrev_b32 v80, 16, v81
    v_and_b32 v81, 0xffff0000, v81
    v_cvt_pk_bf16_f32 v83, v82, v83
    v_lshlrev_b32 v82, 16, v83
    v_and_b32 v83, 0xffff0000, v83
    v_cvt_pk_bf16_f32 v85, v84, v85
    v_lshlrev_b32 v84, 16, v85
    v_and_b32 v85, 0xffff0000, v85
    v_cvt_pk_bf16_f32 v87, v86, v87
    v_lshlrev_b32 v86, 16, v87
    v_and_b32 v87, 0xffff0000, v87
    v_add_f32 v80, v80, v32
    v_add_f32 v81, v81, v33
    v_add_f32 v82, v82, v34
    v_add_f32 v83, v83, v35
    v_add_f32 v84, v84, v36
    v_add_f32 v85, v85, v37
    v_add_f32 v86, v86, v38
    v_add_f32 v87, v87, v39
    v_cvt_pk_bf16_f32 v116, v80, v81
    v_cvt_pk_bf16_f32 v117, v82, v83
    v_cvt_pk_bf16_f32 v118, v84, v85
    v_cvt_pk_bf16_f32 v119, v86, v87
    s_andn2_b64 exec, exec, s[54:55]
    buffer_store_dwordx2 v[112:113], v6, s[8:11], 0 offen
    buffer_store_dwordx2 v[114:115], v6, s[8:11], 0 offen offset:32
    buffer_store_dwordx2 v[116:117], v47, s[8:11], 0 offen
    buffer_store_dwordx2 v[118:119], v47, s[8:11], 0 offen offset:32
    s_mov_b64 exec, -1
    s_add_u32 s16, s56, 43516160
    s_addc_u32 s17, s57, 0
    s_mov_b32 s18, 5120
    s_mov_b32 s19, 0x20000
    v_readfirstlane_b32 s47, v50
    s_and_b32 s3, s2, 7
    s_mul_i32 s33, s3, 640
    s_cmp_lt_u32 s2, 56
    s_cbranch_scc1 T_moe
    v_mov_b32 v0, 0
    s_cmp_lg_u32 s27, 0
    s_cbranch_scc1 T_w0
    s_mov_b32 s34, 200000
T_pw:
    buffer_load_dwordx2 v[40:41], v0, s[16:19], s33 offen sc1
    s_waitcnt vmcnt(0)
    v_cmp_ne_u32 vcc, s99, v41
    s_sub_u32 s34, s34, 1
    s_cbranch_scc1 T_pw_out
    s_cbranch_vccz T_pw_out
    s_nop 0
    s_sleep 16
    s_branch T_pw
T_pw_out:
    v_mov_b32 v41, 83968
    ds_write_b32 v41, v40
    s_waitcnt lgkmcnt(0)
T_w0:
    s_barrier
    v_mov_b32 v41, 83968
    ds_read_b32 v40, v41
    s_waitcnt lgkmcnt(0)
    v_readfirstlane_b32 s44, v40
    s_nop 3
    s_cmp_eq_u32 s44, s47
    s_cbranch_scc1 K2_fin
    s_mov_b64 exec, s[54:55]
    buffer_store_dwordx2 v[112:113], v6, s[8:11], 0 offen
    buffer_store_dwordx2 v[114:115], v6, s[8:11], 0 offen offset:32
    buffer_store_dwordx2 v[116:117], v47, s[8:11], 0 offen
    buffer_store_dwordx2 v[118:119], v47, s[8:11], 0 offen offset:32
    s_branch K2_fin
T_moe:
    v_lshrrev_b32 v2, 4, v1
    v_bfe_u32 v7, v1, 2, 2
    v_lshl_add_u32 v7, v2, 3, v7
    v_and_b32 v5, 3, v1
    v_lshlrev_b32 v5, 3, v5
    v_lshl_add_u32 v10, v7, 6, v5
    s_cmp_lt_u32 s27, 2
    s_cselect_b32 s35, 98304, 0
    s_and_b32 s32, s27, 1
    s_lshl_b32 s32, s32, 5
    s_add_u32 s35, s35, s32
    v_add_u32 v10, s35, v10
    v_mul_u32_u24 v7, 896, v7
    v_add_u32 v7, v7, v5
    s_mul_i32 s35, s27, 224
    s_add_u32 s35, s35, 131072
    v_add_u32 v7, s35, v7
    ds_read_b64_tr_b16 v[128:129], v10 offset:0
    ds_read_b64_tr_b16 v[130:131], v10 offset:256
    ds_read_b64_tr_b16 v[132:133], v10 offset:2048
    ds_read_b64_tr_b16 v[134:135], v10 offset:2304
    ds_read_b64_tr_b16 v[136:137], v10 offset:4096
    ds_read_b64_tr_b16 v[138:139], v10 offset:4352
    ds_read_b64_tr_b16 v[140:141], v10 offset:6144
    ds_read_b64_tr_b16 v[142:143], v10 offset:6400
    ds_read_b64_tr_b16 v[144:145], v10 offset:8192
    ds_read_b64_tr_b16 v[146:147], v10 offset:8448
    ds_read_b64_tr_b16 v[148:149], v10 offset:10240
    ds_read_b64_tr_b16 v[150:151], v10 offset:10496
    ds_read_b64_tr_b16 v[152:153], v10 offset:12288
    ds_read_b64_tr_b16 v[154:155], v10 offset:12544
    ds_read_b64_tr_b16 v[156:157], v10 offset:14336
    ds_read_b64_tr_b16 v[158:159], v10 offset:14592
    ds_read_b64_tr_b16 v[160:161], v10 offset:16384
    ds_read_b64_tr_b16 v[162:163], v10 offset:16640
    ds_read_b64_tr_b16 v[164:165], v10 offset:18432
    ds_read_b64_tr_b16 v[166:167], v10 offset:18688
    ds_read_b64_tr_b16 v[168:169], v10 offset:20480
    ds_read_b64_tr_b16 v[170:171], v10 offset:20736
    ds_read_b64_tr_b16 v[172:173], v10 offset:22528
    ds_read_b64_tr_b16 v[174:175], v10 offset:22784
    ds_read_b64_tr_b16 v[176:177], v10 offset:24576
    ds_read_b64_tr_b16 v[178:179], v10 offset:24832
    ds_read_b64_tr_b16 v[180:181], v10 offset:26624
    ds_read_b64_tr_b16 v[182:183], v10 offset:26880
    ds_read_b64_tr_b16 v[192:193], v7 offset:0
    ds_read_b64_tr_b16 v[194:195], v7 offset:3584
    ds_read_b64_tr_b16 v[196:197], v7 offset:32
    ds_read_b64_tr_b16 v[198:199], v7 offset:3616
    ds_read_b64_tr_b16 v[200:201], v7 offset:64
    ds_read_b64_tr_b16 v[202:203], v7 offset:3648
    ds_read_b64_tr_b16 v[204:205], v7 offset:96
    ds_read_b64_tr_b16 v[206:207], v7 offset:3680
    ds_read_b64_tr_b16 v[208:209], v7 offset:128
    ds_read_b64_tr_b16 v[210:211], v7 offset:3712
    ds_read_b64_tr_b16 v[212:213], v7 offset:160
    ds_read_b64_tr_b16 v[214:215], v7 offset:3744
    ds_read_b64_tr_b16 v[216:217], v7 offset:192
    ds_read_b64_tr_b16 v[218:219], v7 offset:3776
    s_add_u32 s64, s56, 43515904
    s_addc_u32 s65, s57, 0
    s_mov_b32 s66, 163840
    s_mov_b32 s67, 0x20000
    s_add_u32 s60, s56, 42008576
    s_addc_u32 s61, s57, 0
    s_mov_b32 s62, 458752
    s_mov_b32 s63, 0x20000
    s_lshl_b32 s30, s46, 5
    v_lshlrev_b32 v11, 3, v2
    v_add_u32 v11, s30, v11
    v_add_u32 v11, 79104, v11
    ds_read_b64 v[120:121], v11
    v_mov_b32 v3, 83968
    v_mul_u32_u24 v8, 2560, v1
    s_cmp_lg_u32 s27, 0
    s_cbranch_scc1 T_kw
    s_mul_i32 s31, s46, 1920
    v_mov_b32 v10, 0
    s_mov_b32 s34, 200000
T_k1:
    buffer_load_dwordx2 v[12:13], v10, s[64:67], s31 offen sc1
    s_waitcnt vmcnt(0)
    v_cmp_ne_u32 vcc, s99, v13
    s_sub_u32 s34, s34, 1
    s_cbranch_scc1 T_k1_out
    s_cbranch_vccz T_k1_out
    s_nop 0
    s_sleep 4
    s_branch T_k1
T_k1_out:
    s_mov_b32 s34, 200000
T_k2:
    buffer_load_dwordx2 v[12:13], v8, s[64:67], 0 offen offset:0 sc1
    buffer_load_dwordx2 v[14:15], v8, s[64:67], 0 offen offset:640 sc1
    buffer_load_dwordx2 v[16:17], v8, s[64:67], 0 offen offset:1280 sc1
    buffer_load_dwordx2 v[18:19], v8, s[64:67], 0 offen offset:1920 sc1
    s_waitcnt vmcnt(0)
    v_xor_b32 v9, s99, v13
    v_xor_b32 v20, s99, v15
    v_or_b32 v9, v9, v20
    v_xor_b32 v20, s99, v17
    v_or_b32 v9, v9, v20
    v_xor_b32 v20, s99, v19
    v_or_b32 v9, v9, v20
    v_cmp_ne_u32 vcc, 0, v9
    s_sub_u32 s34, s34, 1
    s_cbranch_scc1 T_k2_out
    s_cbranch_vccz T_k2_out
    s_mov_b64 exec, vcc
    s_sleep 1
    s_branch T_k2
T_k2_out:
    s_mov_b64 exec, -1
    v_max_u32 v8, v12, v14
    v_max3_u32 v8, v8, v16, v18
    s_nop 1
    v_max_u32_dpp v8, v8, v8 quad_perm:[1,0,3,2] row_mask:0xf bank_mask:0xf
    s_nop 1
    v_max_u32_dpp v8, v8, v8 quad_perm:[2,3,0,1] row_mask:0xf bank_mask:0xf
    s_nop 1
    v_max_u32_dpp v8, v8, v8 row_half_mirror row_mask:0xf bank_mask:0xf
    s_nop 1
    v_max_u32_dpp v8, v8, v8 row_mirror row_mask:0xf bank_mask:0xf
    v_mov_b32 v11, v8
    s_nop 1
    v_permlane16_swap_b32 v8, v11
    s_nop 1
    v_max_u32 v8, v8, v11
    v_mov_b32 v11, v8
    s_nop 1
    v_permlane32_swap_b32 v8, v11
    s_nop 1
    v_max_u32 v8, v8, v11
    ds_write_b32 v3, v8
    s_waitcnt lgkmcnt(0)
T_kw:
    s_barrier
    ds_read_b32 v8, v3
    s_waitcnt lgkmcnt(0)
    s_nop 0
    v_readfirstlane_b32 s44, v8
    s_nop 3
    s_and_b32 s45, s44, 2047
    s_sub_u32 s45, 2047, s45
    s_lshr_b32 s31, s45, 3
    s_mul_i32 s31, s31, 1792
    s_mov_b32 s34, 200000
T_pr:
    buffer_load_dwordx4 v[16:19], v44, s[60:63], s31 offen sc1
    s_waitcnt vmcnt(0)
    v_max_u32 v9, v16, v17
    v_max3_u32 v9, v9, v18, v19
    v_cmp_eq_u32 vcc, -1, v9
    s_sub_u32 s34, s34, 1
    s_cbranch_scc1 T_pr_out
    s_cbranch_vccz T_pr_out
    s_nop 0
    s_sleep 1
    s_branch T_pr
T_pr_out:
    v_add_u32 v3, 84992, v44
    ds_write_b128 v3, v[16:19]
    v_lshlrev_b32 v5, 4, v2
    v_add_u32 v5, 84992, v5
    s_lshl_b32 s32, s27, 3
    s_or_b32 s32, s32, s2
    s_cmp_ge_u32 s32, 8
    s_cbranch_scc1 T_nw
    v_mov_b32 v9, s99
    s_mov_b64 exec, 1
    buffer_store_dwordx2 v[8:9], off, s[16:19], s33 sc1
    s_mov_b64 exec, -1
T_nw:
    s_waitcnt lgkmcnt(0)
    ds_read_b128 v[16:19], v5 offset:0
    ds_read_b128 v[20:23], v5 offset:64
    ds_read_b128 v[24:27], v5 offset:128
    ds_read_b128 v[28:31], v5 offset:192
    s_waitcnt lgkmcnt(3)
    v_mfma_f32_16x16x32_bf16 v[60:63], v[16:19], v[128:131], 0
    ds_read_b128 v[16:19], v5 offset:256
    s_waitcnt lgkmcnt(3)
    v_mfma_f32_16x16x32_bf16 v[60:63], v[20:23], v[132:135], v[60:63]
    ds_read_b128 v[20:23], v5 offset:320
    s_waitcnt lgkmcnt(3)
    v_mfma_f32_16x16x32_bf16 v[60:63], v[24:27], v[136:139], v[60:63]
    ds_read_b128 v[24:27], v5 offset:384
    s_waitcnt lgkmcnt(3)
    v_mfma_f32_16x16x32_bf16 v[60:63], v[28:31], v[140:143], v[60:63]
    ds_read_b128 v[28:31], v5 offset:448
    s_waitcnt lgkmcnt(3)
    v_mfma_f32_16x16x32_bf16 v[60:63], v[16:19], v[144:147], v[60:63]
    ds_read_b128 v[16:19], v5 offset:512
    s_waitcnt lgkmcnt(3)
    v_mfma_f32_16x16x32_bf16 v[60:63], v[20:23], v[148:151], v[60:63]
    ds_read_b128 v[20:23], v5 offset:576
    s_waitcnt lgkmcnt(3)
    v_mfma_f32_16x16x32_bf16 v[60:63], v[24:27], v[152:155], v[60:63]
    ds_read_b128 v[24:27], v5 offset:640
    s_waitcnt lgkmcnt(3)
    v_mfma_f32_16x16x32_bf16 v[60:63], v[28:31], v[156:159], v[60:63]
    ds_read_b128 v[28:31], v5 offset:704
    s_waitcnt lgkmcnt(3)
    v_mfma_f32_16x16x32_bf16 v[60:63], v[16:19], v[160:163], v[60:63]
    ds_read_b128 v[16:19], v5 offset:768
    s_waitcnt lgkmcnt(3)
    v_mfma_f32_16x16x32_bf16 v[60:63], v[20:23], v[164:167], v[60:63]
    ds_read_b128 v[20:23], v5 offset:832
    s_waitcnt lgkmcnt(3)
    v_mfma_f32_16x16x32_bf16 v[60:63], v[24:27], v[168:171], v[60:63]
    s_waitcnt lgkmcnt(2)
    v_mfma_f32_16x16x32_bf16 v[60:63], v[28:31], v[172:175], v[60:63]
    s_waitcnt lgkmcnt(1)
    v_mfma_f32_16x16x32_bf16 v[60:63], v[16:19], v[176:179], v[60:63]
    s_waitcnt lgkmcnt(0)
    v_mfma_f32_16x16x32_bf16 v[60:63], v[20:23], v[180:183], v[60:63]
    s_lshl_b32 s32, s27, 6
    s_add_u32 s35, s32, 86016
    v_and_b32 v8, 15, v1
    v_lshlrev_b32 v8, 2, v8
    v_add_u32 v8, s35, v8
    v_and_b32 v11, 31, v1
    v_lshlrev_b32 v10, 2, v11
    v_add_u32 v10, 86016, v10
    s_nop 1
    ds_write_b32 v8, v60
    s_waitcnt lgkmcnt(0)
    s_barrier
    ds_read_b32 v16, v10
    ds_read_b32 v17, v10 offset:128
    s_add_u32 s35, s32, 86272
    v_lshlrev_b32 v11, 1, v11
    v_add_u32 v11, s35, v11
    v_lshlrev_b32 v5, 4, v2
    v_add_u32 v5, s35, v5
    s_waitcnt lgkmcnt(0)
    v_cvt_pk_bf16_f32 v17, v16, v17
    v_lshlrev_b32 v16, 16, v17
    v_and_b32 v17, 0xffff0000, v17
    v_mul_f32 v18, 0xbfb8aa3b, v16
    v_exp_f32 v18, v18
    s_nop 0
    v_add_f32 v18, 1.0, v18
    v_rcp_f32 v18, v18
    s_nop 0
    v_mul_f32 v16, v16, v18
    v_cvt_pk_bf16_f32 v16, v16, v16
    v_and_b32 v16, 0xffff0000, v16
    v_mul_f32 v16, v16, v17
    v_cvt_pk_bf16_f32 v16, v16, v16
    ds_write_b16 v11, v16
    s_mul_i32 s3, s46, 1792
    s_mul_i32 s35, s27, 448
    s_add_u32 s3, s3, s35
    s_add_u32 s3, s3, 43057152
    s_waitcnt lgkmcnt(0)
    ds_read_b128 v[16:19], v5
    s_add_u32 s12, s56, s3
    s_addc_u32 s13, s57, 0
    s_mov_b32 s14, 448
    s_mov_b32 s15, 0x20000
    s_add_u32 s76, s56, 43057152
    s_addc_u32 s77, s57, 0
    s_mov_b32 s78, 100352
    s_mov_b32 s79, 0x20000
    v_cmp_eq_u32 s[40:41], 1, v2
    v_cmp_eq_u32 s[42:43], 2, v2
    v_cmp_eq_u32 s[58:59], 3, v2
    v_lshlrev_b32 v8, 2, v1
    s_waitcnt lgkmcnt(0)
    v_mfma_f32_16x16x32_bf16 v[128:131], v[16:19], v[192:195], 0
    v_mfma_f32_16x16x32_bf16 v[132:135], v[16:19], v[196:199], 0
    v_mfma_f32_16x16x32_bf16 v[136:139], v[16:19], v[200:203], 0
    v_mfma_f32_16x16x32_bf16 v[140:143], v[16:19], v[204:207], 0
    v_mfma_f32_16x16x32_bf16 v[144:147], v[16:19], v[208:211], 0
    v_mfma_f32_16x16x32_bf16 v[148:151], v[16:19], v[212:215], 0
    v_mfma_f32_16x16x32_bf16 v[152:155], v[16:19], v[216:219], 0
    s_nop 4
    v_cndmask_b32 v20, v128, v132, s[40:41]
    v_cndmask_b32 v20, v20, v136, s[42:43]
    v_cndmask_b32 v20, v20, v140, s[58:59]
    v_cndmask_b32 v21, v144, v148, s[40:41]
    v_min_u32 v20, -2, v20
    v_cndmask_b32 v21, v21, v152, s[42:43]
    v_min_u32 v21, -2, v21
    buffer_store_dword v20, v8, s[12:15], 0 offen sc1
    buffer_store_dword v21, v8, s[12:15], 0 offen offset:256 sc1
    s_cmp_eq_u32 s44, s47
    s_cbranch_scc1 T_won
    s_mov_b64 exec, s[54:55]
    buffer_store_dwordx2 v[112:113], v6, s[8:11], 0 offen
    buffer_store_dwordx2 v[114:115], v6, s[8:11], 0 offen offset:32
    buffer_store_dwordx2 v[116:117], v47, s[8:11], 0 offen
    buffer_store_dwordx2 v[118:119], v47, s[8:11], 0 offen offset:32
    s_mov_b64 exec, -1
T_won:
    s_cmp_lg_u32 s27, 0
    s_cbranch_scc1 K2_fin
    v_mul_u32_u24 v11, 1792, v1
    v_lshlrev_b32 v10, 2, v2
    s_lshl_b32 s32, s46, 4
    s_add_u32 s35, s32, s31
    s_and_b32 s24, s44, 0xffff0000
    s_xor_b32 s25, s24, 0x80000000
    s_xor_b32 s26, s24, 0xffff0000
    s_cmp_lt_i32 s24, 0
    s_cselect_b32 s24, s25, s26
    v_mov_b32 v28, s24
    v_mul_f32 v28, 0xbfb8aa3b, v28
    v_exp_f32 v28, v28
    s_nop 0
    v_add_f32 v28, 1.0, v28
    v_rcp_f32 v28, v28
    s_nop 0
    v_cvt_pk_bf16_f32 v28, v28, v28
    v_and_b32 v28, 0xffff0000, v28
    s_mul_i32 s3, s45, 896
    s_add_u32 s12, s38, s3
    s_addc_u32 s13, s39, 0
    s_mov_b32 s14, 896
    s_mov_b32 s15, 0x20000
    s_sleep 6
    s_mov_b32 s34, 200000
T_py:
    buffer_load_dwordx4 v[32:35], v11, s[76:79], s30 offen sc1
    buffer_load_dwordx4 v[36:39], v11, s[76:79], s30 offen offset:16 sc1
    buffer_load_dword v72, v10, s[60:63], s35 offen sc1
    buffer_load_dword v73, v10, s[60:63], s35 offen offset:896 sc1
    s_waitcnt vmcnt(0)
    v_max_u32 v9, v32, v33
    v_max3_u32 v9, v9, v34, v35
    v_max3_u32 v9, v9, v36, v37
    v_max3_u32 v9, v9, v38, v39
    v_max3_u32 v9, v9, v72, v73
    v_cmp_eq_u32 vcc, -1, v9
    s_sub_u32 s34, s34, 1
    s_cbranch_scc1 T_py_out
    s_cbranch_vccz T_py_out
    s_nop 0
    s_sleep 2
    s_branch T_py
T_py_out:
    v_permlane32_swap_b32 v32, v36
    v_permlane32_swap_b32 v33, v37
    v_permlane32_swap_b32 v34, v38
    v_permlane32_swap_b32 v35, v39
    s_nop 0
    v_add_f32 v32, v32, v36
    v_add_f32 v33, v33, v37
    v_add_f32 v34, v34, v38
    v_add_f32 v35, v35, v39
    s_nop 0
    v_permlane16_swap_b32 v32, v34
    v_permlane16_swap_b32 v33, v35
    s_nop 1
    v_add_f32 v32, v32, v34
    v_add_f32 v33, v33, v35
    s_nop 1
    v_add_f32_dpp v32, v32, v32 quad_perm:[1,0,3,2] row_mask:0xf bank_mask:0xf
    v_add_f32_dpp v33, v33, v33 quad_perm:[1,0,3,2] row_mask:0xf bank_mask:0xf
    s_nop 1
    v_add_f32_dpp v32, v32, v32 quad_perm:[2,3,0,1] row_mask:0xf bank_mask:0xf
    v_add_f32_dpp v33, v33, v33 quad_perm:[2,3,0,1] row_mask:0xf bank_mask:0xf
    s_nop 1
    v_add_f32_dpp v32, v32, v32 row_half_mirror row_mask:0xf bank_mask:0xf
    v_add_f32_dpp v33, v33, v33 row_half_mirror row_mask:0xf bank_mask:0xf
    s_nop 1
    v_add_f32_dpp v32, v32, v32 row_mirror row_mask:0xf bank_mask:0xf
    v_add_f32_dpp v33, v33, v33 row_mirror row_mask:0xf bank_mask:0xf
    v_cvt_pk_bf16_f32 v33, v32, v33
    v_lshlrev_b32 v32, 16, v33
    v_and_b32 v33, 0xffff0000, v33
    v_mul_f32 v32, v32, v28
    v_mul_f32 v33, v33, v28
    v_lshlrev_b32 v12, 16, v72
    v_and_b32 v13, 0xffff0000, v72
    v_cvt_pk_bf16_f32 v33, v32, v33
    v_lshlrev_b32 v32, 16, v33
    v_and_b32 v33, 0xffff0000, v33
    v_add_f32 v32, v32, v12
    v_add_f32 v33, v33, v13
    v_lshlrev_b32 v12, 16, v73
    v_and_b32 v13, 0xffff0000, v73
    v_cvt_pk_bf16_f32 v33, v32, v33
    v_lshlrev_b32 v32, 16, v33
    v_and_b32 v33, 0xffff0000, v33
    v_mul_f32 v32, v32, v120
    v_mul_f32 v33, v33, v121
    v_cvt_pk_bf16_f32 v33, v32, v33
    v_lshlrev_b32 v32, 16, v33
    v_and_b32 v33, 0xffff0000, v33
    v_add_f32 v32, v32, v12
    v_add_f32 v33, v33, v13
    v_cvt_pk_bf16_f32 v32, v32, v33
    s_mov_b32 exec_lo, 0x00010001
    s_mov_b32 exec_hi, 0x00010001
    buffer_store_dword v32, v10, s[12:15], s32 offen
K2_fin:
K2_end:
    s_endpgm
L_slow_p0:
    s_nop 7
    s_nop 7
    v_max3_f32 v250, v128, v129, v130
    v_max3_f32 v250, v250, v131, v144
    v_max3_f32 v250, v250, v145, v146
    v_max_f32 v250, v250, v147
    v_mov_b32 v251, v250
    s_nop 1
    v_permlane16_swap_b32 v250, v251
    s_nop 1
    v_max_f32 v250, v250, v251
    v_mov_b32 v251, v250
    s_nop 1
    v_permlane32_swap_b32 v250, v251
    s_nop 1
    v_max_f32 v250, v250, v251
    v_add_f32 v250, s26, v250
    v_max_f32 v250, 0, v250
    v_exp_f32 v251, -v250
    v_sub_f32 v224, v224, v250
    v_sub_f32 v225, v225, v250
    v_sub_f32 v226, v226, v250
    v_sub_f32 v227, v227, v250
    v_sub_f32 v128, v128, v250
    v_sub_f32 v129, v129, v250
    v_sub_f32 v130, v130, v250
    v_sub_f32 v131, v131, v250
    v_sub_f32 v144, v144, v250
    v_sub_f32 v145, v145, v250
    v_sub_f32 v146, v146, v250
    v_sub_f32 v147, v147, v250
    v_mul_f32 v240, v240, v251
    v_accvgpr_read_b32 v248, a0
    v_accvgpr_read_b32 v249, a1
    v_mul_f32 v248, v248, v251
    v_mul_f32 v249, v249, v251
    v_accvgpr_write_b32 a0, v248
    v_accvgpr_write_b32 a1, v249
    v_accvgpr_read_b32 v248, a2
    v_accvgpr_read_b32 v249, a3
    v_mul_f32 v248, v248, v251
    v_mul_f32 v249, v249, v251
    v_accvgpr_write_b32 a2, v248
    v_accvgpr_write_b32 a3, v249
    v_accvgpr_read_b32 v248, a16
    v_accvgpr_read_b32 v249, a17
    v_mul_f32 v248, v248, v251
    v_mul_f32 v249, v249, v251
    v_accvgpr_write_b32 a16, v248
    v_accvgpr_write_b32 a17, v249
    v_accvgpr_read_b32 v248, a18
    v_accvgpr_read_b32 v249, a19
    v_mul_f32 v248, v248, v251
    v_mul_f32 v249, v249, v251
    v_accvgpr_write_b32 a18, v248
    v_accvgpr_write_b32 a19, v249
    v_accvgpr_read_b32 v248, a32
    v_accvgpr_read_b32 v249, a33
    v_mul_f32 v248, v248, v251
    v_mul_f32 v249, v249, v251
    v_accvgpr_write_b32 a32, v248
    v_accvgpr_write_b32 a33, v249
    v_accvgpr_read_b32 v248, a34
    v_accvgpr_read_b32 v249, a35
    v_mul_f32 v248, v248, v251
    v_mul_f32 v249, v249, v251
    v_accvgpr_write_b32 a34, v248
    v_accvgpr_write_b32 a35, v249
    v_accvgpr_read_b32 v248, a48
    v_accvgpr_read_b32 v249, a49
    v_mul_f32 v248, v248, v251
    v_mul_f32 v249, v249, v251
    v_accvgpr_write_b32 a48, v248
    v_accvgpr_write_b32 a49, v249
    v_accvgpr_read_b32 v248, a50
    v_accvgpr_read_b32 v249, a51
    v_mul_f32 v248, v248, v251
    v_mul_f32 v249, v249, v251
    v_accvgpr_write_b32 a50, v248
    v_accvgpr_write_b32 a51, v249
    v_accvgpr_read_b32 v248, a64
    v_accvgpr_read_b32 v249, a65
    v_mul_f32 v248, v248, v251
    v_mul_f32 v249, v249, v251
    v_accvgpr_write_b32 a64, v248
    v_accvgpr_write_b32 a65, v249
    v_accvgpr_read_b32 v248, a66
    v_accvgpr_read_b32 v249, a67
    v_mul_f32 v248, v248, v251
    v_mul_f32 v249, v249, v251
    v_accvgpr_write_b32 a66, v248
    v_accvgpr_write_b32 a67, v249
    v_accvgpr_read_b32 v248, a80
    v_accvgpr_read_b32 v249, a81
    v_mul_f32 v248, v248, v251
    v_mul_f32 v249, v249, v251
    v_accvgpr_write_b32 a80, v248
    v_accvgpr_write_b32 a81, v249
    v_accvgpr_read_b32 v248, a82
    v_accvgpr_read_b32 v249, a83
    v_mul_f32 v248, v248, v251
    v_mul_f32 v249, v249, v251
    v_accvgpr_write_b32 a82, v248
    v_accvgpr_write_b32 a83, v249
    v_accvgpr_read_b32 v248, a96
    v_accvgpr_read_b32 v249, a97
    v_mul_f32 v248, v248, v251
    v_mul_f32 v249, v249, v251
    v_accvgpr_write_b32 a96, v248
    v_accvgpr_write_b32 a97, v249
    v_accvgpr_read_b32 v248, a98
    v_accvgpr_read_b32 v249, a99
    v_mul_f32 v248, v248, v251
    v_mul_f32 v249, v249, v251
    v_accvgpr_write_b32 a98, v248
    v_accvgpr_write_b32 a99, v249
    v_accvgpr_read_b32 v248, a112
    v_accvgpr_read_b32 v249, a113
    v_mul_f32 v248, v248, v251
    v_mul_f32 v249, v249, v251
    v_accvgpr_write_b32 a112, v248
    v_accvgpr_write_b32 a113, v249
    v_accvgpr_read_b32 v248, a114
    v_accvgpr_read_b32 v249, a115
    v_mul_f32 v248, v248, v251
    v_mul_f32 v249, v249, v251
    v_accvgpr_write_b32 a114, v248
    v_accvgpr_write_b32 a115, v249
    v_accvgpr_read_b32 v248, a128
    v_accvgpr_read_b32 v249, a129
    v_mul_f32 v248, v248, v251
    v_mul_f32 v249, v249, v251
    v_accvgpr_write_b32 a128, v248
    v_accvgpr_write_b32 a129, v249
    v_accvgpr_read_b32 v248, a130
    v_accvgpr_read_b32 v249, a131
    v_mul_f32 v248, v248, v251
    v_mul_f32 v249, v249, v251
    v_accvgpr_write_b32 a130, v248
    v_accvgpr_write_b32 a131, v249
    v_accvgpr_read_b32 v248, a144
    v_accvgpr_read_b32 v249, a145
    v_mul_f32 v248, v248, v251
    v_mul_f32 v249, v249, v251
    v_accvgpr_write_b32 a144, v248
    v_accvgpr_write_b32 a145, v249
    v_accvgpr_read_b32 v248, a146
    v_accvgpr_read_b32 v249, a147
    v_mul_f32 v248, v248, v251
    v_mul_f32 v249, v249, v251
    v_accvgpr_write_b32 a146, v248
    v_accvgpr_write_b32 a147, v249
    v_accvgpr_read_b32 v248, a160
    v_accvgpr_read_b32 v249, a161
    v_mul_f32 v248, v248, v251
    v_mul_f32 v249, v249, v251
    v_accvgpr_write_b32 a160, v248
    v_accvgpr_write_b32 a161, v249
    v_accvgpr_read_b32 v248, a162
    v_accvgpr_read_b32 v249, a163
    v_mul_f32 v248, v248, v251
    v_mul_f32 v249, v249, v251
    v_accvgpr_write_b32 a162, v248
    v_accvgpr_write_b32 a163, v249
    v_accvgpr_read_b32 v248, a176
    v_accvgpr_read_b32 v249, a177
    v_mul_f32 v248, v248, v251
    v_mul_f32 v249, v249, v251
    v_accvgpr_write_b32 a176, v248
    v_accvgpr_write_b32 a177, v249
    v_accvgpr_read_b32 v248, a178
    v_accvgpr_read_b32 v249, a179
    v_mul_f32 v248, v248, v251
    v_mul_f32 v249, v249, v251
    v_accvgpr_write_b32 a178, v248
    v_accvgpr_write_b32 a179, v249
    v_accvgpr_read_b32 v248, a192
    v_accvgpr_read_b32 v249, a193
    v_mul_f32 v248, v248, v251
    v_mul_f32 v249, v249, v251
    v_accvgpr_write_b32 a192, v248
    v_accvgpr_write_b32 a193, v249
    v_accvgpr_read_b32 v248, a194
    v_accvgpr_read_b32 v249, a195
    v_mul_f32 v248, v248, v251
    v_mul_f32 v249, v249, v251
    v_accvgpr_write_b32 a194, v248
    v_accvgpr_write_b32 a195, v249
    v_accvgpr_read_b32 v248, a208
    v_accvgpr_read_b32 v249, a209
    v_mul_f32 v248, v248, v251
    v_mul_f32 v249, v249, v251
    v_accvgpr_write_b32 a208, v248
    v_accvgpr_write_b32 a209, v249
    v_accvgpr_read_b32 v248, a210
    v_accvgpr_read_b32 v249, a211
    v_mul_f32 v248, v248, v251
    v_mul_f32 v249, v249, v251
    v_accvgpr_write_b32 a210, v248
    v_accvgpr_write_b32 a211, v249
    v_accvgpr_read_b32 v248, a224
    v_accvgpr_read_b32 v249, a225
    v_mul_f32 v248, v248, v251
    v_mul_f32 v249, v249, v251
    v_accvgpr_write_b32 a224, v248
    v_accvgpr_write_b32 a225, v249
    v_accvgpr_read_b32 v248, a226
    v_accvgpr_read_b32 v249, a227
    v_mul_f32 v248, v248, v251
    v_mul_f32 v249, v249, v251
    v_accvgpr_write_b32 a226, v248
    v_accvgpr_write_b32 a227, v249
    v_accvgpr_read_b32 v248, a240
    v_accvgpr_read_b32 v249, a241
    v_mul_f32 v248, v248, v251
    v_mul_f32 v249, v249, v251
    v_accvgpr_write_b32 a240, v248
    v_accvgpr_write_b32 a241, v249
    v_accvgpr_read_b32 v248, a242
    v_accvgpr_read_b32 v249, a243
    v_mul_f32 v248, v248, v251
    v_mul_f32 v249, v249, v251
    v_accvgpr_write_b32 a242, v248
    v_accvgpr_write_b32 a243, v249
    v_exp_f32 v248, v128
    v_exp_f32 v249, v129
    s_nop 0
    v_add_f32 v244, v240, v248
    v_add_f32 v244, v244, v249
    v_cvt_pk_bf16_f32 v176, v248, v249
    v_exp_f32 v248, v130
    v_exp_f32 v249, v131
    s_nop 0
    v_add_f32 v244, v244, v248
    v_add_f32 v244, v244, v249
    v_cvt_pk_bf16_f32 v177, v248, v249
    v_exp_f32 v248, v144
    v_exp_f32 v249, v145
    s_nop 0
    v_add_f32 v244, v244, v248
    v_add_f32 v244, v244, v249
    v_cvt_pk_bf16_f32 v178, v248, v249
    v_exp_f32 v248, v146
    v_exp_f32 v249, v147
    s_nop 0
    v_add_f32 v244, v244, v248
    v_add_f32 v244, v244, v249
    v_cvt_pk_bf16_f32 v179, v248, v249
    v_max3_f32 v250, v132, v133, v134
    v_max3_f32 v250, v250, v135, v148
    v_max3_f32 v250, v250, v149, v150
    v_max_f32 v250, v250, v151
    v_mov_b32 v251, v250
    s_nop 1
    v_permlane16_swap_b32 v250, v251
    s_nop 1
    v_max_f32 v250, v250, v251
    v_mov_b32 v251, v250
    s_nop 1
    v_permlane32_swap_b32 v250, v251
    s_nop 1
    v_max_f32 v250, v250, v251
    v_add_f32 v250, s26, v250
    v_max_f32 v250, 0, v250
    v_exp_f32 v251, -v250
    v_sub_f32 v228, v228, v250
    v_sub_f32 v229, v229, v250
    v_sub_f32 v230, v230, v250
    v_sub_f32 v231, v231, v250
    v_sub_f32 v132, v132, v250
    v_sub_f32 v133, v133, v250
    v_sub_f32 v134, v134, v250
    v_sub_f32 v135, v135, v250
    v_sub_f32 v148, v148, v250
    v_sub_f32 v149, v149, v250
    v_sub_f32 v150, v150, v250
    v_sub_f32 v151, v151, v250
    v_mul_f32 v241, v241, v251
    v_accvgpr_read_b32 v248, a4
    v_accvgpr_read_b32 v249, a5
    v_mul_f32 v248, v248, v251
    v_mul_f32 v249, v249, v251
    v_accvgpr_write_b32 a4, v248
    v_accvgpr_write_b32 a5, v249
    v_accvgpr_read_b32 v248, a6
    v_accvgpr_read_b32 v249, a7
    v_mul_f32 v248, v248, v251
    v_mul_f32 v249, v249, v251
    v_accvgpr_write_b32 a6, v248
    v_accvgpr_write_b32 a7, v249
    v_accvgpr_read_b32 v248, a20
    v_accvgpr_read_b32 v249, a21
    v_mul_f32 v248, v248, v251
    v_mul_f32 v249, v249, v251
    v_accvgpr_write_b32 a20, v248
    v_accvgpr_write_b32 a21, v249
    v_accvgpr_read_b32 v248, a22
    v_accvgpr_read_b32 v249, a23
    v_mul_f32 v248, v248, v251
    v_mul_f32 v249, v249, v251
    v_accvgpr_write_b32 a22, v248
    v_accvgpr_write_b32 a23, v249
    v_accvgpr_read_b32 v248, a36
    v_accvgpr_read_b32 v249, a37
    v_mul_f32 v248, v248, v251
    v_mul_f32 v249, v249, v251
    v_accvgpr_write_b32 a36, v248
    v_accvgpr_write_b32 a37, v249
    v_accvgpr_read_b32 v248, a38
    v_accvgpr_read_b32 v249, a39
    v_mul_f32 v248, v248, v251
    v_mul_f32 v249, v249, v251
    v_accvgpr_write_b32 a38, v248
    v_accvgpr_write_b32 a39, v249
    v_accvgpr_read_b32 v248, a52
    v_accvgpr_read_b32 v249, a53
    v_mul_f32 v248, v248, v251
    v_mul_f32 v249, v249, v251
    v_accvgpr_write_b32 a52, v248
    v_accvgpr_write_b32 a53, v249
    v_accvgpr_read_b32 v248, a54
    v_accvgpr_read_b32 v249, a55
    v_mul_f32 v248, v248, v251
    v_mul_f32 v249, v249, v251
    v_accvgpr_write_b32 a54, v248
    v_accvgpr_write_b32 a55, v249
    v_accvgpr_read_b32 v248, a68
    v_accvgpr_read_b32 v249, a69
    v_mul_f32 v248, v248, v251
    v_mul_f32 v249, v249, v251
    v_accvgpr_write_b32 a68, v248
    v_accvgpr_write_b32 a69, v249
    v_accvgpr_read_b32 v248, a70
    v_accvgpr_read_b32 v249, a71
    v_mul_f32 v248, v248, v251
    v_mul_f32 v249, v249, v251
    v_accvgpr_write_b32 a70, v248
    v_accvgpr_write_b32 a71, v249
    v_accvgpr_read_b32 v248, a84
    v_accvgpr_read_b32 v249, a85
    v_mul_f32 v248, v248, v251
    v_mul_f32 v249, v249, v251
    v_accvgpr_write_b32 a84, v248
    v_accvgpr_write_b32 a85, v249
    v_accvgpr_read_b32 v248, a86
    v_accvgpr_read_b32 v249, a87
    v_mul_f32 v248, v248, v251
    v_mul_f32 v249, v249, v251
    v_accvgpr_write_b32 a86, v248
    v_accvgpr_write_b32 a87, v249
    v_accvgpr_read_b32 v248, a100
    v_accvgpr_read_b32 v249, a101
    v_mul_f32 v248, v248, v251
    v_mul_f32 v249, v249, v251
    v_accvgpr_write_b32 a100, v248
    v_accvgpr_write_b32 a101, v249
    v_accvgpr_read_b32 v248, a102
    v_accvgpr_read_b32 v249, a103
    v_mul_f32 v248, v248, v251
    v_mul_f32 v249, v249, v251
    v_accvgpr_write_b32 a102, v248
    v_accvgpr_write_b32 a103, v249
    v_accvgpr_read_b32 v248, a116
    v_accvgpr_read_b32 v249, a117
    v_mul_f32 v248, v248, v251
    v_mul_f32 v249, v249, v251
    v_accvgpr_write_b32 a116, v248
    v_accvgpr_write_b32 a117, v249
    v_accvgpr_read_b32 v248, a118
    v_accvgpr_read_b32 v249, a119
    v_mul_f32 v248, v248, v251
    v_mul_f32 v249, v249, v251
    v_accvgpr_write_b32 a118, v248
    v_accvgpr_write_b32 a119, v249
    v_accvgpr_read_b32 v248, a132
    v_accvgpr_read_b32 v249, a133
    v_mul_f32 v248, v248, v251
    v_mul_f32 v249, v249, v251
    v_accvgpr_write_b32 a132, v248
    v_accvgpr_write_b32 a133, v249
    v_accvgpr_read_b32 v248, a134
    v_accvgpr_read_b32 v249, a135
    v_mul_f32 v248, v248, v251
    v_mul_f32 v249, v249, v251
    v_accvgpr_write_b32 a134, v248
    v_accvgpr_write_b32 a135, v249
    v_accvgpr_read_b32 v248, a148
    v_accvgpr_read_b32 v249, a149
    v_mul_f32 v248, v248, v251
    v_mul_f32 v249, v249, v251
    v_accvgpr_write_b32 a148, v248
    v_accvgpr_write_b32 a149, v249
    v_accvgpr_read_b32 v248, a150
    v_accvgpr_read_b32 v249, a151
    v_mul_f32 v248, v248, v251
    v_mul_f32 v249, v249, v251
    v_accvgpr_write_b32 a150, v248
    v_accvgpr_write_b32 a151, v249
    v_accvgpr_read_b32 v248, a164
    v_accvgpr_read_b32 v249, a165
    v_mul_f32 v248, v248, v251
    v_mul_f32 v249, v249, v251
    v_accvgpr_write_b32 a164, v248
    v_accvgpr_write_b32 a165, v249
    v_accvgpr_read_b32 v248, a166
    v_accvgpr_read_b32 v249, a167
    v_mul_f32 v248, v248, v251
    v_mul_f32 v249, v249, v251
    v_accvgpr_write_b32 a166, v248
    v_accvgpr_write_b32 a167, v249
    v_accvgpr_read_b32 v248, a180
    v_accvgpr_read_b32 v249, a181
    v_mul_f32 v248, v248, v251
    v_mul_f32 v249, v249, v251
    v_accvgpr_write_b32 a180, v248
    v_accvgpr_write_b32 a181, v249
    v_accvgpr_read_b32 v248, a182
    v_accvgpr_read_b32 v249, a183
    v_mul_f32 v248, v248, v251
    v_mul_f32 v249, v249, v251
    v_accvgpr_write_b32 a182, v248
    v_accvgpr_write_b32 a183, v249
    v_accvgpr_read_b32 v248, a196
    v_accvgpr_read_b32 v249, a197
    v_mul_f32 v248, v248, v251
    v_mul_f32 v249, v249, v251
    v_accvgpr_write_b32 a196, v248
    v_accvgpr_write_b32 a197, v249
    v_accvgpr_read_b32 v248, a198
    v_accvgpr_read_b32 v249, a199
    v_mul_f32 v248, v248, v251
    v_mul_f32 v249, v249, v251
    v_accvgpr_write_b32 a198, v248
    v_accvgpr_write_b32 a199, v249
    v_accvgpr_read_b32 v248, a212
    v_accvgpr_read_b32 v249, a213
    v_mul_f32 v248, v248, v251
    v_mul_f32 v249, v249, v251
    v_accvgpr_write_b32 a212, v248
    v_accvgpr_write_b32 a213, v249
    v_accvgpr_read_b32 v248, a214
    v_accvgpr_read_b32 v249, a215
    v_mul_f32 v248, v248, v251
    v_mul_f32 v249, v249, v251
    v_accvgpr_write_b32 a214, v248
    v_accvgpr_write_b32 a215, v249
    v_accvgpr_read_b32 v248, a228
    v_accvgpr_read_b32 v249, a229
    v_mul_f32 v248, v248, v251
    v_mul_f32 v249, v249, v251
    v_accvgpr_write_b32 a228, v248
    v_accvgpr_write_b32 a229, v249
    v_accvgpr_read_b32 v248, a230
    v_accvgpr_read_b32 v249, a231
    v_mul_f32 v248, v248, v251
    v_mul_f32 v249, v249, v251
    v_accvgpr_write_b32 a230, v248
    v_accvgpr_write_b32 a231, v249
    v_accvgpr_read_b32 v248, a244
    v_accvgpr_read_b32 v249, a245
    v_mul_f32 v248, v248, v251
    v_mul_f32 v249, v249, v251
    v_accvgpr_write_b32 a244, v248
    v_accvgpr_write_b32 a245, v249
    v_accvgpr_read_b32 v248, a246
    v_accvgpr_read_b32 v249, a247
    v_mul_f32 v248, v248, v251
    v_mul_f32 v249, v249, v251
    v_accvgpr_write_b32 a246, v248
    v_accvgpr_write_b32 a247, v249
    v_exp_f32 v248, v132
    v_exp_f32 v249, v133
    s_nop 0
    v_add_f32 v245, v241, v248
    v_add_f32 v245, v245, v249
    v_cvt_pk_bf16_f32 v180, v248, v249
    v_exp_f32 v248, v134
    v_exp_f32 v249, v135
    s_nop 0
    v_add_f32 v245, v245, v248
    v_add_f32 v245, v245, v249
    v_cvt_pk_bf16_f32 v181, v248, v249
    v_exp_f32 v248, v148
    v_exp_f32 v249, v149
    s_nop 0
    v_add_f32 v245, v245, v248
    v_add_f32 v245, v245, v249
    v_cvt_pk_bf16_f32 v182, v248, v249
    v_exp_f32 v248, v150
    v_exp_f32 v249, v151
    s_nop 0
    v_add_f32 v245, v245, v248
    v_add_f32 v245, v245, v249
    v_cvt_pk_bf16_f32 v183, v248, v249
    v_max3_f32 v250, v136, v137, v138
    v_max3_f32 v250, v250, v139, v152
    v_max3_f32 v250, v250, v153, v154
    v_max_f32 v250, v250, v155
    v_mov_b32 v251, v250
    s_nop 1
    v_permlane16_swap_b32 v250, v251
    s_nop 1
    v_max_f32 v250, v250, v251
    v_mov_b32 v251, v250
    s_nop 1
    v_permlane32_swap_b32 v250, v251
    s_nop 1
    v_max_f32 v250, v250, v251
    v_add_f32 v250, s26, v250
    v_max_f32 v250, 0, v250
    v_exp_f32 v251, -v250
    v_sub_f32 v232, v232, v250
    v_sub_f32 v233, v233, v250
    v_sub_f32 v234, v234, v250
    v_sub_f32 v235, v235, v250
    v_sub_f32 v136, v136, v250
    v_sub_f32 v137, v137, v250
    v_sub_f32 v138, v138, v250
    v_sub_f32 v139, v139, v250
    v_sub_f32 v152, v152, v250
    v_sub_f32 v153, v153, v250
    v_sub_f32 v154, v154, v250
    v_sub_f32 v155, v155, v250
    v_mul_f32 v242, v242, v251
    v_accvgpr_read_b32 v248, a8
    v_accvgpr_read_b32 v249, a9
    v_mul_f32 v248, v248, v251
    v_mul_f32 v249, v249, v251
    v_accvgpr_write_b32 a8, v248
    v_accvgpr_write_b32 a9, v249
    v_accvgpr_read_b32 v248, a10
    v_accvgpr_read_b32 v249, a11
    v_mul_f32 v248, v248, v251
    v_mul_f32 v249, v249, v251
    v_accvgpr_write_b32 a10, v248
    v_accvgpr_write_b32 a11, v249
    v_accvgpr_read_b32 v248, a24
    v_accvgpr_read_b32 v249, a25
    v_mul_f32 v248, v248, v251
    v_mul_f32 v249, v249, v251
    v_accvgpr_write_b32 a24, v248
    v_accvgpr_write_b32 a25, v249
    v_accvgpr_read_b32 v248, a26
    v_accvgpr_read_b32 v249, a27
    v_mul_f32 v248, v248, v251
    v_mul_f32 v249, v249, v251
    v_accvgpr_write_b32 a26, v248
    v_accvgpr_write_b32 a27, v249
    v_accvgpr_read_b32 v248, a40
    v_accvgpr_read_b32 v249, a41
    v_mul_f32 v248, v248, v251
    v_mul_f32 v249, v249, v251
    v_accvgpr_write_b32 a40, v248
    v_accvgpr_write_b32 a41, v249
    v_accvgpr_read_b32 v248, a42
    v_accvgpr_read_b32 v249, a43
    v_mul_f32 v248, v248, v251
    v_mul_f32 v249, v249, v251
    v_accvgpr_write_b32 a42, v248
    v_accvgpr_write_b32 a43, v249
    v_accvgpr_read_b32 v248, a56
    v_accvgpr_read_b32 v249, a57
    v_mul_f32 v248, v248, v251
    v_mul_f32 v249, v249, v251
    v_accvgpr_write_b32 a56, v248
    v_accvgpr_write_b32 a57, v249
    v_accvgpr_read_b32 v248, a58
    v_accvgpr_read_b32 v249, a59
    v_mul_f32 v248, v248, v251
    v_mul_f32 v249, v249, v251
    v_accvgpr_write_b32 a58, v248
    v_accvgpr_write_b32 a59, v249
    v_accvgpr_read_b32 v248, a72
    v_accvgpr_read_b32 v249, a73
    v_mul_f32 v248, v248, v251
    v_mul_f32 v249, v249, v251
    v_accvgpr_write_b32 a72, v248
    v_accvgpr_write_b32 a73, v249
    v_accvgpr_read_b32 v248, a74
    v_accvgpr_read_b32 v249, a75
    v_mul_f32 v248, v248, v251
    v_mul_f32 v249, v249, v251
    v_accvgpr_write_b32 a74, v248
    v_accvgpr_write_b32 a75, v249
    v_accvgpr_read_b32 v248, a88
    v_accvgpr_read_b32 v249, a89
    v_mul_f32 v248, v248, v251
    v_mul_f32 v249, v249, v251
    v_accvgpr_write_b32 a88, v248
    v_accvgpr_write_b32 a89, v249
    v_accvgpr_read_b32 v248, a90
    v_accvgpr_read_b32 v249, a91
    v_mul_f32 v248, v248, v251
    v_mul_f32 v249, v249, v251
    v_accvgpr_write_b32 a90, v248
    v_accvgpr_write_b32 a91, v249
    v_accvgpr_read_b32 v248, a104
    v_accvgpr_read_b32 v249, a105
    v_mul_f32 v248, v248, v251
    v_mul_f32 v249, v249, v251
    v_accvgpr_write_b32 a104, v248
    v_accvgpr_write_b32 a105, v249
    v_accvgpr_read_b32 v248, a106
    v_accvgpr_read_b32 v249, a107
    v_mul_f32 v248, v248, v251
    v_mul_f32 v249, v249, v251
    v_accvgpr_write_b32 a106, v248
    v_accvgpr_write_b32 a107, v249
    v_accvgpr_read_b32 v248, a120
    v_accvgpr_read_b32 v249, a121
    v_mul_f32 v248, v248, v251
    v_mul_f32 v249, v249, v251
    v_accvgpr_write_b32 a120, v248
    v_accvgpr_write_b32 a121, v249
    v_accvgpr_read_b32 v248, a122
    v_accvgpr_read_b32 v249, a123
    v_mul_f32 v248, v248, v251
    v_mul_f32 v249, v249, v251
    v_accvgpr_write_b32 a122, v248
    v_accvgpr_write_b32 a123, v249
    v_accvgpr_read_b32 v248, a136
    v_accvgpr_read_b32 v249, a137
    v_mul_f32 v248, v248, v251
    v_mul_f32 v249, v249, v251
    v_accvgpr_write_b32 a136, v248
    v_accvgpr_write_b32 a137, v249
    v_accvgpr_read_b32 v248, a138
    v_accvgpr_read_b32 v249, a139
    v_mul_f32 v248, v248, v251
    v_mul_f32 v249, v249, v251
    v_accvgpr_write_b32 a138, v248
    v_accvgpr_write_b32 a139, v249
    v_accvgpr_read_b32 v248, a152
    v_accvgpr_read_b32 v249, a153
    v_mul_f32 v248, v248, v251
    v_mul_f32 v249, v249, v251
    v_accvgpr_write_b32 a152, v248
    v_accvgpr_write_b32 a153, v249
    v_accvgpr_read_b32 v248, a154
    v_accvgpr_read_b32 v249, a155
    v_mul_f32 v248, v248, v251
    v_mul_f32 v249, v249, v251
    v_accvgpr_write_b32 a154, v248
    v_accvgpr_write_b32 a155, v249
    v_accvgpr_read_b32 v248, a168
    v_accvgpr_read_b32 v249, a169
    v_mul_f32 v248, v248, v251
    v_mul_f32 v249, v249, v251
    v_accvgpr_write_b32 a168, v248
    v_accvgpr_write_b32 a169, v249
    v_accvgpr_read_b32 v248, a170
    v_accvgpr_read_b32 v249, a171
    v_mul_f32 v248, v248, v251
    v_mul_f32 v249, v249, v251
    v_accvgpr_write_b32 a170, v248
    v_accvgpr_write_b32 a171, v249
    v_accvgpr_read_b32 v248, a184
    v_accvgpr_read_b32 v249, a185
    v_mul_f32 v248, v248, v251
    v_mul_f32 v249, v249, v251
    v_accvgpr_write_b32 a184, v248
    v_accvgpr_write_b32 a185, v249
    v_accvgpr_read_b32 v248, a186
    v_accvgpr_read_b32 v249, a187
    v_mul_f32 v248, v248, v251
    v_mul_f32 v249, v249, v251
    v_accvgpr_write_b32 a186, v248
    v_accvgpr_write_b32 a187, v249
    v_accvgpr_read_b32 v248, a200
    v_accvgpr_read_b32 v249, a201
    v_mul_f32 v248, v248, v251
    v_mul_f32 v249, v249, v251
    v_accvgpr_write_b32 a200, v248
    v_accvgpr_write_b32 a201, v249
    v_accvgpr_read_b32 v248, a202
    v_accvgpr_read_b32 v249, a203
    v_mul_f32 v248, v248, v251
    v_mul_f32 v249, v249, v251
    v_accvgpr_write_b32 a202, v248
    v_accvgpr_write_b32 a203, v249
    v_accvgpr_read_b32 v248, a216
    v_accvgpr_read_b32 v249, a217
    v_mul_f32 v248, v248, v251
    v_mul_f32 v249, v249, v251
    v_accvgpr_write_b32 a216, v248
    v_accvgpr_write_b32 a217, v249
    v_accvgpr_read_b32 v248, a218
    v_accvgpr_read_b32 v249, a219
    v_mul_f32 v248, v248, v251
    v_mul_f32 v249, v249, v251
    v_accvgpr_write_b32 a218, v248
    v_accvgpr_write_b32 a219, v249
    v_accvgpr_read_b32 v248, a232
    v_accvgpr_read_b32 v249, a233
    v_mul_f32 v248, v248, v251
    v_mul_f32 v249, v249, v251
    v_accvgpr_write_b32 a232, v248
    v_accvgpr_write_b32 a233, v249
    v_accvgpr_read_b32 v248, a234
    v_accvgpr_read_b32 v249, a235
    v_mul_f32 v248, v248, v251
    v_mul_f32 v249, v249, v251
    v_accvgpr_write_b32 a234, v248
    v_accvgpr_write_b32 a235, v249
    v_accvgpr_read_b32 v248, a248
    v_accvgpr_read_b32 v249, a249
    v_mul_f32 v248, v248, v251
    v_mul_f32 v249, v249, v251
    v_accvgpr_write_b32 a248, v248
    v_accvgpr_write_b32 a249, v249
    v_accvgpr_read_b32 v248, a250
    v_accvgpr_read_b32 v249, a251
    v_mul_f32 v248, v248, v251
    v_mul_f32 v249, v249, v251
    v_accvgpr_write_b32 a250, v248
    v_accvgpr_write_b32 a251, v249
    v_exp_f32 v248, v136
    v_exp_f32 v249, v137
    s_nop 0
    v_add_f32 v246, v242, v248
    v_add_f32 v246, v246, v249
    v_cvt_pk_bf16_f32 v184, v248, v249
    v_exp_f32 v248, v138
    v_exp_f32 v249, v139
    s_nop 0
    v_add_f32 v246, v246, v248
    v_add_f32 v246, v246, v249
    v_cvt_pk_bf16_f32 v185, v248, v249
    v_exp_f32 v248, v152
    v_exp_f32 v249, v153
    s_nop 0
    v_add_f32 v246, v246, v248
    v_add_f32 v246, v246, v249
    v_cvt_pk_bf16_f32 v186, v248, v249
    v_exp_f32 v248, v154
    v_exp_f32 v249, v155
    s_nop 0
    v_add_f32 v246, v246, v248
    v_add_f32 v246, v246, v249
    v_cvt_pk_bf16_f32 v187, v248, v249
    v_max3_f32 v250, v140, v141, v142
    v_max3_f32 v250, v250, v143, v156
    v_max3_f32 v250, v250, v157, v158
    v_max_f32 v250, v250, v159
    v_mov_b32 v251, v250
    s_nop 1
    v_permlane16_swap_b32 v250, v251
    s_nop 1
    v_max_f32 v250, v250, v251
    v_mov_b32 v251, v250
    s_nop 1
    v_permlane32_swap_b32 v250, v251
    s_nop 1
    v_max_f32 v250, v250, v251
    v_add_f32 v250, s26, v250
    v_max_f32 v250, 0, v250
    v_exp_f32 v251, -v250
    v_sub_f32 v236, v236, v250
    v_sub_f32 v237, v237, v250
    v_sub_f32 v238, v238, v250
    v_sub_f32 v239, v239, v250
    v_sub_f32 v140, v140, v250
    v_sub_f32 v141, v141, v250
    v_sub_f32 v142, v142, v250
    v_sub_f32 v143, v143, v250
    v_sub_f32 v156, v156, v250
    v_sub_f32 v157, v157, v250
    v_sub_f32 v158, v158, v250
    v_sub_f32 v159, v159, v250
    v_mul_f32 v243, v243, v251
    v_accvgpr_read_b32 v248, a12
    v_accvgpr_read_b32 v249, a13
    v_mul_f32 v248, v248, v251
    v_mul_f32 v249, v249, v251
    v_accvgpr_write_b32 a12, v248
    v_accvgpr_write_b32 a13, v249
    v_accvgpr_read_b32 v248, a14
    v_accvgpr_read_b32 v249, a15
    v_mul_f32 v248, v248, v251
    v_mul_f32 v249, v249, v251
    v_accvgpr_write_b32 a14, v248
    v_accvgpr_write_b32 a15, v249
    v_accvgpr_read_b32 v248, a28
    v_accvgpr_read_b32 v249, a29
    v_mul_f32 v248, v248, v251
    v_mul_f32 v249, v249, v251
    v_accvgpr_write_b32 a28, v248
    v_accvgpr_write_b32 a29, v249
    v_accvgpr_read_b32 v248, a30
    v_accvgpr_read_b32 v249, a31
    v_mul_f32 v248, v248, v251
    v_mul_f32 v249, v249, v251
    v_accvgpr_write_b32 a30, v248
    v_accvgpr_write_b32 a31, v249
    v_accvgpr_read_b32 v248, a44
    v_accvgpr_read_b32 v249, a45
    v_mul_f32 v248, v248, v251
    v_mul_f32 v249, v249, v251
    v_accvgpr_write_b32 a44, v248
    v_accvgpr_write_b32 a45, v249
    v_accvgpr_read_b32 v248, a46
    v_accvgpr_read_b32 v249, a47
    v_mul_f32 v248, v248, v251
    v_mul_f32 v249, v249, v251
    v_accvgpr_write_b32 a46, v248
    v_accvgpr_write_b32 a47, v249
    v_accvgpr_read_b32 v248, a60
    v_accvgpr_read_b32 v249, a61
    v_mul_f32 v248, v248, v251
    v_mul_f32 v249, v249, v251
    v_accvgpr_write_b32 a60, v248
    v_accvgpr_write_b32 a61, v249
    v_accvgpr_read_b32 v248, a62
    v_accvgpr_read_b32 v249, a63
    v_mul_f32 v248, v248, v251
    v_mul_f32 v249, v249, v251
    v_accvgpr_write_b32 a62, v248
    v_accvgpr_write_b32 a63, v249
    v_accvgpr_read_b32 v248, a76
    v_accvgpr_read_b32 v249, a77
    v_mul_f32 v248, v248, v251
    v_mul_f32 v249, v249, v251
    v_accvgpr_write_b32 a76, v248
    v_accvgpr_write_b32 a77, v249
    v_accvgpr_read_b32 v248, a78
    v_accvgpr_read_b32 v249, a79
    v_mul_f32 v248, v248, v251
    v_mul_f32 v249, v249, v251
    v_accvgpr_write_b32 a78, v248
    v_accvgpr_write_b32 a79, v249
    v_accvgpr_read_b32 v248, a92
    v_accvgpr_read_b32 v249, a93
    v_mul_f32 v248, v248, v251
    v_mul_f32 v249, v249, v251
    v_accvgpr_write_b32 a92, v248
    v_accvgpr_write_b32 a93, v249
    v_accvgpr_read_b32 v248, a94
    v_accvgpr_read_b32 v249, a95
    v_mul_f32 v248, v248, v251
    v_mul_f32 v249, v249, v251
    v_accvgpr_write_b32 a94, v248
    v_accvgpr_write_b32 a95, v249
    v_accvgpr_read_b32 v248, a108
    v_accvgpr_read_b32 v249, a109
    v_mul_f32 v248, v248, v251
    v_mul_f32 v249, v249, v251
    v_accvgpr_write_b32 a108, v248
    v_accvgpr_write_b32 a109, v249
    v_accvgpr_read_b32 v248, a110
    v_accvgpr_read_b32 v249, a111
    v_mul_f32 v248, v248, v251
    v_mul_f32 v249, v249, v251
    v_accvgpr_write_b32 a110, v248
    v_accvgpr_write_b32 a111, v249
    v_accvgpr_read_b32 v248, a124
    v_accvgpr_read_b32 v249, a125
    v_mul_f32 v248, v248, v251
    v_mul_f32 v249, v249, v251
    v_accvgpr_write_b32 a124, v248
    v_accvgpr_write_b32 a125, v249
    v_accvgpr_read_b32 v248, a126
    v_accvgpr_read_b32 v249, a127
    v_mul_f32 v248, v248, v251
    v_mul_f32 v249, v249, v251
    v_accvgpr_write_b32 a126, v248
    v_accvgpr_write_b32 a127, v249
    v_accvgpr_read_b32 v248, a140
    v_accvgpr_read_b32 v249, a141
    v_mul_f32 v248, v248, v251
    v_mul_f32 v249, v249, v251
    v_accvgpr_write_b32 a140, v248
    v_accvgpr_write_b32 a141, v249
    v_accvgpr_read_b32 v248, a142
    v_accvgpr_read_b32 v249, a143
    v_mul_f32 v248, v248, v251
    v_mul_f32 v249, v249, v251
    v_accvgpr_write_b32 a142, v248
    v_accvgpr_write_b32 a143, v249
    v_accvgpr_read_b32 v248, a156
    v_accvgpr_read_b32 v249, a157
    v_mul_f32 v248, v248, v251
    v_mul_f32 v249, v249, v251
    v_accvgpr_write_b32 a156, v248
    v_accvgpr_write_b32 a157, v249
    v_accvgpr_read_b32 v248, a158
    v_accvgpr_read_b32 v249, a159
    v_mul_f32 v248, v248, v251
    v_mul_f32 v249, v249, v251
    v_accvgpr_write_b32 a158, v248
    v_accvgpr_write_b32 a159, v249
    v_accvgpr_read_b32 v248, a172
    v_accvgpr_read_b32 v249, a173
    v_mul_f32 v248, v248, v251
    v_mul_f32 v249, v249, v251
    v_accvgpr_write_b32 a172, v248
    v_accvgpr_write_b32 a173, v249
    v_accvgpr_read_b32 v248, a174
    v_accvgpr_read_b32 v249, a175
    v_mul_f32 v248, v248, v251
    v_mul_f32 v249, v249, v251
    v_accvgpr_write_b32 a174, v248
    v_accvgpr_write_b32 a175, v249
    v_accvgpr_read_b32 v248, a188
    v_accvgpr_read_b32 v249, a189
    v_mul_f32 v248, v248, v251
    v_mul_f32 v249, v249, v251
    v_accvgpr_write_b32 a188, v248
    v_accvgpr_write_b32 a189, v249
    v_accvgpr_read_b32 v248, a190
    v_accvgpr_read_b32 v249, a191
    v_mul_f32 v248, v248, v251
    v_mul_f32 v249, v249, v251
    v_accvgpr_write_b32 a190, v248
    v_accvgpr_write_b32 a191, v249
    v_accvgpr_read_b32 v248, a204
    v_accvgpr_read_b32 v249, a205
    v_mul_f32 v248, v248, v251
    v_mul_f32 v249, v249, v251
    v_accvgpr_write_b32 a204, v248
    v_accvgpr_write_b32 a205, v249
    v_accvgpr_read_b32 v248, a206
    v_accvgpr_read_b32 v249, a207
    v_mul_f32 v248, v248, v251
    v_mul_f32 v249, v249, v251
    v_accvgpr_write_b32 a206, v248
    v_accvgpr_write_b32 a207, v249
    v_accvgpr_read_b32 v248, a220
    v_accvgpr_read_b32 v249, a221
    v_mul_f32 v248, v248, v251
    v_mul_f32 v249, v249, v251
    v_accvgpr_write_b32 a220, v248
    v_accvgpr_write_b32 a221, v249
    v_accvgpr_read_b32 v248, a222
    v_accvgpr_read_b32 v249, a223
    v_mul_f32 v248, v248, v251
    v_mul_f32 v249, v249, v251
    v_accvgpr_write_b32 a222, v248
    v_accvgpr_write_b32 a223, v249
    v_accvgpr_read_b32 v248, a236
    v_accvgpr_read_b32 v249, a237
    v_mul_f32 v248, v248, v251
    v_mul_f32 v249, v249, v251
    v_accvgpr_write_b32 a236, v248
    v_accvgpr_write_b32 a237, v249
    v_accvgpr_read_b32 v248, a238
    v_accvgpr_read_b32 v249, a239
    v_mul_f32 v248, v248, v251
    v_mul_f32 v249, v249, v251
    v_accvgpr_write_b32 a238, v248
    v_accvgpr_write_b32 a239, v249
    v_accvgpr_read_b32 v248, a252
    v_accvgpr_read_b32 v249, a253
    v_mul_f32 v248, v248, v251
    v_mul_f32 v249, v249, v251
    v_accvgpr_write_b32 a252, v248
    v_accvgpr_write_b32 a253, v249
    v_accvgpr_read_b32 v248, a254
    v_accvgpr_read_b32 v249, a255
    v_mul_f32 v248, v248, v251
    v_mul_f32 v249, v249, v251
    v_accvgpr_write_b32 a254, v248
    v_accvgpr_write_b32 a255, v249
    v_exp_f32 v248, v140
    v_exp_f32 v249, v141
    s_nop 0
    v_add_f32 v247, v243, v248
    v_add_f32 v247, v247, v249
    v_cvt_pk_bf16_f32 v188, v248, v249
    v_exp_f32 v248, v142
    v_exp_f32 v249, v143
    s_nop 0
    v_add_f32 v247, v247, v248
    v_add_f32 v247, v247, v249
    v_cvt_pk_bf16_f32 v189, v248, v249
    v_exp_f32 v248, v156
    v_exp_f32 v249, v157
    s_nop 0
    v_add_f32 v247, v247, v248
    v_add_f32 v247, v247, v249
    v_cvt_pk_bf16_f32 v190, v248, v249
    v_exp_f32 v248, v158
    v_exp_f32 v249, v159
    s_nop 0
    v_add_f32 v247, v247, v248
    v_add_f32 v247, v247, v249
    v_cvt_pk_bf16_f32 v191, v248, v249
    s_nop 1
    s_branch L_back_p0
L_slow_a:
    s_nop 7
    s_nop 7
    v_max3_f32 v250, v128, v129, v130
    v_max3_f32 v250, v250, v131, v144
    v_max3_f32 v250, v250, v145, v146
    v_max_f32 v250, v250, v147
    v_mov_b32 v251, v250
    s_nop 1
    v_permlane16_swap_b32 v250, v251
    s_nop 1
    v_max_f32 v250, v250, v251
    v_mov_b32 v251, v250
    s_nop 1
    v_permlane32_swap_b32 v250, v251
    s_nop 1
    v_max_f32 v250, v250, v251
    v_add_f32 v250, s26, v250
    v_max_f32 v250, 0, v250
    v_exp_f32 v251, -v250
    v_sub_f32 v224, v224, v250
    v_sub_f32 v225, v225, v250
    v_sub_f32 v226, v226, v250
    v_sub_f32 v227, v227, v250
    v_sub_f32 v128, v128, v250
    v_sub_f32 v129, v129, v250
    v_sub_f32 v130, v130, v250
    v_sub_f32 v131, v131, v250
    v_sub_f32 v144, v144, v250
    v_sub_f32 v145, v145, v250
    v_sub_f32 v146, v146, v250
    v_sub_f32 v147, v147, v250
    v_mul_f32 v244, v244, v251
    v_accvgpr_read_b32 v248, a0
    v_accvgpr_read_b32 v249, a1
    v_mul_f32 v248, v248, v251
    v_mul_f32 v249, v249, v251
    v_accvgpr_write_b32 a0, v248
    v_accvgpr_write_b32 a1, v249
    v_accvgpr_read_b32 v248, a2
    v_accvgpr_read_b32 v249, a3
    v_mul_f32 v248, v248, v251
    v_mul_f32 v249, v249, v251
    v_accvgpr_write_b32 a2, v248
    v_accvgpr_write_b32 a3, v249
    v_accvgpr_read_b32 v248, a16
    v_accvgpr_read_b32 v249, a17
    v_mul_f32 v248, v248, v251
    v_mul_f32 v249, v249, v251
    v_accvgpr_write_b32 a16, v248
    v_accvgpr_write_b32 a17, v249
    v_accvgpr_read_b32 v248, a18
    v_accvgpr_read_b32 v249, a19
    v_mul_f32 v248, v248, v251
    v_mul_f32 v249, v249, v251
    v_accvgpr_write_b32 a18, v248
    v_accvgpr_write_b32 a19, v249
    v_accvgpr_read_b32 v248, a32
    v_accvgpr_read_b32 v249, a33
    v_mul_f32 v248, v248, v251
    v_mul_f32 v249, v249, v251
    v_accvgpr_write_b32 a32, v248
    v_accvgpr_write_b32 a33, v249
    v_accvgpr_read_b32 v248, a34
    v_accvgpr_read_b32 v249, a35
    v_mul_f32 v248, v248, v251
    v_mul_f32 v249, v249, v251
    v_accvgpr_write_b32 a34, v248
    v_accvgpr_write_b32 a35, v249
    v_accvgpr_read_b32 v248, a48
    v_accvgpr_read_b32 v249, a49
    v_mul_f32 v248, v248, v251
    v_mul_f32 v249, v249, v251
    v_accvgpr_write_b32 a48, v248
    v_accvgpr_write_b32 a49, v249
    v_accvgpr_read_b32 v248, a50
    v_accvgpr_read_b32 v249, a51
    v_mul_f32 v248, v248, v251
    v_mul_f32 v249, v249, v251
    v_accvgpr_write_b32 a50, v248
    v_accvgpr_write_b32 a51, v249
    v_accvgpr_read_b32 v248, a64
    v_accvgpr_read_b32 v249, a65
    v_mul_f32 v248, v248, v251
    v_mul_f32 v249, v249, v251
    v_accvgpr_write_b32 a64, v248
    v_accvgpr_write_b32 a65, v249
    v_accvgpr_read_b32 v248, a66
    v_accvgpr_read_b32 v249, a67
    v_mul_f32 v248, v248, v251
    v_mul_f32 v249, v249, v251
    v_accvgpr_write_b32 a66, v248
    v_accvgpr_write_b32 a67, v249
    v_accvgpr_read_b32 v248, a80
    v_accvgpr_read_b32 v249, a81
    v_mul_f32 v248, v248, v251
    v_mul_f32 v249, v249, v251
    v_accvgpr_write_b32 a80, v248
    v_accvgpr_write_b32 a81, v249
    v_accvgpr_read_b32 v248, a82
    v_accvgpr_read_b32 v249, a83
    v_mul_f32 v248, v248, v251
    v_mul_f32 v249, v249, v251
    v_accvgpr_write_b32 a82, v248
    v_accvgpr_write_b32 a83, v249
    v_accvgpr_read_b32 v248, a96
    v_accvgpr_read_b32 v249, a97
    v_mul_f32 v248, v248, v251
    v_mul_f32 v249, v249, v251
    v_accvgpr_write_b32 a96, v248
    v_accvgpr_write_b32 a97, v249
    v_accvgpr_read_b32 v248, a98
    v_accvgpr_read_b32 v249, a99
    v_mul_f32 v248, v248, v251
    v_mul_f32 v249, v249, v251
    v_accvgpr_write_b32 a98, v248
    v_accvgpr_write_b32 a99, v249
    v_accvgpr_read_b32 v248, a112
    v_accvgpr_read_b32 v249, a113
    v_mul_f32 v248, v248, v251
    v_mul_f32 v249, v249, v251
    v_accvgpr_write_b32 a112, v248
    v_accvgpr_write_b32 a113, v249
    v_accvgpr_read_b32 v248, a114
    v_accvgpr_read_b32 v249, a115
    v_mul_f32 v248, v248, v251
    v_mul_f32 v249, v249, v251
    v_accvgpr_write_b32 a114, v248
    v_accvgpr_write_b32 a115, v249
    v_accvgpr_read_b32 v248, a128
    v_accvgpr_read_b32 v249, a129
    v_mul_f32 v248, v248, v251
    v_mul_f32 v249, v249, v251
    v_accvgpr_write_b32 a128, v248
    v_accvgpr_write_b32 a129, v249
    v_accvgpr_read_b32 v248, a130
    v_accvgpr_read_b32 v249, a131
    v_mul_f32 v248, v248, v251
    v_mul_f32 v249, v249, v251
    v_accvgpr_write_b32 a130, v248
    v_accvgpr_write_b32 a131, v249
    v_accvgpr_read_b32 v248, a144
    v_accvgpr_read_b32 v249, a145
    v_mul_f32 v248, v248, v251
    v_mul_f32 v249, v249, v251
    v_accvgpr_write_b32 a144, v248
    v_accvgpr_write_b32 a145, v249
    v_accvgpr_read_b32 v248, a146
    v_accvgpr_read_b32 v249, a147
    v_mul_f32 v248, v248, v251
    v_mul_f32 v249, v249, v251
    v_accvgpr_write_b32 a146, v248
    v_accvgpr_write_b32 a147, v249
    v_accvgpr_read_b32 v248, a160
    v_accvgpr_read_b32 v249, a161
    v_mul_f32 v248, v248, v251
    v_mul_f32 v249, v249, v251
    v_accvgpr_write_b32 a160, v248
    v_accvgpr_write_b32 a161, v249
    v_accvgpr_read_b32 v248, a162
    v_accvgpr_read_b32 v249, a163
    v_mul_f32 v248, v248, v251
    v_mul_f32 v249, v249, v251
    v_accvgpr_write_b32 a162, v248
    v_accvgpr_write_b32 a163, v249
    v_accvgpr_read_b32 v248, a176
    v_accvgpr_read_b32 v249, a177
    v_mul_f32 v248, v248, v251
    v_mul_f32 v249, v249, v251
    v_accvgpr_write_b32 a176, v248
    v_accvgpr_write_b32 a177, v249
    v_accvgpr_read_b32 v248, a178
    v_accvgpr_read_b32 v249, a179
    v_mul_f32 v248, v248, v251
    v_mul_f32 v249, v249, v251
    v_accvgpr_write_b32 a178, v248
    v_accvgpr_write_b32 a179, v249
    v_accvgpr_read_b32 v248, a192
    v_accvgpr_read_b32 v249, a193
    v_mul_f32 v248, v248, v251
    v_mul_f32 v249, v249, v251
    v_accvgpr_write_b32 a192, v248
    v_accvgpr_write_b32 a193, v249
    v_accvgpr_read_b32 v248, a194
    v_accvgpr_read_b32 v249, a195
    v_mul_f32 v248, v248, v251
    v_mul_f32 v249, v249, v251
    v_accvgpr_write_b32 a194, v248
    v_accvgpr_write_b32 a195, v249
    v_accvgpr_read_b32 v248, a208
    v_accvgpr_read_b32 v249, a209
    v_mul_f32 v248, v248, v251
    v_mul_f32 v249, v249, v251
    v_accvgpr_write_b32 a208, v248
    v_accvgpr_write_b32 a209, v249
    v_accvgpr_read_b32 v248, a210
    v_accvgpr_read_b32 v249, a211
    v_mul_f32 v248, v248, v251
    v_mul_f32 v249, v249, v251
    v_accvgpr_write_b32 a210, v248
    v_accvgpr_write_b32 a211, v249
    v_accvgpr_read_b32 v248, a224
    v_accvgpr_read_b32 v249, a225
    v_mul_f32 v248, v248, v251
    v_mul_f32 v249, v249, v251
    v_accvgpr_write_b32 a224, v248
    v_accvgpr_write_b32 a225, v249
    v_accvgpr_read_b32 v248, a226
    v_accvgpr_read_b32 v249, a227
    v_mul_f32 v248, v248, v251
    v_mul_f32 v249, v249, v251
    v_accvgpr_write_b32 a226, v248
    v_accvgpr_write_b32 a227, v249
    v_accvgpr_read_b32 v248, a240
    v_accvgpr_read_b32 v249, a241
    v_mul_f32 v248, v248, v251
    v_mul_f32 v249, v249, v251
    v_accvgpr_write_b32 a240, v248
    v_accvgpr_write_b32 a241, v249
    v_accvgpr_read_b32 v248, a242
    v_accvgpr_read_b32 v249, a243
    v_mul_f32 v248, v248, v251
    v_mul_f32 v249, v249, v251
    v_accvgpr_write_b32 a242, v248
    v_accvgpr_write_b32 a243, v249
    v_exp_f32 v248, v128
    v_exp_f32 v249, v129
    s_nop 0
    v_add_f32 v240, v244, v248
    v_add_f32 v240, v240, v249
    v_cvt_pk_bf16_f32 v160, v248, v249
    v_exp_f32 v248, v130
    v_exp_f32 v249, v131
    s_nop 0
    v_add_f32 v240, v240, v248
    v_add_f32 v240, v240, v249
    v_cvt_pk_bf16_f32 v161, v248, v249
    v_exp_f32 v248, v144
    v_exp_f32 v249, v145
    s_nop 0
    v_add_f32 v240, v240, v248
    v_add_f32 v240, v240, v249
    v_cvt_pk_bf16_f32 v162, v248, v249
    v_exp_f32 v248, v146
    v_exp_f32 v249, v147
    s_nop 0
    v_add_f32 v240, v240, v248
    v_add_f32 v240, v240, v249
    v_cvt_pk_bf16_f32 v163, v248, v249
    v_max3_f32 v250, v132, v133, v134
    v_max3_f32 v250, v250, v135, v148
    v_max3_f32 v250, v250, v149, v150
    v_max_f32 v250, v250, v151
    v_mov_b32 v251, v250
    s_nop 1
    v_permlane16_swap_b32 v250, v251
    s_nop 1
    v_max_f32 v250, v250, v251
    v_mov_b32 v251, v250
    s_nop 1
    v_permlane32_swap_b32 v250, v251
    s_nop 1
    v_max_f32 v250, v250, v251
    v_add_f32 v250, s26, v250
    v_max_f32 v250, 0, v250
    v_exp_f32 v251, -v250
    v_sub_f32 v228, v228, v250
    v_sub_f32 v229, v229, v250
    v_sub_f32 v230, v230, v250
    v_sub_f32 v231, v231, v250
    v_sub_f32 v132, v132, v250
    v_sub_f32 v133, v133, v250
    v_sub_f32 v134, v134, v250
    v_sub_f32 v135, v135, v250
    v_sub_f32 v148, v148, v250
    v_sub_f32 v149, v149, v250
    v_sub_f32 v150, v150, v250
    v_sub_f32 v151, v151, v250
    v_mul_f32 v245, v245, v251
    v_accvgpr_read_b32 v248, a4
    v_accvgpr_read_b32 v249, a5
    v_mul_f32 v248, v248, v251
    v_mul_f32 v249, v249, v251
    v_accvgpr_write_b32 a4, v248
    v_accvgpr_write_b32 a5, v249
    v_accvgpr_read_b32 v248, a6
    v_accvgpr_read_b32 v249, a7
    v_mul_f32 v248, v248, v251
    v_mul_f32 v249, v249, v251
    v_accvgpr_write_b32 a6, v248
    v_accvgpr_write_b32 a7, v249
    v_accvgpr_read_b32 v248, a20
    v_accvgpr_read_b32 v249, a21
    v_mul_f32 v248, v248, v251
    v_mul_f32 v249, v249, v251
    v_accvgpr_write_b32 a20, v248
    v_accvgpr_write_b32 a21, v249
    v_accvgpr_read_b32 v248, a22
    v_accvgpr_read_b32 v249, a23
    v_mul_f32 v248, v248, v251
    v_mul_f32 v249, v249, v251
    v_accvgpr_write_b32 a22, v248
    v_accvgpr_write_b32 a23, v249
    v_accvgpr_read_b32 v248, a36
    v_accvgpr_read_b32 v249, a37
    v_mul_f32 v248, v248, v251
    v_mul_f32 v249, v249, v251
    v_accvgpr_write_b32 a36, v248
    v_accvgpr_write_b32 a37, v249
    v_accvgpr_read_b32 v248, a38
    v_accvgpr_read_b32 v249, a39
    v_mul_f32 v248, v248, v251
    v_mul_f32 v249, v249, v251
    v_accvgpr_write_b32 a38, v248
    v_accvgpr_write_b32 a39, v249
    v_accvgpr_read_b32 v248, a52
    v_accvgpr_read_b32 v249, a53
    v_mul_f32 v248, v248, v251
    v_mul_f32 v249, v249, v251
    v_accvgpr_write_b32 a52, v248
    v_accvgpr_write_b32 a53, v249
    v_accvgpr_read_b32 v248, a54
    v_accvgpr_read_b32 v249, a55
    v_mul_f32 v248, v248, v251
    v_mul_f32 v249, v249, v251
    v_accvgpr_write_b32 a54, v248
    v_accvgpr_write_b32 a55, v249
    v_accvgpr_read_b32 v248, a68
    v_accvgpr_read_b32 v249, a69
    v_mul_f32 v248, v248, v251
    v_mul_f32 v249, v249, v251
    v_accvgpr_write_b32 a68, v248
    v_accvgpr_write_b32 a69, v249
    v_accvgpr_read_b32 v248, a70
    v_accvgpr_read_b32 v249, a71
    v_mul_f32 v248, v248, v251
    v_mul_f32 v249, v249, v251
    v_accvgpr_write_b32 a70, v248
    v_accvgpr_write_b32 a71, v249
    v_accvgpr_read_b32 v248, a84
    v_accvgpr_read_b32 v249, a85
    v_mul_f32 v248, v248, v251
    v_mul_f32 v249, v249, v251
    v_accvgpr_write_b32 a84, v248
    v_accvgpr_write_b32 a85, v249
    v_accvgpr_read_b32 v248, a86
    v_accvgpr_read_b32 v249, a87
    v_mul_f32 v248, v248, v251
    v_mul_f32 v249, v249, v251
    v_accvgpr_write_b32 a86, v248
    v_accvgpr_write_b32 a87, v249
    v_accvgpr_read_b32 v248, a100
    v_accvgpr_read_b32 v249, a101
    v_mul_f32 v248, v248, v251
    v_mul_f32 v249, v249, v251
    v_accvgpr_write_b32 a100, v248
    v_accvgpr_write_b32 a101, v249
    v_accvgpr_read_b32 v248, a102
    v_accvgpr_read_b32 v249, a103
    v_mul_f32 v248, v248, v251
    v_mul_f32 v249, v249, v251
    v_accvgpr_write_b32 a102, v248
    v_accvgpr_write_b32 a103, v249
    v_accvgpr_read_b32 v248, a116
    v_accvgpr_read_b32 v249, a117
    v_mul_f32 v248, v248, v251
    v_mul_f32 v249, v249, v251
    v_accvgpr_write_b32 a116, v248
    v_accvgpr_write_b32 a117, v249
    v_accvgpr_read_b32 v248, a118
    v_accvgpr_read_b32 v249, a119
    v_mul_f32 v248, v248, v251
    v_mul_f32 v249, v249, v251
    v_accvgpr_write_b32 a118, v248
    v_accvgpr_write_b32 a119, v249
    v_accvgpr_read_b32 v248, a132
    v_accvgpr_read_b32 v249, a133
    v_mul_f32 v248, v248, v251
    v_mul_f32 v249, v249, v251
    v_accvgpr_write_b32 a132, v248
    v_accvgpr_write_b32 a133, v249
    v_accvgpr_read_b32 v248, a134
    v_accvgpr_read_b32 v249, a135
    v_mul_f32 v248, v248, v251
    v_mul_f32 v249, v249, v251
    v_accvgpr_write_b32 a134, v248
    v_accvgpr_write_b32 a135, v249
    v_accvgpr_read_b32 v248, a148
    v_accvgpr_read_b32 v249, a149
    v_mul_f32 v248, v248, v251
    v_mul_f32 v249, v249, v251
    v_accvgpr_write_b32 a148, v248
    v_accvgpr_write_b32 a149, v249
    v_accvgpr_read_b32 v248, a150
    v_accvgpr_read_b32 v249, a151
    v_mul_f32 v248, v248, v251
    v_mul_f32 v249, v249, v251
    v_accvgpr_write_b32 a150, v248
    v_accvgpr_write_b32 a151, v249
    v_accvgpr_read_b32 v248, a164
    v_accvgpr_read_b32 v249, a165
    v_mul_f32 v248, v248, v251
    v_mul_f32 v249, v249, v251
    v_accvgpr_write_b32 a164, v248
    v_accvgpr_write_b32 a165, v249
    v_accvgpr_read_b32 v248, a166
    v_accvgpr_read_b32 v249, a167
    v_mul_f32 v248, v248, v251
    v_mul_f32 v249, v249, v251
    v_accvgpr_write_b32 a166, v248
    v_accvgpr_write_b32 a167, v249
    v_accvgpr_read_b32 v248, a180
    v_accvgpr_read_b32 v249, a181
    v_mul_f32 v248, v248, v251
    v_mul_f32 v249, v249, v251
    v_accvgpr_write_b32 a180, v248
    v_accvgpr_write_b32 a181, v249
    v_accvgpr_read_b32 v248, a182
    v_accvgpr_read_b32 v249, a183
    v_mul_f32 v248, v248, v251
    v_mul_f32 v249, v249, v251
    v_accvgpr_write_b32 a182, v248
    v_accvgpr_write_b32 a183, v249
    v_accvgpr_read_b32 v248, a196
    v_accvgpr_read_b32 v249, a197
    v_mul_f32 v248, v248, v251
    v_mul_f32 v249, v249, v251
    v_accvgpr_write_b32 a196, v248
    v_accvgpr_write_b32 a197, v249
    v_accvgpr_read_b32 v248, a198
    v_accvgpr_read_b32 v249, a199
    v_mul_f32 v248, v248, v251
    v_mul_f32 v249, v249, v251
    v_accvgpr_write_b32 a198, v248
    v_accvgpr_write_b32 a199, v249
    v_accvgpr_read_b32 v248, a212
    v_accvgpr_read_b32 v249, a213
    v_mul_f32 v248, v248, v251
    v_mul_f32 v249, v249, v251
    v_accvgpr_write_b32 a212, v248
    v_accvgpr_write_b32 a213, v249
    v_accvgpr_read_b32 v248, a214
    v_accvgpr_read_b32 v249, a215
    v_mul_f32 v248, v248, v251
    v_mul_f32 v249, v249, v251
    v_accvgpr_write_b32 a214, v248
    v_accvgpr_write_b32 a215, v249
    v_accvgpr_read_b32 v248, a228
    v_accvgpr_read_b32 v249, a229
    v_mul_f32 v248, v248, v251
    v_mul_f32 v249, v249, v251
    v_accvgpr_write_b32 a228, v248
    v_accvgpr_write_b32 a229, v249
    v_accvgpr_read_b32 v248, a230
    v_accvgpr_read_b32 v249, a231
    v_mul_f32 v248, v248, v251
    v_mul_f32 v249, v249, v251
    v_accvgpr_write_b32 a230, v248
    v_accvgpr_write_b32 a231, v249
    v_accvgpr_read_b32 v248, a244
    v_accvgpr_read_b32 v249, a245
    v_mul_f32 v248, v248, v251
    v_mul_f32 v249, v249, v251
    v_accvgpr_write_b32 a244, v248
    v_accvgpr_write_b32 a245, v249
    v_accvgpr_read_b32 v248, a246
    v_accvgpr_read_b32 v249, a247
    v_mul_f32 v248, v248, v251
    v_mul_f32 v249, v249, v251
    v_accvgpr_write_b32 a246, v248
    v_accvgpr_write_b32 a247, v249
    v_exp_f32 v248, v132
    v_exp_f32 v249, v133
    s_nop 0
    v_add_f32 v241, v245, v248
    v_add_f32 v241, v241, v249
    v_cvt_pk_bf16_f32 v164, v248, v249
    v_exp_f32 v248, v134
    v_exp_f32 v249, v135
    s_nop 0
    v_add_f32 v241, v241, v248
    v_add_f32 v241, v241, v249
    v_cvt_pk_bf16_f32 v165, v248, v249
    v_exp_f32 v248, v148
    v_exp_f32 v249, v149
    s_nop 0
    v_add_f32 v241, v241, v248
    v_add_f32 v241, v241, v249
    v_cvt_pk_bf16_f32 v166, v248, v249
    v_exp_f32 v248, v150
    v_exp_f32 v249, v151
    s_nop 0
    v_add_f32 v241, v241, v248
    v_add_f32 v241, v241, v249
    v_cvt_pk_bf16_f32 v167, v248, v249
    v_max3_f32 v250, v136, v137, v138
    v_max3_f32 v250, v250, v139, v152
    v_max3_f32 v250, v250, v153, v154
    v_max_f32 v250, v250, v155
    v_mov_b32 v251, v250
    s_nop 1
    v_permlane16_swap_b32 v250, v251
    s_nop 1
    v_max_f32 v250, v250, v251
    v_mov_b32 v251, v250
    s_nop 1
    v_permlane32_swap_b32 v250, v251
    s_nop 1
    v_max_f32 v250, v250, v251
    v_add_f32 v250, s26, v250
    v_max_f32 v250, 0, v250
    v_exp_f32 v251, -v250
    v_sub_f32 v232, v232, v250
    v_sub_f32 v233, v233, v250
    v_sub_f32 v234, v234, v250
    v_sub_f32 v235, v235, v250
    v_sub_f32 v136, v136, v250
    v_sub_f32 v137, v137, v250
    v_sub_f32 v138, v138, v250
    v_sub_f32 v139, v139, v250
    v_sub_f32 v152, v152, v250
    v_sub_f32 v153, v153, v250
    v_sub_f32 v154, v154, v250
    v_sub_f32 v155, v155, v250
    v_mul_f32 v246, v246, v251
    v_accvgpr_read_b32 v248, a8
    v_accvgpr_read_b32 v249, a9
    v_mul_f32 v248, v248, v251
    v_mul_f32 v249, v249, v251
    v_accvgpr_write_b32 a8, v248
    v_accvgpr_write_b32 a9, v249
    v_accvgpr_read_b32 v248, a10
    v_accvgpr_read_b32 v249, a11
    v_mul_f32 v248, v248, v251
    v_mul_f32 v249, v249, v251
    v_accvgpr_write_b32 a10, v248
    v_accvgpr_write_b32 a11, v249
    v_accvgpr_read_b32 v248, a24
    v_accvgpr_read_b32 v249, a25
    v_mul_f32 v248, v248, v251
    v_mul_f32 v249, v249, v251
    v_accvgpr_write_b32 a24, v248
    v_accvgpr_write_b32 a25, v249
    v_accvgpr_read_b32 v248, a26
    v_accvgpr_read_b32 v249, a27
    v_mul_f32 v248, v248, v251
    v_mul_f32 v249, v249, v251
    v_accvgpr_write_b32 a26, v248
    v_accvgpr_write_b32 a27, v249
    v_accvgpr_read_b32 v248, a40
    v_accvgpr_read_b32 v249, a41
    v_mul_f32 v248, v248, v251
    v_mul_f32 v249, v249, v251
    v_accvgpr_write_b32 a40, v248
    v_accvgpr_write_b32 a41, v249
    v_accvgpr_read_b32 v248, a42
    v_accvgpr_read_b32 v249, a43
    v_mul_f32 v248, v248, v251
    v_mul_f32 v249, v249, v251
    v_accvgpr_write_b32 a42, v248
    v_accvgpr_write_b32 a43, v249
    v_accvgpr_read_b32 v248, a56
    v_accvgpr_read_b32 v249, a57
    v_mul_f32 v248, v248, v251
    v_mul_f32 v249, v249, v251
    v_accvgpr_write_b32 a56, v248
    v_accvgpr_write_b32 a57, v249
    v_accvgpr_read_b32 v248, a58
    v_accvgpr_read_b32 v249, a59
    v_mul_f32 v248, v248, v251
    v_mul_f32 v249, v249, v251
    v_accvgpr_write_b32 a58, v248
    v_accvgpr_write_b32 a59, v249
    v_accvgpr_read_b32 v248, a72
    v_accvgpr_read_b32 v249, a73
    v_mul_f32 v248, v248, v251
    v_mul_f32 v249, v249, v251
    v_accvgpr_write_b32 a72, v248
    v_accvgpr_write_b32 a73, v249
    v_accvgpr_read_b32 v248, a74
    v_accvgpr_read_b32 v249, a75
    v_mul_f32 v248, v248, v251
    v_mul_f32 v249, v249, v251
    v_accvgpr_write_b32 a74, v248
    v_accvgpr_write_b32 a75, v249
    v_accvgpr_read_b32 v248, a88
    v_accvgpr_read_b32 v249, a89
    v_mul_f32 v248, v248, v251
    v_mul_f32 v249, v249, v251
    v_accvgpr_write_b32 a88, v248
    v_accvgpr_write_b32 a89, v249
    v_accvgpr_read_b32 v248, a90
    v_accvgpr_read_b32 v249, a91
    v_mul_f32 v248, v248, v251
    v_mul_f32 v249, v249, v251
    v_accvgpr_write_b32 a90, v248
    v_accvgpr_write_b32 a91, v249
    v_accvgpr_read_b32 v248, a104
    v_accvgpr_read_b32 v249, a105
    v_mul_f32 v248, v248, v251
    v_mul_f32 v249, v249, v251
    v_accvgpr_write_b32 a104, v248
    v_accvgpr_write_b32 a105, v249
    v_accvgpr_read_b32 v248, a106
    v_accvgpr_read_b32 v249, a107
    v_mul_f32 v248, v248, v251
    v_mul_f32 v249, v249, v251
    v_accvgpr_write_b32 a106, v248
    v_accvgpr_write_b32 a107, v249
    v_accvgpr_read_b32 v248, a120
    v_accvgpr_read_b32 v249, a121
    v_mul_f32 v248, v248, v251
    v_mul_f32 v249, v249, v251
    v_accvgpr_write_b32 a120, v248
    v_accvgpr_write_b32 a121, v249
    v_accvgpr_read_b32 v248, a122
    v_accvgpr_read_b32 v249, a123
    v_mul_f32 v248, v248, v251
    v_mul_f32 v249, v249, v251
    v_accvgpr_write_b32 a122, v248
    v_accvgpr_write_b32 a123, v249
    v_accvgpr_read_b32 v248, a136
    v_accvgpr_read_b32 v249, a137
    v_mul_f32 v248, v248, v251
    v_mul_f32 v249, v249, v251
    v_accvgpr_write_b32 a136, v248
    v_accvgpr_write_b32 a137, v249
    v_accvgpr_read_b32 v248, a138
    v_accvgpr_read_b32 v249, a139
    v_mul_f32 v248, v248, v251
    v_mul_f32 v249, v249, v251
    v_accvgpr_write_b32 a138, v248
    v_accvgpr_write_b32 a139, v249
    v_accvgpr_read_b32 v248, a152
    v_accvgpr_read_b32 v249, a153
    v_mul_f32 v248, v248, v251
    v_mul_f32 v249, v249, v251
    v_accvgpr_write_b32 a152, v248
    v_accvgpr_write_b32 a153, v249
    v_accvgpr_read_b32 v248, a154
    v_accvgpr_read_b32 v249, a155
    v_mul_f32 v248, v248, v251
    v_mul_f32 v249, v249, v251
    v_accvgpr_write_b32 a154, v248
    v_accvgpr_write_b32 a155, v249
    v_accvgpr_read_b32 v248, a168
    v_accvgpr_read_b32 v249, a169
    v_mul_f32 v248, v248, v251
    v_mul_f32 v249, v249, v251
    v_accvgpr_write_b32 a168, v248
    v_accvgpr_write_b32 a169, v249
    v_accvgpr_read_b32 v248, a170
    v_accvgpr_read_b32 v249, a171
    v_mul_f32 v248, v248, v251
    v_mul_f32 v249, v249, v251
    v_accvgpr_write_b32 a170, v248
    v_accvgpr_write_b32 a171, v249
    v_accvgpr_read_b32 v248, a184
    v_accvgpr_read_b32 v249, a185
    v_mul_f32 v248, v248, v251
    v_mul_f32 v249, v249, v251
    v_accvgpr_write_b32 a184, v248
    v_accvgpr_write_b32 a185, v249
    v_accvgpr_read_b32 v248, a186
    v_accvgpr_read_b32 v249, a187
    v_mul_f32 v248, v248, v251
    v_mul_f32 v249, v249, v251
    v_accvgpr_write_b32 a186, v248
    v_accvgpr_write_b32 a187, v249
    v_accvgpr_read_b32 v248, a200
    v_accvgpr_read_b32 v249, a201
    v_mul_f32 v248, v248, v251
    v_mul_f32 v249, v249, v251
    v_accvgpr_write_b32 a200, v248
    v_accvgpr_write_b32 a201, v249
    v_accvgpr_read_b32 v248, a202
    v_accvgpr_read_b32 v249, a203
    v_mul_f32 v248, v248, v251
    v_mul_f32 v249, v249, v251
    v_accvgpr_write_b32 a202, v248
    v_accvgpr_write_b32 a203, v249
    v_accvgpr_read_b32 v248, a216
    v_accvgpr_read_b32 v249, a217
    v_mul_f32 v248, v248, v251
    v_mul_f32 v249, v249, v251
    v_accvgpr_write_b32 a216, v248
    v_accvgpr_write_b32 a217, v249
    v_accvgpr_read_b32 v248, a218
    v_accvgpr_read_b32 v249, a219
    v_mul_f32 v248, v248, v251
    v_mul_f32 v249, v249, v251
    v_accvgpr_write_b32 a218, v248
    v_accvgpr_write_b32 a219, v249
    v_accvgpr_read_b32 v248, a232
    v_accvgpr_read_b32 v249, a233
    v_mul_f32 v248, v248, v251
    v_mul_f32 v249, v249, v251
    v_accvgpr_write_b32 a232, v248
    v_accvgpr_write_b32 a233, v249
    v_accvgpr_read_b32 v248, a234
    v_accvgpr_read_b32 v249, a235
    v_mul_f32 v248, v248, v251
    v_mul_f32 v249, v249, v251
    v_accvgpr_write_b32 a234, v248
    v_accvgpr_write_b32 a235, v249
    v_accvgpr_read_b32 v248, a248
    v_accvgpr_read_b32 v249, a249
    v_mul_f32 v248, v248, v251
    v_mul_f32 v249, v249, v251
    v_accvgpr_write_b32 a248, v248
    v_accvgpr_write_b32 a249, v249
    v_accvgpr_read_b32 v248, a250
    v_accvgpr_read_b32 v249, a251
    v_mul_f32 v248, v248, v251
    v_mul_f32 v249, v249, v251
    v_accvgpr_write_b32 a250, v248
    v_accvgpr_write_b32 a251, v249
    v_exp_f32 v248, v136
    v_exp_f32 v249, v137
    s_nop 0
    v_add_f32 v242, v246, v248
    v_add_f32 v242, v242, v249
    v_cvt_pk_bf16_f32 v168, v248, v249
    v_exp_f32 v248, v138
    v_exp_f32 v249, v139
    s_nop 0
    v_add_f32 v242, v242, v248
    v_add_f32 v242, v242, v249
    v_cvt_pk_bf16_f32 v169, v248, v249
    v_exp_f32 v248, v152
    v_exp_f32 v249, v153
    s_nop 0
    v_add_f32 v242, v242, v248
    v_add_f32 v242, v242, v249
    v_cvt_pk_bf16_f32 v170, v248, v249
    v_exp_f32 v248, v154
    v_exp_f32 v249, v155
    s_nop 0
    v_add_f32 v242, v242, v248
    v_add_f32 v242, v242, v249
    v_cvt_pk_bf16_f32 v171, v248, v249
    v_max3_f32 v250, v140, v141, v142
    v_max3_f32 v250, v250, v143, v156
    v_max3_f32 v250, v250, v157, v158
    v_max_f32 v250, v250, v159
    v_mov_b32 v251, v250
    s_nop 1
    v_permlane16_swap_b32 v250, v251
    s_nop 1
    v_max_f32 v250, v250, v251
    v_mov_b32 v251, v250
    s_nop 1
    v_permlane32_swap_b32 v250, v251
    s_nop 1
    v_max_f32 v250, v250, v251
    v_add_f32 v250, s26, v250
    v_max_f32 v250, 0, v250
    v_exp_f32 v251, -v250
    v_sub_f32 v236, v236, v250
    v_sub_f32 v237, v237, v250
    v_sub_f32 v238, v238, v250
    v_sub_f32 v239, v239, v250
    v_sub_f32 v140, v140, v250
    v_sub_f32 v141, v141, v250
    v_sub_f32 v142, v142, v250
    v_sub_f32 v143, v143, v250
    v_sub_f32 v156, v156, v250
    v_sub_f32 v157, v157, v250
    v_sub_f32 v158, v158, v250
    v_sub_f32 v159, v159, v250
    v_mul_f32 v247, v247, v251
    v_accvgpr_read_b32 v248, a12
    v_accvgpr_read_b32 v249, a13
    v_mul_f32 v248, v248, v251
    v_mul_f32 v249, v249, v251
    v_accvgpr_write_b32 a12, v248
    v_accvgpr_write_b32 a13, v249
    v_accvgpr_read_b32 v248, a14
    v_accvgpr_read_b32 v249, a15
    v_mul_f32 v248, v248, v251
    v_mul_f32 v249, v249, v251
    v_accvgpr_write_b32 a14, v248
    v_accvgpr_write_b32 a15, v249
    v_accvgpr_read_b32 v248, a28
    v_accvgpr_read_b32 v249, a29
    v_mul_f32 v248, v248, v251
    v_mul_f32 v249, v249, v251
    v_accvgpr_write_b32 a28, v248
    v_accvgpr_write_b32 a29, v249
    v_accvgpr_read_b32 v248, a30
    v_accvgpr_read_b32 v249, a31
    v_mul_f32 v248, v248, v251
    v_mul_f32 v249, v249, v251
    v_accvgpr_write_b32 a30, v248
    v_accvgpr_write_b32 a31, v249
    v_accvgpr_read_b32 v248, a44
    v_accvgpr_read_b32 v249, a45
    v_mul_f32 v248, v248, v251
    v_mul_f32 v249, v249, v251
    v_accvgpr_write_b32 a44, v248
    v_accvgpr_write_b32 a45, v249
    v_accvgpr_read_b32 v248, a46
    v_accvgpr_read_b32 v249, a47
    v_mul_f32 v248, v248, v251
    v_mul_f32 v249, v249, v251
    v_accvgpr_write_b32 a46, v248
    v_accvgpr_write_b32 a47, v249
    v_accvgpr_read_b32 v248, a60
    v_accvgpr_read_b32 v249, a61
    v_mul_f32 v248, v248, v251
    v_mul_f32 v249, v249, v251
    v_accvgpr_write_b32 a60, v248
    v_accvgpr_write_b32 a61, v249
    v_accvgpr_read_b32 v248, a62
    v_accvgpr_read_b32 v249, a63
    v_mul_f32 v248, v248, v251
    v_mul_f32 v249, v249, v251
    v_accvgpr_write_b32 a62, v248
    v_accvgpr_write_b32 a63, v249
    v_accvgpr_read_b32 v248, a76
    v_accvgpr_read_b32 v249, a77
    v_mul_f32 v248, v248, v251
    v_mul_f32 v249, v249, v251
    v_accvgpr_write_b32 a76, v248
    v_accvgpr_write_b32 a77, v249
    v_accvgpr_read_b32 v248, a78
    v_accvgpr_read_b32 v249, a79
    v_mul_f32 v248, v248, v251
    v_mul_f32 v249, v249, v251
    v_accvgpr_write_b32 a78, v248
    v_accvgpr_write_b32 a79, v249
    v_accvgpr_read_b32 v248, a92
    v_accvgpr_read_b32 v249, a93
    v_mul_f32 v248, v248, v251
    v_mul_f32 v249, v249, v251
    v_accvgpr_write_b32 a92, v248
    v_accvgpr_write_b32 a93, v249
    v_accvgpr_read_b32 v248, a94
    v_accvgpr_read_b32 v249, a95
    v_mul_f32 v248, v248, v251
    v_mul_f32 v249, v249, v251
    v_accvgpr_write_b32 a94, v248
    v_accvgpr_write_b32 a95, v249
    v_accvgpr_read_b32 v248, a108
    v_accvgpr_read_b32 v249, a109
    v_mul_f32 v248, v248, v251
    v_mul_f32 v249, v249, v251
    v_accvgpr_write_b32 a108, v248
    v_accvgpr_write_b32 a109, v249
    v_accvgpr_read_b32 v248, a110
    v_accvgpr_read_b32 v249, a111
    v_mul_f32 v248, v248, v251
    v_mul_f32 v249, v249, v251
    v_accvgpr_write_b32 a110, v248
    v_accvgpr_write_b32 a111, v249
    v_accvgpr_read_b32 v248, a124
    v_accvgpr_read_b32 v249, a125
    v_mul_f32 v248, v248, v251
    v_mul_f32 v249, v249, v251
    v_accvgpr_write_b32 a124, v248
    v_accvgpr_write_b32 a125, v249
    v_accvgpr_read_b32 v248, a126
    v_accvgpr_read_b32 v249, a127
    v_mul_f32 v248, v248, v251
    v_mul_f32 v249, v249, v251
    v_accvgpr_write_b32 a126, v248
    v_accvgpr_write_b32 a127, v249
    v_accvgpr_read_b32 v248, a140
    v_accvgpr_read_b32 v249, a141
    v_mul_f32 v248, v248, v251
    v_mul_f32 v249, v249, v251
    v_accvgpr_write_b32 a140, v248
    v_accvgpr_write_b32 a141, v249
    v_accvgpr_read_b32 v248, a142
    v_accvgpr_read_b32 v249, a143
    v_mul_f32 v248, v248, v251
    v_mul_f32 v249, v249, v251
    v_accvgpr_write_b32 a142, v248
    v_accvgpr_write_b32 a143, v249
    v_accvgpr_read_b32 v248, a156
    v_accvgpr_read_b32 v249, a157
    v_mul_f32 v248, v248, v251
    v_mul_f32 v249, v249, v251
    v_accvgpr_write_b32 a156, v248
    v_accvgpr_write_b32 a157, v249
    v_accvgpr_read_b32 v248, a158
    v_accvgpr_read_b32 v249, a159
    v_mul_f32 v248, v248, v251
    v_mul_f32 v249, v249, v251
    v_accvgpr_write_b32 a158, v248
    v_accvgpr_write_b32 a159, v249
    v_accvgpr_read_b32 v248, a172
    v_accvgpr_read_b32 v249, a173
    v_mul_f32 v248, v248, v251
    v_mul_f32 v249, v249, v251
    v_accvgpr_write_b32 a172, v248
    v_accvgpr_write_b32 a173, v249
    v_accvgpr_read_b32 v248, a174
    v_accvgpr_read_b32 v249, a175
    v_mul_f32 v248, v248, v251
    v_mul_f32 v249, v249, v251
    v_accvgpr_write_b32 a174, v248
    v_accvgpr_write_b32 a175, v249
    v_accvgpr_read_b32 v248, a188
    v_accvgpr_read_b32 v249, a189
    v_mul_f32 v248, v248, v251
    v_mul_f32 v249, v249, v251
    v_accvgpr_write_b32 a188, v248
    v_accvgpr_write_b32 a189, v249
    v_accvgpr_read_b32 v248, a190
    v_accvgpr_read_b32 v249, a191
    v_mul_f32 v248, v248, v251
    v_mul_f32 v249, v249, v251
    v_accvgpr_write_b32 a190, v248
    v_accvgpr_write_b32 a191, v249
    v_accvgpr_read_b32 v248, a204
    v_accvgpr_read_b32 v249, a205
    v_mul_f32 v248, v248, v251
    v_mul_f32 v249, v249, v251
    v_accvgpr_write_b32 a204, v248
    v_accvgpr_write_b32 a205, v249
    v_accvgpr_read_b32 v248, a206
    v_accvgpr_read_b32 v249, a207
    v_mul_f32 v248, v248, v251
    v_mul_f32 v249, v249, v251
    v_accvgpr_write_b32 a206, v248
    v_accvgpr_write_b32 a207, v249
    v_accvgpr_read_b32 v248, a220
    v_accvgpr_read_b32 v249, a221
    v_mul_f32 v248, v248, v251
    v_mul_f32 v249, v249, v251
    v_accvgpr_write_b32 a220, v248
    v_accvgpr_write_b32 a221, v249
    v_accvgpr_read_b32 v248, a222
    v_accvgpr_read_b32 v249, a223
    v_mul_f32 v248, v248, v251
    v_mul_f32 v249, v249, v251
    v_accvgpr_write_b32 a222, v248
    v_accvgpr_write_b32 a223, v249
    v_accvgpr_read_b32 v248, a236
    v_accvgpr_read_b32 v249, a237
    v_mul_f32 v248, v248, v251
    v_mul_f32 v249, v249, v251
    v_accvgpr_write_b32 a236, v248
    v_accvgpr_write_b32 a237, v249
    v_accvgpr_read_b32 v248, a238
    v_accvgpr_read_b32 v249, a239
    v_mul_f32 v248, v248, v251
    v_mul_f32 v249, v249, v251
    v_accvgpr_write_b32 a238, v248
    v_accvgpr_write_b32 a239, v249
    v_accvgpr_read_b32 v248, a252
    v_accvgpr_read_b32 v249, a253
    v_mul_f32 v248, v248, v251
    v_mul_f32 v249, v249, v251
    v_accvgpr_write_b32 a252, v248
    v_accvgpr_write_b32 a253, v249
    v_accvgpr_read_b32 v248, a254
    v_accvgpr_read_b32 v249, a255
    v_mul_f32 v248, v248, v251
    v_mul_f32 v249, v249, v251
    v_accvgpr_write_b32 a254, v248
    v_accvgpr_write_b32 a255, v249
    v_exp_f32 v248, v140
    v_exp_f32 v249, v141
    s_nop 0
    v_add_f32 v243, v247, v248
    v_add_f32 v243, v243, v249
    v_cvt_pk_bf16_f32 v172, v248, v249
    v_exp_f32 v248, v142
    v_exp_f32 v249, v143
    s_nop 0
    v_add_f32 v243, v243, v248
    v_add_f32 v243, v243, v249
    v_cvt_pk_bf16_f32 v173, v248, v249
    v_exp_f32 v248, v156
    v_exp_f32 v249, v157
    s_nop 0
    v_add_f32 v243, v243, v248
    v_add_f32 v243, v243, v249
    v_cvt_pk_bf16_f32 v174, v248, v249
    v_exp_f32 v248, v158
    v_exp_f32 v249, v159
    s_nop 0
    v_add_f32 v243, v243, v248
    v_add_f32 v243, v243, v249
    v_cvt_pk_bf16_f32 v175, v248, v249
    s_nop 1
    s_branch L_back_a
L_slow_b:
    s_nop 7
    s_nop 7
    v_max3_f32 v250, v128, v129, v130
    v_max3_f32 v250, v250, v131, v144
    v_max3_f32 v250, v250, v145, v146
    v_max_f32 v250, v250, v147
    v_mov_b32 v251, v250
    s_nop 1
    v_permlane16_swap_b32 v250, v251
    s_nop 1
    v_max_f32 v250, v250, v251
    v_mov_b32 v251, v250
    s_nop 1
    v_permlane32_swap_b32 v250, v251
    s_nop 1
    v_max_f32 v250, v250, v251
    v_add_f32 v250, s26, v250
    v_max_f32 v250, 0, v250
    v_exp_f32 v251, -v250
    v_sub_f32 v224, v224, v250
    v_sub_f32 v225, v225, v250
    v_sub_f32 v226, v226, v250
    v_sub_f32 v227, v227, v250
    v_sub_f32 v128, v128, v250
    v_sub_f32 v129, v129, v250
    v_sub_f32 v130, v130, v250
    v_sub_f32 v131, v131, v250
    v_sub_f32 v144, v144, v250
    v_sub_f32 v145, v145, v250
    v_sub_f32 v146, v146, v250
    v_sub_f32 v147, v147, v250
    v_mul_f32 v240, v240, v251
    v_accvgpr_read_b32 v248, a0
    v_accvgpr_read_b32 v249, a1
    v_mul_f32 v248, v248, v251
    v_mul_f32 v249, v249, v251
    v_accvgpr_write_b32 a0, v248
    v_accvgpr_write_b32 a1, v249
    v_accvgpr_read_b32 v248, a2
    v_accvgpr_read_b32 v249, a3
    v_mul_f32 v248, v248, v251
    v_mul_f32 v249, v249, v251
    v_accvgpr_write_b32 a2, v248
    v_accvgpr_write_b32 a3, v249
    v_accvgpr_read_b32 v248, a16
    v_accvgpr_read_b32 v249, a17
    v_mul_f32 v248, v248, v251
    v_mul_f32 v249, v249, v251
    v_accvgpr_write_b32 a16, v248
    v_accvgpr_write_b32 a17, v249
    v_accvgpr_read_b32 v248, a18
    v_accvgpr_read_b32 v249, a19
    v_mul_f32 v248, v248, v251
    v_mul_f32 v249, v249, v251
    v_accvgpr_write_b32 a18, v248
    v_accvgpr_write_b32 a19, v249
    v_accvgpr_read_b32 v248, a32
    v_accvgpr_read_b32 v249, a33
    v_mul_f32 v248, v248, v251
    v_mul_f32 v249, v249, v251
    v_accvgpr_write_b32 a32, v248
    v_accvgpr_write_b32 a33, v249
    v_accvgpr_read_b32 v248, a34
    v_accvgpr_read_b32 v249, a35
    v_mul_f32 v248, v248, v251
    v_mul_f32 v249, v249, v251
    v_accvgpr_write_b32 a34, v248
    v_accvgpr_write_b32 a35, v249
    v_accvgpr_read_b32 v248, a48
    v_accvgpr_read_b32 v249, a49
    v_mul_f32 v248, v248, v251
    v_mul_f32 v249, v249, v251
    v_accvgpr_write_b32 a48, v248
    v_accvgpr_write_b32 a49, v249
    v_accvgpr_read_b32 v248, a50
    v_accvgpr_read_b32 v249, a51
    v_mul_f32 v248, v248, v251
    v_mul_f32 v249, v249, v251
    v_accvgpr_write_b32 a50, v248
    v_accvgpr_write_b32 a51, v249
    v_accvgpr_read_b32 v248, a64
    v_accvgpr_read_b32 v249, a65
    v_mul_f32 v248, v248, v251
    v_mul_f32 v249, v249, v251
    v_accvgpr_write_b32 a64, v248
    v_accvgpr_write_b32 a65, v249
    v_accvgpr_read_b32 v248, a66
    v_accvgpr_read_b32 v249, a67
    v_mul_f32 v248, v248, v251
    v_mul_f32 v249, v249, v251
    v_accvgpr_write_b32 a66, v248
    v_accvgpr_write_b32 a67, v249
    v_accvgpr_read_b32 v248, a80
    v_accvgpr_read_b32 v249, a81
    v_mul_f32 v248, v248, v251
    v_mul_f32 v249, v249, v251
    v_accvgpr_write_b32 a80, v248
    v_accvgpr_write_b32 a81, v249
    v_accvgpr_read_b32 v248, a82
    v_accvgpr_read_b32 v249, a83
    v_mul_f32 v248, v248, v251
    v_mul_f32 v249, v249, v251
    v_accvgpr_write_b32 a82, v248
    v_accvgpr_write_b32 a83, v249
    v_accvgpr_read_b32 v248, a96
    v_accvgpr_read_b32 v249, a97
    v_mul_f32 v248, v248, v251
    v_mul_f32 v249, v249, v251
    v_accvgpr_write_b32 a96, v248
    v_accvgpr_write_b32 a97, v249
    v_accvgpr_read_b32 v248, a98
    v_accvgpr_read_b32 v249, a99
    v_mul_f32 v248, v248, v251
    v_mul_f32 v249, v249, v251
    v_accvgpr_write_b32 a98, v248
    v_accvgpr_write_b32 a99, v249
    v_accvgpr_read_b32 v248, a112
    v_accvgpr_read_b32 v249, a113
    v_mul_f32 v248, v248, v251
    v_mul_f32 v249, v249, v251
    v_accvgpr_write_b32 a112, v248
    v_accvgpr_write_b32 a113, v249
    v_accvgpr_read_b32 v248, a114
    v_accvgpr_read_b32 v249, a115
    v_mul_f32 v248, v248, v251
    v_mul_f32 v249, v249, v251
    v_accvgpr_write_b32 a114, v248
    v_accvgpr_write_b32 a115, v249
    v_accvgpr_read_b32 v248, a128
    v_accvgpr_read_b32 v249, a129
    v_mul_f32 v248, v248, v251
    v_mul_f32 v249, v249, v251
    v_accvgpr_write_b32 a128, v248
    v_accvgpr_write_b32 a129, v249
    v_accvgpr_read_b32 v248, a130
    v_accvgpr_read_b32 v249, a131
    v_mul_f32 v248, v248, v251
    v_mul_f32 v249, v249, v251
    v_accvgpr_write_b32 a130, v248
    v_accvgpr_write_b32 a131, v249
    v_accvgpr_read_b32 v248, a144
    v_accvgpr_read_b32 v249, a145
    v_mul_f32 v248, v248, v251
    v_mul_f32 v249, v249, v251
    v_accvgpr_write_b32 a144, v248
    v_accvgpr_write_b32 a145, v249
    v_accvgpr_read_b32 v248, a146
    v_accvgpr_read_b32 v249, a147
    v_mul_f32 v248, v248, v251
    v_mul_f32 v249, v249, v251
    v_accvgpr_write_b32 a146, v248
    v_accvgpr_write_b32 a147, v249
    v_accvgpr_read_b32 v248, a160
    v_accvgpr_read_b32 v249, a161
    v_mul_f32 v248, v248, v251
    v_mul_f32 v249, v249, v251
    v_accvgpr_write_b32 a160, v248
    v_accvgpr_write_b32 a161, v249
    v_accvgpr_read_b32 v248, a162
    v_accvgpr_read_b32 v249, a163
    v_mul_f32 v248, v248, v251
    v_mul_f32 v249, v249, v251
    v_accvgpr_write_b32 a162, v248
    v_accvgpr_write_b32 a163, v249
    v_accvgpr_read_b32 v248, a176
    v_accvgpr_read_b32 v249, a177
    v_mul_f32 v248, v248, v251
    v_mul_f32 v249, v249, v251
    v_accvgpr_write_b32 a176, v248
    v_accvgpr_write_b32 a177, v249
    v_accvgpr_read_b32 v248, a178
    v_accvgpr_read_b32 v249, a179
    v_mul_f32 v248, v248, v251
    v_mul_f32 v249, v249, v251
    v_accvgpr_write_b32 a178, v248
    v_accvgpr_write_b32 a179, v249
    v_accvgpr_read_b32 v248, a192
    v_accvgpr_read_b32 v249, a193
    v_mul_f32 v248, v248, v251
    v_mul_f32 v249, v249, v251
    v_accvgpr_write_b32 a192, v248
    v_accvgpr_write_b32 a193, v249
    v_accvgpr_read_b32 v248, a194
    v_accvgpr_read_b32 v249, a195
    v_mul_f32 v248, v248, v251
    v_mul_f32 v249, v249, v251
    v_accvgpr_write_b32 a194, v248
    v_accvgpr_write_b32 a195, v249
    v_accvgpr_read_b32 v248, a208
    v_accvgpr_read_b32 v249, a209
    v_mul_f32 v248, v248, v251
    v_mul_f32 v249, v249, v251
    v_accvgpr_write_b32 a208, v248
    v_accvgpr_write_b32 a209, v249
    v_accvgpr_read_b32 v248, a210
    v_accvgpr_read_b32 v249, a211
    v_mul_f32 v248, v248, v251
    v_mul_f32 v249, v249, v251
    v_accvgpr_write_b32 a210, v248
    v_accvgpr_write_b32 a211, v249
    v_accvgpr_read_b32 v248, a224
    v_accvgpr_read_b32 v249, a225
    v_mul_f32 v248, v248, v251
    v_mul_f32 v249, v249, v251
    v_accvgpr_write_b32 a224, v248
    v_accvgpr_write_b32 a225, v249
    v_accvgpr_read_b32 v248, a226
    v_accvgpr_read_b32 v249, a227
    v_mul_f32 v248, v248, v251
    v_mul_f32 v249, v249, v251
    v_accvgpr_write_b32 a226, v248
    v_accvgpr_write_b32 a227, v249
    v_accvgpr_read_b32 v248, a240
    v_accvgpr_read_b32 v249, a241
    v_mul_f32 v248, v248, v251
    v_mul_f32 v249, v249, v251
    v_accvgpr_write_b32 a240, v248
    v_accvgpr_write_b32 a241, v249
    v_accvgpr_read_b32 v248, a242
    v_accvgpr_read_b32 v249, a243
    v_mul_f32 v248, v248, v251
    v_mul_f32 v249, v249, v251
    v_accvgpr_write_b32 a242, v248
    v_accvgpr_write_b32 a243, v249
    v_exp_f32 v248, v128
    v_exp_f32 v249, v129
    s_nop 0
    v_add_f32 v244, v240, v248
    v_add_f32 v244, v244, v249
    v_cvt_pk_bf16_f32 v176, v248, v249
    v_exp_f32 v248, v130
    v_exp_f32 v249, v131
    s_nop 0
    v_add_f32 v244, v244, v248
    v_add_f32 v244, v244, v249
    v_cvt_pk_bf16_f32 v177, v248, v249
    v_exp_f32 v248, v144
    v_exp_f32 v249, v145
    s_nop 0
    v_add_f32 v244, v244, v248
    v_add_f32 v244, v244, v249
    v_cvt_pk_bf16_f32 v178, v248, v249
    v_exp_f32 v248, v146
    v_exp_f32 v249, v147
    s_nop 0
    v_add_f32 v244, v244, v248
    v_add_f32 v244, v244, v249
    v_cvt_pk_bf16_f32 v179, v248, v249
    v_max3_f32 v250, v132, v133, v134
    v_max3_f32 v250, v250, v135, v148
    v_max3_f32 v250, v250, v149, v150
    v_max_f32 v250, v250, v151
    v_mov_b32 v251, v250
    s_nop 1
    v_permlane16_swap_b32 v250, v251
    s_nop 1
    v_max_f32 v250, v250, v251
    v_mov_b32 v251, v250
    s_nop 1
    v_permlane32_swap_b32 v250, v251
    s_nop 1
    v_max_f32 v250, v250, v251
    v_add_f32 v250, s26, v250
    v_max_f32 v250, 0, v250
    v_exp_f32 v251, -v250
    v_sub_f32 v228, v228, v250
    v_sub_f32 v229, v229, v250
    v_sub_f32 v230, v230, v250
    v_sub_f32 v231, v231, v250
    v_sub_f32 v132, v132, v250
    v_sub_f32 v133, v133, v250
    v_sub_f32 v134, v134, v250
    v_sub_f32 v135, v135, v250
    v_sub_f32 v148, v148, v250
    v_sub_f32 v149, v149, v250
    v_sub_f32 v150, v150, v250
    v_sub_f32 v151, v151, v250
    v_mul_f32 v241, v241, v251
    v_accvgpr_read_b32 v248, a4
    v_accvgpr_read_b32 v249, a5
    v_mul_f32 v248, v248, v251
    v_mul_f32 v249, v249, v251
    v_accvgpr_write_b32 a4, v248
    v_accvgpr_write_b32 a5, v249
    v_accvgpr_read_b32 v248, a6
    v_accvgpr_read_b32 v249, a7
    v_mul_f32 v248, v248, v251
    v_mul_f32 v249, v249, v251
    v_accvgpr_write_b32 a6, v248
    v_accvgpr_write_b32 a7, v249
    v_accvgpr_read_b32 v248, a20
    v_accvgpr_read_b32 v249, a21
    v_mul_f32 v248, v248, v251
    v_mul_f32 v249, v249, v251
    v_accvgpr_write_b32 a20, v248
    v_accvgpr_write_b32 a21, v249
    v_accvgpr_read_b32 v248, a22
    v_accvgpr_read_b32 v249, a23
    v_mul_f32 v248, v248, v251
    v_mul_f32 v249, v249, v251
    v_accvgpr_write_b32 a22, v248
    v_accvgpr_write_b32 a23, v249
    v_accvgpr_read_b32 v248, a36
    v_accvgpr_read_b32 v249, a37
    v_mul_f32 v248, v248, v251
    v_mul_f32 v249, v249, v251
    v_accvgpr_write_b32 a36, v248
    v_accvgpr_write_b32 a37, v249
    v_accvgpr_read_b32 v248, a38
    v_accvgpr_read_b32 v249, a39
    v_mul_f32 v248, v248, v251
    v_mul_f32 v249, v249, v251
    v_accvgpr_write_b32 a38, v248
    v_accvgpr_write_b32 a39, v249
    v_accvgpr_read_b32 v248, a52
    v_accvgpr_read_b32 v249, a53
    v_mul_f32 v248, v248, v251
    v_mul_f32 v249, v249, v251
    v_accvgpr_write_b32 a52, v248
    v_accvgpr_write_b32 a53, v249
    v_accvgpr_read_b32 v248, a54
    v_accvgpr_read_b32 v249, a55
    v_mul_f32 v248, v248, v251
    v_mul_f32 v249, v249, v251
    v_accvgpr_write_b32 a54, v248
    v_accvgpr_write_b32 a55, v249
    v_accvgpr_read_b32 v248, a68
    v_accvgpr_read_b32 v249, a69
    v_mul_f32 v248, v248, v251
    v_mul_f32 v249, v249, v251
    v_accvgpr_write_b32 a68, v248
    v_accvgpr_write_b32 a69, v249
    v_accvgpr_read_b32 v248, a70
    v_accvgpr_read_b32 v249, a71
    v_mul_f32 v248, v248, v251
    v_mul_f32 v249, v249, v251
    v_accvgpr_write_b32 a70, v248
    v_accvgpr_write_b32 a71, v249
    v_accvgpr_read_b32 v248, a84
    v_accvgpr_read_b32 v249, a85
    v_mul_f32 v248, v248, v251
    v_mul_f32 v249, v249, v251
    v_accvgpr_write_b32 a84, v248
    v_accvgpr_write_b32 a85, v249
    v_accvgpr_read_b32 v248, a86
    v_accvgpr_read_b32 v249, a87
    v_mul_f32 v248, v248, v251
    v_mul_f32 v249, v249, v251
    v_accvgpr_write_b32 a86, v248
    v_accvgpr_write_b32 a87, v249
    v_accvgpr_read_b32 v248, a100
    v_accvgpr_read_b32 v249, a101
    v_mul_f32 v248, v248, v251
    v_mul_f32 v249, v249, v251
    v_accvgpr_write_b32 a100, v248
    v_accvgpr_write_b32 a101, v249
    v_accvgpr_read_b32 v248, a102
    v_accvgpr_read_b32 v249, a103
    v_mul_f32 v248, v248, v251
    v_mul_f32 v249, v249, v251
    v_accvgpr_write_b32 a102, v248
    v_accvgpr_write_b32 a103, v249
    v_accvgpr_read_b32 v248, a116
    v_accvgpr_read_b32 v249, a117
    v_mul_f32 v248, v248, v251
    v_mul_f32 v249, v249, v251
    v_accvgpr_write_b32 a116, v248
    v_accvgpr_write_b32 a117, v249
    v_accvgpr_read_b32 v248, a118
    v_accvgpr_read_b32 v249, a119
    v_mul_f32 v248, v248, v251
    v_mul_f32 v249, v249, v251
    v_accvgpr_write_b32 a118, v248
    v_accvgpr_write_b32 a119, v249
    v_accvgpr_read_b32 v248, a132
    v_accvgpr_read_b32 v249, a133
    v_mul_f32 v248, v248, v251
    v_mul_f32 v249, v249, v251
    v_accvgpr_write_b32 a132, v248
    v_accvgpr_write_b32 a133, v249
    v_accvgpr_read_b32 v248, a134
    v_accvgpr_read_b32 v249, a135
    v_mul_f32 v248, v248, v251
    v_mul_f32 v249, v249, v251
    v_accvgpr_write_b32 a134, v248
    v_accvgpr_write_b32 a135, v249
    v_accvgpr_read_b32 v248, a148
    v_accvgpr_read_b32 v249, a149
    v_mul_f32 v248, v248, v251
    v_mul_f32 v249, v249, v251
    v_accvgpr_write_b32 a148, v248
    v_accvgpr_write_b32 a149, v249
    v_accvgpr_read_b32 v248, a150
    v_accvgpr_read_b32 v249, a151
    v_mul_f32 v248, v248, v251
    v_mul_f32 v249, v249, v251
    v_accvgpr_write_b32 a150, v248
    v_accvgpr_write_b32 a151, v249
    v_accvgpr_read_b32 v248, a164
    v_accvgpr_read_b32 v249, a165
    v_mul_f32 v248, v248, v251
    v_mul_f32 v249, v249, v251
    v_accvgpr_write_b32 a164, v248
    v_accvgpr_write_b32 a165, v249
    v_accvgpr_read_b32 v248, a166
    v_accvgpr_read_b32 v249, a167
    v_mul_f32 v248, v248, v251
    v_mul_f32 v249, v249, v251
    v_accvgpr_write_b32 a166, v248
    v_accvgpr_write_b32 a167, v249
    v_accvgpr_read_b32 v248, a180
    v_accvgpr_read_b32 v249, a181
    v_mul_f32 v248, v248, v251
    v_mul_f32 v249, v249, v251
    v_accvgpr_write_b32 a180, v248
    v_accvgpr_write_b32 a181, v249
    v_accvgpr_read_b32 v248, a182
    v_accvgpr_read_b32 v249, a183
    v_mul_f32 v248, v248, v251
    v_mul_f32 v249, v249, v251
    v_accvgpr_write_b32 a182, v248
    v_accvgpr_write_b32 a183, v249
    v_accvgpr_read_b32 v248, a196
    v_accvgpr_read_b32 v249, a197
    v_mul_f32 v248, v248, v251
    v_mul_f32 v249, v249, v251
    v_accvgpr_write_b32 a196, v248
    v_accvgpr_write_b32 a197, v249
    v_accvgpr_read_b32 v248, a198
    v_accvgpr_read_b32 v249, a199
    v_mul_f32 v248, v248, v251
    v_mul_f32 v249, v249, v251
    v_accvgpr_write_b32 a198, v248
    v_accvgpr_write_b32 a199, v249
    v_accvgpr_read_b32 v248, a212
    v_accvgpr_read_b32 v249, a213
    v_mul_f32 v248, v248, v251
    v_mul_f32 v249, v249, v251
    v_accvgpr_write_b32 a212, v248
    v_accvgpr_write_b32 a213, v249
    v_accvgpr_read_b32 v248, a214
    v_accvgpr_read_b32 v249, a215
    v_mul_f32 v248, v248, v251
    v_mul_f32 v249, v249, v251
    v_accvgpr_write_b32 a214, v248
    v_accvgpr_write_b32 a215, v249
    v_accvgpr_read_b32 v248, a228
    v_accvgpr_read_b32 v249, a229
    v_mul_f32 v248, v248, v251
    v_mul_f32 v249, v249, v251
    v_accvgpr_write_b32 a228, v248
    v_accvgpr_write_b32 a229, v249
    v_accvgpr_read_b32 v248, a230
    v_accvgpr_read_b32 v249, a231
    v_mul_f32 v248, v248, v251
    v_mul_f32 v249, v249, v251
    v_accvgpr_write_b32 a230, v248
    v_accvgpr_write_b32 a231, v249
    v_accvgpr_read_b32 v248, a244
    v_accvgpr_read_b32 v249, a245
    v_mul_f32 v248, v248, v251
    v_mul_f32 v249, v249, v251
    v_accvgpr_write_b32 a244, v248
    v_accvgpr_write_b32 a245, v249
    v_accvgpr_read_b32 v248, a246
    v_accvgpr_read_b32 v249, a247
    v_mul_f32 v248, v248, v251
    v_mul_f32 v249, v249, v251
    v_accvgpr_write_b32 a246, v248
    v_accvgpr_write_b32 a247, v249
    v_exp_f32 v248, v132
    v_exp_f32 v249, v133
    s_nop 0
    v_add_f32 v245, v241, v248
    v_add_f32 v245, v245, v249
    v_cvt_pk_bf16_f32 v180, v248, v249
    v_exp_f32 v248, v134
    v_exp_f32 v249, v135
    s_nop 0
    v_add_f32 v245, v245, v248
    v_add_f32 v245, v245, v249
    v_cvt_pk_bf16_f32 v181, v248, v249
    v_exp_f32 v248, v148
    v_exp_f32 v249, v149
    s_nop 0
    v_add_f32 v245, v245, v248
    v_add_f32 v245, v245, v249
    v_cvt_pk_bf16_f32 v182, v248, v249
    v_exp_f32 v248, v150
    v_exp_f32 v249, v151
    s_nop 0
    v_add_f32 v245, v245, v248
    v_add_f32 v245, v245, v249
    v_cvt_pk_bf16_f32 v183, v248, v249
    v_max3_f32 v250, v136, v137, v138
    v_max3_f32 v250, v250, v139, v152
    v_max3_f32 v250, v250, v153, v154
    v_max_f32 v250, v250, v155
    v_mov_b32 v251, v250
    s_nop 1
    v_permlane16_swap_b32 v250, v251
    s_nop 1
    v_max_f32 v250, v250, v251
    v_mov_b32 v251, v250
    s_nop 1
    v_permlane32_swap_b32 v250, v251
    s_nop 1
    v_max_f32 v250, v250, v251
    v_add_f32 v250, s26, v250
    v_max_f32 v250, 0, v250
    v_exp_f32 v251, -v250
    v_sub_f32 v232, v232, v250
    v_sub_f32 v233, v233, v250
    v_sub_f32 v234, v234, v250
    v_sub_f32 v235, v235, v250
    v_sub_f32 v136, v136, v250
    v_sub_f32 v137, v137, v250
    v_sub_f32 v138, v138, v250
    v_sub_f32 v139, v139, v250
    v_sub_f32 v152, v152, v250
    v_sub_f32 v153, v153, v250
    v_sub_f32 v154, v154, v250
    v_sub_f32 v155, v155, v250
    v_mul_f32 v242, v242, v251
    v_accvgpr_read_b32 v248, a8
    v_accvgpr_read_b32 v249, a9
    v_mul_f32 v248, v248, v251
    v_mul_f32 v249, v249, v251
    v_accvgpr_write_b32 a8, v248
    v_accvgpr_write_b32 a9, v249
    v_accvgpr_read_b32 v248, a10
    v_accvgpr_read_b32 v249, a11
    v_mul_f32 v248, v248, v251
    v_mul_f32 v249, v249, v251
    v_accvgpr_write_b32 a10, v248
    v_accvgpr_write_b32 a11, v249
    v_accvgpr_read_b32 v248, a24
    v_accvgpr_read_b32 v249, a25
    v_mul_f32 v248, v248, v251
    v_mul_f32 v249, v249, v251
    v_accvgpr_write_b32 a24, v248
    v_accvgpr_write_b32 a25, v249
    v_accvgpr_read_b32 v248, a26
    v_accvgpr_read_b32 v249, a27
    v_mul_f32 v248, v248, v251
    v_mul_f32 v249, v249, v251
    v_accvgpr_write_b32 a26, v248
    v_accvgpr_write_b32 a27, v249
    v_accvgpr_read_b32 v248, a40
    v_accvgpr_read_b32 v249, a41
    v_mul_f32 v248, v248, v251
    v_mul_f32 v249, v249, v251
    v_accvgpr_write_b32 a40, v248
    v_accvgpr_write_b32 a41, v249
    v_accvgpr_read_b32 v248, a42
    v_accvgpr_read_b32 v249, a43
    v_mul_f32 v248, v248, v251
    v_mul_f32 v249, v249, v251
    v_accvgpr_write_b32 a42, v248
    v_accvgpr_write_b32 a43, v249
    v_accvgpr_read_b32 v248, a56
    v_accvgpr_read_b32 v249, a57
    v_mul_f32 v248, v248, v251
    v_mul_f32 v249, v249, v251
    v_accvgpr_write_b32 a56, v248
    v_accvgpr_write_b32 a57, v249
    v_accvgpr_read_b32 v248, a58
    v_accvgpr_read_b32 v249, a59
    v_mul_f32 v248, v248, v251
    v_mul_f32 v249, v249, v251
    v_accvgpr_write_b32 a58, v248
    v_accvgpr_write_b32 a59, v249
    v_accvgpr_read_b32 v248, a72
    v_accvgpr_read_b32 v249, a73
    v_mul_f32 v248, v248, v251
    v_mul_f32 v249, v249, v251
    v_accvgpr_write_b32 a72, v248
    v_accvgpr_write_b32 a73, v249
    v_accvgpr_read_b32 v248, a74
    v_accvgpr_read_b32 v249, a75
    v_mul_f32 v248, v248, v251
    v_mul_f32 v249, v249, v251
    v_accvgpr_write_b32 a74, v248
    v_accvgpr_write_b32 a75, v249
    v_accvgpr_read_b32 v248, a88
    v_accvgpr_read_b32 v249, a89
    v_mul_f32 v248, v248, v251
    v_mul_f32 v249, v249, v251
    v_accvgpr_write_b32 a88, v248
    v_accvgpr_write_b32 a89, v249
    v_accvgpr_read_b32 v248, a90
    v_accvgpr_read_b32 v249, a91
    v_mul_f32 v248, v248, v251
    v_mul_f32 v249, v249, v251
    v_accvgpr_write_b32 a90, v248
    v_accvgpr_write_b32 a91, v249
    v_accvgpr_read_b32 v248, a104
    v_accvgpr_read_b32 v249, a105
    v_mul_f32 v248, v248, v251
    v_mul_f32 v249, v249, v251
    v_accvgpr_write_b32 a104, v248
    v_accvgpr_write_b32 a105, v249
    v_accvgpr_read_b32 v248, a106
    v_accvgpr_read_b32 v249, a107
    v_mul_f32 v248, v248, v251
    v_mul_f32 v249, v249, v251
    v_accvgpr_write_b32 a106, v248
    v_accvgpr_write_b32 a107, v249
    v_accvgpr_read_b32 v248, a120
    v_accvgpr_read_b32 v249, a121
    v_mul_f32 v248, v248, v251
    v_mul_f32 v249, v249, v251
    v_accvgpr_write_b32 a120, v248
    v_accvgpr_write_b32 a121, v249
    v_accvgpr_read_b32 v248, a122
    v_accvgpr_read_b32 v249, a123
    v_mul_f32 v248, v248, v251
    v_mul_f32 v249, v249, v251
    v_accvgpr_write_b32 a122, v248
    v_accvgpr_write_b32 a123, v249
    v_accvgpr_read_b32 v248, a136
    v_accvgpr_read_b32 v249, a137
    v_mul_f32 v248, v248, v251
    v_mul_f32 v249, v249, v251
    v_accvgpr_write_b32 a136, v248
    v_accvgpr_write_b32 a137, v249
    v_accvgpr_read_b32 v248, a138
    v_accvgpr_read_b32 v249, a139
    v_mul_f32 v248, v248, v251
    v_mul_f32 v249, v249, v251
    v_accvgpr_write_b32 a138, v248
    v_accvgpr_write_b32 a139, v249
    v_accvgpr_read_b32 v248, a152
    v_accvgpr_read_b32 v249, a153
    v_mul_f32 v248, v248, v251
    v_mul_f32 v249, v249, v251
    v_accvgpr_write_b32 a152, v248
    v_accvgpr_write_b32 a153, v249
    v_accvgpr_read_b32 v248, a154
    v_accvgpr_read_b32 v249, a155
    v_mul_f32 v248, v248, v251
    v_mul_f32 v249, v249, v251
    v_accvgpr_write_b32 a154, v248
    v_accvgpr_write_b32 a155, v249
    v_accvgpr_read_b32 v248, a168
    v_accvgpr_read_b32 v249, a169
    v_mul_f32 v248, v248, v251
    v_mul_f32 v249, v249, v251
    v_accvgpr_write_b32 a168, v248
    v_accvgpr_write_b32 a169, v249
    v_accvgpr_read_b32 v248, a170
    v_accvgpr_read_b32 v249, a171
    v_mul_f32 v248, v248, v251
    v_mul_f32 v249, v249, v251
    v_accvgpr_write_b32 a170, v248
    v_accvgpr_write_b32 a171, v249
    v_accvgpr_read_b32 v248, a184
    v_accvgpr_read_b32 v249, a185
    v_mul_f32 v248, v248, v251
    v_mul_f32 v249, v249, v251
    v_accvgpr_write_b32 a184, v248
    v_accvgpr_write_b32 a185, v249
    v_accvgpr_read_b32 v248, a186
    v_accvgpr_read_b32 v249, a187
    v_mul_f32 v248, v248, v251
    v_mul_f32 v249, v249, v251
    v_accvgpr_write_b32 a186, v248
    v_accvgpr_write_b32 a187, v249
    v_accvgpr_read_b32 v248, a200
    v_accvgpr_read_b32 v249, a201
    v_mul_f32 v248, v248, v251
    v_mul_f32 v249, v249, v251
    v_accvgpr_write_b32 a200, v248
    v_accvgpr_write_b32 a201, v249
    v_accvgpr_read_b32 v248, a202
    v_accvgpr_read_b32 v249, a203
    v_mul_f32 v248, v248, v251
    v_mul_f32 v249, v249, v251
    v_accvgpr_write_b32 a202, v248
    v_accvgpr_write_b32 a203, v249
    v_accvgpr_read_b32 v248, a216
    v_accvgpr_read_b32 v249, a217
    v_mul_f32 v248, v248, v251
    v_mul_f32 v249, v249, v251
    v_accvgpr_write_b32 a216, v248
    v_accvgpr_write_b32 a217, v249
    v_accvgpr_read_b32 v248, a218
    v_accvgpr_read_b32 v249, a219
    v_mul_f32 v248, v248, v251
    v_mul_f32 v249, v249, v251
    v_accvgpr_write_b32 a218, v248
    v_accvgpr_write_b32 a219, v249
    v_accvgpr_read_b32 v248, a232
    v_accvgpr_read_b32 v249, a233
    v_mul_f32 v248, v248, v251
    v_mul_f32 v249, v249, v251
    v_accvgpr_write_b32 a232, v248
    v_accvgpr_write_b32 a233, v249
    v_accvgpr_read_b32 v248, a234
    v_accvgpr_read_b32 v249, a235
    v_mul_f32 v248, v248, v251
    v_mul_f32 v249, v249, v251
    v_accvgpr_write_b32 a234, v248
    v_accvgpr_write_b32 a235, v249
    v_accvgpr_read_b32 v248, a248
    v_accvgpr_read_b32 v249, a249
    v_mul_f32 v248, v248, v251
    v_mul_f32 v249, v249, v251
    v_accvgpr_write_b32 a248, v248
    v_accvgpr_write_b32 a249, v249
    v_accvgpr_read_b32 v248, a250
    v_accvgpr_read_b32 v249, a251
    v_mul_f32 v248, v248, v251
    v_mul_f32 v249, v249, v251
    v_accvgpr_write_b32 a250, v248
    v_accvgpr_write_b32 a251, v249
    v_exp_f32 v248, v136
    v_exp_f32 v249, v137
    s_nop 0
    v_add_f32 v246, v242, v248
    v_add_f32 v246, v246, v249
    v_cvt_pk_bf16_f32 v184, v248, v249
    v_exp_f32 v248, v138
    v_exp_f32 v249, v139
    s_nop 0
    v_add_f32 v246, v246, v248
    v_add_f32 v246, v246, v249
    v_cvt_pk_bf16_f32 v185, v248, v249
    v_exp_f32 v248, v152
    v_exp_f32 v249, v153
    s_nop 0
    v_add_f32 v246, v246, v248
    v_add_f32 v246, v246, v249
    v_cvt_pk_bf16_f32 v186, v248, v249
    v_exp_f32 v248, v154
    v_exp_f32 v249, v155
    s_nop 0
    v_add_f32 v246, v246, v248
    v_add_f32 v246, v246, v249
    v_cvt_pk_bf16_f32 v187, v248, v249
    v_max3_f32 v250, v140, v141, v142
    v_max3_f32 v250, v250, v143, v156
    v_max3_f32 v250, v250, v157, v158
    v_max_f32 v250, v250, v159
    v_mov_b32 v251, v250
    s_nop 1
    v_permlane16_swap_b32 v250, v251
    s_nop 1
    v_max_f32 v250, v250, v251
    v_mov_b32 v251, v250
    s_nop 1
    v_permlane32_swap_b32 v250, v251
    s_nop 1
    v_max_f32 v250, v250, v251
    v_add_f32 v250, s26, v250
    v_max_f32 v250, 0, v250
    v_exp_f32 v251, -v250
    v_sub_f32 v236, v236, v250
    v_sub_f32 v237, v237, v250
    v_sub_f32 v238, v238, v250
    v_sub_f32 v239, v239, v250
    v_sub_f32 v140, v140, v250
    v_sub_f32 v141, v141, v250
    v_sub_f32 v142, v142, v250
    v_sub_f32 v143, v143, v250
    v_sub_f32 v156, v156, v250
    v_sub_f32 v157, v157, v250
    v_sub_f32 v158, v158, v250
    v_sub_f32 v159, v159, v250
    v_mul_f32 v243, v243, v251
    v_accvgpr_read_b32 v248, a12
    v_accvgpr_read_b32 v249, a13
    v_mul_f32 v248, v248, v251
    v_mul_f32 v249, v249, v251
    v_accvgpr_write_b32 a12, v248
    v_accvgpr_write_b32 a13, v249
    v_accvgpr_read_b32 v248, a14
    v_accvgpr_read_b32 v249, a15
    v_mul_f32 v248, v248, v251
    v_mul_f32 v249, v249, v251
    v_accvgpr_write_b32 a14, v248
    v_accvgpr_write_b32 a15, v249
    v_accvgpr_read_b32 v248, a28
    v_accvgpr_read_b32 v249, a29
    v_mul_f32 v248, v248, v251
    v_mul_f32 v249, v249, v251
    v_accvgpr_write_b32 a28, v248
    v_accvgpr_write_b32 a29, v249
    v_accvgpr_read_b32 v248, a30
    v_accvgpr_read_b32 v249, a31
    v_mul_f32 v248, v248, v251
    v_mul_f32 v249, v249, v251
    v_accvgpr_write_b32 a30, v248
    v_accvgpr_write_b32 a31, v249
    v_accvgpr_read_b32 v248, a44
    v_accvgpr_read_b32 v249, a45
    v_mul_f32 v248, v248, v251
    v_mul_f32 v249, v249, v251
    v_accvgpr_write_b32 a44, v248
    v_accvgpr_write_b32 a45, v249
    v_accvgpr_read_b32 v248, a46
    v_accvgpr_read_b32 v249, a47
    v_mul_f32 v248, v248, v251
    v_mul_f32 v249, v249, v251
    v_accvgpr_write_b32 a46, v248
    v_accvgpr_write_b32 a47, v249
    v_accvgpr_read_b32 v248, a60
    v_accvgpr_read_b32 v249, a61
    v_mul_f32 v248, v248, v251
    v_mul_f32 v249, v249, v251
    v_accvgpr_write_b32 a60, v248
    v_accvgpr_write_b32 a61, v249
    v_accvgpr_read_b32 v248, a62
    v_accvgpr_read_b32 v249, a63
    v_mul_f32 v248, v248, v251
    v_mul_f32 v249, v249, v251
    v_accvgpr_write_b32 a62, v248
    v_accvgpr_write_b32 a63, v249
    v_accvgpr_read_b32 v248, a76
    v_accvgpr_read_b32 v249, a77
    v_mul_f32 v248, v248, v251
    v_mul_f32 v249, v249, v251
    v_accvgpr_write_b32 a76, v248
    v_accvgpr_write_b32 a77, v249
    v_accvgpr_read_b32 v248, a78
    v_accvgpr_read_b32 v249, a79
    v_mul_f32 v248, v248, v251
    v_mul_f32 v249, v249, v251
    v_accvgpr_write_b32 a78, v248
    v_accvgpr_write_b32 a79, v249
    v_accvgpr_read_b32 v248, a92
    v_accvgpr_read_b32 v249, a93
    v_mul_f32 v248, v248, v251
    v_mul_f32 v249, v249, v251
    v_accvgpr_write_b32 a92, v248
    v_accvgpr_write_b32 a93, v249
    v_accvgpr_read_b32 v248, a94
    v_accvgpr_read_b32 v249, a95
    v_mul_f32 v248, v248, v251
    v_mul_f32 v249, v249, v251
    v_accvgpr_write_b32 a94, v248
    v_accvgpr_write_b32 a95, v249
    v_accvgpr_read_b32 v248, a108
    v_accvgpr_read_b32 v249, a109
    v_mul_f32 v248, v248, v251
    v_mul_f32 v249, v249, v251
    v_accvgpr_write_b32 a108, v248
    v_accvgpr_write_b32 a109, v249
    v_accvgpr_read_b32 v248, a110
    v_accvgpr_read_b32 v249, a111
    v_mul_f32 v248, v248, v251
    v_mul_f32 v249, v249, v251
    v_accvgpr_write_b32 a110, v248
    v_accvgpr_write_b32 a111, v249
    v_accvgpr_read_b32 v248, a124
    v_accvgpr_read_b32 v249, a125
    v_mul_f32 v248, v248, v251
    v_mul_f32 v249, v249, v251
    v_accvgpr_write_b32 a124, v248
    v_accvgpr_write_b32 a125, v249
    v_accvgpr_read_b32 v248, a126
    v_accvgpr_read_b32 v249, a127
    v_mul_f32 v248, v248, v251
    v_mul_f32 v249, v249, v251
    v_accvgpr_write_b32 a126, v248
    v_accvgpr_write_b32 a127, v249
    v_accvgpr_read_b32 v248, a140
    v_accvgpr_read_b32 v249, a141
    v_mul_f32 v248, v248, v251
    v_mul_f32 v249, v249, v251
    v_accvgpr_write_b32 a140, v248
    v_accvgpr_write_b32 a141, v249
    v_accvgpr_read_b32 v248, a142
    v_accvgpr_read_b32 v249, a143
    v_mul_f32 v248, v248, v251
    v_mul_f32 v249, v249, v251
    v_accvgpr_write_b32 a142, v248
    v_accvgpr_write_b32 a143, v249
    v_accvgpr_read_b32 v248, a156
    v_accvgpr_read_b32 v249, a157
    v_mul_f32 v248, v248, v251
    v_mul_f32 v249, v249, v251
    v_accvgpr_write_b32 a156, v248
    v_accvgpr_write_b32 a157, v249
    v_accvgpr_read_b32 v248, a158
    v_accvgpr_read_b32 v249, a159
    v_mul_f32 v248, v248, v251
    v_mul_f32 v249, v249, v251
    v_accvgpr_write_b32 a158, v248
    v_accvgpr_write_b32 a159, v249
    v_accvgpr_read_b32 v248, a172
    v_accvgpr_read_b32 v249, a173
    v_mul_f32 v248, v248, v251
    v_mul_f32 v249, v249, v251
    v_accvgpr_write_b32 a172, v248
    v_accvgpr_write_b32 a173, v249
    v_accvgpr_read_b32 v248, a174
    v_accvgpr_read_b32 v249, a175
    v_mul_f32 v248, v248, v251
    v_mul_f32 v249, v249, v251
    v_accvgpr_write_b32 a174, v248
    v_accvgpr_write_b32 a175, v249
    v_accvgpr_read_b32 v248, a188
    v_accvgpr_read_b32 v249, a189
    v_mul_f32 v248, v248, v251
    v_mul_f32 v249, v249, v251
    v_accvgpr_write_b32 a188, v248
    v_accvgpr_write_b32 a189, v249
    v_accvgpr_read_b32 v248, a190
    v_accvgpr_read_b32 v249, a191
    v_mul_f32 v248, v248, v251
    v_mul_f32 v249, v249, v251
    v_accvgpr_write_b32 a190, v248
    v_accvgpr_write_b32 a191, v249
    v_accvgpr_read_b32 v248, a204
    v_accvgpr_read_b32 v249, a205
    v_mul_f32 v248, v248, v251
    v_mul_f32 v249, v249, v251
    v_accvgpr_write_b32 a204, v248
    v_accvgpr_write_b32 a205, v249
    v_accvgpr_read_b32 v248, a206
    v_accvgpr_read_b32 v249, a207
    v_mul_f32 v248, v248, v251
    v_mul_f32 v249, v249, v251
    v_accvgpr_write_b32 a206, v248
    v_accvgpr_write_b32 a207, v249
    v_accvgpr_read_b32 v248, a220
    v_accvgpr_read_b32 v249, a221
    v_mul_f32 v248, v248, v251
    v_mul_f32 v249, v249, v251
    v_accvgpr_write_b32 a220, v248
    v_accvgpr_write_b32 a221, v249
    v_accvgpr_read_b32 v248, a222
    v_accvgpr_read_b32 v249, a223
    v_mul_f32 v248, v248, v251
    v_mul_f32 v249, v249, v251
    v_accvgpr_write_b32 a222, v248
    v_accvgpr_write_b32 a223, v249
    v_accvgpr_read_b32 v248, a236
    v_accvgpr_read_b32 v249, a237
    v_mul_f32 v248, v248, v251
    v_mul_f32 v249, v249, v251
    v_accvgpr_write_b32 a236, v248
    v_accvgpr_write_b32 a237, v249
    v_accvgpr_read_b32 v248, a238
    v_accvgpr_read_b32 v249, a239
    v_mul_f32 v248, v248, v251
    v_mul_f32 v249, v249, v251
    v_accvgpr_write_b32 a238, v248
    v_accvgpr_write_b32 a239, v249
    v_accvgpr_read_b32 v248, a252
    v_accvgpr_read_b32 v249, a253
    v_mul_f32 v248, v248, v251
    v_mul_f32 v249, v249, v251
    v_accvgpr_write_b32 a252, v248
    v_accvgpr_write_b32 a253, v249
    v_accvgpr_read_b32 v248, a254
    v_accvgpr_read_b32 v249, a255
    v_mul_f32 v248, v248, v251
    v_mul_f32 v249, v249, v251
    v_accvgpr_write_b32 a254, v248
    v_accvgpr_write_b32 a255, v249
    v_exp_f32 v248, v140
    v_exp_f32 v249, v141
    s_nop 0
    v_add_f32 v247, v243, v248
    v_add_f32 v247, v247, v249
    v_cvt_pk_bf16_f32 v188, v248, v249
    v_exp_f32 v248, v142
    v_exp_f32 v249, v143
    s_nop 0
    v_add_f32 v247, v247, v248
    v_add_f32 v247, v247, v249
    v_cvt_pk_bf16_f32 v189, v248, v249
    v_exp_f32 v248, v156
    v_exp_f32 v249, v157
    s_nop 0
    v_add_f32 v247, v247, v248
    v_add_f32 v247, v247, v249
    v_cvt_pk_bf16_f32 v190, v248, v249
    v_exp_f32 v248, v158
    v_exp_f32 v249, v159
    s_nop 0
    v_add_f32 v247, v247, v248
    v_add_f32 v247, v247, v249
    v_cvt_pk_bf16_f32 v191, v248, v249
    s_nop 1
    s_branch L_back_b
L_slow_p29:
    s_nop 7
    s_nop 7
    v_max3_f32 v250, v128, v129, v130
    v_max3_f32 v250, v250, v131, v144
    v_max3_f32 v250, v250, v145, v146
    v_max_f32 v250, v250, v147
    v_mov_b32 v251, v250
    s_nop 1
    v_permlane16_swap_b32 v250, v251
    s_nop 1
    v_max_f32 v250, v250, v251
    v_mov_b32 v251, v250
    s_nop 1
    v_permlane32_swap_b32 v250, v251
    s_nop 1
    v_max_f32 v250, v250, v251
    v_add_f32 v250, s26, v250
    v_max_f32 v250, 0, v250
    v_exp_f32 v251, -v250
    v_sub_f32 v224, v224, v250
    v_sub_f32 v225, v225, v250
    v_sub_f32 v226, v226, v250
    v_sub_f32 v227, v227, v250
    v_sub_f32 v128, v128, v250
    v_sub_f32 v129, v129, v250
    v_sub_f32 v130, v130, v250
    v_sub_f32 v131, v131, v250
    v_sub_f32 v144, v144, v250
    v_sub_f32 v145, v145, v250
    v_sub_f32 v146, v146, v250
    v_sub_f32 v147, v147, v250
    v_mul_f32 v244, v244, v251
    v_accvgpr_read_b32 v248, a0
    v_accvgpr_read_b32 v249, a1
    v_mul_f32 v248, v248, v251
    v_mul_f32 v249, v249, v251
    v_accvgpr_write_b32 a0, v248
    v_accvgpr_write_b32 a1, v249
    v_accvgpr_read_b32 v248, a2
    v_accvgpr_read_b32 v249, a3
    v_mul_f32 v248, v248, v251
    v_mul_f32 v249, v249, v251
    v_accvgpr_write_b32 a2, v248
    v_accvgpr_write_b32 a3, v249
    v_accvgpr_read_b32 v248, a16
    v_accvgpr_read_b32 v249, a17
    v_mul_f32 v248, v248, v251
    v_mul_f32 v249, v249, v251
    v_accvgpr_write_b32 a16, v248
    v_accvgpr_write_b32 a17, v249
    v_accvgpr_read_b32 v248, a18
    v_accvgpr_read_b32 v249, a19
    v_mul_f32 v248, v248, v251
    v_mul_f32 v249, v249, v251
    v_accvgpr_write_b32 a18, v248
    v_accvgpr_write_b32 a19, v249
    v_accvgpr_read_b32 v248, a32
    v_accvgpr_read_b32 v249, a33
    v_mul_f32 v248, v248, v251
    v_mul_f32 v249, v249, v251
    v_accvgpr_write_b32 a32, v248
    v_accvgpr_write_b32 a33, v249
    v_accvgpr_read_b32 v248, a34
    v_accvgpr_read_b32 v249, a35
    v_mul_f32 v248, v248, v251
    v_mul_f32 v249, v249, v251
    v_accvgpr_write_b32 a34, v248
    v_accvgpr_write_b32 a35, v249
    v_accvgpr_read_b32 v248, a48
    v_accvgpr_read_b32 v249, a49
    v_mul_f32 v248, v248, v251
    v_mul_f32 v249, v249, v251
    v_accvgpr_write_b32 a48, v248
    v_accvgpr_write_b32 a49, v249
    v_accvgpr_read_b32 v248, a50
    v_accvgpr_read_b32 v249, a51
    v_mul_f32 v248, v248, v251
    v_mul_f32 v249, v249, v251
    v_accvgpr_write_b32 a50, v248
    v_accvgpr_write_b32 a51, v249
    v_accvgpr_read_b32 v248, a64
    v_accvgpr_read_b32 v249, a65
    v_mul_f32 v248, v248, v251
    v_mul_f32 v249, v249, v251
    v_accvgpr_write_b32 a64, v248
    v_accvgpr_write_b32 a65, v249
    v_accvgpr_read_b32 v248, a66
    v_accvgpr_read_b32 v249, a67
    v_mul_f32 v248, v248, v251
    v_mul_f32 v249, v249, v251
    v_accvgpr_write_b32 a66, v248
    v_accvgpr_write_b32 a67, v249
    v_accvgpr_read_b32 v248, a80
    v_accvgpr_read_b32 v249, a81
    v_mul_f32 v248, v248, v251
    v_mul_f32 v249, v249, v251
    v_accvgpr_write_b32 a80, v248
    v_accvgpr_write_b32 a81, v249
    v_accvgpr_read_b32 v248, a82
    v_accvgpr_read_b32 v249, a83
    v_mul_f32 v248, v248, v251
    v_mul_f32 v249, v249, v251
    v_accvgpr_write_b32 a82, v248
    v_accvgpr_write_b32 a83, v249
    v_accvgpr_read_b32 v248, a96
    v_accvgpr_read_b32 v249, a97
    v_mul_f32 v248, v248, v251
    v_mul_f32 v249, v249, v251
    v_accvgpr_write_b32 a96, v248
    v_accvgpr_write_b32 a97, v249
    v_accvgpr_read_b32 v248, a98
    v_accvgpr_read_b32 v249, a99
    v_mul_f32 v248, v248, v251
    v_mul_f32 v249, v249, v251
    v_accvgpr_write_b32 a98, v248
    v_accvgpr_write_b32 a99, v249
    v_accvgpr_read_b32 v248, a112
    v_accvgpr_read_b32 v249, a113
    v_mul_f32 v248, v248, v251
    v_mul_f32 v249, v249, v251
    v_accvgpr_write_b32 a112, v248
    v_accvgpr_write_b32 a113, v249
    v_accvgpr_read_b32 v248, a114
    v_accvgpr_read_b32 v249, a115
    v_mul_f32 v248, v248, v251
    v_mul_f32 v249, v249, v251
    v_accvgpr_write_b32 a114, v248
    v_accvgpr_write_b32 a115, v249
    v_accvgpr_read_b32 v248, a128
    v_accvgpr_read_b32 v249, a129
    v_mul_f32 v248, v248, v251
    v_mul_f32 v249, v249, v251
    v_accvgpr_write_b32 a128, v248
    v_accvgpr_write_b32 a129, v249
    v_accvgpr_read_b32 v248, a130
    v_accvgpr_read_b32 v249, a131
    v_mul_f32 v248, v248, v251
    v_mul_f32 v249, v249, v251
    v_accvgpr_write_b32 a130, v248
    v_accvgpr_write_b32 a131, v249
    v_accvgpr_read_b32 v248, a144
    v_accvgpr_read_b32 v249, a145
    v_mul_f32 v248, v248, v251
    v_mul_f32 v249, v249, v251
    v_accvgpr_write_b32 a144, v248
    v_accvgpr_write_b32 a145, v249
    v_accvgpr_read_b32 v248, a146
    v_accvgpr_read_b32 v249, a147
    v_mul_f32 v248, v248, v251
    v_mul_f32 v249, v249, v251
    v_accvgpr_write_b32 a146, v248
    v_accvgpr_write_b32 a147, v249
    v_accvgpr_read_b32 v248, a160
    v_accvgpr_read_b32 v249, a161
    v_mul_f32 v248, v248, v251
    v_mul_f32 v249, v249, v251
    v_accvgpr_write_b32 a160, v248
    v_accvgpr_write_b32 a161, v249
    v_accvgpr_read_b32 v248, a162
    v_accvgpr_read_b32 v249, a163
    v_mul_f32 v248, v248, v251
    v_mul_f32 v249, v249, v251
    v_accvgpr_write_b32 a162, v248
    v_accvgpr_write_b32 a163, v249
    v_accvgpr_read_b32 v248, a176
    v_accvgpr_read_b32 v249, a177
    v_mul_f32 v248, v248, v251
    v_mul_f32 v249, v249, v251
    v_accvgpr_write_b32 a176, v248
    v_accvgpr_write_b32 a177, v249
    v_accvgpr_read_b32 v248, a178
    v_accvgpr_read_b32 v249, a179
    v_mul_f32 v248, v248, v251
    v_mul_f32 v249, v249, v251
    v_accvgpr_write_b32 a178, v248
    v_accvgpr_write_b32 a179, v249
    v_accvgpr_read_b32 v248, a192
    v_accvgpr_read_b32 v249, a193
    v_mul_f32 v248, v248, v251
    v_mul_f32 v249, v249, v251
    v_accvgpr_write_b32 a192, v248
    v_accvgpr_write_b32 a193, v249
    v_accvgpr_read_b32 v248, a194
    v_accvgpr_read_b32 v249, a195
    v_mul_f32 v248, v248, v251
    v_mul_f32 v249, v249, v251
    v_accvgpr_write_b32 a194, v248
    v_accvgpr_write_b32 a195, v249
    v_accvgpr_read_b32 v248, a208
    v_accvgpr_read_b32 v249, a209
    v_mul_f32 v248, v248, v251
    v_mul_f32 v249, v249, v251
    v_accvgpr_write_b32 a208, v248
    v_accvgpr_write_b32 a209, v249
    v_accvgpr_read_b32 v248, a210
    v_accvgpr_read_b32 v249, a211
    v_mul_f32 v248, v248, v251
    v_mul_f32 v249, v249, v251
    v_accvgpr_write_b32 a210, v248
    v_accvgpr_write_b32 a211, v249
    v_accvgpr_read_b32 v248, a224
    v_accvgpr_read_b32 v249, a225
    v_mul_f32 v248, v248, v251
    v_mul_f32 v249, v249, v251
    v_accvgpr_write_b32 a224, v248
    v_accvgpr_write_b32 a225, v249
    v_accvgpr_read_b32 v248, a226
    v_accvgpr_read_b32 v249, a227
    v_mul_f32 v248, v248, v251
    v_mul_f32 v249, v249, v251
    v_accvgpr_write_b32 a226, v248
    v_accvgpr_write_b32 a227, v249
    v_accvgpr_read_b32 v248, a240
    v_accvgpr_read_b32 v249, a241
    v_mul_f32 v248, v248, v251
    v_mul_f32 v249, v249, v251
    v_accvgpr_write_b32 a240, v248
    v_accvgpr_write_b32 a241, v249
    v_accvgpr_read_b32 v248, a242
    v_accvgpr_read_b32 v249, a243
    v_mul_f32 v248, v248, v251
    v_mul_f32 v249, v249, v251
    v_accvgpr_write_b32 a242, v248
    v_accvgpr_write_b32 a243, v249
    v_exp_f32 v248, v128
    v_exp_f32 v249, v129
    s_nop 0
    v_add_f32 v240, v244, v248
    v_add_f32 v240, v240, v249
    v_cvt_pk_bf16_f32 v160, v248, v249
    v_exp_f32 v248, v130
    v_exp_f32 v249, v131
    s_nop 0
    v_add_f32 v240, v240, v248
    v_add_f32 v240, v240, v249
    v_cvt_pk_bf16_f32 v161, v248, v249
    v_exp_f32 v248, v144
    v_exp_f32 v249, v145
    s_nop 0
    v_add_f32 v240, v240, v248
    v_add_f32 v240, v240, v249
    v_cvt_pk_bf16_f32 v162, v248, v249
    v_exp_f32 v248, v146
    v_exp_f32 v249, v147
    s_nop 0
    v_add_f32 v240, v240, v248
    v_add_f32 v240, v240, v249
    v_cvt_pk_bf16_f32 v163, v248, v249
    v_max3_f32 v250, v132, v133, v134
    v_max3_f32 v250, v250, v135, v148
    v_max3_f32 v250, v250, v149, v150
    v_max_f32 v250, v250, v151
    v_mov_b32 v251, v250
    s_nop 1
    v_permlane16_swap_b32 v250, v251
    s_nop 1
    v_max_f32 v250, v250, v251
    v_mov_b32 v251, v250
    s_nop 1
    v_permlane32_swap_b32 v250, v251
    s_nop 1
    v_max_f32 v250, v250, v251
    v_add_f32 v250, s26, v250
    v_max_f32 v250, 0, v250
    v_exp_f32 v251, -v250
    v_sub_f32 v228, v228, v250
    v_sub_f32 v229, v229, v250
    v_sub_f32 v230, v230, v250
    v_sub_f32 v231, v231, v250
    v_sub_f32 v132, v132, v250
    v_sub_f32 v133, v133, v250
    v_sub_f32 v134, v134, v250
    v_sub_f32 v135, v135, v250
    v_sub_f32 v148, v148, v250
    v_sub_f32 v149, v149, v250
    v_sub_f32 v150, v150, v250
    v_sub_f32 v151, v151, v250
    v_mul_f32 v245, v245, v251
    v_accvgpr_read_b32 v248, a4
    v_accvgpr_read_b32 v249, a5
    v_mul_f32 v248, v248, v251
    v_mul_f32 v249, v249, v251
    v_accvgpr_write_b32 a4, v248
    v_accvgpr_write_b32 a5, v249
    v_accvgpr_read_b32 v248, a6
    v_accvgpr_read_b32 v249, a7
    v_mul_f32 v248, v248, v251
    v_mul_f32 v249, v249, v251
    v_accvgpr_write_b32 a6, v248
    v_accvgpr_write_b32 a7, v249
    v_accvgpr_read_b32 v248, a20
    v_accvgpr_read_b32 v249, a21
    v_mul_f32 v248, v248, v251
    v_mul_f32 v249, v249, v251
    v_accvgpr_write_b32 a20, v248
    v_accvgpr_write_b32 a21, v249
    v_accvgpr_read_b32 v248, a22
    v_accvgpr_read_b32 v249, a23
    v_mul_f32 v248, v248, v251
    v_mul_f32 v249, v249, v251
    v_accvgpr_write_b32 a22, v248
    v_accvgpr_write_b32 a23, v249
    v_accvgpr_read_b32 v248, a36
    v_accvgpr_read_b32 v249, a37
    v_mul_f32 v248, v248, v251
    v_mul_f32 v249, v249, v251
    v_accvgpr_write_b32 a36, v248
    v_accvgpr_write_b32 a37, v249
    v_accvgpr_read_b32 v248, a38
    v_accvgpr_read_b32 v249, a39
    v_mul_f32 v248, v248, v251
    v_mul_f32 v249, v249, v251
    v_accvgpr_write_b32 a38, v248
    v_accvgpr_write_b32 a39, v249
    v_accvgpr_read_b32 v248, a52
    v_accvgpr_read_b32 v249, a53
    v_mul_f32 v248, v248, v251
    v_mul_f32 v249, v249, v251
    v_accvgpr_write_b32 a52, v248
    v_accvgpr_write_b32 a53, v249
    v_accvgpr_read_b32 v248, a54
    v_accvgpr_read_b32 v249, a55
    v_mul_f32 v248, v248, v251
    v_mul_f32 v249, v249, v251
    v_accvgpr_write_b32 a54, v248
    v_accvgpr_write_b32 a55, v249
    v_accvgpr_read_b32 v248, a68
    v_accvgpr_read_b32 v249, a69
    v_mul_f32 v248, v248, v251
    v_mul_f32 v249, v249, v251
    v_accvgpr_write_b32 a68, v248
    v_accvgpr_write_b32 a69, v249
    v_accvgpr_read_b32 v248, a70
    v_accvgpr_read_b32 v249, a71
    v_mul_f32 v248, v248, v251
    v_mul_f32 v249, v249, v251
    v_accvgpr_write_b32 a70, v248
    v_accvgpr_write_b32 a71, v249
    v_accvgpr_read_b32 v248, a84
    v_accvgpr_read_b32 v249, a85
    v_mul_f32 v248, v248, v251
    v_mul_f32 v249, v249, v251
    v_accvgpr_write_b32 a84, v248
    v_accvgpr_write_b32 a85, v249
    v_accvgpr_read_b32 v248, a86
    v_accvgpr_read_b32 v249, a87
    v_mul_f32 v248, v248, v251
    v_mul_f32 v249, v249, v251
    v_accvgpr_write_b32 a86, v248
    v_accvgpr_write_b32 a87, v249
    v_accvgpr_read_b32 v248, a100
    v_accvgpr_read_b32 v249, a101
    v_mul_f32 v248, v248, v251
    v_mul_f32 v249, v249, v251
    v_accvgpr_write_b32 a100, v248
    v_accvgpr_write_b32 a101, v249
    v_accvgpr_read_b32 v248, a102
    v_accvgpr_read_b32 v249, a103
    v_mul_f32 v248, v248, v251
    v_mul_f32 v249, v249, v251
    v_accvgpr_write_b32 a102, v248
    v_accvgpr_write_b32 a103, v249
    v_accvgpr_read_b32 v248, a116
    v_accvgpr_read_b32 v249, a117
    v_mul_f32 v248, v248, v251
    v_mul_f32 v249, v249, v251
    v_accvgpr_write_b32 a116, v248
    v_accvgpr_write_b32 a117, v249
    v_accvgpr_read_b32 v248, a118
    v_accvgpr_read_b32 v249, a119
    v_mul_f32 v248, v248, v251
    v_mul_f32 v249, v249, v251
    v_accvgpr_write_b32 a118, v248
    v_accvgpr_write_b32 a119, v249
    v_accvgpr_read_b32 v248, a132
    v_accvgpr_read_b32 v249, a133
    v_mul_f32 v248, v248, v251
    v_mul_f32 v249, v249, v251
    v_accvgpr_write_b32 a132, v248
    v_accvgpr_write_b32 a133, v249
    v_accvgpr_read_b32 v248, a134
    v_accvgpr_read_b32 v249, a135
    v_mul_f32 v248, v248, v251
    v_mul_f32 v249, v249, v251
    v_accvgpr_write_b32 a134, v248
    v_accvgpr_write_b32 a135, v249
    v_accvgpr_read_b32 v248, a148
    v_accvgpr_read_b32 v249, a149
    v_mul_f32 v248, v248, v251
    v_mul_f32 v249, v249, v251
    v_accvgpr_write_b32 a148, v248
    v_accvgpr_write_b32 a149, v249
    v_accvgpr_read_b32 v248, a150
    v_accvgpr_read_b32 v249, a151
    v_mul_f32 v248, v248, v251
    v_mul_f32 v249, v249, v251
    v_accvgpr_write_b32 a150, v248
    v_accvgpr_write_b32 a151, v249
    v_accvgpr_read_b32 v248, a164
    v_accvgpr_read_b32 v249, a165
    v_mul_f32 v248, v248, v251
    v_mul_f32 v249, v249, v251
    v_accvgpr_write_b32 a164, v248
    v_accvgpr_write_b32 a165, v249
    v_accvgpr_read_b32 v248, a166
    v_accvgpr_read_b32 v249, a167
    v_mul_f32 v248, v248, v251
    v_mul_f32 v249, v249, v251
    v_accvgpr_write_b32 a166, v248
    v_accvgpr_write_b32 a167, v249
    v_accvgpr_read_b32 v248, a180
    v_accvgpr_read_b32 v249, a181
    v_mul_f32 v248, v248, v251
    v_mul_f32 v249, v249, v251
    v_accvgpr_write_b32 a180, v248
    v_accvgpr_write_b32 a181, v249
    v_accvgpr_read_b32 v248, a182
    v_accvgpr_read_b32 v249, a183
    v_mul_f32 v248, v248, v251
    v_mul_f32 v249, v249, v251
    v_accvgpr_write_b32 a182, v248
    v_accvgpr_write_b32 a183, v249
    v_accvgpr_read_b32 v248, a196
    v_accvgpr_read_b32 v249, a197
    v_mul_f32 v248, v248, v251
    v_mul_f32 v249, v249, v251
    v_accvgpr_write_b32 a196, v248
    v_accvgpr_write_b32 a197, v249
    v_accvgpr_read_b32 v248, a198
    v_accvgpr_read_b32 v249, a199
    v_mul_f32 v248, v248, v251
    v_mul_f32 v249, v249, v251
    v_accvgpr_write_b32 a198, v248
    v_accvgpr_write_b32 a199, v249
    v_accvgpr_read_b32 v248, a212
    v_accvgpr_read_b32 v249, a213
    v_mul_f32 v248, v248, v251
    v_mul_f32 v249, v249, v251
    v_accvgpr_write_b32 a212, v248
    v_accvgpr_write_b32 a213, v249
    v_accvgpr_read_b32 v248, a214
    v_accvgpr_read_b32 v249, a215
    v_mul_f32 v248, v248, v251
    v_mul_f32 v249, v249, v251
    v_accvgpr_write_b32 a214, v248
    v_accvgpr_write_b32 a215, v249
    v_accvgpr_read_b32 v248, a228
    v_accvgpr_read_b32 v249, a229
    v_mul_f32 v248, v248, v251
    v_mul_f32 v249, v249, v251
    v_accvgpr_write_b32 a228, v248
    v_accvgpr_write_b32 a229, v249
    v_accvgpr_read_b32 v248, a230
    v_accvgpr_read_b32 v249, a231
    v_mul_f32 v248, v248, v251
    v_mul_f32 v249, v249, v251
    v_accvgpr_write_b32 a230, v248
    v_accvgpr_write_b32 a231, v249
    v_accvgpr_read_b32 v248, a244
    v_accvgpr_read_b32 v249, a245
    v_mul_f32 v248, v248, v251
    v_mul_f32 v249, v249, v251
    v_accvgpr_write_b32 a244, v248
    v_accvgpr_write_b32 a245, v249
    v_accvgpr_read_b32 v248, a246
    v_accvgpr_read_b32 v249, a247
    v_mul_f32 v248, v248, v251
    v_mul_f32 v249, v249, v251
    v_accvgpr_write_b32 a246, v248
    v_accvgpr_write_b32 a247, v249
    v_exp_f32 v248, v132
    v_exp_f32 v249, v133
    s_nop 0
    v_add_f32 v241, v245, v248
    v_add_f32 v241, v241, v249
    v_cvt_pk_bf16_f32 v164, v248, v249
    v_exp_f32 v248, v134
    v_exp_f32 v249, v135
    s_nop 0
    v_add_f32 v241, v241, v248
    v_add_f32 v241, v241, v249
    v_cvt_pk_bf16_f32 v165, v248, v249
    v_exp_f32 v248, v148
    v_exp_f32 v249, v149
    s_nop 0
    v_add_f32 v241, v241, v248
    v_add_f32 v241, v241, v249
    v_cvt_pk_bf16_f32 v166, v248, v249
    v_exp_f32 v248, v150
    v_exp_f32 v249, v151
    s_nop 0
    v_add_f32 v241, v241, v248
    v_add_f32 v241, v241, v249
    v_cvt_pk_bf16_f32 v167, v248, v249
    v_max3_f32 v250, v136, v137, v138
    v_max3_f32 v250, v250, v139, v152
    v_max3_f32 v250, v250, v153, v154
    v_max_f32 v250, v250, v155
    v_mov_b32 v251, v250
    s_nop 1
    v_permlane16_swap_b32 v250, v251
    s_nop 1
    v_max_f32 v250, v250, v251
    v_mov_b32 v251, v250
    s_nop 1
    v_permlane32_swap_b32 v250, v251
    s_nop 1
    v_max_f32 v250, v250, v251
    v_add_f32 v250, s26, v250
    v_max_f32 v250, 0, v250
    v_exp_f32 v251, -v250
    v_sub_f32 v232, v232, v250
    v_sub_f32 v233, v233, v250
    v_sub_f32 v234, v234, v250
    v_sub_f32 v235, v235, v250
    v_sub_f32 v136, v136, v250
    v_sub_f32 v137, v137, v250
    v_sub_f32 v138, v138, v250
    v_sub_f32 v139, v139, v250
    v_sub_f32 v152, v152, v250
    v_sub_f32 v153, v153, v250
    v_sub_f32 v154, v154, v250
    v_sub_f32 v155, v155, v250
    v_mul_f32 v246, v246, v251
    v_accvgpr_read_b32 v248, a8
    v_accvgpr_read_b32 v249, a9
    v_mul_f32 v248, v248, v251
    v_mul_f32 v249, v249, v251
    v_accvgpr_write_b32 a8, v248
    v_accvgpr_write_b32 a9, v249
    v_accvgpr_read_b32 v248, a10
    v_accvgpr_read_b32 v249, a11
    v_mul_f32 v248, v248, v251
    v_mul_f32 v249, v249, v251
    v_accvgpr_write_b32 a10, v248
    v_accvgpr_write_b32 a11, v249
    v_accvgpr_read_b32 v248, a24
    v_accvgpr_read_b32 v249, a25
    v_mul_f32 v248, v248, v251
    v_mul_f32 v249, v249, v251
    v_accvgpr_write_b32 a24, v248
    v_accvgpr_write_b32 a25, v249
    v_accvgpr_read_b32 v248, a26
    v_accvgpr_read_b32 v249, a27
    v_mul_f32 v248, v248, v251
    v_mul_f32 v249, v249, v251
    v_accvgpr_write_b32 a26, v248
    v_accvgpr_write_b32 a27, v249
    v_accvgpr_read_b32 v248, a40
    v_accvgpr_read_b32 v249, a41
    v_mul_f32 v248, v248, v251
    v_mul_f32 v249, v249, v251
    v_accvgpr_write_b32 a40, v248
    v_accvgpr_write_b32 a41, v249
    v_accvgpr_read_b32 v248, a42
    v_accvgpr_read_b32 v249, a43
    v_mul_f32 v248, v248, v251
    v_mul_f32 v249, v249, v251
    v_accvgpr_write_b32 a42, v248
    v_accvgpr_write_b32 a43, v249
    v_accvgpr_read_b32 v248, a56
    v_accvgpr_read_b32 v249, a57
    v_mul_f32 v248, v248, v251
    v_mul_f32 v249, v249, v251
    v_accvgpr_write_b32 a56, v248
    v_accvgpr_write_b32 a57, v249
    v_accvgpr_read_b32 v248, a58
    v_accvgpr_read_b32 v249, a59
    v_mul_f32 v248, v248, v251
    v_mul_f32 v249, v249, v251
    v_accvgpr_write_b32 a58, v248
    v_accvgpr_write_b32 a59, v249
    v_accvgpr_read_b32 v248, a72
    v_accvgpr_read_b32 v249, a73
    v_mul_f32 v248, v248, v251
    v_mul_f32 v249, v249, v251
    v_accvgpr_write_b32 a72, v248
    v_accvgpr_write_b32 a73, v249
    v_accvgpr_read_b32 v248, a74
    v_accvgpr_read_b32 v249, a75
    v_mul_f32 v248, v248, v251
    v_mul_f32 v249, v249, v251
    v_accvgpr_write_b32 a74, v248
    v_accvgpr_write_b32 a75, v249
    v_accvgpr_read_b32 v248, a88
    v_accvgpr_read_b32 v249, a89
    v_mul_f32 v248, v248, v251
    v_mul_f32 v249, v249, v251
    v_accvgpr_write_b32 a88, v248
    v_accvgpr_write_b32 a89, v249
    v_accvgpr_read_b32 v248, a90
    v_accvgpr_read_b32 v249, a91
    v_mul_f32 v248, v248, v251
    v_mul_f32 v249, v249, v251
    v_accvgpr_write_b32 a90, v248
    v_accvgpr_write_b32 a91, v249
    v_accvgpr_read_b32 v248, a104
    v_accvgpr_read_b32 v249, a105
    v_mul_f32 v248, v248, v251
    v_mul_f32 v249, v249, v251
    v_accvgpr_write_b32 a104, v248
    v_accvgpr_write_b32 a105, v249
    v_accvgpr_read_b32 v248, a106
    v_accvgpr_read_b32 v249, a107
    v_mul_f32 v248, v248, v251
    v_mul_f32 v249, v249, v251
    v_accvgpr_write_b32 a106, v248
    v_accvgpr_write_b32 a107, v249
    v_accvgpr_read_b32 v248, a120
    v_accvgpr_read_b32 v249, a121
    v_mul_f32 v248, v248, v251
    v_mul_f32 v249, v249, v251
    v_accvgpr_write_b32 a120, v248
    v_accvgpr_write_b32 a121, v249
    v_accvgpr_read_b32 v248, a122
    v_accvgpr_read_b32 v249, a123
    v_mul_f32 v248, v248, v251
    v_mul_f32 v249, v249, v251
    v_accvgpr_write_b32 a122, v248
    v_accvgpr_write_b32 a123, v249
    v_accvgpr_read_b32 v248, a136
    v_accvgpr_read_b32 v249, a137
    v_mul_f32 v248, v248, v251
    v_mul_f32 v249, v249, v251
    v_accvgpr_write_b32 a136, v248
    v_accvgpr_write_b32 a137, v249
    v_accvgpr_read_b32 v248, a138
    v_accvgpr_read_b32 v249, a139
    v_mul_f32 v248, v248, v251
    v_mul_f32 v249, v249, v251
    v_accvgpr_write_b32 a138, v248
    v_accvgpr_write_b32 a139, v249
    v_accvgpr_read_b32 v248, a152
    v_accvgpr_read_b32 v249, a153
    v_mul_f32 v248, v248, v251
    v_mul_f32 v249, v249, v251
    v_accvgpr_write_b32 a152, v248
    v_accvgpr_write_b32 a153, v249
    v_accvgpr_read_b32 v248, a154
    v_accvgpr_read_b32 v249, a155
    v_mul_f32 v248, v248, v251
    v_mul_f32 v249, v249, v251
    v_accvgpr_write_b32 a154, v248
    v_accvgpr_write_b32 a155, v249
    v_accvgpr_read_b32 v248, a168
    v_accvgpr_read_b32 v249, a169
    v_mul_f32 v248, v248, v251
    v_mul_f32 v249, v249, v251
    v_accvgpr_write_b32 a168, v248
    v_accvgpr_write_b32 a169, v249
    v_accvgpr_read_b32 v248, a170
    v_accvgpr_read_b32 v249, a171
    v_mul_f32 v248, v248, v251
    v_mul_f32 v249, v249, v251
    v_accvgpr_write_b32 a170, v248
    v_accvgpr_write_b32 a171, v249
    v_accvgpr_read_b32 v248, a184
    v_accvgpr_read_b32 v249, a185
    v_mul_f32 v248, v248, v251
    v_mul_f32 v249, v249, v251
    v_accvgpr_write_b32 a184, v248
    v_accvgpr_write_b32 a185, v249
    v_accvgpr_read_b32 v248, a186
    v_accvgpr_read_b32 v249, a187
    v_mul_f32 v248, v248, v251
    v_mul_f32 v249, v249, v251
    v_accvgpr_write_b32 a186, v248
    v_accvgpr_write_b32 a187, v249
    v_accvgpr_read_b32 v248, a200
    v_accvgpr_read_b32 v249, a201
    v_mul_f32 v248, v248, v251
    v_mul_f32 v249, v249, v251
    v_accvgpr_write_b32 a200, v248
    v_accvgpr_write_b32 a201, v249
    v_accvgpr_read_b32 v248, a202
    v_accvgpr_read_b32 v249, a203
    v_mul_f32 v248, v248, v251
    v_mul_f32 v249, v249, v251
    v_accvgpr_write_b32 a202, v248
    v_accvgpr_write_b32 a203, v249
    v_accvgpr_read_b32 v248, a216
    v_accvgpr_read_b32 v249, a217
    v_mul_f32 v248, v248, v251
    v_mul_f32 v249, v249, v251
    v_accvgpr_write_b32 a216, v248
    v_accvgpr_write_b32 a217, v249
    v_accvgpr_read_b32 v248, a218
    v_accvgpr_read_b32 v249, a219
    v_mul_f32 v248, v248, v251
    v_mul_f32 v249, v249, v251
    v_accvgpr_write_b32 a218, v248
    v_accvgpr_write_b32 a219, v249
    v_accvgpr_read_b32 v248, a232
    v_accvgpr_read_b32 v249, a233
    v_mul_f32 v248, v248, v251
    v_mul_f32 v249, v249, v251
    v_accvgpr_write_b32 a232, v248
    v_accvgpr_write_b32 a233, v249
    v_accvgpr_read_b32 v248, a234
    v_accvgpr_read_b32 v249, a235
    v_mul_f32 v248, v248, v251
    v_mul_f32 v249, v249, v251
    v_accvgpr_write_b32 a234, v248
    v_accvgpr_write_b32 a235, v249
    v_accvgpr_read_b32 v248, a248
    v_accvgpr_read_b32 v249, a249
    v_mul_f32 v248, v248, v251
    v_mul_f32 v249, v249, v251
    v_accvgpr_write_b32 a248, v248
    v_accvgpr_write_b32 a249, v249
    v_accvgpr_read_b32 v248, a250
    v_accvgpr_read_b32 v249, a251
    v_mul_f32 v248, v248, v251
    v_mul_f32 v249, v249, v251
    v_accvgpr_write_b32 a250, v248
    v_accvgpr_write_b32 a251, v249
    v_exp_f32 v248, v136
    v_exp_f32 v249, v137
    s_nop 0
    v_add_f32 v242, v246, v248
    v_add_f32 v242, v242, v249
    v_cvt_pk_bf16_f32 v168, v248, v249
    v_exp_f32 v248, v138
    v_exp_f32 v249, v139
    s_nop 0
    v_add_f32 v242, v242, v248
    v_add_f32 v242, v242, v249
    v_cvt_pk_bf16_f32 v169, v248, v249
    v_exp_f32 v248, v152
    v_exp_f32 v249, v153
    s_nop 0
    v_add_f32 v242, v242, v248
    v_add_f32 v242, v242, v249
    v_cvt_pk_bf16_f32 v170, v248, v249
    v_exp_f32 v248, v154
    v_exp_f32 v249, v155
    s_nop 0
    v_add_f32 v242, v242, v248
    v_add_f32 v242, v242, v249
    v_cvt_pk_bf16_f32 v171, v248, v249
    v_max3_f32 v250, v140, v141, v142
    v_max3_f32 v250, v250, v143, v156
    v_max3_f32 v250, v250, v157, v158
    v_max_f32 v250, v250, v159
    v_mov_b32 v251, v250
    s_nop 1
    v_permlane16_swap_b32 v250, v251
    s_nop 1
    v_max_f32 v250, v250, v251
    v_mov_b32 v251, v250
    s_nop 1
    v_permlane32_swap_b32 v250, v251
    s_nop 1
    v_max_f32 v250, v250, v251
    v_add_f32 v250, s26, v250
    v_max_f32 v250, 0, v250
    v_exp_f32 v251, -v250
    v_sub_f32 v236, v236, v250
    v_sub_f32 v237, v237, v250
    v_sub_f32 v238, v238, v250
    v_sub_f32 v239, v239, v250
    v_sub_f32 v140, v140, v250
    v_sub_f32 v141, v141, v250
    v_sub_f32 v142, v142, v250
    v_sub_f32 v143, v143, v250
    v_sub_f32 v156, v156, v250
    v_sub_f32 v157, v157, v250
    v_sub_f32 v158, v158, v250
    v_sub_f32 v159, v159, v250
    v_mul_f32 v247, v247, v251
    v_accvgpr_read_b32 v248, a12
    v_accvgpr_read_b32 v249, a13
    v_mul_f32 v248, v248, v251
    v_mul_f32 v249, v249, v251
    v_accvgpr_write_b32 a12, v248
    v_accvgpr_write_b32 a13, v249
    v_accvgpr_read_b32 v248, a14
    v_accvgpr_read_b32 v249, a15
    v_mul_f32 v248, v248, v251
    v_mul_f32 v249, v249, v251
    v_accvgpr_write_b32 a14, v248
    v_accvgpr_write_b32 a15, v249
    v_accvgpr_read_b32 v248, a28
    v_accvgpr_read_b32 v249, a29
    v_mul_f32 v248, v248, v251
    v_mul_f32 v249, v249, v251
    v_accvgpr_write_b32 a28, v248
    v_accvgpr_write_b32 a29, v249
    v_accvgpr_read_b32 v248, a30
    v_accvgpr_read_b32 v249, a31
    v_mul_f32 v248, v248, v251
    v_mul_f32 v249, v249, v251
    v_accvgpr_write_b32 a30, v248
    v_accvgpr_write_b32 a31, v249
    v_accvgpr_read_b32 v248, a44
    v_accvgpr_read_b32 v249, a45
    v_mul_f32 v248, v248, v251
    v_mul_f32 v249, v249, v251
    v_accvgpr_write_b32 a44, v248
    v_accvgpr_write_b32 a45, v249
    v_accvgpr_read_b32 v248, a46
    v_accvgpr_read_b32 v249, a47
    v_mul_f32 v248, v248, v251
    v_mul_f32 v249, v249, v251
    v_accvgpr_write_b32 a46, v248
    v_accvgpr_write_b32 a47, v249
    v_accvgpr_read_b32 v248, a60
    v_accvgpr_read_b32 v249, a61
    v_mul_f32 v248, v248, v251
    v_mul_f32 v249, v249, v251
    v_accvgpr_write_b32 a60, v248
    v_accvgpr_write_b32 a61, v249
    v_accvgpr_read_b32 v248, a62
    v_accvgpr_read_b32 v249, a63
    v_mul_f32 v248, v248, v251
    v_mul_f32 v249, v249, v251
    v_accvgpr_write_b32 a62, v248
    v_accvgpr_write_b32 a63, v249
    v_accvgpr_read_b32 v248, a76
    v_accvgpr_read_b32 v249, a77
    v_mul_f32 v248, v248, v251
    v_mul_f32 v249, v249, v251
    v_accvgpr_write_b32 a76, v248
    v_accvgpr_write_b32 a77, v249
    v_accvgpr_read_b32 v248, a78
    v_accvgpr_read_b32 v249, a79
    v_mul_f32 v248, v248, v251
    v_mul_f32 v249, v249, v251
    v_accvgpr_write_b32 a78, v248
    v_accvgpr_write_b32 a79, v249
    v_accvgpr_read_b32 v248, a92
    v_accvgpr_read_b32 v249, a93
    v_mul_f32 v248, v248, v251
    v_mul_f32 v249, v249, v251
    v_accvgpr_write_b32 a92, v248
    v_accvgpr_write_b32 a93, v249
    v_accvgpr_read_b32 v248, a94
    v_accvgpr_read_b32 v249, a95
    v_mul_f32 v248, v248, v251
    v_mul_f32 v249, v249, v251
    v_accvgpr_write_b32 a94, v248
    v_accvgpr_write_b32 a95, v249
    v_accvgpr_read_b32 v248, a108
    v_accvgpr_read_b32 v249, a109
    v_mul_f32 v248, v248, v251
    v_mul_f32 v249, v249, v251
    v_accvgpr_write_b32 a108, v248
    v_accvgpr_write_b32 a109, v249
    v_accvgpr_read_b32 v248, a110
    v_accvgpr_read_b32 v249, a111
    v_mul_f32 v248, v248, v251
    v_mul_f32 v249, v249, v251
    v_accvgpr_write_b32 a110, v248
    v_accvgpr_write_b32 a111, v249
    v_accvgpr_read_b32 v248, a124
    v_accvgpr_read_b32 v249, a125
    v_mul_f32 v248, v248, v251
    v_mul_f32 v249, v249, v251
    v_accvgpr_write_b32 a124, v248
    v_accvgpr_write_b32 a125, v249
    v_accvgpr_read_b32 v248, a126
    v_accvgpr_read_b32 v249, a127
    v_mul_f32 v248, v248, v251
    v_mul_f32 v249, v249, v251
    v_accvgpr_write_b32 a126, v248
    v_accvgpr_write_b32 a127, v249
    v_accvgpr_read_b32 v248, a140
    v_accvgpr_read_b32 v249, a141
    v_mul_f32 v248, v248, v251
    v_mul_f32 v249, v249, v251
    v_accvgpr_write_b32 a140, v248
    v_accvgpr_write_b32 a141, v249
    v_accvgpr_read_b32 v248, a142
    v_accvgpr_read_b32 v249, a143
    v_mul_f32 v248, v248, v251
    v_mul_f32 v249, v249, v251
    v_accvgpr_write_b32 a142, v248
    v_accvgpr_write_b32 a143, v249
    v_accvgpr_read_b32 v248, a156
    v_accvgpr_read_b32 v249, a157
    v_mul_f32 v248, v248, v251
    v_mul_f32 v249, v249, v251
    v_accvgpr_write_b32 a156, v248
    v_accvgpr_write_b32 a157, v249
    v_accvgpr_read_b32 v248, a158
    v_accvgpr_read_b32 v249, a159
    v_mul_f32 v248, v248, v251
    v_mul_f32 v249, v249, v251
    v_accvgpr_write_b32 a158, v248
    v_accvgpr_write_b32 a159, v249
    v_accvgpr_read_b32 v248, a172
    v_accvgpr_read_b32 v249, a173
    v_mul_f32 v248, v248, v251
    v_mul_f32 v249, v249, v251
    v_accvgpr_write_b32 a172, v248
    v_accvgpr_write_b32 a173, v249
    v_accvgpr_read_b32 v248, a174
    v_accvgpr_read_b32 v249, a175
    v_mul_f32 v248, v248, v251
    v_mul_f32 v249, v249, v251
    v_accvgpr_write_b32 a174, v248
    v_accvgpr_write_b32 a175, v249
    v_accvgpr_read_b32 v248, a188
    v_accvgpr_read_b32 v249, a189
    v_mul_f32 v248, v248, v251
    v_mul_f32 v249, v249, v251
    v_accvgpr_write_b32 a188, v248
    v_accvgpr_write_b32 a189, v249
    v_accvgpr_read_b32 v248, a190
    v_accvgpr_read_b32 v249, a191
    v_mul_f32 v248, v248, v251
    v_mul_f32 v249, v249, v251
    v_accvgpr_write_b32 a190, v248
    v_accvgpr_write_b32 a191, v249
    v_accvgpr_read_b32 v248, a204
    v_accvgpr_read_b32 v249, a205
    v_mul_f32 v248, v248, v251
    v_mul_f32 v249, v249, v251
    v_accvgpr_write_b32 a204, v248
    v_accvgpr_write_b32 a205, v249
    v_accvgpr_read_b32 v248, a206
    v_accvgpr_read_b32 v249, a207
    v_mul_f32 v248, v248, v251
    v_mul_f32 v249, v249, v251
    v_accvgpr_write_b32 a206, v248
    v_accvgpr_write_b32 a207, v249
    v_accvgpr_read_b32 v248, a220
    v_accvgpr_read_b32 v249, a221
    v_mul_f32 v248, v248, v251
    v_mul_f32 v249, v249, v251
    v_accvgpr_write_b32 a220, v248
    v_accvgpr_write_b32 a221, v249
    v_accvgpr_read_b32 v248, a222
    v_accvgpr_read_b32 v249, a223
    v_mul_f32 v248, v248, v251
    v_mul_f32 v249, v249, v251
    v_accvgpr_write_b32 a222, v248
    v_accvgpr_write_b32 a223, v249
    v_accvgpr_read_b32 v248, a236
    v_accvgpr_read_b32 v249, a237
    v_mul_f32 v248, v248, v251
    v_mul_f32 v249, v249, v251
    v_accvgpr_write_b32 a236, v248
    v_accvgpr_write_b32 a237, v249
    v_accvgpr_read_b32 v248, a238
    v_accvgpr_read_b32 v249, a239
    v_mul_f32 v248, v248, v251
    v_mul_f32 v249, v249, v251
    v_accvgpr_write_b32 a238, v248
    v_accvgpr_write_b32 a239, v249
    v_accvgpr_read_b32 v248, a252
    v_accvgpr_read_b32 v249, a253
    v_mul_f32 v248, v248, v251
    v_mul_f32 v249, v249, v251
    v_accvgpr_write_b32 a252, v248
    v_accvgpr_write_b32 a253, v249
    v_accvgpr_read_b32 v248, a254
    v_accvgpr_read_b32 v249, a255
    v_mul_f32 v248, v248, v251
    v_mul_f32 v249, v249, v251
    v_accvgpr_write_b32 a254, v248
    v_accvgpr_write_b32 a255, v249
    v_exp_f32 v248, v140
    v_exp_f32 v249, v141
    s_nop 0
    v_add_f32 v243, v247, v248
    v_add_f32 v243, v243, v249
    v_cvt_pk_bf16_f32 v172, v248, v249
    v_exp_f32 v248, v142
    v_exp_f32 v249, v143
    s_nop 0
    v_add_f32 v243, v243, v248
    v_add_f32 v243, v243, v249
    v_cvt_pk_bf16_f32 v173, v248, v249
    v_exp_f32 v248, v156
    v_exp_f32 v249, v157
    s_nop 0
    v_add_f32 v243, v243, v248
    v_add_f32 v243, v243, v249
    v_cvt_pk_bf16_f32 v174, v248, v249
    v_exp_f32 v248, v158
    v_exp_f32 v249, v159
    s_nop 0
    v_add_f32 v243, v243, v248
    v_add_f32 v243, v243, v249
    v_cvt_pk_bf16_f32 v175, v248, v249
    s_nop 1
    s_branch L_back_p29
L_slow_p30:
    s_nop 7
    s_nop 7
    v_max3_f32 v250, v128, v129, v130
    v_max3_f32 v250, v250, v131, v144
    v_max3_f32 v250, v250, v145, v146
    v_max_f32 v250, v250, v147
    v_mov_b32 v251, v250
    s_nop 1
    v_permlane16_swap_b32 v250, v251
    s_nop 1
    v_max_f32 v250, v250, v251
    v_mov_b32 v251, v250
    s_nop 1
    v_permlane32_swap_b32 v250, v251
    s_nop 1
    v_max_f32 v250, v250, v251
    v_add_f32 v250, s26, v250
    v_max_f32 v250, 0, v250
    v_exp_f32 v251, -v250
    v_sub_f32 v224, v224, v250
    v_sub_f32 v225, v225, v250
    v_sub_f32 v226, v226, v250
    v_sub_f32 v227, v227, v250
    v_sub_f32 v128, v128, v250
    v_sub_f32 v129, v129, v250
    v_sub_f32 v130, v130, v250
    v_sub_f32 v131, v131, v250
    v_sub_f32 v144, v144, v250
    v_sub_f32 v145, v145, v250
    v_sub_f32 v146, v146, v250
    v_sub_f32 v147, v147, v250
    v_mul_f32 v240, v240, v251
    v_accvgpr_read_b32 v248, a0
    v_accvgpr_read_b32 v249, a1
    v_mul_f32 v248, v248, v251
    v_mul_f32 v249, v249, v251
    v_accvgpr_write_b32 a0, v248
    v_accvgpr_write_b32 a1, v249
    v_accvgpr_read_b32 v248, a2
    v_accvgpr_read_b32 v249, a3
    v_mul_f32 v248, v248, v251
    v_mul_f32 v249, v249, v251
    v_accvgpr_write_b32 a2, v248
    v_accvgpr_write_b32 a3, v249
    v_accvgpr_read_b32 v248, a16
    v_accvgpr_read_b32 v249, a17
    v_mul_f32 v248, v248, v251
    v_mul_f32 v249, v249, v251
    v_accvgpr_write_b32 a16, v248
    v_accvgpr_write_b32 a17, v249
    v_accvgpr_read_b32 v248, a18
    v_accvgpr_read_b32 v249, a19
    v_mul_f32 v248, v248, v251
    v_mul_f32 v249, v249, v251
    v_accvgpr_write_b32 a18, v248
    v_accvgpr_write_b32 a19, v249
    v_accvgpr_read_b32 v248, a32
    v_accvgpr_read_b32 v249, a33
    v_mul_f32 v248, v248, v251
    v_mul_f32 v249, v249, v251
    v_accvgpr_write_b32 a32, v248
    v_accvgpr_write_b32 a33, v249
    v_accvgpr_read_b32 v248, a34
    v_accvgpr_read_b32 v249, a35
    v_mul_f32 v248, v248, v251
    v_mul_f32 v249, v249, v251
    v_accvgpr_write_b32 a34, v248
    v_accvgpr_write_b32 a35, v249
    v_accvgpr_read_b32 v248, a48
    v_accvgpr_read_b32 v249, a49
    v_mul_f32 v248, v248, v251
    v_mul_f32 v249, v249, v251
    v_accvgpr_write_b32 a48, v248
    v_accvgpr_write_b32 a49, v249
    v_accvgpr_read_b32 v248, a50
    v_accvgpr_read_b32 v249, a51
    v_mul_f32 v248, v248, v251
    v_mul_f32 v249, v249, v251
    v_accvgpr_write_b32 a50, v248
    v_accvgpr_write_b32 a51, v249
    v_accvgpr_read_b32 v248, a64
    v_accvgpr_read_b32 v249, a65
    v_mul_f32 v248, v248, v251
    v_mul_f32 v249, v249, v251
    v_accvgpr_write_b32 a64, v248
    v_accvgpr_write_b32 a65, v249
    v_accvgpr_read_b32 v248, a66
    v_accvgpr_read_b32 v249, a67
    v_mul_f32 v248, v248, v251
    v_mul_f32 v249, v249, v251
    v_accvgpr_write_b32 a66, v248
    v_accvgpr_write_b32 a67, v249
    v_accvgpr_read_b32 v248, a80
    v_accvgpr_read_b32 v249, a81
    v_mul_f32 v248, v248, v251
    v_mul_f32 v249, v249, v251
    v_accvgpr_write_b32 a80, v248
    v_accvgpr_write_b32 a81, v249
    v_accvgpr_read_b32 v248, a82
    v_accvgpr_read_b32 v249, a83
    v_mul_f32 v248, v248, v251
    v_mul_f32 v249, v249, v251
    v_accvgpr_write_b32 a82, v248
    v_accvgpr_write_b32 a83, v249
    v_accvgpr_read_b32 v248, a96
    v_accvgpr_read_b32 v249, a97
    v_mul_f32 v248, v248, v251
    v_mul_f32 v249, v249, v251
    v_accvgpr_write_b32 a96, v248
    v_accvgpr_write_b32 a97, v249
    v_accvgpr_read_b32 v248, a98
    v_accvgpr_read_b32 v249, a99
    v_mul_f32 v248, v248, v251
    v_mul_f32 v249, v249, v251
    v_accvgpr_write_b32 a98, v248
    v_accvgpr_write_b32 a99, v249
    v_accvgpr_read_b32 v248, a112
    v_accvgpr_read_b32 v249, a113
    v_mul_f32 v248, v248, v251
    v_mul_f32 v249, v249, v251
    v_accvgpr_write_b32 a112, v248
    v_accvgpr_write_b32 a113, v249
    v_accvgpr_read_b32 v248, a114
    v_accvgpr_read_b32 v249, a115
    v_mul_f32 v248, v248, v251
    v_mul_f32 v249, v249, v251
    v_accvgpr_write_b32 a114, v248
    v_accvgpr_write_b32 a115, v249
    v_accvgpr_read_b32 v248, a128
    v_accvgpr_read_b32 v249, a129
    v_mul_f32 v248, v248, v251
    v_mul_f32 v249, v249, v251
    v_accvgpr_write_b32 a128, v248
    v_accvgpr_write_b32 a129, v249
    v_accvgpr_read_b32 v248, a130
    v_accvgpr_read_b32 v249, a131
    v_mul_f32 v248, v248, v251
    v_mul_f32 v249, v249, v251
    v_accvgpr_write_b32 a130, v248
    v_accvgpr_write_b32 a131, v249
    v_accvgpr_read_b32 v248, a144
    v_accvgpr_read_b32 v249, a145
    v_mul_f32 v248, v248, v251
    v_mul_f32 v249, v249, v251
    v_accvgpr_write_b32 a144, v248
    v_accvgpr_write_b32 a145, v249
    v_accvgpr_read_b32 v248, a146
    v_accvgpr_read_b32 v249, a147
    v_mul_f32 v248, v248, v251
    v_mul_f32 v249, v249, v251
    v_accvgpr_write_b32 a146, v248
    v_accvgpr_write_b32 a147, v249
    v_accvgpr_read_b32 v248, a160
    v_accvgpr_read_b32 v249, a161
    v_mul_f32 v248, v248, v251
    v_mul_f32 v249, v249, v251
    v_accvgpr_write_b32 a160, v248
    v_accvgpr_write_b32 a161, v249
    v_accvgpr_read_b32 v248, a162
    v_accvgpr_read_b32 v249, a163
    v_mul_f32 v248, v248, v251
    v_mul_f32 v249, v249, v251
    v_accvgpr_write_b32 a162, v248
    v_accvgpr_write_b32 a163, v249
    v_accvgpr_read_b32 v248, a176
    v_accvgpr_read_b32 v249, a177
    v_mul_f32 v248, v248, v251
    v_mul_f32 v249, v249, v251
    v_accvgpr_write_b32 a176, v248
    v_accvgpr_write_b32 a177, v249
    v_accvgpr_read_b32 v248, a178
    v_accvgpr_read_b32 v249, a179
    v_mul_f32 v248, v248, v251
    v_mul_f32 v249, v249, v251
    v_accvgpr_write_b32 a178, v248
    v_accvgpr_write_b32 a179, v249
    v_accvgpr_read_b32 v248, a192
    v_accvgpr_read_b32 v249, a193
    v_mul_f32 v248, v248, v251
    v_mul_f32 v249, v249, v251
    v_accvgpr_write_b32 a192, v248
    v_accvgpr_write_b32 a193, v249
    v_accvgpr_read_b32 v248, a194
    v_accvgpr_read_b32 v249, a195
    v_mul_f32 v248, v248, v251
    v_mul_f32 v249, v249, v251
    v_accvgpr_write_b32 a194, v248
    v_accvgpr_write_b32 a195, v249
    v_accvgpr_read_b32 v248, a208
    v_accvgpr_read_b32 v249, a209
    v_mul_f32 v248, v248, v251
    v_mul_f32 v249, v249, v251
    v_accvgpr_write_b32 a208, v248
    v_accvgpr_write_b32 a209, v249
    v_accvgpr_read_b32 v248, a210
    v_accvgpr_read_b32 v249, a211
    v_mul_f32 v248, v248, v251
    v_mul_f32 v249, v249, v251
    v_accvgpr_write_b32 a210, v248
    v_accvgpr_write_b32 a211, v249
    v_accvgpr_read_b32 v248, a224
    v_accvgpr_read_b32 v249, a225
    v_mul_f32 v248, v248, v251
    v_mul_f32 v249, v249, v251
    v_accvgpr_write_b32 a224, v248
    v_accvgpr_write_b32 a225, v249
    v_accvgpr_read_b32 v248, a226
    v_accvgpr_read_b32 v249, a227
    v_mul_f32 v248, v248, v251
    v_mul_f32 v249, v249, v251
    v_accvgpr_write_b32 a226, v248
    v_accvgpr_write_b32 a227, v249
    v_accvgpr_read_b32 v248, a240
    v_accvgpr_read_b32 v249, a241
    v_mul_f32 v248, v248, v251
    v_mul_f32 v249, v249, v251
    v_accvgpr_write_b32 a240, v248
    v_accvgpr_write_b32 a241, v249
    v_accvgpr_read_b32 v248, a242
    v_accvgpr_read_b32 v249, a243
    v_mul_f32 v248, v248, v251
    v_mul_f32 v249, v249, v251
    v_accvgpr_write_b32 a242, v248
    v_accvgpr_write_b32 a243, v249
    v_exp_f32 v248, v128
    v_exp_f32 v249, v129
    s_nop 0
    v_add_f32 v244, v240, v248
    v_add_f32 v244, v244, v249
    v_cvt_pk_bf16_f32 v176, v248, v249
    v_exp_f32 v248, v130
    v_exp_f32 v249, v131
    s_nop 0
    v_add_f32 v244, v244, v248
    v_add_f32 v244, v244, v249
    v_cvt_pk_bf16_f32 v177, v248, v249
    v_exp_f32 v248, v144
    v_exp_f32 v249, v145
    s_nop 0
    v_add_f32 v244, v244, v248
    v_add_f32 v244, v244, v249
    v_cvt_pk_bf16_f32 v178, v248, v249
    v_exp_f32 v248, v146
    v_exp_f32 v249, v147
    s_nop 0
    v_add_f32 v244, v244, v248
    v_add_f32 v244, v244, v249
    v_cvt_pk_bf16_f32 v179, v248, v249
    v_max3_f32 v250, v132, v133, v134
    v_max3_f32 v250, v250, v135, v148
    v_max3_f32 v250, v250, v149, v150
    v_max_f32 v250, v250, v151
    v_mov_b32 v251, v250
    s_nop 1
    v_permlane16_swap_b32 v250, v251
    s_nop 1
    v_max_f32 v250, v250, v251
    v_mov_b32 v251, v250
    s_nop 1
    v_permlane32_swap_b32 v250, v251
    s_nop 1
    v_max_f32 v250, v250, v251
    v_add_f32 v250, s26, v250
    v_max_f32 v250, 0, v250
    v_exp_f32 v251, -v250
    v_sub_f32 v228, v228, v250
    v_sub_f32 v229, v229, v250
    v_sub_f32 v230, v230, v250
    v_sub_f32 v231, v231, v250
    v_sub_f32 v132, v132, v250
    v_sub_f32 v133, v133, v250
    v_sub_f32 v134, v134, v250
    v_sub_f32 v135, v135, v250
    v_sub_f32 v148, v148, v250
    v_sub_f32 v149, v149, v250
    v_sub_f32 v150, v150, v250
    v_sub_f32 v151, v151, v250
    v_mul_f32 v241, v241, v251
    v_accvgpr_read_b32 v248, a4
    v_accvgpr_read_b32 v249, a5
    v_mul_f32 v248, v248, v251
    v_mul_f32 v249, v249, v251
    v_accvgpr_write_b32 a4, v248
    v_accvgpr_write_b32 a5, v249
    v_accvgpr_read_b32 v248, a6
    v_accvgpr_read_b32 v249, a7
    v_mul_f32 v248, v248, v251
    v_mul_f32 v249, v249, v251
    v_accvgpr_write_b32 a6, v248
    v_accvgpr_write_b32 a7, v249
    v_accvgpr_read_b32 v248, a20
    v_accvgpr_read_b32 v249, a21
    v_mul_f32 v248, v248, v251
    v_mul_f32 v249, v249, v251
    v_accvgpr_write_b32 a20, v248
    v_accvgpr_write_b32 a21, v249
    v_accvgpr_read_b32 v248, a22
    v_accvgpr_read_b32 v249, a23
    v_mul_f32 v248, v248, v251
    v_mul_f32 v249, v249, v251
    v_accvgpr_write_b32 a22, v248
    v_accvgpr_write_b32 a23, v249
    v_accvgpr_read_b32 v248, a36
    v_accvgpr_read_b32 v249, a37
    v_mul_f32 v248, v248, v251
    v_mul_f32 v249, v249, v251
    v_accvgpr_write_b32 a36, v248
    v_accvgpr_write_b32 a37, v249
    v_accvgpr_read_b32 v248, a38
    v_accvgpr_read_b32 v249, a39
    v_mul_f32 v248, v248, v251
    v_mul_f32 v249, v249, v251
    v_accvgpr_write_b32 a38, v248
    v_accvgpr_write_b32 a39, v249
    v_accvgpr_read_b32 v248, a52
    v_accvgpr_read_b32 v249, a53
    v_mul_f32 v248, v248, v251
    v_mul_f32 v249, v249, v251
    v_accvgpr_write_b32 a52, v248
    v_accvgpr_write_b32 a53, v249
    v_accvgpr_read_b32 v248, a54
    v_accvgpr_read_b32 v249, a55
    v_mul_f32 v248, v248, v251
    v_mul_f32 v249, v249, v251
    v_accvgpr_write_b32 a54, v248
    v_accvgpr_write_b32 a55, v249
    v_accvgpr_read_b32 v248, a68
    v_accvgpr_read_b32 v249, a69
    v_mul_f32 v248, v248, v251
    v_mul_f32 v249, v249, v251
    v_accvgpr_write_b32 a68, v248
    v_accvgpr_write_b32 a69, v249
    v_accvgpr_read_b32 v248, a70
    v_accvgpr_read_b32 v249, a71
    v_mul_f32 v248, v248, v251
    v_mul_f32 v249, v249, v251
    v_accvgpr_write_b32 a70, v248
    v_accvgpr_write_b32 a71, v249
    v_accvgpr_read_b32 v248, a84
    v_accvgpr_read_b32 v249, a85
    v_mul_f32 v248, v248, v251
    v_mul_f32 v249, v249, v251
    v_accvgpr_write_b32 a84, v248
    v_accvgpr_write_b32 a85, v249
    v_accvgpr_read_b32 v248, a86
    v_accvgpr_read_b32 v249, a87
    v_mul_f32 v248, v248, v251
    v_mul_f32 v249, v249, v251
    v_accvgpr_write_b32 a86, v248
    v_accvgpr_write_b32 a87, v249
    v_accvgpr_read_b32 v248, a100
    v_accvgpr_read_b32 v249, a101
    v_mul_f32 v248, v248, v251
    v_mul_f32 v249, v249, v251
    v_accvgpr_write_b32 a100, v248
    v_accvgpr_write_b32 a101, v249
    v_accvgpr_read_b32 v248, a102
    v_accvgpr_read_b32 v249, a103
    v_mul_f32 v248, v248, v251
    v_mul_f32 v249, v249, v251
    v_accvgpr_write_b32 a102, v248
    v_accvgpr_write_b32 a103, v249
    v_accvgpr_read_b32 v248, a116
    v_accvgpr_read_b32 v249, a117
    v_mul_f32 v248, v248, v251
    v_mul_f32 v249, v249, v251
    v_accvgpr_write_b32 a116, v248
    v_accvgpr_write_b32 a117, v249
    v_accvgpr_read_b32 v248, a118
    v_accvgpr_read_b32 v249, a119
    v_mul_f32 v248, v248, v251
    v_mul_f32 v249, v249, v251
    v_accvgpr_write_b32 a118, v248
    v_accvgpr_write_b32 a119, v249
    v_accvgpr_read_b32 v248, a132
    v_accvgpr_read_b32 v249, a133
    v_mul_f32 v248, v248, v251
    v_mul_f32 v249, v249, v251
    v_accvgpr_write_b32 a132, v248
    v_accvgpr_write_b32 a133, v249
    v_accvgpr_read_b32 v248, a134
    v_accvgpr_read_b32 v249, a135
    v_mul_f32 v248, v248, v251
    v_mul_f32 v249, v249, v251
    v_accvgpr_write_b32 a134, v248
    v_accvgpr_write_b32 a135, v249
    v_accvgpr_read_b32 v248, a148
    v_accvgpr_read_b32 v249, a149
    v_mul_f32 v248, v248, v251
    v_mul_f32 v249, v249, v251
    v_accvgpr_write_b32 a148, v248
    v_accvgpr_write_b32 a149, v249
    v_accvgpr_read_b32 v248, a150
    v_accvgpr_read_b32 v249, a151
    v_mul_f32 v248, v248, v251
    v_mul_f32 v249, v249, v251
    v_accvgpr_write_b32 a150, v248
    v_accvgpr_write_b32 a151, v249
    v_accvgpr_read_b32 v248, a164
    v_accvgpr_read_b32 v249, a165
    v_mul_f32 v248, v248, v251
    v_mul_f32 v249, v249, v251
    v_accvgpr_write_b32 a164, v248
    v_accvgpr_write_b32 a165, v249
    v_accvgpr_read_b32 v248, a166
    v_accvgpr_read_b32 v249, a167
    v_mul_f32 v248, v248, v251
    v_mul_f32 v249, v249, v251
    v_accvgpr_write_b32 a166, v248
    v_accvgpr_write_b32 a167, v249
    v_accvgpr_read_b32 v248, a180
    v_accvgpr_read_b32 v249, a181
    v_mul_f32 v248, v248, v251
    v_mul_f32 v249, v249, v251
    v_accvgpr_write_b32 a180, v248
    v_accvgpr_write_b32 a181, v249
    v_accvgpr_read_b32 v248, a182
    v_accvgpr_read_b32 v249, a183
    v_mul_f32 v248, v248, v251
    v_mul_f32 v249, v249, v251
    v_accvgpr_write_b32 a182, v248
    v_accvgpr_write_b32 a183, v249
    v_accvgpr_read_b32 v248, a196
    v_accvgpr_read_b32 v249, a197
    v_mul_f32 v248, v248, v251
    v_mul_f32 v249, v249, v251
    v_accvgpr_write_b32 a196, v248
    v_accvgpr_write_b32 a197, v249
    v_accvgpr_read_b32 v248, a198
    v_accvgpr_read_b32 v249, a199
    v_mul_f32 v248, v248, v251
    v_mul_f32 v249, v249, v251
    v_accvgpr_write_b32 a198, v248
    v_accvgpr_write_b32 a199, v249
    v_accvgpr_read_b32 v248, a212
    v_accvgpr_read_b32 v249, a213
    v_mul_f32 v248, v248, v251
    v_mul_f32 v249, v249, v251
    v_accvgpr_write_b32 a212, v248
    v_accvgpr_write_b32 a213, v249
    v_accvgpr_read_b32 v248, a214
    v_accvgpr_read_b32 v249, a215
    v_mul_f32 v248, v248, v251
    v_mul_f32 v249, v249, v251
    v_accvgpr_write_b32 a214, v248
    v_accvgpr_write_b32 a215, v249
    v_accvgpr_read_b32 v248, a228
    v_accvgpr_read_b32 v249, a229
    v_mul_f32 v248, v248, v251
    v_mul_f32 v249, v249, v251
    v_accvgpr_write_b32 a228, v248
    v_accvgpr_write_b32 a229, v249
    v_accvgpr_read_b32 v248, a230
    v_accvgpr_read_b32 v249, a231
    v_mul_f32 v248, v248, v251
    v_mul_f32 v249, v249, v251
    v_accvgpr_write_b32 a230, v248
    v_accvgpr_write_b32 a231, v249
    v_accvgpr_read_b32 v248, a244
    v_accvgpr_read_b32 v249, a245
    v_mul_f32 v248, v248, v251
    v_mul_f32 v249, v249, v251
    v_accvgpr_write_b32 a244, v248
    v_accvgpr_write_b32 a245, v249
    v_accvgpr_read_b32 v248, a246
    v_accvgpr_read_b32 v249, a247
    v_mul_f32 v248, v248, v251
    v_mul_f32 v249, v249, v251
    v_accvgpr_write_b32 a246, v248
    v_accvgpr_write_b32 a247, v249
    v_exp_f32 v248, v132
    v_exp_f32 v249, v133
    s_nop 0
    v_add_f32 v245, v241, v248
    v_add_f32 v245, v245, v249
    v_cvt_pk_bf16_f32 v180, v248, v249
    v_exp_f32 v248, v134
    v_exp_f32 v249, v135
    s_nop 0
    v_add_f32 v245, v245, v248
    v_add_f32 v245, v245, v249
    v_cvt_pk_bf16_f32 v181, v248, v249
    v_exp_f32 v248, v148
    v_exp_f32 v249, v149
    s_nop 0
    v_add_f32 v245, v245, v248
    v_add_f32 v245, v245, v249
    v_cvt_pk_bf16_f32 v182, v248, v249
    v_exp_f32 v248, v150
    v_exp_f32 v249, v151
    s_nop 0
    v_add_f32 v245, v245, v248
    v_add_f32 v245, v245, v249
    v_cvt_pk_bf16_f32 v183, v248, v249
    v_max3_f32 v250, v136, v137, v138
    v_max3_f32 v250, v250, v139, v152
    v_max3_f32 v250, v250, v153, v154
    v_max_f32 v250, v250, v155
    v_mov_b32 v251, v250
    s_nop 1
    v_permlane16_swap_b32 v250, v251
    s_nop 1
    v_max_f32 v250, v250, v251
    v_mov_b32 v251, v250
    s_nop 1
    v_permlane32_swap_b32 v250, v251
    s_nop 1
    v_max_f32 v250, v250, v251
    v_add_f32 v250, s26, v250
    v_max_f32 v250, 0, v250
    v_exp_f32 v251, -v250
    v_sub_f32 v232, v232, v250
    v_sub_f32 v233, v233, v250
    v_sub_f32 v234, v234, v250
    v_sub_f32 v235, v235, v250
    v_sub_f32 v136, v136, v250
    v_sub_f32 v137, v137, v250
    v_sub_f32 v138, v138, v250
    v_sub_f32 v139, v139, v250
    v_sub_f32 v152, v152, v250
    v_sub_f32 v153, v153, v250
    v_sub_f32 v154, v154, v250
    v_sub_f32 v155, v155, v250
    v_mul_f32 v242, v242, v251
    v_accvgpr_read_b32 v248, a8
    v_accvgpr_read_b32 v249, a9
    v_mul_f32 v248, v248, v251
    v_mul_f32 v249, v249, v251
    v_accvgpr_write_b32 a8, v248
    v_accvgpr_write_b32 a9, v249
    v_accvgpr_read_b32 v248, a10
    v_accvgpr_read_b32 v249, a11
    v_mul_f32 v248, v248, v251
    v_mul_f32 v249, v249, v251
    v_accvgpr_write_b32 a10, v248
    v_accvgpr_write_b32 a11, v249
    v_accvgpr_read_b32 v248, a24
    v_accvgpr_read_b32 v249, a25
    v_mul_f32 v248, v248, v251
    v_mul_f32 v249, v249, v251
    v_accvgpr_write_b32 a24, v248
    v_accvgpr_write_b32 a25, v249
    v_accvgpr_read_b32 v248, a26
    v_accvgpr_read_b32 v249, a27
    v_mul_f32 v248, v248, v251
    v_mul_f32 v249, v249, v251
    v_accvgpr_write_b32 a26, v248
    v_accvgpr_write_b32 a27, v249
    v_accvgpr_read_b32 v248, a40
    v_accvgpr_read_b32 v249, a41
    v_mul_f32 v248, v248, v251
    v_mul_f32 v249, v249, v251
    v_accvgpr_write_b32 a40, v248
    v_accvgpr_write_b32 a41, v249
    v_accvgpr_read_b32 v248, a42
    v_accvgpr_read_b32 v249, a43
    v_mul_f32 v248, v248, v251
    v_mul_f32 v249, v249, v251
    v_accvgpr_write_b32 a42, v248
    v_accvgpr_write_b32 a43, v249
    v_accvgpr_read_b32 v248, a56
    v_accvgpr_read_b32 v249, a57
    v_mul_f32 v248, v248, v251
    v_mul_f32 v249, v249, v251
    v_accvgpr_write_b32 a56, v248
    v_accvgpr_write_b32 a57, v249
    v_accvgpr_read_b32 v248, a58
    v_accvgpr_read_b32 v249, a59
    v_mul_f32 v248, v248, v251
    v_mul_f32 v249, v249, v251
    v_accvgpr_write_b32 a58, v248
    v_accvgpr_write_b32 a59, v249
    v_accvgpr_read_b32 v248, a72
    v_accvgpr_read_b32 v249, a73
    v_mul_f32 v248, v248, v251
    v_mul_f32 v249, v249, v251
    v_accvgpr_write_b32 a72, v248
    v_accvgpr_write_b32 a73, v249
    v_accvgpr_read_b32 v248, a74
    v_accvgpr_read_b32 v249, a75
    v_mul_f32 v248, v248, v251
    v_mul_f32 v249, v249, v251
    v_accvgpr_write_b32 a74, v248
    v_accvgpr_write_b32 a75, v249
    v_accvgpr_read_b32 v248, a88
    v_accvgpr_read_b32 v249, a89
    v_mul_f32 v248, v248, v251
    v_mul_f32 v249, v249, v251
    v_accvgpr_write_b32 a88, v248
    v_accvgpr_write_b32 a89, v249
    v_accvgpr_read_b32 v248, a90
    v_accvgpr_read_b32 v249, a91
    v_mul_f32 v248, v248, v251
    v_mul_f32 v249, v249, v251
    v_accvgpr_write_b32 a90, v248
    v_accvgpr_write_b32 a91, v249
    v_accvgpr_read_b32 v248, a104
    v_accvgpr_read_b32 v249, a105
    v_mul_f32 v248, v248, v251
    v_mul_f32 v249, v249, v251
    v_accvgpr_write_b32 a104, v248
    v_accvgpr_write_b32 a105, v249
    v_accvgpr_read_b32 v248, a106
    v_accvgpr_read_b32 v249, a107
    v_mul_f32 v248, v248, v251
    v_mul_f32 v249, v249, v251
    v_accvgpr_write_b32 a106, v248
    v_accvgpr_write_b32 a107, v249
    v_accvgpr_read_b32 v248, a120
    v_accvgpr_read_b32 v249, a121
    v_mul_f32 v248, v248, v251
    v_mul_f32 v249, v249, v251
    v_accvgpr_write_b32 a120, v248
    v_accvgpr_write_b32 a121, v249
    v_accvgpr_read_b32 v248, a122
    v_accvgpr_read_b32 v249, a123
    v_mul_f32 v248, v248, v251
    v_mul_f32 v249, v249, v251
    v_accvgpr_write_b32 a122, v248
    v_accvgpr_write_b32 a123, v249
    v_accvgpr_read_b32 v248, a136
    v_accvgpr_read_b32 v249, a137
    v_mul_f32 v248, v248, v251
    v_mul_f32 v249, v249, v251
    v_accvgpr_write_b32 a136, v248
    v_accvgpr_write_b32 a137, v249
    v_accvgpr_read_b32 v248, a138
    v_accvgpr_read_b32 v249, a139
    v_mul_f32 v248, v248, v251
    v_mul_f32 v249, v249, v251
    v_accvgpr_write_b32 a138, v248
    v_accvgpr_write_b32 a139, v249
    v_accvgpr_read_b32 v248, a152
    v_accvgpr_read_b32 v249, a153
    v_mul_f32 v248, v248, v251
    v_mul_f32 v249, v249, v251
    v_accvgpr_write_b32 a152, v248
    v_accvgpr_write_b32 a153, v249
    v_accvgpr_read_b32 v248, a154
    v_accvgpr_read_b32 v249, a155
    v_mul_f32 v248, v248, v251
    v_mul_f32 v249, v249, v251
    v_accvgpr_write_b32 a154, v248
    v_accvgpr_write_b32 a155, v249
    v_accvgpr_read_b32 v248, a168
    v_accvgpr_read_b32 v249, a169
    v_mul_f32 v248, v248, v251
    v_mul_f32 v249, v249, v251
    v_accvgpr_write_b32 a168, v248
    v_accvgpr_write_b32 a169, v249
    v_accvgpr_read_b32 v248, a170
    v_accvgpr_read_b32 v249, a171
    v_mul_f32 v248, v248, v251
    v_mul_f32 v249, v249, v251
    v_accvgpr_write_b32 a170, v248
    v_accvgpr_write_b32 a171, v249
    v_accvgpr_read_b32 v248, a184
    v_accvgpr_read_b32 v249, a185
    v_mul_f32 v248, v248, v251
    v_mul_f32 v249, v249, v251
    v_accvgpr_write_b32 a184, v248
    v_accvgpr_write_b32 a185, v249
    v_accvgpr_read_b32 v248, a186
    v_accvgpr_read_b32 v249, a187
    v_mul_f32 v248, v248, v251
    v_mul_f32 v249, v249, v251
    v_accvgpr_write_b32 a186, v248
    v_accvgpr_write_b32 a187, v249
    v_accvgpr_read_b32 v248, a200
    v_accvgpr_read_b32 v249, a201
    v_mul_f32 v248, v248, v251
    v_mul_f32 v249, v249, v251
    v_accvgpr_write_b32 a200, v248
    v_accvgpr_write_b32 a201, v249
    v_accvgpr_read_b32 v248, a202
    v_accvgpr_read_b32 v249, a203
    v_mul_f32 v248, v248, v251
    v_mul_f32 v249, v249, v251
    v_accvgpr_write_b32 a202, v248
    v_accvgpr_write_b32 a203, v249
    v_accvgpr_read_b32 v248, a216
    v_accvgpr_read_b32 v249, a217
    v_mul_f32 v248, v248, v251
    v_mul_f32 v249, v249, v251
    v_accvgpr_write_b32 a216, v248
    v_accvgpr_write_b32 a217, v249
    v_accvgpr_read_b32 v248, a218
    v_accvgpr_read_b32 v249, a219
    v_mul_f32 v248, v248, v251
    v_mul_f32 v249, v249, v251
    v_accvgpr_write_b32 a218, v248
    v_accvgpr_write_b32 a219, v249
    v_accvgpr_read_b32 v248, a232
    v_accvgpr_read_b32 v249, a233
    v_mul_f32 v248, v248, v251
    v_mul_f32 v249, v249, v251
    v_accvgpr_write_b32 a232, v248
    v_accvgpr_write_b32 a233, v249
    v_accvgpr_read_b32 v248, a234
    v_accvgpr_read_b32 v249, a235
    v_mul_f32 v248, v248, v251
    v_mul_f32 v249, v249, v251
    v_accvgpr_write_b32 a234, v248
    v_accvgpr_write_b32 a235, v249
    v_accvgpr_read_b32 v248, a248
    v_accvgpr_read_b32 v249, a249
    v_mul_f32 v248, v248, v251
    v_mul_f32 v249, v249, v251
    v_accvgpr_write_b32 a248, v248
    v_accvgpr_write_b32 a249, v249
    v_accvgpr_read_b32 v248, a250
    v_accvgpr_read_b32 v249, a251
    v_mul_f32 v248, v248, v251
    v_mul_f32 v249, v249, v251
    v_accvgpr_write_b32 a250, v248
    v_accvgpr_write_b32 a251, v249
    v_exp_f32 v248, v136
    v_exp_f32 v249, v137
    s_nop 0
    v_add_f32 v246, v242, v248
    v_add_f32 v246, v246, v249
    v_cvt_pk_bf16_f32 v184, v248, v249
    v_exp_f32 v248, v138
    v_exp_f32 v249, v139
    s_nop 0
    v_add_f32 v246, v246, v248
    v_add_f32 v246, v246, v249
    v_cvt_pk_bf16_f32 v185, v248, v249
    v_exp_f32 v248, v152
    v_exp_f32 v249, v153
    s_nop 0
    v_add_f32 v246, v246, v248
    v_add_f32 v246, v246, v249
    v_cvt_pk_bf16_f32 v186, v248, v249
    v_exp_f32 v248, v154
    v_exp_f32 v249, v155
    s_nop 0
    v_add_f32 v246, v246, v248
    v_add_f32 v246, v246, v249
    v_cvt_pk_bf16_f32 v187, v248, v249
    v_max3_f32 v250, v140, v141, v142
    v_max3_f32 v250, v250, v143, v156
    v_max3_f32 v250, v250, v157, v158
    v_max_f32 v250, v250, v159
    v_mov_b32 v251, v250
    s_nop 1
    v_permlane16_swap_b32 v250, v251
    s_nop 1
    v_max_f32 v250, v250, v251
    v_mov_b32 v251, v250
    s_nop 1
    v_permlane32_swap_b32 v250, v251
    s_nop 1
    v_max_f32 v250, v250, v251
    v_add_f32 v250, s26, v250
    v_max_f32 v250, 0, v250
    v_exp_f32 v251, -v250
    v_sub_f32 v236, v236, v250
    v_sub_f32 v237, v237, v250
    v_sub_f32 v238, v238, v250
    v_sub_f32 v239, v239, v250
    v_sub_f32 v140, v140, v250
    v_sub_f32 v141, v141, v250
    v_sub_f32 v142, v142, v250
    v_sub_f32 v143, v143, v250
    v_sub_f32 v156, v156, v250
    v_sub_f32 v157, v157, v250
    v_sub_f32 v158, v158, v250
    v_sub_f32 v159, v159, v250
    v_mul_f32 v243, v243, v251
    v_accvgpr_read_b32 v248, a12
    v_accvgpr_read_b32 v249, a13
    v_mul_f32 v248, v248, v251
    v_mul_f32 v249, v249, v251
    v_accvgpr_write_b32 a12, v248
    v_accvgpr_write_b32 a13, v249
    v_accvgpr_read_b32 v248, a14
    v_accvgpr_read_b32 v249, a15
    v_mul_f32 v248, v248, v251
    v_mul_f32 v249, v249, v251
    v_accvgpr_write_b32 a14, v248
    v_accvgpr_write_b32 a15, v249
    v_accvgpr_read_b32 v248, a28
    v_accvgpr_read_b32 v249, a29
    v_mul_f32 v248, v248, v251
    v_mul_f32 v249, v249, v251
    v_accvgpr_write_b32 a28, v248
    v_accvgpr_write_b32 a29, v249
    v_accvgpr_read_b32 v248, a30
    v_accvgpr_read_b32 v249, a31
    v_mul_f32 v248, v248, v251
    v_mul_f32 v249, v249, v251
    v_accvgpr_write_b32 a30, v248
    v_accvgpr_write_b32 a31, v249
    v_accvgpr_read_b32 v248, a44
    v_accvgpr_read_b32 v249, a45
    v_mul_f32 v248, v248, v251
    v_mul_f32 v249, v249, v251
    v_accvgpr_write_b32 a44, v248
    v_accvgpr_write_b32 a45, v249
    v_accvgpr_read_b32 v248, a46
    v_accvgpr_read_b32 v249, a47
    v_mul_f32 v248, v248, v251
    v_mul_f32 v249, v249, v251
    v_accvgpr_write_b32 a46, v248
    v_accvgpr_write_b32 a47, v249
    v_accvgpr_read_b32 v248, a60
    v_accvgpr_read_b32 v249, a61
    v_mul_f32 v248, v248, v251
    v_mul_f32 v249, v249, v251
    v_accvgpr_write_b32 a60, v248
    v_accvgpr_write_b32 a61, v249
    v_accvgpr_read_b32 v248, a62
    v_accvgpr_read_b32 v249, a63
    v_mul_f32 v248, v248, v251
    v_mul_f32 v249, v249, v251
    v_accvgpr_write_b32 a62, v248
    v_accvgpr_write_b32 a63, v249
    v_accvgpr_read_b32 v248, a76
    v_accvgpr_read_b32 v249, a77
    v_mul_f32 v248, v248, v251
    v_mul_f32 v249, v249, v251
    v_accvgpr_write_b32 a76, v248
    v_accvgpr_write_b32 a77, v249
    v_accvgpr_read_b32 v248, a78
    v_accvgpr_read_b32 v249, a79
    v_mul_f32 v248, v248, v251
    v_mul_f32 v249, v249, v251
    v_accvgpr_write_b32 a78, v248
    v_accvgpr_write_b32 a79, v249
    v_accvgpr_read_b32 v248, a92
    v_accvgpr_read_b32 v249, a93
    v_mul_f32 v248, v248, v251
    v_mul_f32 v249, v249, v251
    v_accvgpr_write_b32 a92, v248
    v_accvgpr_write_b32 a93, v249
    v_accvgpr_read_b32 v248, a94
    v_accvgpr_read_b32 v249, a95
    v_mul_f32 v248, v248, v251
    v_mul_f32 v249, v249, v251
    v_accvgpr_write_b32 a94, v248
    v_accvgpr_write_b32 a95, v249
    v_accvgpr_read_b32 v248, a108
    v_accvgpr_read_b32 v249, a109
    v_mul_f32 v248, v248, v251
    v_mul_f32 v249, v249, v251
    v_accvgpr_write_b32 a108, v248
    v_accvgpr_write_b32 a109, v249
    v_accvgpr_read_b32 v248, a110
    v_accvgpr_read_b32 v249, a111
    v_mul_f32 v248, v248, v251
    v_mul_f32 v249, v249, v251
    v_accvgpr_write_b32 a110, v248
    v_accvgpr_write_b32 a111, v249
    v_accvgpr_read_b32 v248, a124
    v_accvgpr_read_b32 v249, a125
    v_mul_f32 v248, v248, v251
    v_mul_f32 v249, v249, v251
    v_accvgpr_write_b32 a124, v248
    v_accvgpr_write_b32 a125, v249
    v_accvgpr_read_b32 v248, a126
    v_accvgpr_read_b32 v249, a127
    v_mul_f32 v248, v248, v251
    v_mul_f32 v249, v249, v251
    v_accvgpr_write_b32 a126, v248
    v_accvgpr_write_b32 a127, v249
    v_accvgpr_read_b32 v248, a140
    v_accvgpr_read_b32 v249, a141
    v_mul_f32 v248, v248, v251
    v_mul_f32 v249, v249, v251
    v_accvgpr_write_b32 a140, v248
    v_accvgpr_write_b32 a141, v249
    v_accvgpr_read_b32 v248, a142
    v_accvgpr_read_b32 v249, a143
    v_mul_f32 v248, v248, v251
    v_mul_f32 v249, v249, v251
    v_accvgpr_write_b32 a142, v248
    v_accvgpr_write_b32 a143, v249
    v_accvgpr_read_b32 v248, a156
    v_accvgpr_read_b32 v249, a157
    v_mul_f32 v248, v248, v251
    v_mul_f32 v249, v249, v251
    v_accvgpr_write_b32 a156, v248
    v_accvgpr_write_b32 a157, v249
    v_accvgpr_read_b32 v248, a158
    v_accvgpr_read_b32 v249, a159
    v_mul_f32 v248, v248, v251
    v_mul_f32 v249, v249, v251
    v_accvgpr_write_b32 a158, v248
    v_accvgpr_write_b32 a159, v249
    v_accvgpr_read_b32 v248, a172
    v_accvgpr_read_b32 v249, a173
    v_mul_f32 v248, v248, v251
    v_mul_f32 v249, v249, v251
    v_accvgpr_write_b32 a172, v248
    v_accvgpr_write_b32 a173, v249
    v_accvgpr_read_b32 v248, a174
    v_accvgpr_read_b32 v249, a175
    v_mul_f32 v248, v248, v251
    v_mul_f32 v249, v249, v251
    v_accvgpr_write_b32 a174, v248
    v_accvgpr_write_b32 a175, v249
    v_accvgpr_read_b32 v248, a188
    v_accvgpr_read_b32 v249, a189
    v_mul_f32 v248, v248, v251
    v_mul_f32 v249, v249, v251
    v_accvgpr_write_b32 a188, v248
    v_accvgpr_write_b32 a189, v249
    v_accvgpr_read_b32 v248, a190
    v_accvgpr_read_b32 v249, a191
    v_mul_f32 v248, v248, v251
    v_mul_f32 v249, v249, v251
    v_accvgpr_write_b32 a190, v248
    v_accvgpr_write_b32 a191, v249
    v_accvgpr_read_b32 v248, a204
    v_accvgpr_read_b32 v249, a205
    v_mul_f32 v248, v248, v251
    v_mul_f32 v249, v249, v251
    v_accvgpr_write_b32 a204, v248
    v_accvgpr_write_b32 a205, v249
    v_accvgpr_read_b32 v248, a206
    v_accvgpr_read_b32 v249, a207
    v_mul_f32 v248, v248, v251
    v_mul_f32 v249, v249, v251
    v_accvgpr_write_b32 a206, v248
    v_accvgpr_write_b32 a207, v249
    v_accvgpr_read_b32 v248, a220
    v_accvgpr_read_b32 v249, a221
    v_mul_f32 v248, v248, v251
    v_mul_f32 v249, v249, v251
    v_accvgpr_write_b32 a220, v248
    v_accvgpr_write_b32 a221, v249
    v_accvgpr_read_b32 v248, a222
    v_accvgpr_read_b32 v249, a223
    v_mul_f32 v248, v248, v251
    v_mul_f32 v249, v249, v251
    v_accvgpr_write_b32 a222, v248
    v_accvgpr_write_b32 a223, v249
    v_accvgpr_read_b32 v248, a236
    v_accvgpr_read_b32 v249, a237
    v_mul_f32 v248, v248, v251
    v_mul_f32 v249, v249, v251
    v_accvgpr_write_b32 a236, v248
    v_accvgpr_write_b32 a237, v249
    v_accvgpr_read_b32 v248, a238
    v_accvgpr_read_b32 v249, a239
    v_mul_f32 v248, v248, v251
    v_mul_f32 v249, v249, v251
    v_accvgpr_write_b32 a238, v248
    v_accvgpr_write_b32 a239, v249
    v_accvgpr_read_b32 v248, a252
    v_accvgpr_read_b32 v249, a253
    v_mul_f32 v248, v248, v251
    v_mul_f32 v249, v249, v251
    v_accvgpr_write_b32 a252, v248
    v_accvgpr_write_b32 a253, v249
    v_accvgpr_read_b32 v248, a254
    v_accvgpr_read_b32 v249, a255
    v_mul_f32 v248, v248, v251
    v_mul_f32 v249, v249, v251
    v_accvgpr_write_b32 a254, v248
    v_accvgpr_write_b32 a255, v249
    v_exp_f32 v248, v140
    v_exp_f32 v249, v141
    s_nop 0
    v_add_f32 v247, v243, v248
    v_add_f32 v247, v247, v249
    v_cvt_pk_bf16_f32 v188, v248, v249
    v_exp_f32 v248, v142
    v_exp_f32 v249, v143
    s_nop 0
    v_add_f32 v247, v247, v248
    v_add_f32 v247, v247, v249
    v_cvt_pk_bf16_f32 v189, v248, v249
    v_exp_f32 v248, v156
    v_exp_f32 v249, v157
    s_nop 0
    v_add_f32 v247, v247, v248
    v_add_f32 v247, v247, v249
    v_cvt_pk_bf16_f32 v190, v248, v249
    v_exp_f32 v248, v158
    v_exp_f32 v249, v159
    s_nop 0
    v_add_f32 v247, v247, v248
    v_add_f32 v247, v247, v249
    v_cvt_pk_bf16_f32 v191, v248, v249
    s_nop 1
    s_branch L_back_p30
K2_comb_general:
    ds_read_b128 v[32:35], v248 offset:8192
    ds_read_b128 v[36:39], v248 offset:9216
    v_accvgpr_read_b32 v192, a0
    v_accvgpr_read_b32 v193, a1
    v_accvgpr_read_b32 v194, a2
    v_accvgpr_read_b32 v195, a3
    s_waitcnt lgkmcnt(0)
    v_mul_f32 v0, v0, v206
    v_fmac_f32 v0, v192, v204
    v_mul_f32 v1, v1, v206
    v_fmac_f32 v1, v193, v204
    v_mul_f32 v2, v2, v206
    v_fmac_f32 v2, v194, v204
    v_mul_f32 v3, v3, v206
    v_fmac_f32 v3, v195, v204
    v_cvt_pk_bf16_f32 v128, v0, v1
    v_cvt_pk_bf16_f32 v129, v2, v3
    ds_read_b128 v[40:43], v248 offset:10240
    ds_read_b128 v[44:47], v248 offset:11264
    v_accvgpr_read_b32 v192, a4
    v_accvgpr_read_b32 v193, a5
    v_accvgpr_read_b32 v194, a6
    v_accvgpr_read_b32 v195, a7
    s_waitcnt lgkmcnt(0)
    v_mul_f32 v4, v4, v207
    v_fmac_f32 v4, v192, v205
    v_mul_f32 v5, v5, v207
    v_fmac_f32 v5, v193, v205
    v_mul_f32 v6, v6, v207
    v_fmac_f32 v6, v194, v205
    v_mul_f32 v7, v7, v207
    v_fmac_f32 v7, v195, v205
    v_cvt_pk_bf16_f32 v160, v4, v5
    v_cvt_pk_bf16_f32 v161, v6, v7
    ds_read_b128 v[48:51], v248 offset:12288
    ds_read_b128 v[52:55], v248 offset:13312
    v_accvgpr_read_b32 v192, a16
    v_accvgpr_read_b32 v193, a17
    v_accvgpr_read_b32 v194, a18
    v_accvgpr_read_b32 v195, a19
    s_waitcnt lgkmcnt(0)
    v_mul_f32 v8, v8, v206
    v_fmac_f32 v8, v192, v204
    v_mul_f32 v9, v9, v206
    v_fmac_f32 v9, v193, v204
    v_mul_f32 v10, v10, v206
    v_fmac_f32 v10, v194, v204
    v_mul_f32 v11, v11, v206
    v_fmac_f32 v11, v195, v204
    v_cvt_pk_bf16_f32 v130, v8, v9
    v_cvt_pk_bf16_f32 v131, v10, v11
    ds_read_b128 v[56:59], v248 offset:14336
    ds_read_b128 v[60:63], v248 offset:15360
    v_accvgpr_read_b32 v192, a20
    v_accvgpr_read_b32 v193, a21
    v_accvgpr_read_b32 v194, a22
    v_accvgpr_read_b32 v195, a23
    s_waitcnt lgkmcnt(0)
    v_mul_f32 v12, v12, v207
    v_fmac_f32 v12, v192, v205
    v_mul_f32 v13, v13, v207
    v_fmac_f32 v13, v193, v205
    v_mul_f32 v14, v14, v207
    v_fmac_f32 v14, v194, v205
    v_mul_f32 v15, v15, v207
    v_fmac_f32 v15, v195, v205
    v_cvt_pk_bf16_f32 v162, v12, v13
    v_cvt_pk_bf16_f32 v163, v14, v15
    ds_read_b128 v[64:67], v248 offset:16384
    ds_read_b128 v[68:71], v248 offset:17408
    v_accvgpr_read_b32 v192, a32
    v_accvgpr_read_b32 v193, a33
    v_accvgpr_read_b32 v194, a34
    v_accvgpr_read_b32 v195, a35
    s_waitcnt lgkmcnt(0)
    v_mul_f32 v16, v16, v206
    v_fmac_f32 v16, v192, v204
    v_mul_f32 v17, v17, v206
    v_fmac_f32 v17, v193, v204
    v_mul_f32 v18, v18, v206
    v_fmac_f32 v18, v194, v204
    v_mul_f32 v19, v19, v206
    v_fmac_f32 v19, v195, v204
    v_cvt_pk_bf16_f32 v132, v16, v17
    v_cvt_pk_bf16_f32 v133, v18, v19
    ds_read_b128 v[72:75], v248 offset:18432
    ds_read_b128 v[76:79], v248 offset:19456
    v_accvgpr_read_b32 v192, a36
    v_accvgpr_read_b32 v193, a37
    v_accvgpr_read_b32 v194, a38
    v_accvgpr_read_b32 v195, a39
    s_waitcnt lgkmcnt(0)
    v_mul_f32 v20, v20, v207
    v_fmac_f32 v20, v192, v205
    v_mul_f32 v21, v21, v207
    v_fmac_f32 v21, v193, v205
    v_mul_f32 v22, v22, v207
    v_fmac_f32 v22, v194, v205
    v_mul_f32 v23, v23, v207
    v_fmac_f32 v23, v195, v205
    v_cvt_pk_bf16_f32 v164, v20, v21
    v_cvt_pk_bf16_f32 v165, v22, v23
    ds_read_b128 v[80:83], v248 offset:20480
    ds_read_b128 v[84:87], v248 offset:21504
    v_accvgpr_read_b32 v192, a48
    v_accvgpr_read_b32 v193, a49
    v_accvgpr_read_b32 v194, a50
    v_accvgpr_read_b32 v195, a51
    s_waitcnt lgkmcnt(0)
    v_mul_f32 v24, v24, v206
    v_fmac_f32 v24, v192, v204
    v_mul_f32 v25, v25, v206
    v_fmac_f32 v25, v193, v204
    v_mul_f32 v26, v26, v206
    v_fmac_f32 v26, v194, v204
    v_mul_f32 v27, v27, v206
    v_fmac_f32 v27, v195, v204
    v_cvt_pk_bf16_f32 v134, v24, v25
    v_cvt_pk_bf16_f32 v135, v26, v27
    ds_read_b128 v[88:91], v248 offset:22528
    ds_read_b128 v[92:95], v248 offset:23552
    v_accvgpr_read_b32 v192, a52
    v_accvgpr_read_b32 v193, a53
    v_accvgpr_read_b32 v194, a54
    v_accvgpr_read_b32 v195, a55
    s_waitcnt lgkmcnt(0)
    v_mul_f32 v28, v28, v207
    v_fmac_f32 v28, v192, v205
    v_mul_f32 v29, v29, v207
    v_fmac_f32 v29, v193, v205
    v_mul_f32 v30, v30, v207
    v_fmac_f32 v30, v194, v205
    v_mul_f32 v31, v31, v207
    v_fmac_f32 v31, v195, v205
    v_cvt_pk_bf16_f32 v166, v28, v29
    v_cvt_pk_bf16_f32 v167, v30, v31
    v_accvgpr_read_b32 v192, a64
    v_accvgpr_read_b32 v193, a65
    v_accvgpr_read_b32 v194, a66
    v_accvgpr_read_b32 v195, a67
    s_waitcnt lgkmcnt(0)
    v_mul_f32 v32, v32, v206
    v_fmac_f32 v32, v192, v204
    v_mul_f32 v33, v33, v206
    v_fmac_f32 v33, v193, v204
    v_mul_f32 v34, v34, v206
    v_fmac_f32 v34, v194, v204
    v_mul_f32 v35, v35, v206
    v_fmac_f32 v35, v195, v204
    v_cvt_pk_bf16_f32 v136, v32, v33
    v_cvt_pk_bf16_f32 v137, v34, v35
    v_accvgpr_read_b32 v192, a68
    v_accvgpr_read_b32 v193, a69
    v_accvgpr_read_b32 v194, a70
    v_accvgpr_read_b32 v195, a71
    s_waitcnt lgkmcnt(0)
    v_mul_f32 v36, v36, v207
    v_fmac_f32 v36, v192, v205
    v_mul_f32 v37, v37, v207
    v_fmac_f32 v37, v193, v205
    v_mul_f32 v38, v38, v207
    v_fmac_f32 v38, v194, v205
    v_mul_f32 v39, v39, v207
    v_fmac_f32 v39, v195, v205
    v_cvt_pk_bf16_f32 v168, v36, v37
    v_cvt_pk_bf16_f32 v169, v38, v39
    s_waitcnt lgkmcnt(0)
    s_barrier
    ds_read_b128 v[96:99], v249 offset:0
    s_add_u32 m0, s70, 0
    s_mov_b32 s71, 0
    v_accvgpr_read_b32 v192, a80
    v_accvgpr_read_b32 v193, a81
    v_accvgpr_read_b32 v194, a82
    v_accvgpr_read_b32 v195, a83
    buffer_load_dwordx4 v242, s[4:7], s71 offen lds
    v_mul_f32 v40, v40, v206
    v_fmac_f32 v40, v192, v204
    v_mul_f32 v41, v41, v206
    v_fmac_f32 v41, v193, v204
    v_mul_f32 v42, v42, v206
    v_fmac_f32 v42, v194, v204
    v_mul_f32 v43, v43, v206
    v_fmac_f32 v43, v195, v204
    v_cvt_pk_bf16_f32 v138, v40, v41
    v_cvt_pk_bf16_f32 v139, v42, v43
    ds_read_b128 v[100:103], v249 offset:1024
    s_add_u32 m0, s70, 1024
    s_mov_b32 s71, 7168
    v_accvgpr_read_b32 v192, a84
    v_accvgpr_read_b32 v193, a85
    v_accvgpr_read_b32 v194, a86
    v_accvgpr_read_b32 v195, a87
    buffer_load_dwordx4 v242, s[4:7], s71 offen lds
    v_mul_f32 v44, v44, v207
    v_fmac_f32 v44, v192, v205
    v_mul_f32 v45, v45, v207
    v_fmac_f32 v45, v193, v205
    v_mul_f32 v46, v46, v207
    v_fmac_f32 v46, v194, v205
    v_mul_f32 v47, v47, v207
    v_fmac_f32 v47, v195, v205
    v_cvt_pk_bf16_f32 v170, v44, v45
    v_cvt_pk_bf16_f32 v171, v46, v47
    ds_read_b128 v[104:107], v249 offset:2048
    v_accvgpr_read_b32 v192, a96
    v_accvgpr_read_b32 v193, a97
    v_accvgpr_read_b32 v194, a98
    v_accvgpr_read_b32 v195, a99
    v_mul_f32 v48, v48, v206
    v_fmac_f32 v48, v192, v204
    v_mul_f32 v49, v49, v206
    v_fmac_f32 v49, v193, v204
    v_mul_f32 v50, v50, v206
    v_fmac_f32 v50, v194, v204
    v_mul_f32 v51, v51, v206
    v_fmac_f32 v51, v195, v204
    v_cvt_pk_bf16_f32 v140, v48, v49
    v_cvt_pk_bf16_f32 v141, v50, v51
    ds_read_b128 v[108:111], v249 offset:3072
    s_add_u32 m0, s70, 2048
    s_mov_b32 s71, 14336
    v_accvgpr_read_b32 v192, a100
    v_accvgpr_read_b32 v193, a101
    v_accvgpr_read_b32 v194, a102
    v_accvgpr_read_b32 v195, a103
    buffer_load_dwordx4 v242, s[4:7], s71 offen lds
    v_mul_f32 v52, v52, v207
    v_fmac_f32 v52, v192, v205
    v_mul_f32 v53, v53, v207
    v_fmac_f32 v53, v193, v205
    v_mul_f32 v54, v54, v207
    v_fmac_f32 v54, v194, v205
    v_mul_f32 v55, v55, v207
    v_fmac_f32 v55, v195, v205
    v_cvt_pk_bf16_f32 v172, v52, v53
    v_cvt_pk_bf16_f32 v173, v54, v55
    ds_read_b128 v[112:115], v249 offset:4096
    v_accvgpr_read_b32 v192, a112
    v_accvgpr_read_b32 v193, a113
    v_accvgpr_read_b32 v194, a114
    v_accvgpr_read_b32 v195, a115
    v_mul_f32 v56, v56, v206
    v_fmac_f32 v56, v192, v204
    v_mul_f32 v57, v57, v206
    v_fmac_f32 v57, v193, v204
    v_mul_f32 v58, v58, v206
    v_fmac_f32 v58, v194, v204
    v_mul_f32 v59, v59, v206
    v_fmac_f32 v59, v195, v204
    v_cvt_pk_bf16_f32 v142, v56, v57
    v_cvt_pk_bf16_f32 v143, v58, v59
    ds_read_b128 v[116:119], v249 offset:5120
    s_add_u32 m0, s70, 3072
    s_mov_b32 s71, 21504
    v_accvgpr_read_b32 v192, a116
    v_accvgpr_read_b32 v193, a117
    v_accvgpr_read_b32 v194, a118
    v_accvgpr_read_b32 v195, a119
    buffer_load_dwordx4 v242, s[4:7], s71 offen lds
    v_mul_f32 v60, v60, v207
    v_fmac_f32 v60, v192, v205
    v_mul_f32 v61, v61, v207
    v_fmac_f32 v61, v193, v205
    v_mul_f32 v62, v62, v207
    v_fmac_f32 v62, v194, v205
    v_mul_f32 v63, v63, v207
    v_fmac_f32 v63, v195, v205
    v_cvt_pk_bf16_f32 v174, v60, v61
    v_cvt_pk_bf16_f32 v175, v62, v63
    ds_read_b128 v[120:123], v249 offset:6144
    v_accvgpr_read_b32 v192, a128
    v_accvgpr_read_b32 v193, a129
    v_accvgpr_read_b32 v194, a130
    v_accvgpr_read_b32 v195, a131
    v_mul_f32 v64, v64, v206
    v_fmac_f32 v64, v192, v204
    v_mul_f32 v65, v65, v206
    v_fmac_f32 v65, v193, v204
    v_mul_f32 v66, v66, v206
    v_fmac_f32 v66, v194, v204
    v_mul_f32 v67, v67, v206
    v_fmac_f32 v67, v195, v204
    v_cvt_pk_bf16_f32 v144, v64, v65
    v_cvt_pk_bf16_f32 v145, v66, v67
    ds_read_b128 v[124:127], v249 offset:7168
    s_add_u32 m0, s70, 4096
    s_mov_b32 s71, 28672
    v_accvgpr_read_b32 v192, a132
    v_accvgpr_read_b32 v193, a133
    v_accvgpr_read_b32 v194, a134
    v_accvgpr_read_b32 v195, a135
    buffer_load_dwordx4 v242, s[4:7], s71 offen lds
    v_mul_f32 v68, v68, v207
    v_fmac_f32 v68, v192, v205
    v_mul_f32 v69, v69, v207
    v_fmac_f32 v69, v193, v205
    v_mul_f32 v70, v70, v207
    v_fmac_f32 v70, v194, v205
    v_mul_f32 v71, v71, v207
    v_fmac_f32 v71, v195, v205
    v_cvt_pk_bf16_f32 v176, v68, v69
    v_cvt_pk_bf16_f32 v177, v70, v71
    v_accvgpr_read_b32 v192, a144
    v_accvgpr_read_b32 v193, a145
    v_accvgpr_read_b32 v194, a146
    v_accvgpr_read_b32 v195, a147
    v_mul_f32 v72, v72, v206
    v_fmac_f32 v72, v192, v204
    v_mul_f32 v73, v73, v206
    v_fmac_f32 v73, v193, v204
    v_mul_f32 v74, v74, v206
    v_fmac_f32 v74, v194, v204
    v_mul_f32 v75, v75, v206
    v_fmac_f32 v75, v195, v204
    v_cvt_pk_bf16_f32 v146, v72, v73
    v_cvt_pk_bf16_f32 v147, v74, v75
    s_add_u32 m0, s70, 5120
    s_mov_b32 s71, 35840
    v_accvgpr_read_b32 v192, a148
    v_accvgpr_read_b32 v193, a149
    v_accvgpr_read_b32 v194, a150
    v_accvgpr_read_b32 v195, a151
    buffer_load_dwordx4 v242, s[4:7], s71 offen lds
    v_mul_f32 v76, v76, v207
    v_fmac_f32 v76, v192, v205
    v_mul_f32 v77, v77, v207
    v_fmac_f32 v77, v193, v205
    v_mul_f32 v78, v78, v207
    v_fmac_f32 v78, v194, v205
    v_mul_f32 v79, v79, v207
    v_fmac_f32 v79, v195, v205
    v_cvt_pk_bf16_f32 v178, v76, v77
    v_cvt_pk_bf16_f32 v179, v78, v79
    v_accvgpr_read_b32 v192, a160
    v_accvgpr_read_b32 v193, a161
    v_accvgpr_read_b32 v194, a162
    v_accvgpr_read_b32 v195, a163
    v_mul_f32 v80, v80, v206
    v_fmac_f32 v80, v192, v204
    v_mul_f32 v81, v81, v206
    v_fmac_f32 v81, v193, v204
    v_mul_f32 v82, v82, v206
    v_fmac_f32 v82, v194, v204
    v_mul_f32 v83, v83, v206
    v_fmac_f32 v83, v195, v204
    v_cvt_pk_bf16_f32 v148, v80, v81
    v_cvt_pk_bf16_f32 v149, v82, v83
    s_add_u32 m0, s70, 6144
    s_mov_b32 s71, 43008
    v_accvgpr_read_b32 v192, a164
    v_accvgpr_read_b32 v193, a165
    v_accvgpr_read_b32 v194, a166
    v_accvgpr_read_b32 v195, a167
    buffer_load_dwordx4 v242, s[4:7], s71 offen lds
    v_mul_f32 v84, v84, v207
    v_fmac_f32 v84, v192, v205
    v_mul_f32 v85, v85, v207
    v_fmac_f32 v85, v193, v205
    v_mul_f32 v86, v86, v207
    v_fmac_f32 v86, v194, v205
    v_mul_f32 v87, v87, v207
    v_fmac_f32 v87, v195, v205
    v_cvt_pk_bf16_f32 v180, v84, v85
    v_cvt_pk_bf16_f32 v181, v86, v87
    s_add_u32 m0, s70, 7168
    s_mov_b32 s71, 50176
    v_accvgpr_read_b32 v192, a176
    v_accvgpr_read_b32 v193, a177
    v_accvgpr_read_b32 v194, a178
    v_accvgpr_read_b32 v195, a179
    buffer_load_dwordx4 v242, s[4:7], s71 offen lds
    v_mul_f32 v88, v88, v206
    v_fmac_f32 v88, v192, v204
    v_mul_f32 v89, v89, v206
    v_fmac_f32 v89, v193, v204
    v_mul_f32 v90, v90, v206
    v_fmac_f32 v90, v194, v204
    v_mul_f32 v91, v91, v206
    v_fmac_f32 v91, v195, v204
    v_cvt_pk_bf16_f32 v150, v88, v89
    v_cvt_pk_bf16_f32 v151, v90, v91
    v_accvgpr_read_b32 v192, a180
    v_accvgpr_read_b32 v193, a181
    v_accvgpr_read_b32 v194, a182
    v_accvgpr_read_b32 v195, a183
    v_mul_f32 v92, v92, v207
    v_fmac_f32 v92, v192, v205
    v_mul_f32 v93, v93, v207
    v_fmac_f32 v93, v193, v205
    v_mul_f32 v94, v94, v207
    v_fmac_f32 v94, v194, v205
    v_mul_f32 v95, v95, v207
    v_fmac_f32 v95, v195, v205
    v_cvt_pk_bf16_f32 v182, v92, v93
    v_cvt_pk_bf16_f32 v183, v94, v95
    s_add_u32 m0, s70, 32768
    s_mov_b32 s71, 128
    v_accvgpr_read_b32 v192, a192
    v_accvgpr_read_b32 v193, a193
    v_accvgpr_read_b32 v194, a194
    v_accvgpr_read_b32 v195, a195
    buffer_load_dwordx4 v242, s[4:7], s71 offen lds
    s_waitcnt lgkmcnt(0)
    v_mul_f32 v96, v96, v206
    v_fmac_f32 v96, v192, v204
    v_mul_f32 v97, v97, v206
    v_fmac_f32 v97, v193, v204
    v_mul_f32 v98, v98, v206
    v_fmac_f32 v98, v194, v204
    v_mul_f32 v99, v99, v206
    v_fmac_f32 v99, v195, v204
    v_cvt_pk_bf16_f32 v152, v96, v97
    v_cvt_pk_bf16_f32 v153, v98, v99
    v_accvgpr_read_b32 v192, a196
    v_accvgpr_read_b32 v193, a197
    v_accvgpr_read_b32 v194, a198
    v_accvgpr_read_b32 v195, a199
    s_waitcnt lgkmcnt(0)
    v_mul_f32 v100, v100, v207
    v_fmac_f32 v100, v192, v205
    v_mul_f32 v101, v101, v207
    v_fmac_f32 v101, v193, v205
    v_mul_f32 v102, v102, v207
    v_fmac_f32 v102, v194, v205
    v_mul_f32 v103, v103, v207
    v_fmac_f32 v103, v195, v205
    v_cvt_pk_bf16_f32 v184, v100, v101
    v_cvt_pk_bf16_f32 v185, v102, v103
    s_add_u32 m0, s70, 33792
    s_mov_b32 s71, 7296
    v_accvgpr_read_b32 v192, a208
    v_accvgpr_read_b32 v193, a209
    v_accvgpr_read_b32 v194, a210
    v_accvgpr_read_b32 v195, a211
    buffer_load_dwordx4 v242, s[4:7], s71 offen lds
    s_waitcnt lgkmcnt(0)
    v_mul_f32 v104, v104, v206
    v_fmac_f32 v104, v192, v204
    v_mul_f32 v105, v105, v206
    v_fmac_f32 v105, v193, v204
    v_mul_f32 v106, v106, v206
    v_fmac_f32 v106, v194, v204
    v_mul_f32 v107, v107, v206
    v_fmac_f32 v107, v195, v204
    v_cvt_pk_bf16_f32 v154, v104, v105
    v_cvt_pk_bf16_f32 v155, v106, v107
    v_accvgpr_read_b32 v192, a212
    v_accvgpr_read_b32 v193, a213
    v_accvgpr_read_b32 v194, a214
    v_accvgpr_read_b32 v195, a215
    s_waitcnt lgkmcnt(0)
    v_mul_f32 v108, v108, v207
    v_fmac_f32 v108, v192, v205
    v_mul_f32 v109, v109, v207
    v_fmac_f32 v109, v193, v205
    v_mul_f32 v110, v110, v207
    v_fmac_f32 v110, v194, v205
    v_mul_f32 v111, v111, v207
    v_fmac_f32 v111, v195, v205
    v_cvt_pk_bf16_f32 v186, v108, v109
    v_cvt_pk_bf16_f32 v187, v110, v111
    s_add_u32 m0, s70, 34816
    s_mov_b32 s71, 14464
    v_accvgpr_read_b32 v192, a224
    v_accvgpr_read_b32 v193, a225
    v_accvgpr_read_b32 v194, a226
    v_accvgpr_read_b32 v195, a227
    buffer_load_dwordx4 v242, s[4:7], s71 offen lds
    s_waitcnt lgkmcnt(0)
    v_mul_f32 v112, v112, v206
    v_fmac_f32 v112, v192, v204
    v_mul_f32 v113, v113, v206
    v_fmac_f32 v113, v193, v204
    v_mul_f32 v114, v114, v206
    v_fmac_f32 v114, v194, v204
    v_mul_f32 v115, v115, v206
    v_fmac_f32 v115, v195, v204
    v_cvt_pk_bf16_f32 v156, v112, v113
    v_cvt_pk_bf16_f32 v157, v114, v115
    v_accvgpr_read_b32 v192, a228
    v_accvgpr_read_b32 v193, a229
    v_accvgpr_read_b32 v194, a230
    v_accvgpr_read_b32 v195, a231
    s_waitcnt lgkmcnt(0)
    v_mul_f32 v116, v116, v207
    v_fmac_f32 v116, v192, v205
    v_mul_f32 v117, v117, v207
    v_fmac_f32 v117, v193, v205
    v_mul_f32 v118, v118, v207
    v_fmac_f32 v118, v194, v205
    v_mul_f32 v119, v119, v207
    v_fmac_f32 v119, v195, v205
    v_cvt_pk_bf16_f32 v188, v116, v117
    v_cvt_pk_bf16_f32 v189, v118, v119
    s_add_u32 m0, s70, 35840
    s_mov_b32 s71, 21632
    v_accvgpr_read_b32 v192, a240
    v_accvgpr_read_b32 v193, a241
    v_accvgpr_read_b32 v194, a242
    v_accvgpr_read_b32 v195, a243
    buffer_load_dwordx4 v242, s[4:7], s71 offen lds
    s_waitcnt lgkmcnt(0)
    v_mul_f32 v120, v120, v206
    v_fmac_f32 v120, v192, v204
    v_mul_f32 v121, v121, v206
    v_fmac_f32 v121, v193, v204
    v_mul_f32 v122, v122, v206
    v_fmac_f32 v122, v194, v204
    v_mul_f32 v123, v123, v206
    v_fmac_f32 v123, v195, v204
    v_cvt_pk_bf16_f32 v158, v120, v121
    v_cvt_pk_bf16_f32 v159, v122, v123
    v_accvgpr_read_b32 v192, a244
    v_accvgpr_read_b32 v193, a245
    v_accvgpr_read_b32 v194, a246
    v_accvgpr_read_b32 v195, a247
    s_waitcnt lgkmcnt(0)
    v_mul_f32 v124, v124, v207
    v_fmac_f32 v124, v192, v205
    v_mul_f32 v125, v125, v207
    v_fmac_f32 v125, v193, v205
    v_mul_f32 v126, v126, v207
    v_fmac_f32 v126, v194, v205
    v_mul_f32 v127, v127, v207
    v_fmac_f32 v127, v195, v205
    v_cvt_pk_bf16_f32 v190, v124, v125
    v_cvt_pk_bf16_f32 v191, v126, v127
    s_branch K2_comb_done
P0_late:
    s_mov_b32 s34, 200000
P0_lp:
    buffer_load_dword v59, v58, s[76:79], 0 offen sc1
    s_waitcnt vmcnt(0)
    v_cmp_ne_u32 vcc, s99, v59
    s_sub_u32 s34, s34, 1
    s_cbranch_scc1 P0_lp_out
    s_cbranch_vccz P0_lp_out
    s_nop 0
    s_sleep 4
    s_branch P0_lp
P0_lp_out:
    s_branch P0_lateok
P0_again:
    s_mov_b32 s34, 200000
P0_ag:
    buffer_load_dwordx2 v[24:25], v20, s[76:79], 0 offen offset:0 sc1
    buffer_load_dwordx2 v[26:27], v20, s[76:79], 0 offen offset:2048 sc1
    buffer_load_dwordx2 v[28:29], v20, s[76:79], s35 offen sc1
    buffer_load_dwordx2 v[30:31], v23, s[76:79], 0 offen sc1
    s_waitcnt vmcnt(0)
    v_xor_b32 v17, s99, v25
    v_xor_b32 v18, s99, v27
    v_or_b32 v17, v17, v18
    v_xor_b32 v18, s99, v29
    v_or_b32 v17, v17, v18
    v_xor_b32 v18, s99, v31
    v_or_b32 v17, v17, v18
    v_cmp_ne_u32 vcc, 0, v17
    s_sub_u32 s34, s34, 1
    s_cbranch_scc1 P0_ag_out
    s_cbranch_vccz P0_ag_out
    s_mov_b64 exec, vcc
    s_sleep 4
    s_branch P0_ag
P0_ag_out:
    s_mov_b64 exec, -1
    s_branch P0_have
.section .rodata,"a"
.p2align 6
.amdhsa_kernel adaLN_cond__mha_block_cached__moe_arch_mod__prompt_kernel
  .amdhsa_next_free_vgpr 512
  .amdhsa_next_free_sgpr 102
  .amdhsa_accum_offset 256
  .amdhsa_group_segment_fixed_size 0
  .amdhsa_kernarg_size 120
  .amdhsa_user_sgpr_count 2
  .amdhsa_user_sgpr_kernarg_segment_ptr 1
  .amdhsa_system_sgpr_workgroup_id_x 1
.end_amdhsa_kernel
```
